```python
import torch

def _softmax(x, axis=-1):
    return torch.softmax(x, dim=axis)
def _gelu(x):
    return torch.nn.functional.gelu(x, approximate="tanh")
def _silu(x):
    return torch.nn.functional.silu(x)
def _sigmoid(x):
    return torch.sigmoid(x)
def _layernorm(x, axis=-1, eps=1e-5):
    m = x.mean(dim=axis, keepdim=True)
    v = x.var(dim=axis, keepdim=True, unbiased=False)
    return (x - m) / torch.sqrt(v + eps)
def _scatter_add(tgt, idx, src, axis=0):
    return tgt.clone().index_add_(axis, idx, src)
def _segment_sum(src, seg, n):
    out = torch.zeros((n,) + src.shape[1:], dtype=src.dtype)
    return out.index_add_(0, seg, src)
def _pad(x, pw):
    flat = tuple(v for pair in reversed(pw) for v in pair)
    return torch.nn.functional.pad(x, flat)

kernel_name = 'recurrent_scan__sliding_block__mixer_s_mlp__prompt'

def setup_inputs():

    _w = (lambda a: (lambda t: t.to(torch.bfloat16) if t.is_floating_point() else t)(torch.as_tensor(a)))
    def _A_setup():
        B, S, D = 1, 2048, 640
        return {
            "x": _w((lambda *s: torch.randn(*s, dtype=torch.bfloat16) * 0.05)(B, S, D)),
            "wqkv": _w((lambda *s: torch.randn(*s, dtype=torch.bfloat16) * 0.05)(D, 3 * D)),
            "wo": _w((lambda *s: torch.randn(*s, dtype=torch.bfloat16) * 0.05)(D, D)),
        }
    _A_in = _A_setup()

    def _B_setup():
        B, S, D, F = 1, 2048, 640, 1728
        return {
            "x":  _w((lambda *s: torch.randn(*s, dtype=torch.bfloat16) * 0.05)(B, S, D)),
            "w1": _w((lambda *s: torch.randn(*s, dtype=torch.bfloat16) * 0.8)(D, D) * (D ** -0.5)),
            "w2": _w((lambda *s: torch.randn(*s, dtype=torch.bfloat16) * 0.8)(D, D) * (D ** -0.5)),
            "w3": _w((lambda *s: torch.randn(*s, dtype=torch.bfloat16) * 0.8)(D, F) * (D ** -0.5)),
            "w4": _w((lambda *s: torch.randn(*s, dtype=torch.bfloat16) * 0.8)(F, D) * (F ** -0.5)),
        }
    _B_in = _B_setup()

    return {
        "A_x": _A_in["x"],
        "A_wqkv": _A_in["wqkv"],
        "A_wo": _A_in["wo"],
        "B_x": _B_in["x"],
        "B_w1": _B_in["w1"],
        "B_w2": _B_in["w2"],
        "B_w3": _B_in["w3"],
        "B_w4": _B_in["w4"],
    }

def reference(A_x, A_wqkv, A_wo, B_x, B_w1, B_w2, B_w3, B_w4):
    def _A_ref(x, wqkv, wo):
        B, S, D = x.shape
        H = 32; Dh = D // H; W = 256
        qkv = (lambda x, *d: x.permute(*d))((x @ wqkv).reshape(B, S, 3, H, Dh), 2, 0, 3, 1, 4)
        q, k, v = qkv[0], qkv[1], qkv[2]
        scores = torch.einsum("bhqd,bhkd->bhqk", q, k) * (Dh ** -0.5)
        idx = torch.arange(S)
        mask = (idx[:, None] - idx[None, :] >= 0) & (idx[:, None] - idx[None, :] < W)
        scores = torch.where(mask[None, None], scores, -1e9)
        p = _softmax(scores, axis=-1)
        o = torch.einsum("bhqk,bhkd->bhqd", p, v)
        return (lambda x, *d: x.permute(*d))(o, 0, 2, 1, 3).reshape(B, S, D) @ wo

    def _B_ref(x, w1, w2, w3, w4):
        B, S, D = x.shape
        h = _gelu(_layernorm(x, axis=-1) @ w1)
        c = D // 4
        g0 = _pad(h[:, :, 0*c:1*c], ((0, 0), (1, 0), (0, 0)))[:, :S, :]
        g1 = _pad(h[:, :, 1*c:2*c], ((0, 0), (0, 1), (0, 0)))[:, 1:, :]
        g2 = _pad(h[:, :, 2*c:3*c], ((0, 0), (2, 0), (0, 0)))[:, :S, :]
        g3 = _pad(h[:, :, 3*c:   ], ((0, 0), (0, 2), (0, 0)))[:, 2:, :]
        hs = torch.concatenate([g0, g1, g2, g3], axis=-1) @ w2
        x1 = x + hs
        h2 = _gelu(_layernorm(x1, axis=-1) @ w3) @ w4
        return x1 + h2

    x = A_x
    xn = _layernorm(x, axis=-1)
    s = _A_ref(xn, A_wqkv, A_wo)
    g = _silu(_B_ref(xn, B_w1, B_w2, B_w3, B_w4))
    return x + s * g
```

```asm
; @launch grid=(256,1,1) block=(256,1,1) lds=163840
.amdgcn_target "amdgcn-amd-amdhsa--gfx950"
.text
.globl recurrent_scan__sliding_block__mixer_s_mlp__prompt_kernel
.p2align 8
.type recurrent_scan__sliding_block__mixer_s_mlp__prompt_kernel,@function
recurrent_scan__sliding_block__mixer_s_mlp__prompt_kernel:
s_cmp_lt_u32 s2, 256
s_cbranch_scc1 L_go
s_endpgm
L_go:
s_load_dwordx16 s[64:79], s[0:1], 0
s_load_dwordx4 s[80:83], s[0:1], 64
s_load_dwordx2 s[84:85], s[0:1], 80
v_lshrrev_b32 v1, 6, v0
v_and_b32 v3, 63, v0
v_readfirstlane_b32 s40, v1
s_lshr_b32 s43, s2, 3
s_getpc_b64 s[86:87]
L_pc1:
s_lshl_b32 s3, s43, 2
s_add_u32 s3, s3, s40
s_mul_i32 s3, s3, 8
s_and_b32 s3, s3, 1023
v_min_u32 v44, 7, v3
v_add_lshl_u32 v44, v44, s3, 7
v_min_u32 v44, L_codeend-L_pc1-4, v44
v_and_b32 v44, -4, v44
global_load_dword a223, v44, s[86:87]
s_and_b32 s42, s2, 7
s_lshl_b32 s41, s40, 12
s_bfe_u32 s60, s43, 0x20002
s_lshr_b32 s3, s42, 2
s_lshl_b32 s3, s3, 1
s_lshr_b32 s62, s43, 4
s_add_u32 s62, s62, s3
s_and_b32 s3, s42, 3
s_lshl_b32 s3, s3, 2
s_and_b32 s6, s43, 3
s_add_u32 s3, s3, s6
s_lshl_b32 s3, s3, 2
s_add_u32 s44, s3, s40
s_lshr_b32 s4, s43, 2
s_add_u32 s63, s6, s4
s_mov_b32 s5, s62
s_lshr_b32 s3, s60, 1
s_add_u32 s3, s3, 1
s_sub_u32 s4, 0, s3
s_bitcmp1_b32 s60, 0
s_cselect_b32 s3, s3, s4
s_cmp_eq_u32 s5, 0
s_cselect_b32 s3, s3, 0
s_lshl_b32 s4, s44, 5
s_add_u32 s7, s4, s3
s_mul_i32 s4, s63, 52
s_lshr_b32 s4, s4, 8
s_mul_i32 s4, s4, 5
s_sub_u32 s63, s63, s4
s_lshl_b32 s63, s63, 1
s_mov_b32 s10, 2621440
s_mov_b32 s11, 0x20000
v_lshrrev_b32 v36, 4, v3
v_xor_b32 v36, v36, v3
v_and_b32 v36, 7, v36
v_lshlrev_b32 v36, 4, v36
v_lshrrev_b32 v64, 3, v3
v_add_u32 v64, s7, v64
v_mul_i32_i24 v64, 1280, v64
v_or_b32 v64, v64, v36
v_xor_b32 v65, 64, v64
v_add_u32 v65, 9216, v65
v_add_u32 v66, 18432, v64
v_add_u32 v67, 18432, v65
s_waitcnt lgkmcnt(0)
s_mov_b32 s8, s64
s_mov_b32 s9, s65
s_add_u32 m0, s41, 0
s_add_u32 s6, s63, 0
s_sub_u32 s96, s6, 10
s_cselect_b32 s6, s6, s96
s_lshl_b32 s6, s6, 7
buffer_load_dwordx4 v64, s[8:11], s6 offen lds
buffer_load_dwordx4 v65, s[8:11], s6 offen offset:1024 lds
buffer_load_dwordx4 v66, s[8:11], s6 offen offset:2048 lds
buffer_load_dwordx4 v67, s[8:11], s6 offen offset:3072 lds
s_add_u32 m0, s41, 16384
s_add_u32 s6, s63, 1
s_sub_u32 s96, s6, 10
s_cselect_b32 s6, s6, s96
s_lshl_b32 s6, s6, 7
buffer_load_dwordx4 v64, s[8:11], s6 offen lds
buffer_load_dwordx4 v65, s[8:11], s6 offen offset:1024 lds
buffer_load_dwordx4 v66, s[8:11], s6 offen offset:2048 lds
buffer_load_dwordx4 v67, s[8:11], s6 offen offset:3072 lds
s_add_u32 m0, s41, 32768
s_add_u32 s6, s63, 2
s_sub_u32 s96, s6, 10
s_cselect_b32 s6, s6, s96
s_lshl_b32 s6, s6, 7
buffer_load_dwordx4 v64, s[8:11], s6 offen lds
buffer_load_dwordx4 v65, s[8:11], s6 offen offset:1024 lds
buffer_load_dwordx4 v66, s[8:11], s6 offen offset:2048 lds
buffer_load_dwordx4 v67, s[8:11], s6 offen offset:3072 lds
v_lshlrev_b32 v0, 4, v3
v_cmp_eq_u32 vcc, 0, v3
v_mov_b32 v13, 1073741824
v_mov_b32 v14, 1
v_cndmask_b32 v13, v13, 0, vcc
s_mov_b32 s32, s84
s_mov_b32 s33, s85
s_mov_b32 s34, 26345472
s_mov_b32 s35, 0x20000
s_sub_u32 s4, s43, 16
s_cmp_eq_u32 s42, 0
s_cselect_b32 s4, s4, 99
s_lshl_b32 s3, s4, 2
s_add_u32 s3, s3, s40
s_lshl_b32 s3, s3, 11
s_cmp_lt_u32 s4, 13
s_cselect_b32 s2, s40, 1
s_cselect_b32 s3, s3, 1073741824
v_mov_b32 v56, 0
v_mov_b32 v57, 0
v_mov_b32 v58, 0
v_mov_b32 v59, 0
s_mov_b32 s51, s3
s_cmp_eq_u32 s5, 0
s_cselect_b32 s12, s72, s66
s_cselect_b32 s13, s73, s67
s_mov_b32 s14, 2457600
s_cselect_b32 s14, 819200, s14
s_movk_i32 s45, 3840
s_cselect_b32 s45, 1280, s45
s_cmp_eq_u32 s5, 0
s_cselect_b32 s20, s68, s76
s_cselect_b32 s21, s69, s77
s_mov_b32 s22, 2211840
s_cselect_b32 s22, 819200, s22
s_movk_i32 s57, 3456
s_cselect_b32 s57, 1280, s57
s_mov_b32 s15, 0x20000
s_mov_b32 s23, 0x20000
s_mov_b32 s16, s74
s_mov_b32 s17, s75
s_mov_b32 s18, 819200
s_mov_b32 s19, 0x20000
s_mov_b32 s24, s78
s_mov_b32 s25, s79
s_mov_b32 s26, 2211840
s_mov_b32 s27, 0x20000
s_mov_b32 s28, s80
s_mov_b32 s29, s81
s_mov_b32 s30, 2621440
s_mov_b32 s31, 0x20000
s_mov_b32 s36, s82
s_mov_b32 s37, s83
s_mov_b32 s38, 256
s_mov_b32 s39, 0x20000
s_sub_u32 s3, s5, 1
s_max_i32 s3, s3, 0
s_lshl_b32 s3, s3, 2
s_add_u32 s3, s3, s60
s_mul_i32 s4, s3, 320
s_and_b32 s6, s60, 1
s_lshl_b32 s7, s6, 6
s_add_u32 s46, s4, s7
s_xor_b32 s7, s6, 1
s_lshl_b32 s7, s7, 8
s_add_u32 s48, s4, s7
s_and_b32 s6, s60, 1
s_mul_i32 s4, s5, 2621440
s_add_u32 s4, s4, 655360
s_mul_i32 s7, s44, 40960
s_add_u32 s4, s4, s7
s_cmp_eq_u32 s5, 3
s_movk_i32 s7, 2048
s_cselect_b32 s7, 512, s7
s_mul_i32 s49, s60, 5
s_add_u32 s50, s49, 4
s_add_u32 s49, s49, s6
s_lshl_b32 s6, s6, 2
s_sub_u32 s50, s50, s6
s_mul_i32 s49, s49, s7
s_mul_i32 s50, s50, s7
s_add_u32 s49, s49, s4
s_add_u32 s50, s50, s4
s_sub_u32 s4, s5, 1
s_lshl_b32 s4, s4, 2
s_add_u32 s4, s4, s60
s_lshl_b32 s6, s4, 4
s_lshr_b32 s7, s44, 2
s_add_u32 s6, s6, s7
s_lshl_b32 s6, s6, 7
s_add_u32 s6, s6, 65536
s_lshl_b32 s7, s44, 9
s_add_u32 s47, s7, 256
s_cmp_eq_u32 s5, 0
s_cselect_b32 s47, s47, s6
s_xor_b32 s5, s62, 0
s_mul_i32 s4, s60, 320
s_and_b32 s6, s60, 1
s_lshl_b32 s7, s6, 6
s_add_u32 s58, s4, s7
s_xor_b32 s7, s6, 1
s_lshl_b32 s7, s7, 8
s_add_u32 s59, s4, s7
s_sub_u32 s3, s5, 1
s_mul_i32 s3, s3, 1152
s_lshl_b32 s4, s60, 8
s_add_u32 s4, s4, s3
s_mul_i32 s6, s60, 1152
s_add_u32 s6, s6, 1024
s_cmp_eq_u32 s5, 0
s_cselect_b32 s58, s58, s4
s_cselect_b32 s59, s59, s6
s_add_u32 s3, s43, 23
s_cmp_lt_u32 s43, 25
s_cselect_b32 s3, 99, s3
s_add_u32 s4, s43, 32
s_cmp_lt_u32 s43, 16
s_cselect_b32 s3, s4, s3
s_bitcmp1_b32 s42, 2
s_cselect_b32 s3, s43, s3
s_and_b32 s4, s42, 3
s_mul_i32 s4, s4, 55
s_add_u32 s7, s4, s3
s_mul_i32 s4, s7, 205
s_lshr_b32 s4, s4, 11
s_mul_i32 s6, s4, 10
s_sub_u32 s6, s7, s6
s_lshl_b32 s55, s6, 7
s_cmp_lt_u32 s3, 55
s_cselect_b32 s56, 0, 1073741824
s_cselect_b32 s6, s40, 3
s_mul_i32 s54, s4, 3
v_mov_b32 v44, s54
v_accvgpr_write_b32 a219, v44
s_add_u32 s54, s54, s40
s_cmp_lt_u32 s6, 3
s_cselect_b32 s54, s54, 64
s_cmp_lt_u32 s54, 64
s_cselect_b32 s61, 1, 0
s_min_u32 s54, s54, 64
s_and_b32 s3, s42, 3
s_lshl_b32 s3, s3, 3
s_and_b32 s4, s43, 3
s_add_u32 s3, s3, s4
s_cmp_lt_u32 s43, 16
s_cselect_b32 s4, 4, 0
s_add_u32 s43, s3, s4
s_and_b32 s42, s42, 4
s_add_u32 s42, s42, s60
v_and_b32 v40, 31, v3
v_lshlrev_b32 v41, 7, v40
v_add_u32 v41, s41, v41
v_bfe_u32 v40, v3, 1, 3
v_lshrrev_b32 v42, 5, v3
v_xor_b32 v40, v40, v42
v_xor_b32 v68, 0, v40
v_lshl_add_u32 v68, v68, 4, v41
v_xor_b32 v69, 2, v40
v_lshl_add_u32 v69, v69, 4, v41
v_xor_b32 v70, 4, v40
v_lshl_add_u32 v70, v70, 4, v41
v_xor_b32 v71, 6, v40
v_lshl_add_u32 v71, v71, 4, v41
v_mov_b32 v72, 0
v_mov_b32 v73, 0
v_mov_b32 v74, 0
v_mov_b32 v75, 0
s_lshl_b32 s7, s54, 5
v_lshrrev_b32 v44, 4, v3
v_xor_b32 v44, v44, v3
v_and_b32 v44, 7, v44
v_lshlrev_b32 v44, 4, v44
v_lshrrev_b32 v50, 3, v3
v_add_u32 v50, s7, v50
v_mul_i32_i24 v50, 1280, v50
v_or_b32 v50, v50, v44
v_xor_b32 v51, 64, v50
v_add_u32 v51, 9216, v51
v_add_u32 v52, 18432, v50
v_add_u32 v53, 18432, v51
v_accvgpr_write_b32 a204, v50
v_accvgpr_write_b32 a205, v51
v_accvgpr_write_b32 a206, v52
v_accvgpr_write_b32 a207, v53
s_lshl_b32 s0, s43, 1
s_sub_u32 s0, s0, 8
v_and_b32 v44, 15, v3
v_lshrrev_b32 v45, 4, v3
v_cmp_eq_u32 vcc, 2, v45
v_mov_b32 v48, 10
s_nop 0
v_cndmask_b32 v48, v48, 2, vcc
v_cndmask_b32 v49, 0, 8, vcc
v_cmp_lt_u32 s[4:5], v44, v48
v_add3_u32 v44, v44, v49, s0
v_max_i32 v44, 0, v44
v_lshrrev_b32 v44, 2, v44
v_lshlrev_b32 v44, 7, v44
v_add_u32 v48, 1, v45
v_cndmask_b32 v48, v48, 0, vcc
v_lshlrev_b32 v48, 13, v48
s_lshr_b32 s3, s42, 1
s_lshl_b32 s3, s3, 11
s_add_u32 s3, s3, 65536
v_add3_u32 v48, v48, v44, s3
v_cmp_gt_u32 vcc, 3, v45
s_nop 1
s_and_b64 vcc, vcc, s[4:5]
v_mov_b32 v44, 1073741824
v_cndmask_b32 v49, 0, 4, vcc
v_cndmask_b32 v48, v44, v48, vcc
v_accvgpr_write_b32 a221, v48
v_accvgpr_write_b32 a222, v49
s_mov_b32 s64, 0xffffffff
s_mov_b32 s65, 0xfffffff0
s_mov_b32 s66, 0xfffffffe
s_mov_b32 s67, 0xffffffe0
s_mov_b32 s68, 0xfffffffc
s_mov_b32 s69, 0xffffffc0
s_mov_b32 s70, 0xfffffff8
s_mov_b32 s71, 0xffffff80
s_mov_b32 s72, 0xffffff00
s_mov_b32 s73, 0xfffff000
s_mov_b32 s74, 0xfffffe00
s_mov_b32 s75, 0xffffe000
s_mov_b32 s76, 0xfffffc00
s_mov_b32 s77, 0xffffc000
s_mov_b32 s78, 0xfffff800
s_mov_b32 s79, 0xffff8000
s_mov_b32 s80, 0xffff0000
s_mov_b32 s81, 0xfff00000
s_mov_b32 s82, 0xfffe0000
s_mov_b32 s83, 0xffe00000
s_mov_b32 s84, 0xfffc0000
s_mov_b32 s85, 0xffc00000
s_mov_b32 s86, 0xfff80000
s_mov_b32 s87, 0xff800000
s_mov_b32 s88, 0xff000000
s_mov_b32 s89, 0xf0000000
s_mov_b32 s90, 0xfe000000
s_mov_b32 s91, 0xe0000000
s_mov_b32 s92, 0xfc000000
s_mov_b32 s93, 0xc0000000
s_mov_b32 s94, 0xf8000000
s_mov_b32 s95, 0x80000000
v_mov_b32 v44, 0xffff
v_mov_b32 v45, 0xffff0000
v_cndmask_b32 v46, 0, v44, s[64:65]
v_cndmask_b32 v47, 0, v45, s[66:67]
v_or_b32 v46, v46, v47
v_accvgpr_write_b32 a208, v46
v_cndmask_b32 v46, 0, v44, s[68:69]
v_cndmask_b32 v47, 0, v45, s[70:71]
v_or_b32 v46, v46, v47
v_accvgpr_write_b32 a209, v46
v_cndmask_b32 v46, 0, v44, s[72:73]
v_cndmask_b32 v47, 0, v45, s[74:75]
v_or_b32 v46, v46, v47
v_accvgpr_write_b32 a210, v46
v_cndmask_b32 v46, 0, v44, s[76:77]
v_cndmask_b32 v47, 0, v45, s[78:79]
v_or_b32 v46, v46, v47
v_accvgpr_write_b32 a211, v46
v_cndmask_b32 v46, 0, v44, s[80:81]
v_cndmask_b32 v47, 0, v45, s[82:83]
v_or_b32 v46, v46, v47
v_accvgpr_write_b32 a212, v46
v_cndmask_b32 v46, 0, v44, s[84:85]
v_cndmask_b32 v47, 0, v45, s[86:87]
v_or_b32 v46, v46, v47
s_add_u32 m0, s41, 49152
s_add_u32 s6, s63, 3
s_sub_u32 s96, s6, 10
s_cselect_b32 s6, s6, s96
s_lshl_b32 s6, s6, 7
buffer_load_dwordx4 v64, s[8:11], s6 offen lds
buffer_load_dwordx4 v65, s[8:11], s6 offen offset:1024 lds
buffer_load_dwordx4 v66, s[8:11], s6 offen offset:2048 lds
buffer_load_dwordx4 v67, s[8:11], s6 offen offset:3072 lds
v_accvgpr_write_b32 a213, v46
v_cndmask_b32 v46, 0, v44, s[88:89]
v_cndmask_b32 v47, 0, v45, s[90:91]
v_or_b32 v46, v46, v47
v_accvgpr_write_b32 a214, v46
v_cndmask_b32 v46, 0, v44, s[92:93]
v_cndmask_b32 v47, 0, v45, s[94:95]
v_or_b32 v46, v46, v47
v_accvgpr_write_b32 a215, v46
s_mul_i32 s3, s40, 5
v_lshrrev_b32 v44, 5, v3
v_and_b32 v46, 31, v3
v_lshlrev_b32 v46, 4, v46
v_add_u32 v46, 147456, v46
v_add3_u32 v45, v44, s3, 0
v_lshrrev_b32 v48, 2, v45
v_lshl_add_u32 v48, v48, 10, v46
v_and_b32 v47, 1, v45
v_lshl_add_u32 v48, v47, 9, v48
v_bfe_u32 v47, v45, 1, 1
v_lshl_add_u32 v48, v47, 3, v48
v_accvgpr_write_b32 a216, v48
v_add3_u32 v45, v44, s3, 2
v_lshrrev_b32 v48, 2, v45
v_lshl_add_u32 v48, v48, 10, v46
v_and_b32 v47, 1, v45
v_lshl_add_u32 v48, v47, 9, v48
v_bfe_u32 v47, v45, 1, 1
v_lshl_add_u32 v48, v47, 3, v48
v_accvgpr_write_b32 a217, v48
s_add_u32 s3, s3, 4
v_mov_b32 v45, s3
v_lshrrev_b32 v48, 2, v45
v_lshl_add_u32 v48, v48, 10, v46
v_and_b32 v47, 1, v45
v_lshl_add_u32 v48, v47, 9, v48
v_bfe_u32 v47, v45, 1, 1
v_lshl_add_u32 v48, v47, 3, v48
v_cmp_gt_u32 vcc, 32, v3
v_lshlrev_b32 v45, 3, v3
v_add_u32 v45, 157696, v45
v_cndmask_b32 v48, v45, v48, vcc
s_add_u32 m0, s41, 65536
s_add_u32 s6, s63, 4
s_sub_u32 s96, s6, 10
s_cselect_b32 s6, s6, s96
s_lshl_b32 s6, s6, 7
buffer_load_dwordx4 v64, s[8:11], s6 offen lds
buffer_load_dwordx4 v65, s[8:11], s6 offen offset:1024 lds
buffer_load_dwordx4 v66, s[8:11], s6 offen offset:2048 lds
buffer_load_dwordx4 v67, s[8:11], s6 offen offset:3072 lds
v_accvgpr_write_b32 a218, v48
v_lshrrev_b32 v44, 1, v3
v_xor_b32 v44, v44, v3
v_and_b32 v44, 8, v44
v_cmp_eq_u32 vcc, 0, v44
v_mov_b32 v48, 0x3f803f80
s_nop 0
v_cndmask_b32 v45, 0, v48, vcc
v_accvgpr_write_b32 a192, v45
v_accvgpr_write_b32 a193, v45
v_accvgpr_write_b32 a194, v45
v_accvgpr_write_b32 a195, v45
v_accvgpr_write_b32 a198, 0
v_accvgpr_write_b32 a199, 0
v_and_b32 v44, 31, v3
v_lshrrev_b32 v45, 5, v3
v_lshlrev_b32 v45, 2, v45
v_sub_u32 v44, v44, v45
v_mov_b32 v46, 0x3f80
v_mov_b32 v47, 0x3f800000
v_cmp_eq_u32 vcc, 0, v44
s_nop 1
v_cndmask_b32 v45, 0, v46, vcc
v_cmp_eq_u32 vcc, 1, v44
s_nop 1
v_cndmask_b32 v45, v45, v47, vcc
v_accvgpr_write_b32 a16, v45
v_cmp_eq_u32 vcc, 2, v44
s_nop 1
v_cndmask_b32 v45, 0, v46, vcc
v_cmp_eq_u32 vcc, 3, v44
s_nop 1
v_cndmask_b32 v45, v45, v47, vcc
v_accvgpr_write_b32 a17, v45
v_cmp_eq_u32 vcc, 8, v44
s_nop 1
v_cndmask_b32 v45, 0, v46, vcc
v_cmp_eq_u32 vcc, 9, v44
s_nop 1
v_cndmask_b32 v45, v45, v47, vcc
v_accvgpr_write_b32 a18, v45
v_cmp_eq_u32 vcc, 10, v44
s_nop 1
v_cndmask_b32 v45, 0, v46, vcc
v_cmp_eq_u32 vcc, 11, v44
s_nop 1
v_cndmask_b32 v45, v45, v47, vcc
v_accvgpr_write_b32 a19, v45
v_cmp_eq_u32 vcc, 16, v44
s_nop 1
v_cndmask_b32 v45, 0, v46, vcc
v_cmp_eq_u32 vcc, 17, v44
s_nop 1
v_cndmask_b32 v45, v45, v47, vcc
v_accvgpr_write_b32 a20, v45
v_cmp_eq_u32 vcc, 18, v44
s_nop 1
v_cndmask_b32 v45, 0, v46, vcc
v_cmp_eq_u32 vcc, 19, v44
s_nop 1
v_cndmask_b32 v45, v45, v47, vcc
v_accvgpr_write_b32 a21, v45
v_cmp_eq_u32 vcc, 24, v44
s_nop 1
v_cndmask_b32 v45, 0, v46, vcc
v_cmp_eq_u32 vcc, 25, v44
s_nop 1
v_cndmask_b32 v45, v45, v47, vcc
v_accvgpr_write_b32 a22, v45
v_cmp_eq_u32 vcc, 26, v44
s_nop 1
v_cndmask_b32 v45, 0, v46, vcc
v_cmp_eq_u32 vcc, 27, v44
s_nop 1
v_cndmask_b32 v45, v45, v47, vcc
v_accvgpr_write_b32 a23, v45
v_accvgpr_write_b32 a200, v48
v_accvgpr_write_b32 a201, v48
v_accvgpr_write_b32 a202, v48
v_accvgpr_write_b32 a203, v48
v_cmp_gt_u32 vcc, 32, v3
v_mov_b32 v50, 0x3afe3f80
v_mov_b32 v51, 0
v_cndmask_b32 v50, 0, v50, vcc
v_mov_b32 v52, 0
v_mov_b32 v53, 0
s_nop 1
v_mfma_f32_32x32x16_bf16 a[80:95], a[200:203], v[50:53], 0
v_mfma_f32_32x32x16_bf16 a[96:111], a[200:203], v[50:53], 0
v_mfma_f32_32x32x16_bf16 a[112:127], a[200:203], v[50:53], 0
v_mfma_f32_32x32x16_bf16 a[128:143], a[200:203], v[50:53], 0
v_mfma_f32_32x32x16_bf16 a[144:159], a[200:203], v[50:53], 0
s_lshl_b32 s79, s44, 9
s_mul_i32 s5, s62, s60
s_cmp_lt_u32 s62, 2
s_cselect_b32 s5, s5, 1
s_cmp_eq_u32 s5, 0
s_cselect_b32 s79, s79, 1073741824
s_cmp_eq_u32 s2, 0
s_cselect_b32 s2, 0, 1073741824
s_waitcnt vmcnt(16)
ds_read_b128 v[96:99], v68 offset:0
ds_read_b128 v[100:103], v69 offset:0
ds_read_b128 v[104:107], v70 offset:0
ds_read_b128 v[108:111], v71 offset:0
s_add_u32 m0, s41, 81920
s_add_u32 s6, s63, 5
s_sub_u32 s96, s6, 10
s_cselect_b32 s6, s6, s96
s_lshl_b32 s6, s6, 7
buffer_load_dwordx4 v64, s[8:11], s6 offen lds
buffer_load_dwordx4 v65, s[8:11], s6 offen offset:1024 lds
buffer_load_dwordx4 v66, s[8:11], s6 offen offset:2048 lds
buffer_load_dwordx4 v67, s[8:11], s6 offen offset:3072 lds
s_waitcnt vmcnt(16)
ds_read_b128 v[112:115], v68 offset:16384
ds_read_b128 v[116:119], v69 offset:16384
ds_read_b128 v[120:123], v70 offset:16384
ds_read_b128 v[124:127], v71 offset:16384
buffer_store_dwordx4 v[56:59], v0, s[32:35], s51 offen sc1
buffer_store_dwordx4 v[56:59], v0, s[32:35], s51 offen offset:1024 sc1
s_waitcnt lgkmcnt(7)
v_dot2c_f32_bf16 v72, 0x3f803f80, v96
v_dot2c_f32_bf16 v74, v96, v96
v_dot2c_f32_bf16 v73, 0x3f803f80, v97
v_dot2c_f32_bf16 v75, v97, v97
v_dot2c_f32_bf16 v72, 0x3f803f80, v98
v_dot2c_f32_bf16 v74, v98, v98
v_dot2c_f32_bf16 v73, 0x3f803f80, v99
v_dot2c_f32_bf16 v75, v99, v99
s_waitcnt lgkmcnt(6)
v_dot2c_f32_bf16 v72, 0x3f803f80, v100
v_dot2c_f32_bf16 v74, v100, v100
v_dot2c_f32_bf16 v73, 0x3f803f80, v101
v_dot2c_f32_bf16 v75, v101, v101
v_dot2c_f32_bf16 v72, 0x3f803f80, v102
v_dot2c_f32_bf16 v74, v102, v102
v_dot2c_f32_bf16 v73, 0x3f803f80, v103
v_dot2c_f32_bf16 v75, v103, v103
s_waitcnt lgkmcnt(5)
v_dot2c_f32_bf16 v72, 0x3f803f80, v104
v_dot2c_f32_bf16 v74, v104, v104
v_dot2c_f32_bf16 v73, 0x3f803f80, v105
v_dot2c_f32_bf16 v75, v105, v105
v_dot2c_f32_bf16 v72, 0x3f803f80, v106
v_dot2c_f32_bf16 v74, v106, v106
v_dot2c_f32_bf16 v73, 0x3f803f80, v107
v_dot2c_f32_bf16 v75, v107, v107
s_waitcnt lgkmcnt(4)
v_dot2c_f32_bf16 v72, 0x3f803f80, v108
v_dot2c_f32_bf16 v74, v108, v108
v_dot2c_f32_bf16 v73, 0x3f803f80, v109
v_dot2c_f32_bf16 v75, v109, v109
v_dot2c_f32_bf16 v72, 0x3f803f80, v110
v_dot2c_f32_bf16 v74, v110, v110
v_dot2c_f32_bf16 v73, 0x3f803f80, v111
v_dot2c_f32_bf16 v75, v111, v111
s_add_u32 m0, s41, 98304
s_add_u32 s6, s63, 6
s_sub_u32 s96, s6, 10
s_cselect_b32 s6, s6, s96
s_lshl_b32 s6, s6, 7
buffer_load_dwordx4 v64, s[8:11], s6 offen lds
buffer_load_dwordx4 v65, s[8:11], s6 offen offset:1024 lds
buffer_load_dwordx4 v66, s[8:11], s6 offen offset:2048 lds
buffer_load_dwordx4 v67, s[8:11], s6 offen offset:3072 lds
s_waitcnt vmcnt(18)
ds_read_b128 v[128:131], v68 offset:32768
ds_read_b128 v[132:135], v69 offset:32768
ds_read_b128 v[136:139], v70 offset:32768
ds_read_b128 v[140:143], v71 offset:32768
s_waitcnt lgkmcnt(7)
v_dot2c_f32_bf16 v72, 0x3f803f80, v112
v_dot2c_f32_bf16 v74, v112, v112
v_dot2c_f32_bf16 v73, 0x3f803f80, v113
v_dot2c_f32_bf16 v75, v113, v113
v_dot2c_f32_bf16 v72, 0x3f803f80, v114
v_dot2c_f32_bf16 v74, v114, v114
v_dot2c_f32_bf16 v73, 0x3f803f80, v115
v_dot2c_f32_bf16 v75, v115, v115
s_waitcnt lgkmcnt(6)
v_dot2c_f32_bf16 v72, 0x3f803f80, v116
v_dot2c_f32_bf16 v74, v116, v116
v_dot2c_f32_bf16 v73, 0x3f803f80, v117
v_dot2c_f32_bf16 v75, v117, v117
v_dot2c_f32_bf16 v72, 0x3f803f80, v118
v_dot2c_f32_bf16 v74, v118, v118
v_dot2c_f32_bf16 v73, 0x3f803f80, v119
v_dot2c_f32_bf16 v75, v119, v119
s_waitcnt lgkmcnt(5)
v_dot2c_f32_bf16 v72, 0x3f803f80, v120
v_dot2c_f32_bf16 v74, v120, v120
v_dot2c_f32_bf16 v73, 0x3f803f80, v121
v_dot2c_f32_bf16 v75, v121, v121
v_dot2c_f32_bf16 v72, 0x3f803f80, v122
v_dot2c_f32_bf16 v74, v122, v122
v_dot2c_f32_bf16 v73, 0x3f803f80, v123
v_dot2c_f32_bf16 v75, v123, v123
s_waitcnt lgkmcnt(4)
v_dot2c_f32_bf16 v72, 0x3f803f80, v124
v_dot2c_f32_bf16 v74, v124, v124
v_dot2c_f32_bf16 v73, 0x3f803f80, v125
v_dot2c_f32_bf16 v75, v125, v125
v_dot2c_f32_bf16 v72, 0x3f803f80, v126
v_dot2c_f32_bf16 v74, v126, v126
v_dot2c_f32_bf16 v73, 0x3f803f80, v127
v_dot2c_f32_bf16 v75, v127, v127
s_add_u32 m0, s41, 114688
s_add_u32 s6, s63, 7
s_sub_u32 s96, s6, 10
s_cselect_b32 s6, s6, s96
s_lshl_b32 s6, s6, 7
buffer_load_dwordx4 v64, s[8:11], s6 offen lds
buffer_load_dwordx4 v65, s[8:11], s6 offen offset:1024 lds
buffer_load_dwordx4 v66, s[8:11], s6 offen offset:2048 lds
buffer_load_dwordx4 v67, s[8:11], s6 offen offset:3072 lds
s_waitcnt vmcnt(18)
ds_read_b128 v[144:147], v68 offset:49152
ds_read_b128 v[148:151], v69 offset:49152
ds_read_b128 v[152:155], v70 offset:49152
ds_read_b128 v[156:159], v71 offset:49152
s_waitcnt lgkmcnt(7)
v_dot2c_f32_bf16 v72, 0x3f803f80, v128
v_dot2c_f32_bf16 v74, v128, v128
v_dot2c_f32_bf16 v73, 0x3f803f80, v129
v_dot2c_f32_bf16 v75, v129, v129
v_dot2c_f32_bf16 v72, 0x3f803f80, v130
v_dot2c_f32_bf16 v74, v130, v130
v_dot2c_f32_bf16 v73, 0x3f803f80, v131
v_dot2c_f32_bf16 v75, v131, v131
s_waitcnt lgkmcnt(6)
v_dot2c_f32_bf16 v72, 0x3f803f80, v132
v_dot2c_f32_bf16 v74, v132, v132
v_dot2c_f32_bf16 v73, 0x3f803f80, v133
v_dot2c_f32_bf16 v75, v133, v133
v_dot2c_f32_bf16 v72, 0x3f803f80, v134
v_dot2c_f32_bf16 v74, v134, v134
v_dot2c_f32_bf16 v73, 0x3f803f80, v135
v_dot2c_f32_bf16 v75, v135, v135
s_waitcnt lgkmcnt(5)
v_dot2c_f32_bf16 v72, 0x3f803f80, v136
v_dot2c_f32_bf16 v74, v136, v136
v_dot2c_f32_bf16 v73, 0x3f803f80, v137
v_dot2c_f32_bf16 v75, v137, v137
v_dot2c_f32_bf16 v72, 0x3f803f80, v138
v_dot2c_f32_bf16 v74, v138, v138
v_dot2c_f32_bf16 v73, 0x3f803f80, v139
v_dot2c_f32_bf16 v75, v139, v139
s_waitcnt lgkmcnt(4)
v_dot2c_f32_bf16 v72, 0x3f803f80, v140
v_dot2c_f32_bf16 v74, v140, v140
v_dot2c_f32_bf16 v73, 0x3f803f80, v141
v_dot2c_f32_bf16 v75, v141, v141
v_dot2c_f32_bf16 v72, 0x3f803f80, v142
v_dot2c_f32_bf16 v74, v142, v142
v_dot2c_f32_bf16 v73, 0x3f803f80, v143
v_dot2c_f32_bf16 v75, v143, v143
v_lshrrev_b32 v4, 3, v3
s_lshl_b32 s53, s40, 5
v_add_u32 v4, s53, v4
v_bfe_u32 v5, v3, 4, 1
v_lshlrev_b32 v5, 2, v5
v_and_b32 v6, 7, v3
v_xor_b32 v5, v5, v6
v_lshlrev_b32 v5, 4, v5
v_mad_u32_u24 v4, v4, s45, v5
s_lshl_b32 s53, s45, 3
s_sub_u32 s53, s53, 1024
v_add_u32 v5, s53, v4
v_add_u32 v6, s53, v5
v_add_u32 v7, s53, v6
s_lshl_b32 s53, s45, 6
s_add_u32 m0, s41, 0
s_mul_i32 s52, s63, s53
s_add_u32 s52, s52, s46
buffer_load_dwordx4 v4, s[12:15], s52 offen lds
buffer_load_dwordx4 v5, s[12:15], s52 offen offset:1024 lds
buffer_load_dwordx4 v6, s[12:15], s52 offen offset:2048 lds
buffer_load_dwordx4 v7, s[12:15], s52 offen offset:3072 lds
s_waitcnt vmcnt(18)
v_add_u32 v68, 65536, v68
v_add_u32 v69, 65536, v69
v_add_u32 v70, 65536, v70
v_add_u32 v71, 65536, v71
ds_read_b128 v[160:163], v68 offset:0
ds_read_b128 v[164:167], v69 offset:0
ds_read_b128 v[168:171], v70 offset:0
ds_read_b128 v[172:175], v71 offset:0
s_waitcnt lgkmcnt(7)
v_dot2c_f32_bf16 v72, 0x3f803f80, v144
v_dot2c_f32_bf16 v74, v144, v144
v_dot2c_f32_bf16 v73, 0x3f803f80, v145
v_dot2c_f32_bf16 v75, v145, v145
v_dot2c_f32_bf16 v72, 0x3f803f80, v146
v_dot2c_f32_bf16 v74, v146, v146
v_dot2c_f32_bf16 v73, 0x3f803f80, v147
v_dot2c_f32_bf16 v75, v147, v147
s_waitcnt lgkmcnt(6)
v_dot2c_f32_bf16 v72, 0x3f803f80, v148
v_dot2c_f32_bf16 v74, v148, v148
v_dot2c_f32_bf16 v73, 0x3f803f80, v149
v_dot2c_f32_bf16 v75, v149, v149
v_dot2c_f32_bf16 v72, 0x3f803f80, v150
v_dot2c_f32_bf16 v74, v150, v150
v_dot2c_f32_bf16 v73, 0x3f803f80, v151
v_dot2c_f32_bf16 v75, v151, v151
s_waitcnt lgkmcnt(5)
v_dot2c_f32_bf16 v72, 0x3f803f80, v152
v_dot2c_f32_bf16 v74, v152, v152
v_dot2c_f32_bf16 v73, 0x3f803f80, v153
v_dot2c_f32_bf16 v75, v153, v153
v_dot2c_f32_bf16 v72, 0x3f803f80, v154
v_dot2c_f32_bf16 v74, v154, v154
v_dot2c_f32_bf16 v73, 0x3f803f80, v155
v_dot2c_f32_bf16 v75, v155, v155
s_waitcnt lgkmcnt(4)
v_dot2c_f32_bf16 v72, 0x3f803f80, v156
v_dot2c_f32_bf16 v74, v156, v156
v_dot2c_f32_bf16 v73, 0x3f803f80, v157
v_dot2c_f32_bf16 v75, v157, v157
v_dot2c_f32_bf16 v72, 0x3f803f80, v158
v_dot2c_f32_bf16 v74, v158, v158
v_dot2c_f32_bf16 v73, 0x3f803f80, v159
v_dot2c_f32_bf16 v75, v159, v159
s_add_u32 m0, s41, 131072
s_add_u32 s6, s63, 8
s_sub_u32 s96, s6, 10
s_cselect_b32 s6, s6, s96
s_lshl_b32 s6, s6, 7
buffer_load_dwordx4 v64, s[8:11], s6 offen lds
buffer_load_dwordx4 v65, s[8:11], s6 offen offset:1024 lds
buffer_load_dwordx4 v66, s[8:11], s6 offen offset:2048 lds
buffer_load_dwordx4 v67, s[8:11], s6 offen offset:3072 lds
s_waitcnt vmcnt(18)
ds_read_b128 v[176:179], v68 offset:16384
ds_read_b128 v[180:183], v69 offset:16384
ds_read_b128 v[184:187], v70 offset:16384
ds_read_b128 v[188:191], v71 offset:16384
s_waitcnt lgkmcnt(7)
v_dot2c_f32_bf16 v72, 0x3f803f80, v160
v_dot2c_f32_bf16 v74, v160, v160
v_dot2c_f32_bf16 v73, 0x3f803f80, v161
v_dot2c_f32_bf16 v75, v161, v161
v_dot2c_f32_bf16 v72, 0x3f803f80, v162
v_dot2c_f32_bf16 v74, v162, v162
v_dot2c_f32_bf16 v73, 0x3f803f80, v163
v_dot2c_f32_bf16 v75, v163, v163
s_waitcnt lgkmcnt(6)
v_dot2c_f32_bf16 v72, 0x3f803f80, v164
v_dot2c_f32_bf16 v74, v164, v164
v_dot2c_f32_bf16 v73, 0x3f803f80, v165
v_dot2c_f32_bf16 v75, v165, v165
v_dot2c_f32_bf16 v72, 0x3f803f80, v166
v_dot2c_f32_bf16 v74, v166, v166
v_dot2c_f32_bf16 v73, 0x3f803f80, v167
v_dot2c_f32_bf16 v75, v167, v167
s_waitcnt lgkmcnt(5)
v_dot2c_f32_bf16 v72, 0x3f803f80, v168
v_dot2c_f32_bf16 v74, v168, v168
v_dot2c_f32_bf16 v73, 0x3f803f80, v169
v_dot2c_f32_bf16 v75, v169, v169
v_dot2c_f32_bf16 v72, 0x3f803f80, v170
v_dot2c_f32_bf16 v74, v170, v170
v_dot2c_f32_bf16 v73, 0x3f803f80, v171
v_dot2c_f32_bf16 v75, v171, v171
s_waitcnt lgkmcnt(4)
v_dot2c_f32_bf16 v72, 0x3f803f80, v172
v_dot2c_f32_bf16 v74, v172, v172
v_dot2c_f32_bf16 v73, 0x3f803f80, v173
v_dot2c_f32_bf16 v75, v173, v173
v_dot2c_f32_bf16 v72, 0x3f803f80, v174
v_dot2c_f32_bf16 v74, v174, v174
v_dot2c_f32_bf16 v73, 0x3f803f80, v175
v_dot2c_f32_bf16 v75, v175, v175
s_add_u32 m0, s41, 147456
s_add_u32 s6, s63, 9
s_sub_u32 s96, s6, 10
s_cselect_b32 s6, s6, s96
s_lshl_b32 s6, s6, 7
buffer_load_dwordx4 v64, s[8:11], s6 offen lds
buffer_load_dwordx4 v65, s[8:11], s6 offen offset:1024 lds
buffer_load_dwordx4 v66, s[8:11], s6 offen offset:2048 lds
buffer_load_dwordx4 v67, s[8:11], s6 offen offset:3072 lds
s_waitcnt vmcnt(16)
ds_read_b128 v[192:195], v68 offset:32768
ds_read_b128 v[196:199], v69 offset:32768
ds_read_b128 v[200:203], v70 offset:32768
ds_read_b128 v[204:207], v71 offset:32768
s_waitcnt lgkmcnt(7)
v_dot2c_f32_bf16 v72, 0x3f803f80, v176
v_dot2c_f32_bf16 v74, v176, v176
v_dot2c_f32_bf16 v73, 0x3f803f80, v177
v_dot2c_f32_bf16 v75, v177, v177
v_dot2c_f32_bf16 v72, 0x3f803f80, v178
v_dot2c_f32_bf16 v74, v178, v178
v_dot2c_f32_bf16 v73, 0x3f803f80, v179
v_dot2c_f32_bf16 v75, v179, v179
s_waitcnt lgkmcnt(6)
v_dot2c_f32_bf16 v72, 0x3f803f80, v180
v_dot2c_f32_bf16 v74, v180, v180
v_dot2c_f32_bf16 v73, 0x3f803f80, v181
v_dot2c_f32_bf16 v75, v181, v181
v_dot2c_f32_bf16 v72, 0x3f803f80, v182
v_dot2c_f32_bf16 v74, v182, v182
v_dot2c_f32_bf16 v73, 0x3f803f80, v183
v_dot2c_f32_bf16 v75, v183, v183
s_waitcnt lgkmcnt(5)
v_dot2c_f32_bf16 v72, 0x3f803f80, v184
v_dot2c_f32_bf16 v74, v184, v184
v_dot2c_f32_bf16 v73, 0x3f803f80, v185
v_dot2c_f32_bf16 v75, v185, v185
v_dot2c_f32_bf16 v72, 0x3f803f80, v186
v_dot2c_f32_bf16 v74, v186, v186
v_dot2c_f32_bf16 v73, 0x3f803f80, v187
v_dot2c_f32_bf16 v75, v187, v187
s_waitcnt lgkmcnt(4)
v_dot2c_f32_bf16 v72, 0x3f803f80, v188
v_dot2c_f32_bf16 v74, v188, v188
v_dot2c_f32_bf16 v73, 0x3f803f80, v189
v_dot2c_f32_bf16 v75, v189, v189
v_dot2c_f32_bf16 v72, 0x3f803f80, v190
v_dot2c_f32_bf16 v74, v190, v190
v_dot2c_f32_bf16 v73, 0x3f803f80, v191
v_dot2c_f32_bf16 v75, v191, v191
s_add_u32 m0, s41, 16384
s_add_u32 s51, s63, 2
s_sub_u32 s52, s51, 10
s_cselect_b32 s51, s51, s52
s_mul_i32 s52, s51, s53
s_add_u32 s52, s52, s46
buffer_load_dwordx4 v4, s[12:15], s52 offen lds
buffer_load_dwordx4 v5, s[12:15], s52 offen offset:1024 lds
buffer_load_dwordx4 v6, s[12:15], s52 offen offset:2048 lds
buffer_load_dwordx4 v7, s[12:15], s52 offen offset:3072 lds
s_waitcnt vmcnt(16)
ds_read_b128 v[208:211], v68 offset:49152
ds_read_b128 v[212:215], v69 offset:49152
ds_read_b128 v[216:219], v70 offset:49152
ds_read_b128 v[220:223], v71 offset:49152
s_waitcnt lgkmcnt(7)
v_dot2c_f32_bf16 v72, 0x3f803f80, v192
v_dot2c_f32_bf16 v74, v192, v192
v_dot2c_f32_bf16 v73, 0x3f803f80, v193
v_dot2c_f32_bf16 v75, v193, v193
v_dot2c_f32_bf16 v72, 0x3f803f80, v194
v_dot2c_f32_bf16 v74, v194, v194
v_dot2c_f32_bf16 v73, 0x3f803f80, v195
v_dot2c_f32_bf16 v75, v195, v195
s_waitcnt lgkmcnt(6)
v_dot2c_f32_bf16 v72, 0x3f803f80, v196
v_dot2c_f32_bf16 v74, v196, v196
v_dot2c_f32_bf16 v73, 0x3f803f80, v197
v_dot2c_f32_bf16 v75, v197, v197
v_dot2c_f32_bf16 v72, 0x3f803f80, v198
v_dot2c_f32_bf16 v74, v198, v198
v_dot2c_f32_bf16 v73, 0x3f803f80, v199
v_dot2c_f32_bf16 v75, v199, v199
s_waitcnt lgkmcnt(5)
v_dot2c_f32_bf16 v72, 0x3f803f80, v200
v_dot2c_f32_bf16 v74, v200, v200
v_dot2c_f32_bf16 v73, 0x3f803f80, v201
v_dot2c_f32_bf16 v75, v201, v201
v_dot2c_f32_bf16 v72, 0x3f803f80, v202
v_dot2c_f32_bf16 v74, v202, v202
v_dot2c_f32_bf16 v73, 0x3f803f80, v203
v_dot2c_f32_bf16 v75, v203, v203
s_waitcnt lgkmcnt(4)
v_dot2c_f32_bf16 v72, 0x3f803f80, v204
v_dot2c_f32_bf16 v74, v204, v204
v_dot2c_f32_bf16 v73, 0x3f803f80, v205
v_dot2c_f32_bf16 v75, v205, v205
v_dot2c_f32_bf16 v72, 0x3f803f80, v206
v_dot2c_f32_bf16 v74, v206, v206
v_dot2c_f32_bf16 v73, 0x3f803f80, v207
v_dot2c_f32_bf16 v75, v207, v207
s_add_u32 m0, s41, 32768
s_add_u32 s51, s63, 4
s_sub_u32 s52, s51, 10
s_cselect_b32 s51, s51, s52
s_mul_i32 s52, s51, s53
s_add_u32 s52, s52, s46
buffer_load_dwordx4 v4, s[12:15], s52 offen lds
buffer_load_dwordx4 v5, s[12:15], s52 offen offset:1024 lds
buffer_load_dwordx4 v6, s[12:15], s52 offen offset:2048 lds
buffer_load_dwordx4 v7, s[12:15], s52 offen offset:3072 lds
s_waitcnt vmcnt(12)
v_add_u32 v68, 65536, v68
v_add_u32 v69, 65536, v69
v_add_u32 v70, 65536, v70
v_add_u32 v71, 65536, v71
ds_read_b128 v[224:227], v68 offset:0
ds_read_b128 v[228:231], v69 offset:0
ds_read_b128 v[232:235], v70 offset:0
ds_read_b128 v[236:239], v71 offset:0
s_waitcnt lgkmcnt(7)
v_dot2c_f32_bf16 v72, 0x3f803f80, v208
v_dot2c_f32_bf16 v74, v208, v208
v_dot2c_f32_bf16 v73, 0x3f803f80, v209
v_dot2c_f32_bf16 v75, v209, v209
v_dot2c_f32_bf16 v72, 0x3f803f80, v210
v_dot2c_f32_bf16 v74, v210, v210
v_dot2c_f32_bf16 v73, 0x3f803f80, v211
v_dot2c_f32_bf16 v75, v211, v211
s_waitcnt lgkmcnt(6)
v_dot2c_f32_bf16 v72, 0x3f803f80, v212
v_dot2c_f32_bf16 v74, v212, v212
v_dot2c_f32_bf16 v73, 0x3f803f80, v213
v_dot2c_f32_bf16 v75, v213, v213
v_dot2c_f32_bf16 v72, 0x3f803f80, v214
v_dot2c_f32_bf16 v74, v214, v214
v_dot2c_f32_bf16 v73, 0x3f803f80, v215
v_dot2c_f32_bf16 v75, v215, v215
s_waitcnt lgkmcnt(5)
v_dot2c_f32_bf16 v72, 0x3f803f80, v216
v_dot2c_f32_bf16 v74, v216, v216
v_dot2c_f32_bf16 v73, 0x3f803f80, v217
v_dot2c_f32_bf16 v75, v217, v217
v_dot2c_f32_bf16 v72, 0x3f803f80, v218
v_dot2c_f32_bf16 v74, v218, v218
v_dot2c_f32_bf16 v73, 0x3f803f80, v219
v_dot2c_f32_bf16 v75, v219, v219
s_waitcnt lgkmcnt(4)
v_dot2c_f32_bf16 v72, 0x3f803f80, v220
v_dot2c_f32_bf16 v74, v220, v220
v_dot2c_f32_bf16 v73, 0x3f803f80, v221
v_dot2c_f32_bf16 v75, v221, v221
v_dot2c_f32_bf16 v72, 0x3f803f80, v222
v_dot2c_f32_bf16 v74, v222, v222
v_dot2c_f32_bf16 v73, 0x3f803f80, v223
v_dot2c_f32_bf16 v75, v223, v223
s_add_u32 m0, s41, 49152
s_add_u32 s51, s63, 6
s_sub_u32 s52, s51, 10
s_cselect_b32 s51, s51, s52
s_mul_i32 s52, s51, s53
s_add_u32 s52, s52, s46
buffer_load_dwordx4 v4, s[12:15], s52 offen lds
buffer_load_dwordx4 v5, s[12:15], s52 offen offset:1024 lds
buffer_load_dwordx4 v6, s[12:15], s52 offen offset:2048 lds
buffer_load_dwordx4 v7, s[12:15], s52 offen offset:3072 lds
s_waitcnt vmcnt(12)
ds_read_b128 v[240:243], v68 offset:16384
ds_read_b128 v[244:247], v69 offset:16384
ds_read_b128 v[248:251], v70 offset:16384
ds_read_b128 v[252:255], v71 offset:16384
s_waitcnt lgkmcnt(7)
v_dot2c_f32_bf16 v72, 0x3f803f80, v224
v_dot2c_f32_bf16 v74, v224, v224
v_dot2c_f32_bf16 v73, 0x3f803f80, v225
v_dot2c_f32_bf16 v75, v225, v225
v_dot2c_f32_bf16 v72, 0x3f803f80, v226
v_dot2c_f32_bf16 v74, v226, v226
v_dot2c_f32_bf16 v73, 0x3f803f80, v227
v_dot2c_f32_bf16 v75, v227, v227
s_waitcnt lgkmcnt(6)
v_dot2c_f32_bf16 v72, 0x3f803f80, v228
v_dot2c_f32_bf16 v74, v228, v228
v_dot2c_f32_bf16 v73, 0x3f803f80, v229
v_dot2c_f32_bf16 v75, v229, v229
v_dot2c_f32_bf16 v72, 0x3f803f80, v230
v_dot2c_f32_bf16 v74, v230, v230
v_dot2c_f32_bf16 v73, 0x3f803f80, v231
v_dot2c_f32_bf16 v75, v231, v231
s_waitcnt lgkmcnt(5)
v_dot2c_f32_bf16 v72, 0x3f803f80, v232
v_dot2c_f32_bf16 v74, v232, v232
v_dot2c_f32_bf16 v73, 0x3f803f80, v233
v_dot2c_f32_bf16 v75, v233, v233
v_dot2c_f32_bf16 v72, 0x3f803f80, v234
v_dot2c_f32_bf16 v74, v234, v234
v_dot2c_f32_bf16 v73, 0x3f803f80, v235
v_dot2c_f32_bf16 v75, v235, v235
s_waitcnt lgkmcnt(4)
v_dot2c_f32_bf16 v72, 0x3f803f80, v236
v_dot2c_f32_bf16 v74, v236, v236
v_dot2c_f32_bf16 v73, 0x3f803f80, v237
v_dot2c_f32_bf16 v75, v237, v237
v_dot2c_f32_bf16 v72, 0x3f803f80, v238
v_dot2c_f32_bf16 v74, v238, v238
v_dot2c_f32_bf16 v73, 0x3f803f80, v239
v_dot2c_f32_bf16 v75, v239, v239
s_waitcnt lgkmcnt(3)
v_dot2c_f32_bf16 v72, 0x3f803f80, v240
v_dot2c_f32_bf16 v74, v240, v240
v_dot2c_f32_bf16 v73, 0x3f803f80, v241
v_dot2c_f32_bf16 v75, v241, v241
v_dot2c_f32_bf16 v72, 0x3f803f80, v242
v_dot2c_f32_bf16 v74, v242, v242
v_dot2c_f32_bf16 v73, 0x3f803f80, v243
v_dot2c_f32_bf16 v75, v243, v243
s_waitcnt lgkmcnt(2)
v_dot2c_f32_bf16 v72, 0x3f803f80, v244
v_dot2c_f32_bf16 v74, v244, v244
v_dot2c_f32_bf16 v73, 0x3f803f80, v245
v_dot2c_f32_bf16 v75, v245, v245
v_dot2c_f32_bf16 v72, 0x3f803f80, v246
v_dot2c_f32_bf16 v74, v246, v246
v_dot2c_f32_bf16 v73, 0x3f803f80, v247
v_dot2c_f32_bf16 v75, v247, v247
s_waitcnt lgkmcnt(1)
v_dot2c_f32_bf16 v72, 0x3f803f80, v248
v_dot2c_f32_bf16 v74, v248, v248
v_dot2c_f32_bf16 v73, 0x3f803f80, v249
v_dot2c_f32_bf16 v75, v249, v249
v_dot2c_f32_bf16 v72, 0x3f803f80, v250
v_dot2c_f32_bf16 v74, v250, v250
v_dot2c_f32_bf16 v73, 0x3f803f80, v251
v_dot2c_f32_bf16 v75, v251, v251
s_waitcnt lgkmcnt(0)
v_dot2c_f32_bf16 v72, 0x3f803f80, v252
v_dot2c_f32_bf16 v74, v252, v252
v_dot2c_f32_bf16 v73, 0x3f803f80, v253
v_dot2c_f32_bf16 v75, v253, v253
v_dot2c_f32_bf16 v72, 0x3f803f80, v254
v_dot2c_f32_bf16 v74, v254, v254
v_dot2c_f32_bf16 v73, 0x3f803f80, v255
v_dot2c_f32_bf16 v75, v255, v255
s_nop 1
v_add_f32 v72, v72, v73
v_add_f32 v74, v74, v75
v_mov_b32 v73, v72
s_nop 1
v_permlane32_swap_b32 v72, v73
v_add_f32 v72, v72, v73
v_mov_b32 v75, v74
s_nop 1
v_permlane32_swap_b32 v74, v75
v_add_f32 v74, v74, v75
v_mul_f32 v72, 0xbacccccd, v72
v_mul_f32 v74, 0x3acccccd, v74
v_fma_f32 v74, -v72, v72, v74
v_max_f32 v74, 0, v74
v_add_f32 v73, 0x3727c5ac, v74
v_rsq_f32 v8, v73
v_cmp_gt_u32 vcc, 32, v3
v_mul_f32 v9, v72, v8
v_mov_b32 v80, v72
v_mov_b32 v81, v72
v_mov_b32 v82, v72
v_mov_b32 v83, v72
v_mov_b32 v84, v72
v_mov_b32 v85, v72
v_mov_b32 v86, v72
v_mov_b32 v87, v72
v_mov_b32 v88, v72
v_mov_b32 v89, v72
v_mov_b32 v90, v72
v_mov_b32 v91, v72
v_mov_b32 v92, v72
v_mov_b32 v93, v72
v_mov_b32 v94, v72
v_mov_b32 v95, v72
v_mov_b32 v20, v74
s_cmp_eq_u32 s62, 0
s_cbranch_scc1 L_s1h
s_cmp_eq_u32 s62, 3
s_cbranch_scc1 L_s1v
s_add_u32 s7, s49, 4096
v_mfma_f32_32x32x16_bf16 v[64:79], a[16:19], v[96:99], v[80:95]
v_mfma_f32_32x32x16_bf16 v[64:79], a[20:23], v[100:103], v[64:79]
s_barrier
v_bfe_u32 v30, v3, 2, 2
v_lshrrev_b32 v31, 5, v3
v_lshl_add_u32 v30, v31, 3, v30
v_lshlrev_b32 v1, 7, v30
v_bfe_u32 v30, v3, 4, 1
v_lshl_add_u32 v1, v30, 5, v1
v_and_b32 v30, 3, v3
v_lshl_add_u32 v1, v30, 3, v1
v_bfe_u32 v30, v3, 3, 1
v_lshl_add_u32 v1, v30, 6, v1
v_xor_b32 v2, 64, v1
ds_read_b64_tr_b16 a[160:161], v1 offset:0
ds_read_b64_tr_b16 a[162:163], v1 offset:512
ds_read_b64_tr_b16 a[164:165], v2 offset:0
ds_read_b64_tr_b16 a[166:167], v2 offset:512
ds_read_b64_tr_b16 a[168:169], v1 offset:2048
ds_read_b64_tr_b16 a[170:171], v1 offset:2560
ds_read_b64_tr_b16 a[172:173], v2 offset:2048
ds_read_b64_tr_b16 a[174:175], v2 offset:2560
ds_read_b64_tr_b16 a[176:177], v1 offset:4096
ds_read_b64_tr_b16 a[178:179], v1 offset:4608
ds_read_b64_tr_b16 a[180:181], v2 offset:4096
ds_read_b64_tr_b16 a[182:183], v2 offset:4608
v_cvt_pk_bf16_f32 v96, v64, v65
v_cvt_pk_bf16_f32 v97, v66, v67
v_cvt_pk_bf16_f32 v98, v68, v69
v_cvt_pk_bf16_f32 v99, v70, v71
v_cvt_pk_bf16_f32 v100, v72, v73
v_cvt_pk_bf16_f32 v101, v74, v75
v_cvt_pk_bf16_f32 v102, v76, v77
v_cvt_pk_bf16_f32 v103, v78, v79
v_mfma_f32_32x32x16_bf16 v[64:79], a[16:19], v[104:107], v[80:95]
v_mfma_f32_32x32x16_bf16 v[64:79], a[20:23], v[108:111], v[64:79]
s_waitcnt lgkmcnt(8)
v_mfma_f32_32x32x16_bf16 v[32:47], a[160:163], v[96:99], 0
ds_read_b64_tr_b16 a[184:185], v1 offset:6144
ds_read_b64_tr_b16 a[186:187], v1 offset:6656
v_mfma_f32_32x32x16_bf16 v[48:63], a[164:167], v[96:99], 0
ds_read_b64_tr_b16 a[188:189], v2 offset:6144
ds_read_b64_tr_b16 a[190:191], v2 offset:6656
s_waitcnt lgkmcnt(8)
v_mfma_f32_32x32x16_bf16 v[32:47], a[168:171], v[100:103], v[32:47]
ds_read_b64_tr_b16 a[160:161], v1 offset:8192
ds_read_b64_tr_b16 a[162:163], v1 offset:8704
s_nop 0
v_cvt_pk_bf16_f32 v104, v64, v65
v_cvt_pk_bf16_f32 v105, v66, v67
v_cvt_pk_bf16_f32 v106, v68, v69
v_cvt_pk_bf16_f32 v107, v70, v71
v_mfma_f32_32x32x16_bf16 v[48:63], a[172:175], v[100:103], v[48:63]
ds_read_b64_tr_b16 a[164:165], v2 offset:8192
ds_read_b64_tr_b16 a[166:167], v2 offset:8704
v_cvt_pk_bf16_f32 v108, v72, v73
v_cvt_pk_bf16_f32 v109, v74, v75
v_cvt_pk_bf16_f32 v110, v76, v77
v_cvt_pk_bf16_f32 v111, v78, v79
v_mfma_f32_32x32x16_bf16 v[64:79], a[16:19], v[112:115], v[80:95]
v_mfma_f32_32x32x16_bf16 v[64:79], a[20:23], v[116:119], v[64:79]
s_waitcnt lgkmcnt(8)
v_mfma_f32_32x32x16_bf16 v[32:47], a[176:179], v[104:107], v[32:47]
ds_read_b64_tr_b16 a[168:169], v1 offset:10240
ds_read_b64_tr_b16 a[170:171], v1 offset:10752
v_mfma_f32_32x32x16_bf16 v[48:63], a[180:183], v[104:107], v[48:63]
ds_read_b64_tr_b16 a[172:173], v2 offset:10240
ds_read_b64_tr_b16 a[174:175], v2 offset:10752
s_waitcnt lgkmcnt(8)
v_mfma_f32_32x32x16_bf16 v[32:47], a[184:187], v[108:111], v[32:47]
ds_read_b64_tr_b16 a[176:177], v1 offset:12288
ds_read_b64_tr_b16 a[178:179], v1 offset:12800
s_nop 0
v_cvt_pk_bf16_f32 v112, v64, v65
v_cvt_pk_bf16_f32 v113, v66, v67
v_cvt_pk_bf16_f32 v114, v68, v69
v_cvt_pk_bf16_f32 v115, v70, v71
v_mfma_f32_32x32x16_bf16 v[48:63], a[188:191], v[108:111], v[48:63]
ds_read_b64_tr_b16 a[180:181], v2 offset:12288
ds_read_b64_tr_b16 a[182:183], v2 offset:12800
v_cvt_pk_bf16_f32 v116, v72, v73
v_cvt_pk_bf16_f32 v117, v74, v75
v_cvt_pk_bf16_f32 v118, v76, v77
v_cvt_pk_bf16_f32 v119, v78, v79
v_mfma_f32_32x32x16_bf16 v[64:79], a[16:19], v[120:123], v[80:95]
v_mfma_f32_32x32x16_bf16 v[64:79], a[20:23], v[124:127], v[64:79]
s_waitcnt lgkmcnt(8)
v_mfma_f32_32x32x16_bf16 v[32:47], a[160:163], v[112:115], v[32:47]
ds_read_b64_tr_b16 a[184:185], v1 offset:14336
ds_read_b64_tr_b16 a[186:187], v1 offset:14848
v_mfma_f32_32x32x16_bf16 v[48:63], a[164:167], v[112:115], v[48:63]
ds_read_b64_tr_b16 a[188:189], v2 offset:14336
ds_read_b64_tr_b16 a[190:191], v2 offset:14848
s_waitcnt lgkmcnt(8)
v_mfma_f32_32x32x16_bf16 v[32:47], a[168:171], v[116:119], v[32:47]
s_waitcnt vmcnt(8)
s_barrier
ds_read_b64_tr_b16 a[160:161], v1 offset:16384
ds_read_b64_tr_b16 a[162:163], v1 offset:16896
v_cvt_pk_bf16_f32 v120, v64, v65
v_cvt_pk_bf16_f32 v121, v66, v67
v_cvt_pk_bf16_f32 v122, v68, v69
v_cvt_pk_bf16_f32 v123, v70, v71
v_mfma_f32_32x32x16_bf16 v[48:63], a[172:175], v[116:119], v[48:63]
ds_read_b64_tr_b16 a[164:165], v2 offset:16384
ds_read_b64_tr_b16 a[166:167], v2 offset:16896
v_cvt_pk_bf16_f32 v124, v72, v73
v_cvt_pk_bf16_f32 v125, v74, v75
v_cvt_pk_bf16_f32 v126, v76, v77
v_cvt_pk_bf16_f32 v127, v78, v79
v_mfma_f32_32x32x16_bf16 v[64:79], a[16:19], v[128:131], v[80:95]
s_add_u32 m0, s41, 65536
s_add_u32 s51, s63, 8
s_sub_u32 s52, s51, 10
s_cselect_b32 s51, s51, s52
s_mul_i32 s52, s51, s53
s_add_u32 s52, s52, s46
v_mfma_f32_32x32x16_bf16 v[64:79], a[20:23], v[132:135], v[64:79]
buffer_load_dwordx4 v4, s[12:15], s52 offen lds
s_waitcnt lgkmcnt(8)
v_mfma_f32_32x32x16_bf16 v[32:47], a[176:179], v[120:123], v[32:47]
ds_read_b64_tr_b16 a[168:169], v1 offset:18432
ds_read_b64_tr_b16 a[170:171], v1 offset:18944
buffer_load_dwordx4 v5, s[12:15], s52 offen offset:1024 lds
v_mfma_f32_32x32x16_bf16 v[48:63], a[180:183], v[120:123], v[48:63]
ds_read_b64_tr_b16 a[172:173], v2 offset:18432
ds_read_b64_tr_b16 a[174:175], v2 offset:18944
s_waitcnt lgkmcnt(8)
v_mfma_f32_32x32x16_bf16 v[32:47], a[184:187], v[124:127], v[32:47]
ds_read_b64_tr_b16 a[176:177], v1 offset:20480
ds_read_b64_tr_b16 a[178:179], v1 offset:20992
v_cvt_pk_bf16_f32 v128, v64, v65
v_cvt_pk_bf16_f32 v129, v66, v67
v_cvt_pk_bf16_f32 v130, v68, v69
v_cvt_pk_bf16_f32 v131, v70, v71
v_mfma_f32_32x32x16_bf16 v[48:63], a[188:191], v[124:127], v[48:63]
ds_read_b64_tr_b16 a[180:181], v2 offset:20480
ds_read_b64_tr_b16 a[182:183], v2 offset:20992
v_cvt_pk_bf16_f32 v132, v72, v73
v_cvt_pk_bf16_f32 v133, v74, v75
v_cvt_pk_bf16_f32 v134, v76, v77
v_cvt_pk_bf16_f32 v135, v78, v79
v_mfma_f32_32x32x16_bf16 v[64:79], a[16:19], v[136:139], v[80:95]
buffer_load_dwordx4 v6, s[12:15], s52 offen offset:2048 lds
v_mov_b32 v26, 1
v_mfma_f32_32x32x16_bf16 v[64:79], a[20:23], v[140:143], v[64:79]
buffer_load_dwordx4 v7, s[12:15], s52 offen offset:3072 lds
s_add_u32 m0, s41, 81920
s_waitcnt lgkmcnt(8)
v_mfma_f32_32x32x16_bf16 v[32:47], a[160:163], v[128:131], v[32:47]
ds_read_b64_tr_b16 a[184:185], v1 offset:22528
ds_read_b64_tr_b16 a[186:187], v1 offset:23040
s_mul_i32 s52, s63, s53
s_add_u32 s52, s52, s46
s_add_u32 s52, s52, 128
v_mfma_f32_32x32x16_bf16 v[48:63], a[164:167], v[128:131], v[48:63]
ds_read_b64_tr_b16 a[188:189], v2 offset:22528
ds_read_b64_tr_b16 a[190:191], v2 offset:23040
buffer_atomic_add v26, v13, s[36:39], s2 offen sc0 sc1
s_waitcnt lgkmcnt(8)
v_mfma_f32_32x32x16_bf16 v[32:47], a[168:171], v[132:135], v[32:47]
ds_read_b64_tr_b16 a[160:161], v1 offset:24576
ds_read_b64_tr_b16 a[162:163], v1 offset:25088
v_cvt_pk_bf16_f32 v136, v64, v65
v_cvt_pk_bf16_f32 v137, v66, v67
v_cvt_pk_bf16_f32 v138, v68, v69
v_cvt_pk_bf16_f32 v139, v70, v71
v_mfma_f32_32x32x16_bf16 v[48:63], a[172:175], v[132:135], v[48:63]
ds_read_b64_tr_b16 a[164:165], v2 offset:24576
ds_read_b64_tr_b16 a[166:167], v2 offset:25088
v_cvt_pk_bf16_f32 v140, v72, v73
v_cvt_pk_bf16_f32 v141, v74, v75
v_cvt_pk_bf16_f32 v142, v76, v77
v_cvt_pk_bf16_f32 v143, v78, v79
v_mfma_f32_32x32x16_bf16 v[64:79], a[16:19], v[144:147], v[80:95]
buffer_load_dwordx4 v4, s[12:15], s52 offen lds
v_mfma_f32_32x32x16_bf16 v[64:79], a[20:23], v[148:151], v[64:79]
buffer_load_dwordx4 v5, s[12:15], s52 offen offset:1024 lds
s_waitcnt lgkmcnt(8)
v_mfma_f32_32x32x16_bf16 v[32:47], a[176:179], v[136:139], v[32:47]
ds_read_b64_tr_b16 a[168:169], v1 offset:26624
ds_read_b64_tr_b16 a[170:171], v1 offset:27136
buffer_load_dwordx4 v6, s[12:15], s52 offen offset:2048 lds
v_mfma_f32_32x32x16_bf16 v[48:63], a[180:183], v[136:139], v[48:63]
ds_read_b64_tr_b16 a[172:173], v2 offset:26624
ds_read_b64_tr_b16 a[174:175], v2 offset:27136
s_waitcnt lgkmcnt(8)
v_mfma_f32_32x32x16_bf16 v[32:47], a[184:187], v[140:143], v[32:47]
ds_read_b64_tr_b16 a[176:177], v1 offset:28672
ds_read_b64_tr_b16 a[178:179], v1 offset:29184
v_cvt_pk_bf16_f32 v144, v64, v65
v_cvt_pk_bf16_f32 v145, v66, v67
v_cvt_pk_bf16_f32 v146, v68, v69
v_cvt_pk_bf16_f32 v147, v70, v71
v_mfma_f32_32x32x16_bf16 v[48:63], a[188:191], v[140:143], v[48:63]
ds_read_b64_tr_b16 a[180:181], v2 offset:28672
ds_read_b64_tr_b16 a[182:183], v2 offset:29184
v_cvt_pk_bf16_f32 v148, v72, v73
v_cvt_pk_bf16_f32 v149, v74, v75
v_cvt_pk_bf16_f32 v150, v76, v77
v_cvt_pk_bf16_f32 v151, v78, v79
v_mfma_f32_32x32x16_bf16 v[64:79], a[16:19], v[152:155], v[80:95]
buffer_load_dwordx4 v7, s[12:15], s52 offen offset:3072 lds
v_mfma_f32_32x32x16_bf16 v[64:79], a[20:23], v[156:159], v[64:79]
s_waitcnt lgkmcnt(8)
v_mfma_f32_32x32x16_bf16 v[32:47], a[160:163], v[144:147], v[32:47]
ds_read_b64_tr_b16 a[184:185], v1 offset:30720
ds_read_b64_tr_b16 a[186:187], v1 offset:31232
s_cmp_eq_u32 s62, 1
s_cselect_b32 s3, 0x3ea52b5c, 1.0
v_mul_f32 v10, s3, v8
s_cselect_b32 s4, s60, 1
v_mfma_f32_32x32x16_bf16 v[48:63], a[164:167], v[144:147], v[48:63]
ds_read_b64_tr_b16 a[188:189], v2 offset:30720
ds_read_b64_tr_b16 a[190:191], v2 offset:31232
s_lshl_b32 s3, s44, 8
s_add_u32 s3, s3, 114688
s_cmp_eq_u32 s4, 0
s_cselect_b32 s3, s3, 1073741824
s_waitcnt lgkmcnt(8)
v_mfma_f32_32x32x16_bf16 v[32:47], a[168:171], v[148:151], v[32:47]
s_waitcnt vmcnt(13)
s_barrier
ds_read_b64_tr_b16 a[160:161], v1 offset:32768
ds_read_b64_tr_b16 a[162:163], v1 offset:33280
v_cvt_pk_bf16_f32 v152, v64, v65
v_cvt_pk_bf16_f32 v153, v66, v67
v_cvt_pk_bf16_f32 v154, v68, v69
v_cvt_pk_bf16_f32 v155, v70, v71
v_mfma_f32_32x32x16_bf16 v[48:63], a[172:175], v[148:151], v[48:63]
ds_read_b64_tr_b16 a[164:165], v2 offset:32768
ds_read_b64_tr_b16 a[166:167], v2 offset:33280
v_cvt_pk_bf16_f32 v156, v72, v73
v_cvt_pk_bf16_f32 v157, v74, v75
v_cvt_pk_bf16_f32 v158, v76, v77
v_cvt_pk_bf16_f32 v159, v78, v79
v_mfma_f32_32x32x16_bf16 v[64:79], a[16:19], v[160:163], v[80:95]
s_add_u32 m0, s41, 98304
s_add_u32 s51, s63, 2
s_sub_u32 s52, s51, 10
s_cselect_b32 s51, s51, s52
s_mul_i32 s52, s51, s53
s_add_u32 s52, s52, s46
v_mfma_f32_32x32x16_bf16 v[64:79], a[20:23], v[164:167], v[64:79]
s_add_u32 s52, s52, 128
buffer_load_dwordx4 v4, s[12:15], s52 offen lds
v_and_b32 v21, 31, v3
v_lshlrev_b32 v21, 3, v21
buffer_store_dwordx2 v[8:9], v21, s[32:35], s3 offen sc1
s_waitcnt lgkmcnt(8)
v_mfma_f32_32x32x16_bf16 v[32:47], a[176:179], v[152:155], v[32:47]
ds_read_b64_tr_b16 a[168:169], v1 offset:34816
ds_read_b64_tr_b16 a[170:171], v1 offset:35328
buffer_load_dwordx4 v5, s[12:15], s52 offen offset:1024 lds
v_mfma_f32_32x32x16_bf16 v[48:63], a[180:183], v[152:155], v[48:63]
ds_read_b64_tr_b16 a[172:173], v2 offset:34816
ds_read_b64_tr_b16 a[174:175], v2 offset:35328
s_mov_b32 s3, s62
s_lshl_b32 s3, s3, 2
s_add_u32 s3, s3, s60
s_waitcnt lgkmcnt(8)
v_mfma_f32_32x32x16_bf16 v[32:47], a[184:187], v[156:159], v[32:47]
ds_read_b64_tr_b16 a[176:177], v1 offset:36864
ds_read_b64_tr_b16 a[178:179], v1 offset:37376
v_cvt_pk_bf16_f32 v160, v64, v65
v_cvt_pk_bf16_f32 v161, v66, v67
v_cvt_pk_bf16_f32 v162, v68, v69
v_cvt_pk_bf16_f32 v163, v70, v71
v_mfma_f32_32x32x16_bf16 v[48:63], a[188:191], v[156:159], v[48:63]
ds_read_b64_tr_b16 a[180:181], v2 offset:36864
ds_read_b64_tr_b16 a[182:183], v2 offset:37376
v_cvt_pk_bf16_f32 v164, v72, v73
v_cvt_pk_bf16_f32 v165, v74, v75
v_cvt_pk_bf16_f32 v166, v76, v77
v_cvt_pk_bf16_f32 v167, v78, v79
v_mfma_f32_32x32x16_bf16 v[64:79], a[16:19], v[168:171], v[80:95]
buffer_load_dwordx4 v6, s[12:15], s52 offen offset:2048 lds
s_lshl_b32 s3, s3, 4
s_lshr_b32 s4, s44, 2
v_mfma_f32_32x32x16_bf16 v[64:79], a[20:23], v[172:175], v[64:79]
buffer_load_dwordx4 v7, s[12:15], s52 offen offset:3072 lds
s_add_u32 m0, s41, 114688
s_add_u32 s3, s3, s4
s_lshl_b32 s3, s3, 2
s_add_u32 s3, s3, s40
s_mul_i32 s3, s3, 896
v_min_u32 v28, 6, v3
v_add_lshl_u32 v28, v28, 0, 7
buffer_load_dword a223, v28, s[16:19], s3 offen
s_waitcnt lgkmcnt(8)
v_mfma_f32_32x32x16_bf16 v[32:47], a[160:163], v[160:163], v[32:47]
ds_read_b64_tr_b16 a[184:185], v1 offset:38912
ds_read_b64_tr_b16 a[186:187], v1 offset:39424
s_add_u32 s51, s63, 4
s_sub_u32 s52, s51, 10
s_cselect_b32 s51, s51, s52
s_mul_i32 s52, s51, s53
v_mfma_f32_32x32x16_bf16 v[48:63], a[164:167], v[160:163], v[48:63]
ds_read_b64_tr_b16 a[188:189], v2 offset:38912
ds_read_b64_tr_b16 a[190:191], v2 offset:39424
s_add_u32 s52, s52, s46
s_add_u32 s52, s52, 128
s_max_u32 s3, s62, 1
s_waitcnt lgkmcnt(8)
v_mfma_f32_32x32x16_bf16 v[32:47], a[168:171], v[164:167], v[32:47]
ds_read_b64_tr_b16 a[160:161], v1 offset:40960
ds_read_b64_tr_b16 a[162:163], v1 offset:41472
v_cvt_pk_bf16_f32 v168, v64, v65
v_cvt_pk_bf16_f32 v169, v66, v67
v_cvt_pk_bf16_f32 v170, v68, v69
v_cvt_pk_bf16_f32 v171, v70, v71
v_mfma_f32_32x32x16_bf16 v[48:63], a[172:175], v[164:167], v[48:63]
ds_read_b64_tr_b16 a[164:165], v2 offset:40960
ds_read_b64_tr_b16 a[166:167], v2 offset:41472
v_cvt_pk_bf16_f32 v172, v72, v73
v_cvt_pk_bf16_f32 v173, v74, v75
v_cvt_pk_bf16_f32 v174, v76, v77
v_cvt_pk_bf16_f32 v175, v78, v79
v_mfma_f32_32x32x16_bf16 v[64:79], a[16:19], v[176:179], v[80:95]
buffer_load_dwordx4 v4, s[12:15], s52 offen lds
s_sub_u32 s3, s3, 1
s_lshl_b32 s3, s3, 2
v_mfma_f32_32x32x16_bf16 v[64:79], a[20:23], v[180:183], v[64:79]
buffer_load_dwordx4 v5, s[12:15], s52 offen offset:1024 lds
s_add_u32 s3, s3, s60
s_lshl_b32 s3, s3, 4
s_lshr_b32 s4, s44, 2
s_add_u32 s3, s3, s4
s_lshl_b32 s3, s3, 2
s_add_u32 s3, s3, s40
s_mul_i32 s3, s3, 3200
v_min_u32 v28, 24, v3
v_add_lshl_u32 v28, v28, 0, 7
buffer_load_dword a223, v28, s[20:23], s3 offen
s_waitcnt lgkmcnt(8)
v_mfma_f32_32x32x16_bf16 v[32:47], a[176:179], v[168:171], v[32:47]
ds_read_b64_tr_b16 a[168:169], v1 offset:43008
ds_read_b64_tr_b16 a[170:171], v1 offset:43520
buffer_load_dwordx4 v6, s[12:15], s52 offen offset:2048 lds
v_mfma_f32_32x32x16_bf16 v[48:63], a[180:183], v[168:171], v[48:63]
ds_read_b64_tr_b16 a[172:173], v2 offset:43008
ds_read_b64_tr_b16 a[174:175], v2 offset:43520
s_waitcnt lgkmcnt(8)
v_mfma_f32_32x32x16_bf16 v[32:47], a[184:187], v[172:175], v[32:47]
ds_read_b64_tr_b16 a[176:177], v1 offset:45056
ds_read_b64_tr_b16 a[178:179], v1 offset:45568
v_cvt_pk_bf16_f32 v176, v64, v65
v_cvt_pk_bf16_f32 v177, v66, v67
v_cvt_pk_bf16_f32 v178, v68, v69
v_cvt_pk_bf16_f32 v179, v70, v71
v_mfma_f32_32x32x16_bf16 v[48:63], a[188:191], v[172:175], v[48:63]
ds_read_b64_tr_b16 a[180:181], v2 offset:45056
ds_read_b64_tr_b16 a[182:183], v2 offset:45568
v_cvt_pk_bf16_f32 v180, v72, v73
v_cvt_pk_bf16_f32 v181, v74, v75
v_cvt_pk_bf16_f32 v182, v76, v77
v_cvt_pk_bf16_f32 v183, v78, v79
v_mfma_f32_32x32x16_bf16 v[64:79], a[16:19], v[184:187], v[80:95]
buffer_load_dwordx4 v7, s[12:15], s52 offen offset:3072 lds
v_mfma_f32_32x32x16_bf16 v[64:79], a[20:23], v[188:191], v[64:79]
s_waitcnt lgkmcnt(8)
v_mfma_f32_32x32x16_bf16 v[32:47], a[160:163], v[176:179], v[32:47]
ds_read_b64_tr_b16 a[184:185], v1 offset:47104
ds_read_b64_tr_b16 a[186:187], v1 offset:47616
v_mfma_f32_32x32x16_bf16 v[48:63], a[164:167], v[176:179], v[48:63]
ds_read_b64_tr_b16 a[188:189], v2 offset:47104
ds_read_b64_tr_b16 a[190:191], v2 offset:47616
s_waitcnt lgkmcnt(8)
v_mfma_f32_32x32x16_bf16 v[32:47], a[168:171], v[180:183], v[32:47]
s_waitcnt vmcnt(20)
s_barrier
ds_read_b64_tr_b16 a[160:161], v1 offset:49152
ds_read_b64_tr_b16 a[162:163], v1 offset:49664
v_cvt_pk_bf16_f32 v184, v64, v65
v_cvt_pk_bf16_f32 v185, v66, v67
v_cvt_pk_bf16_f32 v186, v68, v69
v_cvt_pk_bf16_f32 v187, v70, v71
v_mfma_f32_32x32x16_bf16 v[48:63], a[172:175], v[180:183], v[48:63]
ds_read_b64_tr_b16 a[164:165], v2 offset:49152
ds_read_b64_tr_b16 a[166:167], v2 offset:49664
v_cvt_pk_bf16_f32 v188, v72, v73
v_cvt_pk_bf16_f32 v189, v74, v75
v_cvt_pk_bf16_f32 v190, v76, v77
v_cvt_pk_bf16_f32 v191, v78, v79
v_mfma_f32_32x32x16_bf16 v[64:79], a[16:19], v[192:195], v[80:95]
s_add_u32 m0, s41, 131072
s_add_u32 s51, s63, 6
s_sub_u32 s52, s51, 10
s_cselect_b32 s51, s51, s52
s_mul_i32 s52, s51, s53
s_add_u32 s52, s52, s46
v_mfma_f32_32x32x16_bf16 v[64:79], a[20:23], v[196:199], v[64:79]
s_add_u32 s52, s52, 128
buffer_load_dwordx4 v4, s[12:15], s52 offen lds
s_waitcnt lgkmcnt(8)
v_mfma_f32_32x32x16_bf16 v[32:47], a[176:179], v[184:187], v[32:47]
ds_read_b64_tr_b16 a[168:169], v1 offset:51200
ds_read_b64_tr_b16 a[170:171], v1 offset:51712
buffer_load_dwordx4 v5, s[12:15], s52 offen offset:1024 lds
v_mfma_f32_32x32x16_bf16 v[48:63], a[180:183], v[184:187], v[48:63]
ds_read_b64_tr_b16 a[172:173], v2 offset:51200
ds_read_b64_tr_b16 a[174:175], v2 offset:51712
s_waitcnt vmcnt(17)
v_cmp_eq_u32 vcc, 12, v26
v_mov_b32 v27, 1073741824
s_nop 0
v_cndmask_b32 v27, v27, v13, vcc
s_waitcnt lgkmcnt(8)
v_mfma_f32_32x32x16_bf16 v[32:47], a[184:187], v[188:191], v[32:47]
ds_read_b64_tr_b16 a[176:177], v1 offset:53248
ds_read_b64_tr_b16 a[178:179], v1 offset:53760
v_cvt_pk_bf16_f32 v192, v64, v65
v_cvt_pk_bf16_f32 v193, v66, v67
v_cvt_pk_bf16_f32 v194, v68, v69
v_cvt_pk_bf16_f32 v195, v70, v71
v_mfma_f32_32x32x16_bf16 v[48:63], a[188:191], v[188:191], v[48:63]
ds_read_b64_tr_b16 a[180:181], v2 offset:53248
ds_read_b64_tr_b16 a[182:183], v2 offset:53760
v_cvt_pk_bf16_f32 v196, v72, v73
v_cvt_pk_bf16_f32 v197, v74, v75
v_cvt_pk_bf16_f32 v198, v76, v77
v_cvt_pk_bf16_f32 v199, v78, v79
v_mfma_f32_32x32x16_bf16 v[64:79], a[16:19], v[200:203], v[80:95]
buffer_load_dwordx4 v6, s[12:15], s52 offen offset:2048 lds
v_mfma_f32_32x32x16_bf16 v[64:79], a[20:23], v[204:207], v[64:79]
buffer_load_dwordx4 v7, s[12:15], s52 offen offset:3072 lds
s_add_u32 m0, s41, 0
buffer_store_dword v14, v27, s[36:39], s2 offen offset:128 sc1
s_waitcnt lgkmcnt(8)
v_mfma_f32_32x32x16_bf16 v[32:47], a[160:163], v[192:195], v[32:47]
ds_read_b64_tr_b16 a[184:185], v1 offset:55296
ds_read_b64_tr_b16 a[186:187], v1 offset:55808
s_add_u32 s51, s63, 8
s_sub_u32 s52, s51, 10
s_cselect_b32 s51, s51, s52
s_mul_i32 s52, s51, s53
v_mfma_f32_32x32x16_bf16 v[48:63], a[164:167], v[192:195], v[48:63]
ds_read_b64_tr_b16 a[188:189], v2 offset:55296
ds_read_b64_tr_b16 a[190:191], v2 offset:55808
s_add_u32 s52, s52, s46
s_add_u32 s52, s52, 128
s_waitcnt lgkmcnt(8)
v_mfma_f32_32x32x16_bf16 v[32:47], a[168:171], v[196:199], v[32:47]
ds_read_b64_tr_b16 a[160:161], v1 offset:57344
ds_read_b64_tr_b16 a[162:163], v1 offset:57856
v_cvt_pk_bf16_f32 v200, v64, v65
v_cvt_pk_bf16_f32 v201, v66, v67
v_cvt_pk_bf16_f32 v202, v68, v69
v_cvt_pk_bf16_f32 v203, v70, v71
v_mfma_f32_32x32x16_bf16 v[48:63], a[172:175], v[196:199], v[48:63]
ds_read_b64_tr_b16 a[164:165], v2 offset:57344
ds_read_b64_tr_b16 a[166:167], v2 offset:57856
v_cvt_pk_bf16_f32 v204, v72, v73
v_cvt_pk_bf16_f32 v205, v74, v75
v_cvt_pk_bf16_f32 v206, v76, v77
v_cvt_pk_bf16_f32 v207, v78, v79
v_mfma_f32_32x32x16_bf16 v[64:79], a[16:19], v[208:211], v[80:95]
buffer_load_dwordx4 v4, s[12:15], s52 offen lds
v_mfma_f32_32x32x16_bf16 v[64:79], a[20:23], v[212:215], v[64:79]
buffer_load_dwordx4 v5, s[12:15], s52 offen offset:1024 lds
s_waitcnt lgkmcnt(8)
v_mfma_f32_32x32x16_bf16 v[32:47], a[176:179], v[200:203], v[32:47]
ds_read_b64_tr_b16 a[168:169], v1 offset:59392
ds_read_b64_tr_b16 a[170:171], v1 offset:59904
buffer_load_dwordx4 v6, s[12:15], s52 offen offset:2048 lds
v_mfma_f32_32x32x16_bf16 v[48:63], a[180:183], v[200:203], v[48:63]
ds_read_b64_tr_b16 a[172:173], v2 offset:59392
ds_read_b64_tr_b16 a[174:175], v2 offset:59904
s_waitcnt lgkmcnt(8)
v_mfma_f32_32x32x16_bf16 v[32:47], a[184:187], v[204:207], v[32:47]
ds_read_b64_tr_b16 a[176:177], v1 offset:61440
ds_read_b64_tr_b16 a[178:179], v1 offset:61952
v_cvt_pk_bf16_f32 v208, v64, v65
v_cvt_pk_bf16_f32 v209, v66, v67
v_cvt_pk_bf16_f32 v210, v68, v69
v_cvt_pk_bf16_f32 v211, v70, v71
v_mfma_f32_32x32x16_bf16 v[48:63], a[188:191], v[204:207], v[48:63]
ds_read_b64_tr_b16 a[180:181], v2 offset:61440
ds_read_b64_tr_b16 a[182:183], v2 offset:61952
v_cvt_pk_bf16_f32 v212, v72, v73
v_cvt_pk_bf16_f32 v213, v74, v75
v_cvt_pk_bf16_f32 v214, v76, v77
v_cvt_pk_bf16_f32 v215, v78, v79
v_mfma_f32_32x32x16_bf16 v[64:79], a[16:19], v[216:219], v[80:95]
buffer_load_dwordx4 v7, s[12:15], s52 offen offset:3072 lds
v_mfma_f32_32x32x16_bf16 v[64:79], a[20:23], v[220:223], v[64:79]
s_waitcnt lgkmcnt(8)
v_mfma_f32_32x32x16_bf16 v[32:47], a[160:163], v[208:211], v[32:47]
ds_read_b64_tr_b16 a[184:185], v1 offset:63488
ds_read_b64_tr_b16 a[186:187], v1 offset:64000
v_mfma_f32_32x32x16_bf16 v[48:63], a[164:167], v[208:211], v[48:63]
ds_read_b64_tr_b16 a[188:189], v2 offset:63488
ds_read_b64_tr_b16 a[190:191], v2 offset:64000
s_waitcnt lgkmcnt(8)
v_mfma_f32_32x32x16_bf16 v[32:47], a[168:171], v[212:215], v[32:47]
s_barrier
v_add_u32 v1, 65536, v1
v_add_u32 v2, 65536, v2
ds_read_b64_tr_b16 a[160:161], v1 offset:0
ds_read_b64_tr_b16 a[162:163], v1 offset:512
v_cvt_pk_bf16_f32 v216, v64, v65
v_cvt_pk_bf16_f32 v217, v66, v67
v_cvt_pk_bf16_f32 v218, v68, v69
v_cvt_pk_bf16_f32 v219, v70, v71
v_mfma_f32_32x32x16_bf16 v[48:63], a[172:175], v[212:215], v[48:63]
ds_read_b64_tr_b16 a[164:165], v2 offset:0
ds_read_b64_tr_b16 a[166:167], v2 offset:512
v_cvt_pk_bf16_f32 v220, v72, v73
v_cvt_pk_bf16_f32 v221, v74, v75
v_cvt_pk_bf16_f32 v222, v76, v77
v_cvt_pk_bf16_f32 v223, v78, v79
v_mfma_f32_32x32x16_bf16 v[64:79], a[16:19], v[224:227], v[80:95]
v_lshrrev_b32 v4, 2, v3
v_and_b32 v5, 3, v3
v_lshlrev_b32 v5, 4, v5
v_mad_u32_u24 v4, v4, s45, v5
s_lshl_b32 s53, s45, 4
s_sub_u32 s53, s53, 1024
v_mfma_f32_32x32x16_bf16 v[64:79], a[20:23], v[228:231], v[64:79]
v_add_u32 v5, s53, v4
v_add_u32 v6, s53, v5
v_add_u32 v7, s53, v6
s_lshl_b32 s53, s45, 6
s_add_u32 m0, s41, 16384
s_add_u32 s51, s63, s40
s_add_u32 s51, s51, 0
s_sub_u32 s52, s51, 10
s_cselect_b32 s51, s51, s52
s_mul_i32 s52, s51, s53
s_add_u32 s52, s52, s48
buffer_load_dwordx4 v4, s[12:15], s52 offen lds
s_waitcnt lgkmcnt(8)
v_mfma_f32_32x32x16_bf16 v[32:47], a[176:179], v[216:219], v[32:47]
ds_read_b64_tr_b16 a[168:169], v1 offset:2048
ds_read_b64_tr_b16 a[170:171], v1 offset:2560
v_mfma_f32_32x32x16_bf16 v[48:63], a[180:183], v[216:219], v[48:63]
ds_read_b64_tr_b16 a[172:173], v2 offset:2048
ds_read_b64_tr_b16 a[174:175], v2 offset:2560
s_waitcnt lgkmcnt(8)
v_mfma_f32_32x32x16_bf16 v[32:47], a[184:187], v[220:223], v[32:47]
ds_read_b64_tr_b16 a[176:177], v1 offset:4096
ds_read_b64_tr_b16 a[178:179], v1 offset:4608
v_cvt_pk_bf16_f32 v224, v64, v65
v_cvt_pk_bf16_f32 v225, v66, v67
v_cvt_pk_bf16_f32 v226, v68, v69
v_cvt_pk_bf16_f32 v227, v70, v71
v_mfma_f32_32x32x16_bf16 v[48:63], a[188:191], v[220:223], v[48:63]
ds_read_b64_tr_b16 a[180:181], v2 offset:4096
ds_read_b64_tr_b16 a[182:183], v2 offset:4608
v_cvt_pk_bf16_f32 v228, v72, v73
v_cvt_pk_bf16_f32 v229, v74, v75
v_cvt_pk_bf16_f32 v230, v76, v77
v_cvt_pk_bf16_f32 v231, v78, v79
v_mfma_f32_32x32x16_bf16 v[64:79], a[16:19], v[232:235], v[80:95]
buffer_load_dwordx4 v5, s[12:15], s52 offen offset:1024 lds
v_mfma_f32_32x32x16_bf16 v[64:79], a[20:23], v[236:239], v[64:79]
s_waitcnt lgkmcnt(8)
v_mfma_f32_32x32x16_bf16 v[32:47], a[160:163], v[224:227], v[32:47]
ds_read_b64_tr_b16 a[184:185], v1 offset:6144
ds_read_b64_tr_b16 a[186:187], v1 offset:6656
v_mfma_f32_32x32x16_bf16 v[48:63], a[164:167], v[224:227], v[48:63]
ds_read_b64_tr_b16 a[188:189], v2 offset:6144
ds_read_b64_tr_b16 a[190:191], v2 offset:6656
s_waitcnt lgkmcnt(8)
v_mfma_f32_32x32x16_bf16 v[32:47], a[168:171], v[228:231], v[32:47]
ds_read_b64_tr_b16 a[160:161], v1 offset:8192
ds_read_b64_tr_b16 a[162:163], v1 offset:8704
s_nop 0
v_cvt_pk_bf16_f32 v232, v64, v65
v_cvt_pk_bf16_f32 v233, v66, v67
v_cvt_pk_bf16_f32 v234, v68, v69
v_cvt_pk_bf16_f32 v235, v70, v71
v_mfma_f32_32x32x16_bf16 v[48:63], a[172:175], v[228:231], v[48:63]
ds_read_b64_tr_b16 a[164:165], v2 offset:8192
ds_read_b64_tr_b16 a[166:167], v2 offset:8704
v_cvt_pk_bf16_f32 v236, v72, v73
v_cvt_pk_bf16_f32 v237, v74, v75
v_cvt_pk_bf16_f32 v238, v76, v77
v_cvt_pk_bf16_f32 v239, v78, v79
v_mfma_f32_32x32x16_bf16 v[64:79], a[16:19], v[240:243], v[80:95]
buffer_load_dwordx4 v6, s[12:15], s52 offen offset:2048 lds
v_mfma_f32_32x32x16_bf16 v[64:79], a[20:23], v[244:247], v[64:79]
s_waitcnt lgkmcnt(8)
v_mfma_f32_32x32x16_bf16 v[32:47], a[176:179], v[232:235], v[32:47]
ds_read_b64_tr_b16 a[168:169], v1 offset:10240
ds_read_b64_tr_b16 a[170:171], v1 offset:10752
buffer_load_dwordx4 v7, s[12:15], s52 offen offset:3072 lds
v_mfma_f32_32x32x16_bf16 v[48:63], a[180:183], v[232:235], v[48:63]
ds_read_b64_tr_b16 a[172:173], v2 offset:10240
ds_read_b64_tr_b16 a[174:175], v2 offset:10752
s_waitcnt lgkmcnt(8)
v_mfma_f32_32x32x16_bf16 v[32:47], a[184:187], v[236:239], v[32:47]
ds_read_b64_tr_b16 a[176:177], v1 offset:12288
ds_read_b64_tr_b16 a[178:179], v1 offset:12800
v_cvt_pk_bf16_f32 v240, v64, v65
v_cvt_pk_bf16_f32 v241, v66, v67
v_cvt_pk_bf16_f32 v242, v68, v69
v_cvt_pk_bf16_f32 v243, v70, v71
v_mfma_f32_32x32x16_bf16 v[48:63], a[188:191], v[236:239], v[48:63]
ds_read_b64_tr_b16 a[180:181], v2 offset:12288
ds_read_b64_tr_b16 a[182:183], v2 offset:12800
v_cvt_pk_bf16_f32 v244, v72, v73
v_cvt_pk_bf16_f32 v245, v74, v75
v_cvt_pk_bf16_f32 v246, v76, v77
v_cvt_pk_bf16_f32 v247, v78, v79
v_mfma_f32_32x32x16_bf16 v[64:79], a[16:19], v[248:251], v[80:95]
v_mfma_f32_32x32x16_bf16 v[64:79], a[20:23], v[252:255], v[64:79]
s_waitcnt lgkmcnt(8)
v_mfma_f32_32x32x16_bf16 v[32:47], a[160:163], v[240:243], v[32:47]
ds_read_b64_tr_b16 a[184:185], v1 offset:14336
ds_read_b64_tr_b16 a[186:187], v1 offset:14848
v_mfma_f32_32x32x16_bf16 v[48:63], a[164:167], v[240:243], v[48:63]
ds_read_b64_tr_b16 a[188:189], v2 offset:14336
ds_read_b64_tr_b16 a[190:191], v2 offset:14848
s_waitcnt lgkmcnt(8)
v_mfma_f32_32x32x16_bf16 v[32:47], a[168:171], v[244:247], v[32:47]
s_waitcnt vmcnt(24)
s_barrier
ds_read_b64_tr_b16 a[160:161], v1 offset:16384
ds_read_b64_tr_b16 a[162:163], v1 offset:16896
v_cvt_pk_bf16_f32 v248, v64, v65
v_cvt_pk_bf16_f32 v249, v66, v67
v_cvt_pk_bf16_f32 v250, v68, v69
v_cvt_pk_bf16_f32 v251, v70, v71
v_mfma_f32_32x32x16_bf16 v[48:63], a[172:175], v[244:247], v[48:63]
ds_read_b64_tr_b16 a[164:165], v2 offset:16384
ds_read_b64_tr_b16 a[166:167], v2 offset:16896
v_cvt_pk_bf16_f32 v252, v72, v73
v_cvt_pk_bf16_f32 v253, v74, v75
v_cvt_pk_bf16_f32 v254, v76, v77
v_cvt_pk_bf16_f32 v255, v78, v79
s_waitcnt lgkmcnt(8)
v_mfma_f32_32x32x16_bf16 v[32:47], a[176:179], v[248:251], v[32:47]
ds_read_b64_tr_b16 a[168:169], v1 offset:18432
ds_read_b64_tr_b16 a[170:171], v1 offset:18944
s_add_u32 m0, s41, 32768
s_add_u32 s51, s63, s40
s_add_u32 s51, s51, 4
s_sub_u32 s52, s51, 10
s_cselect_b32 s51, s51, s52
v_mfma_f32_32x32x16_bf16 v[48:63], a[180:183], v[248:251], v[48:63]
ds_read_b64_tr_b16 a[172:173], v2 offset:18432
ds_read_b64_tr_b16 a[174:175], v2 offset:18944
s_mul_i32 s52, s51, s53
s_add_u32 s52, s52, s48
buffer_load_dwordx4 v4, s[12:15], s52 offen lds
s_waitcnt lgkmcnt(8)
v_mfma_f32_32x32x16_bf16 v[32:47], a[184:187], v[252:255], v[32:47]
ds_read_b64_tr_b16 a[176:177], v1 offset:20480
ds_read_b64_tr_b16 a[178:179], v1 offset:20992
buffer_load_dwordx4 v5, s[12:15], s52 offen offset:1024 lds
v_mfma_f32_32x32x16_bf16 v[48:63], a[188:191], v[252:255], v[48:63]
ds_read_b64_tr_b16 a[180:181], v2 offset:20480
ds_read_b64_tr_b16 a[182:183], v2 offset:20992
buffer_load_dwordx4 v6, s[12:15], s52 offen offset:2048 lds
buffer_load_dwordx4 v7, s[12:15], s52 offen offset:3072 lds
s_waitcnt lgkmcnt(8)
v_mfma_f32_32x32x16_bf16 v[64:79], a[160:163], v[96:99], 0
ds_read_b64_tr_b16 a[184:185], v1 offset:22528
ds_read_b64_tr_b16 a[186:187], v1 offset:23040
v_mfma_f32_32x32x16_bf16 v[80:95], a[164:167], v[96:99], 0
ds_read_b64_tr_b16 a[188:189], v2 offset:22528
ds_read_b64_tr_b16 a[190:191], v2 offset:23040
s_waitcnt lgkmcnt(8)
v_mfma_f32_32x32x16_bf16 v[64:79], a[168:171], v[100:103], v[64:79]
ds_read_b64_tr_b16 a[160:161], v1 offset:24576
ds_read_b64_tr_b16 a[162:163], v1 offset:25088
v_mul_f32 v32, v10, v32
v_mul_f32 v33, v10, v33
v_mul_f32 v34, v10, v34
v_mul_f32 v35, v10, v35
v_mfma_f32_32x32x16_bf16 v[80:95], a[172:175], v[100:103], v[80:95]
ds_read_b64_tr_b16 a[164:165], v2 offset:24576
ds_read_b64_tr_b16 a[166:167], v2 offset:25088
v_mul_f32 v36, v10, v36
v_mul_f32 v37, v10, v37
s_waitcnt lgkmcnt(8)
v_mfma_f32_32x32x16_bf16 v[64:79], a[176:179], v[104:107], v[64:79]
ds_read_b64_tr_b16 a[168:169], v1 offset:26624
ds_read_b64_tr_b16 a[170:171], v1 offset:27136
v_mul_f32 v38, v10, v38
v_mul_f32 v39, v10, v39
v_cvt_pk_bf16_f32 v32, v32, v33
v_cvt_pk_bf16_f32 v33, v34, v35
v_mfma_f32_32x32x16_bf16 v[80:95], a[180:183], v[104:107], v[80:95]
ds_read_b64_tr_b16 a[172:173], v2 offset:26624
ds_read_b64_tr_b16 a[174:175], v2 offset:27136
v_cvt_pk_bf16_f32 v34, v36, v37
v_cvt_pk_bf16_f32 v35, v38, v39
s_waitcnt lgkmcnt(8)
v_mfma_f32_32x32x16_bf16 v[64:79], a[184:187], v[108:111], v[64:79]
ds_read_b64_tr_b16 a[176:177], v1 offset:28672
ds_read_b64_tr_b16 a[178:179], v1 offset:29184
v_mfma_f32_32x32x16_bf16 v[80:95], a[188:191], v[108:111], v[80:95]
ds_read_b64_tr_b16 a[180:181], v2 offset:28672
ds_read_b64_tr_b16 a[182:183], v2 offset:29184
buffer_store_dwordx4 v[32:35], v0, s[32:35], s49 offen sc1
s_waitcnt lgkmcnt(8)
v_mfma_f32_32x32x16_bf16 v[64:79], a[160:163], v[112:115], v[64:79]
ds_read_b64_tr_b16 a[184:185], v1 offset:30720
ds_read_b64_tr_b16 a[186:187], v1 offset:31232
v_mul_f32 v40, v10, v40
v_mfma_f32_32x32x16_bf16 v[80:95], a[164:167], v[112:115], v[80:95]
ds_read_b64_tr_b16 a[188:189], v2 offset:30720
ds_read_b64_tr_b16 a[190:191], v2 offset:31232
v_mul_f32 v41, v10, v41
v_mul_f32 v42, v10, v42
s_waitcnt lgkmcnt(8)
v_mfma_f32_32x32x16_bf16 v[64:79], a[168:171], v[116:119], v[64:79]
s_waitcnt vmcnt(24)
s_barrier
ds_read_b64_tr_b16 a[160:161], v1 offset:32768
ds_read_b64_tr_b16 a[162:163], v1 offset:33280
s_add_u32 m0, s41, 49152
s_add_u32 s51, s63, s40
v_mfma_f32_32x32x16_bf16 v[80:95], a[172:175], v[116:119], v[80:95]
ds_read_b64_tr_b16 a[164:165], v2 offset:32768
ds_read_b64_tr_b16 a[166:167], v2 offset:33280
s_add_u32 s51, s51, 8
s_sub_u32 s52, s51, 10
s_cselect_b32 s51, s51, s52
s_waitcnt lgkmcnt(8)
v_mfma_f32_32x32x16_bf16 v[64:79], a[176:179], v[120:123], v[64:79]
ds_read_b64_tr_b16 a[168:169], v1 offset:34816
ds_read_b64_tr_b16 a[170:171], v1 offset:35328
s_mul_i32 s52, s51, s53
s_add_u32 s52, s52, s48
s_cmp_lt_u32 s40, 2
s_cselect_b32 s52, s52, 1073741824
v_mfma_f32_32x32x16_bf16 v[80:95], a[180:183], v[120:123], v[80:95]
ds_read_b64_tr_b16 a[172:173], v2 offset:34816
ds_read_b64_tr_b16 a[174:175], v2 offset:35328
buffer_load_dwordx4 v4, s[12:15], s52 offen lds
s_waitcnt lgkmcnt(8)
v_mfma_f32_32x32x16_bf16 v[64:79], a[184:187], v[124:127], v[64:79]
ds_read_b64_tr_b16 a[176:177], v1 offset:36864
ds_read_b64_tr_b16 a[178:179], v1 offset:37376
buffer_load_dwordx4 v5, s[12:15], s52 offen offset:1024 lds
v_mul_f32 v43, v10, v43
v_mfma_f32_32x32x16_bf16 v[80:95], a[188:191], v[124:127], v[80:95]
ds_read_b64_tr_b16 a[180:181], v2 offset:36864
ds_read_b64_tr_b16 a[182:183], v2 offset:37376
v_mul_f32 v44, v10, v44
v_mul_f32 v45, v10, v45
s_waitcnt lgkmcnt(8)
v_mfma_f32_32x32x16_bf16 v[64:79], a[160:163], v[128:131], v[64:79]
ds_read_b64_tr_b16 a[184:185], v1 offset:38912
ds_read_b64_tr_b16 a[186:187], v1 offset:39424
buffer_load_dwordx4 v6, s[12:15], s52 offen offset:2048 lds
v_mul_f32 v46, v10, v46
v_mfma_f32_32x32x16_bf16 v[80:95], a[164:167], v[128:131], v[80:95]
ds_read_b64_tr_b16 a[188:189], v2 offset:38912
ds_read_b64_tr_b16 a[190:191], v2 offset:39424
v_mul_f32 v47, v10, v47
v_cvt_pk_bf16_f32 v40, v40, v41
s_waitcnt lgkmcnt(8)
v_mfma_f32_32x32x16_bf16 v[64:79], a[168:171], v[132:135], v[64:79]
ds_read_b64_tr_b16 a[160:161], v1 offset:40960
ds_read_b64_tr_b16 a[162:163], v1 offset:41472
buffer_load_dwordx4 v7, s[12:15], s52 offen offset:3072 lds
v_mfma_f32_32x32x16_bf16 v[80:95], a[172:175], v[132:135], v[80:95]
ds_read_b64_tr_b16 a[164:165], v2 offset:40960
ds_read_b64_tr_b16 a[166:167], v2 offset:41472
s_movk_i32 s96, 1280
v_lshrrev_b32 v4, 3, v3
s_lshl_b32 s53, s40, 5
s_waitcnt lgkmcnt(8)
v_mfma_f32_32x32x16_bf16 v[64:79], a[176:179], v[136:139], v[64:79]
ds_read_b64_tr_b16 a[168:169], v1 offset:43008
ds_read_b64_tr_b16 a[170:171], v1 offset:43520
s_lshr_b32 s52, s40, 1
s_mul_i32 s52, s52, 128
s_add_u32 s53, s53, s52
v_add_u32 v4, s53, v4
v_bfe_u32 v5, v3, 4, 1
v_lshlrev_b32 v5, 2, v5
v_and_b32 v6, 7, v3
v_xor_b32 v5, v5, v6
v_lshlrev_b32 v5, 4, v5
v_mad_u32_u24 v4, v4, s96, v5
s_lshl_b32 s53, s96, 3
s_sub_u32 s53, s53, 1024
v_add_u32 v4, s56, v4
v_add_u32 v5, s53, v4
v_add_u32 v6, s53, v5
v_add_u32 v7, s53, v6
s_lshl_b32 s53, s96, 6
s_add_u32 m0, s41, 65536
s_add_u32 s52, s55, 0
buffer_load_dwordx4 v4, s[16:19], s52 offen lds
v_mfma_f32_32x32x16_bf16 v[80:95], a[180:183], v[136:139], v[80:95]
ds_read_b64_tr_b16 a[172:173], v2 offset:43008
ds_read_b64_tr_b16 a[174:175], v2 offset:43520
buffer_load_dwordx4 v5, s[16:19], s52 offen offset:1024 lds
s_waitcnt lgkmcnt(8)
v_mfma_f32_32x32x16_bf16 v[64:79], a[184:187], v[140:143], v[64:79]
ds_read_b64_tr_b16 a[176:177], v1 offset:45056
ds_read_b64_tr_b16 a[178:179], v1 offset:45568
buffer_load_dwordx4 v6, s[16:19], s52 offen offset:2048 lds
v_cvt_pk_bf16_f32 v41, v42, v43
v_mfma_f32_32x32x16_bf16 v[80:95], a[188:191], v[140:143], v[80:95]
ds_read_b64_tr_b16 a[180:181], v2 offset:45056
ds_read_b64_tr_b16 a[182:183], v2 offset:45568
v_cvt_pk_bf16_f32 v42, v44, v45
v_cvt_pk_bf16_f32 v43, v46, v47
s_waitcnt lgkmcnt(8)
v_mfma_f32_32x32x16_bf16 v[64:79], a[160:163], v[144:147], v[64:79]
ds_read_b64_tr_b16 a[184:185], v1 offset:47104
ds_read_b64_tr_b16 a[186:187], v1 offset:47616
buffer_load_dwordx4 v7, s[16:19], s52 offen offset:3072 lds
v_mfma_f32_32x32x16_bf16 v[80:95], a[164:167], v[144:147], v[80:95]
ds_read_b64_tr_b16 a[188:189], v2 offset:47104
ds_read_b64_tr_b16 a[190:191], v2 offset:47616
s_waitcnt lgkmcnt(8)
v_mfma_f32_32x32x16_bf16 v[64:79], a[168:171], v[148:151], v[64:79]
s_waitcnt vmcnt(26)
s_barrier
ds_read_b64_tr_b16 a[160:161], v1 offset:49152
ds_read_b64_tr_b16 a[162:163], v1 offset:49664
s_add_u32 m0, s41, 81920
s_add_u32 s52, s55, 409600
v_mfma_f32_32x32x16_bf16 v[80:95], a[172:175], v[148:151], v[80:95]
ds_read_b64_tr_b16 a[164:165], v2 offset:49152
ds_read_b64_tr_b16 a[166:167], v2 offset:49664
buffer_store_dwordx4 v[40:43], v0, s[32:35], s49 offen offset:1024 sc1
s_waitcnt lgkmcnt(8)
v_mfma_f32_32x32x16_bf16 v[64:79], a[176:179], v[152:155], v[64:79]
ds_read_b64_tr_b16 a[168:169], v1 offset:51200
ds_read_b64_tr_b16 a[170:171], v1 offset:51712
buffer_load_dwordx4 v4, s[16:19], s52 offen lds
v_mfma_f32_32x32x16_bf16 v[80:95], a[180:183], v[152:155], v[80:95]
ds_read_b64_tr_b16 a[172:173], v2 offset:51200
ds_read_b64_tr_b16 a[174:175], v2 offset:51712
s_waitcnt lgkmcnt(8)
v_mfma_f32_32x32x16_bf16 v[64:79], a[184:187], v[156:159], v[64:79]
ds_read_b64_tr_b16 a[176:177], v1 offset:53248
ds_read_b64_tr_b16 a[178:179], v1 offset:53760
buffer_load_dwordx4 v5, s[16:19], s52 offen offset:1024 lds
v_mfma_f32_32x32x16_bf16 v[80:95], a[188:191], v[156:159], v[80:95]
ds_read_b64_tr_b16 a[180:181], v2 offset:53248
ds_read_b64_tr_b16 a[182:183], v2 offset:53760
v_mul_f32 v48, v10, v48
v_mul_f32 v49, v10, v49
s_waitcnt lgkmcnt(8)
v_mfma_f32_32x32x16_bf16 v[64:79], a[160:163], v[160:163], v[64:79]
ds_read_b64_tr_b16 a[184:185], v1 offset:55296
ds_read_b64_tr_b16 a[186:187], v1 offset:55808
v_mul_f32 v50, v10, v50
v_mul_f32 v51, v10, v51
v_mul_f32 v52, v10, v52
v_mfma_f32_32x32x16_bf16 v[80:95], a[164:167], v[160:163], v[80:95]
ds_read_b64_tr_b16 a[188:189], v2 offset:55296
ds_read_b64_tr_b16 a[190:191], v2 offset:55808
v_mul_f32 v53, v10, v53
v_mul_f32 v54, v10, v54
v_mul_f32 v55, v10, v55
s_waitcnt lgkmcnt(8)
v_mfma_f32_32x32x16_bf16 v[64:79], a[168:171], v[164:167], v[64:79]
ds_read_b64_tr_b16 a[160:161], v1 offset:57344
ds_read_b64_tr_b16 a[162:163], v1 offset:57856
buffer_load_dwordx4 v6, s[16:19], s52 offen offset:2048 lds
v_mfma_f32_32x32x16_bf16 v[80:95], a[172:175], v[164:167], v[80:95]
ds_read_b64_tr_b16 a[164:165], v2 offset:57344
ds_read_b64_tr_b16 a[166:167], v2 offset:57856
v_cvt_pk_bf16_f32 v48, v48, v49
v_cvt_pk_bf16_f32 v49, v50, v51
v_cvt_pk_bf16_f32 v50, v52, v53
s_waitcnt lgkmcnt(8)
v_mfma_f32_32x32x16_bf16 v[64:79], a[176:179], v[168:171], v[64:79]
ds_read_b64_tr_b16 a[168:169], v1 offset:59392
ds_read_b64_tr_b16 a[170:171], v1 offset:59904
buffer_load_dwordx4 v7, s[16:19], s52 offen offset:3072 lds
v_mfma_f32_32x32x16_bf16 v[80:95], a[180:183], v[168:171], v[80:95]
ds_read_b64_tr_b16 a[172:173], v2 offset:59392
ds_read_b64_tr_b16 a[174:175], v2 offset:59904
v_cvt_pk_bf16_f32 v51, v54, v55
s_waitcnt lgkmcnt(8)
v_mfma_f32_32x32x16_bf16 v[64:79], a[184:187], v[172:175], v[64:79]
ds_read_b64_tr_b16 a[176:177], v1 offset:61440
ds_read_b64_tr_b16 a[178:179], v1 offset:61952
buffer_store_dwordx4 v[48:51], v0, s[32:35], s49 offen offset:2048 sc1
v_mfma_f32_32x32x16_bf16 v[80:95], a[188:191], v[172:175], v[80:95]
ds_read_b64_tr_b16 a[180:181], v2 offset:61440
ds_read_b64_tr_b16 a[182:183], v2 offset:61952
s_waitcnt lgkmcnt(8)
v_mfma_f32_32x32x16_bf16 v[64:79], a[160:163], v[176:179], v[64:79]
ds_read_b64_tr_b16 a[184:185], v1 offset:63488
ds_read_b64_tr_b16 a[186:187], v1 offset:64000
s_getpc_b64 s[86:87]
L_pc5:
s_lshl_b32 s3, s42, 3
s_xor_b32 s3, s3, s43
s_lshl_b32 s3, s3, 2
v_mfma_f32_32x32x16_bf16 v[80:95], a[164:167], v[176:179], v[80:95]
ds_read_b64_tr_b16 a[188:189], v2 offset:63488
ds_read_b64_tr_b16 a[190:191], v2 offset:64000
s_add_u32 s3, s3, s40
s_mul_i32 s3, s3, 8
s_and_b32 s3, s3, 1023
s_waitcnt lgkmcnt(8)
v_mfma_f32_32x32x16_bf16 v[64:79], a[168:171], v[180:183], v[64:79]
s_waitcnt vmcnt(28)
s_barrier
v_add_u32 v1, 65536, v1
v_add_u32 v2, 65536, v2
ds_read_b64_tr_b16 a[160:161], v1 offset:0
ds_read_b64_tr_b16 a[162:163], v1 offset:512
v_mfma_f32_32x32x16_bf16 v[80:95], a[172:175], v[180:183], v[80:95]
ds_read_b64_tr_b16 a[164:165], v2 offset:0
ds_read_b64_tr_b16 a[166:167], v2 offset:512
s_add_u32 m0, s41, 98304
s_add_u32 s52, s55, 81920
v_min_u32 v26, 7, v3
v_add_lshl_u32 v26, v26, s3, 7
v_min_u32 v26, L_codeend-L_pc5-4, v26
v_and_b32 v26, -4, v26
global_load_dword a223, v26, s[86:87]
s_waitcnt lgkmcnt(8)
v_mfma_f32_32x32x16_bf16 v[64:79], a[176:179], v[184:187], v[64:79]
ds_read_b64_tr_b16 a[168:169], v1 offset:2048
ds_read_b64_tr_b16 a[170:171], v1 offset:2560
buffer_load_dwordx4 v4, s[16:19], s52 offen lds
v_mfma_f32_32x32x16_bf16 v[80:95], a[180:183], v[184:187], v[80:95]
ds_read_b64_tr_b16 a[172:173], v2 offset:2048
ds_read_b64_tr_b16 a[174:175], v2 offset:2560
v_mul_f32 v56, v10, v56
s_waitcnt lgkmcnt(8)
v_mfma_f32_32x32x16_bf16 v[64:79], a[184:187], v[188:191], v[64:79]
ds_read_b64_tr_b16 a[176:177], v1 offset:4096
ds_read_b64_tr_b16 a[178:179], v1 offset:4608
buffer_load_dwordx4 v5, s[16:19], s52 offen offset:1024 lds
v_mfma_f32_32x32x16_bf16 v[80:95], a[188:191], v[188:191], v[80:95]
ds_read_b64_tr_b16 a[180:181], v2 offset:4096
ds_read_b64_tr_b16 a[182:183], v2 offset:4608
v_mul_f32 v57, v10, v57
v_mul_f32 v58, v10, v58
v_mul_f32 v59, v10, v59
s_waitcnt lgkmcnt(8)
v_mfma_f32_32x32x16_bf16 v[64:79], a[160:163], v[192:195], v[64:79]
ds_read_b64_tr_b16 a[184:185], v1 offset:6144
ds_read_b64_tr_b16 a[186:187], v1 offset:6656
v_mul_f32 v60, v10, v60
v_mul_f32 v61, v10, v61
v_mul_f32 v62, v10, v62
v_mul_f32 v63, v10, v63
v_mfma_f32_32x32x16_bf16 v[80:95], a[164:167], v[192:195], v[80:95]
ds_read_b64_tr_b16 a[188:189], v2 offset:6144
ds_read_b64_tr_b16 a[190:191], v2 offset:6656
v_cvt_pk_bf16_f32 v56, v56, v57
v_cvt_pk_bf16_f32 v57, v58, v59
s_waitcnt lgkmcnt(8)
v_mfma_f32_32x32x16_bf16 v[64:79], a[168:171], v[196:199], v[64:79]
ds_read_b64_tr_b16 a[160:161], v1 offset:8192
ds_read_b64_tr_b16 a[162:163], v1 offset:8704
buffer_load_dwordx4 v6, s[16:19], s52 offen offset:2048 lds
v_mfma_f32_32x32x16_bf16 v[80:95], a[172:175], v[196:199], v[80:95]
ds_read_b64_tr_b16 a[164:165], v2 offset:8192
ds_read_b64_tr_b16 a[166:167], v2 offset:8704
v_cvt_pk_bf16_f32 v58, v60, v61
v_cvt_pk_bf16_f32 v59, v62, v63
s_waitcnt lgkmcnt(8)
v_mfma_f32_32x32x16_bf16 v[64:79], a[176:179], v[200:203], v[64:79]
ds_read_b64_tr_b16 a[168:169], v1 offset:10240
ds_read_b64_tr_b16 a[170:171], v1 offset:10752
buffer_load_dwordx4 v7, s[16:19], s52 offen offset:3072 lds
v_mfma_f32_32x32x16_bf16 v[80:95], a[180:183], v[200:203], v[80:95]
ds_read_b64_tr_b16 a[172:173], v2 offset:10240
ds_read_b64_tr_b16 a[174:175], v2 offset:10752
v_bfe_u32 v30, v3, 2, 2
v_lshrrev_b32 v31, 5, v3
v_lshl_add_u32 v30, v31, 3, v30
s_waitcnt lgkmcnt(8)
v_mfma_f32_32x32x16_bf16 v[64:79], a[184:187], v[204:207], v[64:79]
ds_read_b64_tr_b16 a[176:177], v1 offset:12288
ds_read_b64_tr_b16 a[178:179], v1 offset:12800
v_lshlrev_b32 v31, 6, v30
v_bfe_u32 v30, v3, 4, 1
v_lshl_add_u32 v31, v30, 5, v31
v_and_b32 v30, 3, v3
v_mfma_f32_32x32x16_bf16 v[80:95], a[188:191], v[204:207], v[80:95]
ds_read_b64_tr_b16 a[180:181], v2 offset:12288
ds_read_b64_tr_b16 a[182:183], v2 offset:12800
v_lshl_add_u32 v31, v30, 3, v31
s_waitcnt lgkmcnt(8)
v_mfma_f32_32x32x16_bf16 v[64:79], a[160:163], v[208:211], v[64:79]
ds_read_b64_tr_b16 a[184:185], v1 offset:14336
ds_read_b64_tr_b16 a[186:187], v1 offset:14848
buffer_store_dwordx4 v[56:59], v0, s[32:35], s49 offen offset:3072 sc1
v_mfma_f32_32x32x16_bf16 v[80:95], a[164:167], v[208:211], v[80:95]
ds_read_b64_tr_b16 a[188:189], v2 offset:14336
ds_read_b64_tr_b16 a[190:191], v2 offset:14848
s_waitcnt lgkmcnt(8)
v_mfma_f32_32x32x16_bf16 v[64:79], a[168:171], v[212:215], v[64:79]
s_waitcnt vmcnt(29)
s_barrier
v_subrev_u32 v1, 131072, v1
v_subrev_u32 v2, 131072, v2
ds_read_b64_tr_b16 a[160:161], v1 offset:0
ds_read_b64_tr_b16 a[162:163], v1 offset:512
v_mfma_f32_32x32x16_bf16 v[80:95], a[172:175], v[212:215], v[80:95]
ds_read_b64_tr_b16 a[164:165], v2 offset:0
ds_read_b64_tr_b16 a[166:167], v2 offset:512
s_add_u32 m0, s41, 114688
s_add_u32 s52, s55, 491520
s_waitcnt lgkmcnt(8)
v_mfma_f32_32x32x16_bf16 v[64:79], a[176:179], v[216:219], v[64:79]
ds_read_b64_tr_b16 a[168:169], v1 offset:2048
ds_read_b64_tr_b16 a[170:171], v1 offset:2560
buffer_load_dwordx4 v4, s[16:19], s52 offen lds
v_mfma_f32_32x32x16_bf16 v[80:95], a[180:183], v[216:219], v[80:95]
ds_read_b64_tr_b16 a[172:173], v2 offset:2048
ds_read_b64_tr_b16 a[174:175], v2 offset:2560
s_waitcnt lgkmcnt(8)
v_mfma_f32_32x32x16_bf16 v[64:79], a[184:187], v[220:223], v[64:79]
ds_read_b64_tr_b16 a[176:177], v1 offset:4096
ds_read_b64_tr_b16 a[178:179], v1 offset:4608
buffer_load_dwordx4 v5, s[16:19], s52 offen offset:1024 lds
v_mfma_f32_32x32x16_bf16 v[80:95], a[188:191], v[220:223], v[80:95]
ds_read_b64_tr_b16 a[180:181], v2 offset:4096
ds_read_b64_tr_b16 a[182:183], v2 offset:4608
buffer_load_dword v29, off, s[36:39], 0 offset:128 sc1
s_waitcnt lgkmcnt(8)
v_mfma_f32_32x32x16_bf16 v[64:79], a[160:163], v[224:227], v[64:79]
ds_read_b64_tr_b16 a[184:185], v1 offset:6144
ds_read_b64_tr_b16 a[186:187], v1 offset:6656
v_mfma_f32_32x32x16_bf16 v[80:95], a[164:167], v[224:227], v[80:95]
ds_read_b64_tr_b16 a[188:189], v2 offset:6144
ds_read_b64_tr_b16 a[190:191], v2 offset:6656
s_waitcnt lgkmcnt(8)
v_mfma_f32_32x32x16_bf16 v[64:79], a[168:171], v[228:231], v[64:79]
ds_read_b64_tr_b16 a[160:161], v1 offset:8192
ds_read_b64_tr_b16 a[162:163], v1 offset:8704
buffer_load_dwordx4 v6, s[16:19], s52 offen offset:2048 lds
v_mfma_f32_32x32x16_bf16 v[80:95], a[172:175], v[228:231], v[80:95]
ds_read_b64_tr_b16 a[164:165], v2 offset:8192
ds_read_b64_tr_b16 a[166:167], v2 offset:8704
s_waitcnt lgkmcnt(8)
v_mfma_f32_32x32x16_bf16 v[64:79], a[176:179], v[232:235], v[64:79]
ds_read_b64_tr_b16 a[168:169], v1 offset:10240
ds_read_b64_tr_b16 a[170:171], v1 offset:10752
buffer_load_dwordx4 v7, s[16:19], s52 offen offset:3072 lds
v_mfma_f32_32x32x16_bf16 v[80:95], a[180:183], v[232:235], v[80:95]
ds_read_b64_tr_b16 a[172:173], v2 offset:10240
ds_read_b64_tr_b16 a[174:175], v2 offset:10752
s_waitcnt lgkmcnt(8)
v_mfma_f32_32x32x16_bf16 v[64:79], a[184:187], v[236:239], v[64:79]
ds_read_b64_tr_b16 a[176:177], v1 offset:12288
ds_read_b64_tr_b16 a[178:179], v1 offset:12800
v_mfma_f32_32x32x16_bf16 v[80:95], a[188:191], v[236:239], v[80:95]
ds_read_b64_tr_b16 a[180:181], v2 offset:12288
ds_read_b64_tr_b16 a[182:183], v2 offset:12800
s_waitcnt lgkmcnt(8)
v_mfma_f32_32x32x16_bf16 v[64:79], a[160:163], v[240:243], v[64:79]
ds_read_b64_tr_b16 a[184:185], v1 offset:14336
ds_read_b64_tr_b16 a[186:187], v1 offset:14848
v_mfma_f32_32x32x16_bf16 v[80:95], a[164:167], v[240:243], v[80:95]
ds_read_b64_tr_b16 a[188:189], v2 offset:14336
ds_read_b64_tr_b16 a[190:191], v2 offset:14848
s_waitcnt lgkmcnt(8)
v_mfma_f32_32x32x16_bf16 v[64:79], a[168:171], v[244:247], v[64:79]
s_waitcnt vmcnt(30)
s_barrier
v_add_u32 v1, 0, v31
ds_read_b64_tr_b16 a[160:161], v1 offset:16384
ds_read_b64_tr_b16 a[162:163], v1 offset:16640
s_movk_i32 s96, 1280
v_mfma_f32_32x32x16_bf16 v[80:95], a[172:175], v[244:247], v[80:95]
v_lshrrev_b32 v4, 3, v3
s_lshl_b32 s53, s40, 5
s_lshr_b32 s52, s40, 1
s_mul_i32 s52, s52, 256
s_add_u32 s53, s53, s52
s_waitcnt lgkmcnt(6)
v_mfma_f32_32x32x16_bf16 v[64:79], a[176:179], v[248:251], v[64:79]
ds_read_b64_tr_b16 a[168:169], v1 offset:17408
ds_read_b64_tr_b16 a[170:171], v1 offset:17664
v_add_u32 v4, s53, v4
v_bfe_u32 v5, v3, 4, 1
v_lshlrev_b32 v5, 2, v5
v_and_b32 v6, 7, v3
v_mfma_f32_32x32x16_bf16 v[80:95], a[180:183], v[248:251], v[80:95]
v_xor_b32 v5, v5, v6
v_lshlrev_b32 v5, 4, v5
v_mad_u32_u24 v4, v4, s96, v5
s_lshl_b32 s53, s96, 3
s_sub_u32 s53, s53, 1024
v_add_u32 v4, s56, v4
v_add_u32 v5, s53, v4
v_add_u32 v6, s53, v5
v_add_u32 v7, s53, v6
s_lshl_b32 s53, s96, 6
s_add_u32 m0, s41, 131072
s_add_u32 s52, s55, 163840
buffer_load_dwordx4 v4, s[16:19], s52 offen lds
s_waitcnt lgkmcnt(4)
v_mfma_f32_32x32x16_bf16 v[64:79], a[184:187], v[252:255], v[64:79]
ds_read_b64_tr_b16 a[176:177], v1 offset:18432
ds_read_b64_tr_b16 a[178:179], v1 offset:18688
buffer_load_dwordx4 v5, s[16:19], s52 offen offset:1024 lds
v_mfma_f32_32x32x16_bf16 v[80:95], a[188:191], v[252:255], v[80:95]
buffer_load_dwordx4 v6, s[16:19], s52 offen offset:2048 lds
buffer_load_dwordx4 v7, s[16:19], s52 offen offset:3072 lds
s_waitcnt vmcnt(6)
v_cmp_gt_u32 vcc, 1, v29
s_nop 1
s_cbranch_vccnz L_pw2
L_pr4:
s_waitcnt lgkmcnt(4)
v_mfma_f32_32x32x16_bf16 v[32:47], a[160:163], v[96:99], 0
ds_read_b64_tr_b16 a[184:185], v1 offset:19456
ds_read_b64_tr_b16 a[186:187], v1 offset:19712
s_waitcnt lgkmcnt(4)
v_mfma_f32_32x32x16_bf16 v[32:47], a[168:171], v[100:103], v[32:47]
ds_read_b64_tr_b16 a[160:161], v1 offset:20480
ds_read_b64_tr_b16 a[162:163], v1 offset:20736
s_waitcnt lgkmcnt(4)
v_mfma_f32_32x32x16_bf16 v[32:47], a[176:179], v[104:107], v[32:47]
ds_read_b64_tr_b16 a[168:169], v1 offset:21504
ds_read_b64_tr_b16 a[170:171], v1 offset:21760
v_mul_f32 v64, v10, v64
v_mul_f32 v65, v10, v65
v_mul_f32 v66, v10, v66
v_mul_f32 v67, v10, v67
s_waitcnt lgkmcnt(4)
v_mfma_f32_32x32x16_bf16 v[32:47], a[184:187], v[108:111], v[32:47]
ds_read_b64_tr_b16 a[176:177], v1 offset:22528
ds_read_b64_tr_b16 a[178:179], v1 offset:22784
v_mul_f32 v68, v10, v68
v_mul_f32 v69, v10, v69
v_mul_f32 v70, v10, v70
s_waitcnt lgkmcnt(4)
v_mfma_f32_32x32x16_bf16 v[32:47], a[160:163], v[112:115], v[32:47]
ds_read_b64_tr_b16 a[184:185], v1 offset:23552
ds_read_b64_tr_b16 a[186:187], v1 offset:23808
v_mul_f32 v71, v10, v71
v_cvt_pk_bf16_f32 v64, v64, v65
v_cvt_pk_bf16_f32 v65, v66, v67
v_cvt_pk_bf16_f32 v66, v68, v69
s_waitcnt lgkmcnt(4)
v_mfma_f32_32x32x16_bf16 v[32:47], a[168:171], v[116:119], v[32:47]
ds_read_b64_tr_b16 a[160:161], v1 offset:24576
ds_read_b64_tr_b16 a[162:163], v1 offset:24832
buffer_atomic_add v14, v13, s[32:35], s79 offen sc1
s_waitcnt lgkmcnt(4)
v_mfma_f32_32x32x16_bf16 v[32:47], a[176:179], v[120:123], v[32:47]
ds_read_b64_tr_b16 a[168:169], v1 offset:25600
ds_read_b64_tr_b16 a[170:171], v1 offset:25856
v_cvt_pk_bf16_f32 v67, v70, v71
s_waitcnt lgkmcnt(4)
v_mfma_f32_32x32x16_bf16 v[32:47], a[184:187], v[124:127], v[32:47]
ds_read_b64_tr_b16 a[176:177], v1 offset:26624
ds_read_b64_tr_b16 a[178:179], v1 offset:26880
buffer_store_dwordx4 v[64:67], v0, s[32:35], s7 offen sc1
s_waitcnt lgkmcnt(4)
v_mfma_f32_32x32x16_bf16 v[32:47], a[160:163], v[128:131], v[32:47]
ds_read_b64_tr_b16 a[184:185], v1 offset:27648
ds_read_b64_tr_b16 a[186:187], v1 offset:27904
s_waitcnt lgkmcnt(4)
v_mfma_f32_32x32x16_bf16 v[32:47], a[168:171], v[132:135], v[32:47]
ds_read_b64_tr_b16 a[160:161], v1 offset:28672
ds_read_b64_tr_b16 a[162:163], v1 offset:28928
v_mul_f32 v72, v10, v72
v_mul_f32 v73, v10, v73
v_mul_f32 v74, v10, v74
v_mul_f32 v75, v10, v75
s_waitcnt lgkmcnt(4)
v_mfma_f32_32x32x16_bf16 v[32:47], a[176:179], v[136:139], v[32:47]
ds_read_b64_tr_b16 a[168:169], v1 offset:29696
ds_read_b64_tr_b16 a[170:171], v1 offset:29952
v_mul_f32 v76, v10, v76
v_mul_f32 v77, v10, v77
v_mul_f32 v78, v10, v78
s_waitcnt lgkmcnt(4)
v_mfma_f32_32x32x16_bf16 v[32:47], a[184:187], v[140:143], v[32:47]
ds_read_b64_tr_b16 a[176:177], v1 offset:30720
ds_read_b64_tr_b16 a[178:179], v1 offset:30976
v_mul_f32 v79, v10, v79
v_cvt_pk_bf16_f32 v72, v72, v73
v_cvt_pk_bf16_f32 v73, v74, v75
v_cvt_pk_bf16_f32 v74, v76, v77
s_waitcnt lgkmcnt(4)
v_mfma_f32_32x32x16_bf16 v[32:47], a[160:163], v[144:147], v[32:47]
ds_read_b64_tr_b16 a[184:185], v1 offset:31744
ds_read_b64_tr_b16 a[186:187], v1 offset:32000
v_cvt_pk_bf16_f32 v75, v78, v79
s_waitcnt lgkmcnt(4)
v_mfma_f32_32x32x16_bf16 v[32:47], a[168:171], v[148:151], v[32:47]
s_barrier
ds_read_b64_tr_b16 a[160:161], v1 offset:32768
ds_read_b64_tr_b16 a[162:163], v1 offset:33024
s_waitcnt lgkmcnt(4)
v_mfma_f32_32x32x16_bf16 v[32:47], a[176:179], v[152:155], v[32:47]
ds_read_b64_tr_b16 a[168:169], v1 offset:33792
ds_read_b64_tr_b16 a[170:171], v1 offset:34048
buffer_store_dwordx4 v[72:75], v0, s[32:35], s7 offen offset:1024 sc1
s_waitcnt lgkmcnt(4)
v_mfma_f32_32x32x16_bf16 v[32:47], a[184:187], v[156:159], v[32:47]
ds_read_b64_tr_b16 a[176:177], v1 offset:34816
ds_read_b64_tr_b16 a[178:179], v1 offset:35072
v_mul_f32 v80, v10, v80
v_mul_f32 v81, v10, v81
s_waitcnt lgkmcnt(4)
v_mfma_f32_32x32x16_bf16 v[32:47], a[160:163], v[160:163], v[32:47]
ds_read_b64_tr_b16 a[184:185], v1 offset:35840
ds_read_b64_tr_b16 a[186:187], v1 offset:36096
v_mul_f32 v82, v10, v82
v_mul_f32 v83, v10, v83
v_mul_f32 v84, v10, v84
s_waitcnt lgkmcnt(4)
v_mfma_f32_32x32x16_bf16 v[32:47], a[168:171], v[164:167], v[32:47]
ds_read_b64_tr_b16 a[160:161], v1 offset:36864
ds_read_b64_tr_b16 a[162:163], v1 offset:37120
v_mul_f32 v85, v10, v85
v_mul_f32 v86, v10, v86
v_mul_f32 v87, v10, v87
v_cvt_pk_bf16_f32 v80, v80, v81
s_waitcnt lgkmcnt(4)
v_mfma_f32_32x32x16_bf16 v[32:47], a[176:179], v[168:171], v[32:47]
ds_read_b64_tr_b16 a[168:169], v1 offset:37888
ds_read_b64_tr_b16 a[170:171], v1 offset:38144
v_cvt_pk_bf16_f32 v81, v82, v83
v_cvt_pk_bf16_f32 v82, v84, v85
v_cvt_pk_bf16_f32 v83, v86, v87
s_waitcnt lgkmcnt(4)
v_mfma_f32_32x32x16_bf16 v[32:47], a[184:187], v[172:175], v[32:47]
ds_read_b64_tr_b16 a[176:177], v1 offset:38912
ds_read_b64_tr_b16 a[178:179], v1 offset:39168
s_waitcnt lgkmcnt(4)
v_mfma_f32_32x32x16_bf16 v[32:47], a[160:163], v[176:179], v[32:47]
ds_read_b64_tr_b16 a[184:185], v1 offset:39936
ds_read_b64_tr_b16 a[186:187], v1 offset:40192
v_accvgpr_read_b32 v20, a204
v_accvgpr_read_b32 v21, a205
v_accvgpr_read_b32 v22, a206
s_waitcnt lgkmcnt(4)
v_mfma_f32_32x32x16_bf16 v[32:47], a[168:171], v[180:183], v[32:47]
ds_read_b64_tr_b16 a[160:161], v1 offset:40960
ds_read_b64_tr_b16 a[162:163], v1 offset:41216
v_accvgpr_read_b32 v23, a207
s_add_u32 m0, s41, 147456
s_nop 0
buffer_load_dwordx4 v20, s[8:11], s55 offen lds
buffer_load_dwordx4 v21, s[8:11], s55 offen offset:1024 lds
buffer_load_dwordx4 v22, s[8:11], s55 offen offset:2048 lds
buffer_load_dwordx4 v23, s[8:11], s55 offen offset:3072 lds
s_waitcnt lgkmcnt(4)
v_mfma_f32_32x32x16_bf16 v[32:47], a[176:179], v[184:187], v[32:47]
ds_read_b64_tr_b16 a[168:169], v1 offset:41984
ds_read_b64_tr_b16 a[170:171], v1 offset:42240
buffer_store_dwordx4 v[80:83], v0, s[32:35], s7 offen offset:2048 sc1
s_waitcnt lgkmcnt(4)
v_mfma_f32_32x32x16_bf16 v[32:47], a[184:187], v[188:191], v[32:47]
ds_read_b64_tr_b16 a[176:177], v1 offset:43008
ds_read_b64_tr_b16 a[178:179], v1 offset:43264
v_mul_f32 v88, v10, v88
v_mul_f32 v89, v10, v89
s_waitcnt lgkmcnt(4)
v_mfma_f32_32x32x16_bf16 v[32:47], a[160:163], v[192:195], v[32:47]
ds_read_b64_tr_b16 a[184:185], v1 offset:44032
ds_read_b64_tr_b16 a[186:187], v1 offset:44288
v_mul_f32 v90, v10, v90
v_mul_f32 v91, v10, v91
v_mul_f32 v92, v10, v92
v_mul_f32 v93, v10, v93
s_waitcnt lgkmcnt(4)
v_mfma_f32_32x32x16_bf16 v[32:47], a[168:171], v[196:199], v[32:47]
ds_read_b64_tr_b16 a[160:161], v1 offset:45056
ds_read_b64_tr_b16 a[162:163], v1 offset:45312
v_mul_f32 v94, v10, v94
v_mul_f32 v95, v10, v95
v_cvt_pk_bf16_f32 v88, v88, v89
s_waitcnt lgkmcnt(4)
v_mfma_f32_32x32x16_bf16 v[32:47], a[176:179], v[200:203], v[32:47]
ds_read_b64_tr_b16 a[168:169], v1 offset:46080
ds_read_b64_tr_b16 a[170:171], v1 offset:46336
v_cvt_pk_bf16_f32 v89, v90, v91
v_cvt_pk_bf16_f32 v90, v92, v93
v_cvt_pk_bf16_f32 v91, v94, v95
s_waitcnt lgkmcnt(4)
v_mfma_f32_32x32x16_bf16 v[32:47], a[184:187], v[204:207], v[32:47]
ds_read_b64_tr_b16 a[176:177], v1 offset:47104
ds_read_b64_tr_b16 a[178:179], v1 offset:47360
s_waitcnt lgkmcnt(4)
v_mfma_f32_32x32x16_bf16 v[32:47], a[160:163], v[208:211], v[32:47]
ds_read_b64_tr_b16 a[184:185], v1 offset:48128
ds_read_b64_tr_b16 a[186:187], v1 offset:48384
buffer_store_dwordx4 v[88:91], v0, s[32:35], s7 offen offset:3072 sc1
s_waitcnt lgkmcnt(4)
v_mfma_f32_32x32x16_bf16 v[32:47], a[168:171], v[212:215], v[32:47]
s_barrier
ds_read_b64_tr_b16 a[160:161], v1 offset:49152
ds_read_b64_tr_b16 a[162:163], v1 offset:49408
s_waitcnt lgkmcnt(4)
v_mfma_f32_32x32x16_bf16 v[32:47], a[176:179], v[216:219], v[32:47]
ds_read_b64_tr_b16 a[168:169], v1 offset:50176
ds_read_b64_tr_b16 a[170:171], v1 offset:50432
s_lshl_b32 s6, s54, 9
s_waitcnt lgkmcnt(4)
v_mfma_f32_32x32x16_bf16 v[32:47], a[184:187], v[220:223], v[32:47]
ds_read_b64_tr_b16 a[176:177], v1 offset:51200
ds_read_b64_tr_b16 a[178:179], v1 offset:51456
buffer_load_dword v29, off, s[32:35], s6 sc1
s_mul_i32 s4, s54, 40960
s_add_u32 s4, s4, 655360
s_mul_i32 s3, s61, 5
s_cmp_eq_u32 s61, 0
s_cselect_b32 s4, 1073741824, s4
s_waitcnt lgkmcnt(4)
v_mfma_f32_32x32x16_bf16 v[32:47], a[160:163], v[224:227], v[32:47]
ds_read_b64_tr_b16 a[184:185], v1 offset:52224
ds_read_b64_tr_b16 a[186:187], v1 offset:52480
s_waitcnt lgkmcnt(4)
v_mfma_f32_32x32x16_bf16 v[32:47], a[168:171], v[228:231], v[32:47]
ds_read_b64_tr_b16 a[160:161], v1 offset:53248
ds_read_b64_tr_b16 a[162:163], v1 offset:53504
s_waitcnt lgkmcnt(4)
v_mfma_f32_32x32x16_bf16 v[32:47], a[176:179], v[232:235], v[32:47]
ds_read_b64_tr_b16 a[168:169], v1 offset:54272
ds_read_b64_tr_b16 a[170:171], v1 offset:54528
s_waitcnt lgkmcnt(4)
v_mfma_f32_32x32x16_bf16 v[32:47], a[184:187], v[236:239], v[32:47]
ds_read_b64_tr_b16 a[176:177], v1 offset:55296
ds_read_b64_tr_b16 a[178:179], v1 offset:55552
s_waitcnt lgkmcnt(4)
v_mfma_f32_32x32x16_bf16 v[32:47], a[160:163], v[240:243], v[32:47]
ds_read_b64_tr_b16 a[184:185], v1 offset:56320
ds_read_b64_tr_b16 a[186:187], v1 offset:56576
s_waitcnt lgkmcnt(4)
v_mfma_f32_32x32x16_bf16 v[32:47], a[168:171], v[244:247], v[32:47]
s_waitcnt lgkmcnt(2)
v_mfma_f32_32x32x16_bf16 v[32:47], a[176:179], v[248:251], v[32:47]
s_waitcnt lgkmcnt(0)
v_mfma_f32_32x32x16_bf16 v[32:47], a[184:187], v[252:255], v[32:47]
s_nop 11
v_mul_f32 v32, v10, v32
v_mul_f32 v33, v10, v33
v_mul_f32 v34, v10, v34
v_mul_f32 v35, v10, v35
v_mul_f32 v36, v10, v36
v_mul_f32 v37, v10, v37
v_mul_f32 v38, v10, v38
v_mul_f32 v39, v10, v39
v_cvt_pk_bf16_f32 v32, v32, v33
v_cvt_pk_bf16_f32 v33, v34, v35
v_cvt_pk_bf16_f32 v34, v36, v37
v_cvt_pk_bf16_f32 v35, v38, v39
buffer_store_dwordx4 v[32:35], v0, s[32:35], s50 offen sc1
v_mul_f32 v40, v10, v40
v_mul_f32 v41, v10, v41
v_mul_f32 v42, v10, v42
v_mul_f32 v43, v10, v43
v_mul_f32 v44, v10, v44
v_mul_f32 v45, v10, v45
v_mul_f32 v46, v10, v46
v_mul_f32 v47, v10, v47
v_cvt_pk_bf16_f32 v40, v40, v41
v_cvt_pk_bf16_f32 v41, v42, v43
v_cvt_pk_bf16_f32 v42, v44, v45
v_cvt_pk_bf16_f32 v43, v46, v47
buffer_store_dwordx4 v[40:43], v0, s[32:35], s50 offen offset:1024 sc1
s_waitcnt vmcnt(2)
v_cmp_gt_u32 vcc, s3, v29
s_nop 1
s_cbranch_vccnz L_pw6
L_pr8:
s_add_u32 s5, s4, 0
buffer_load_dwordx4 v[160:163], v0, s[32:35], s5 offen sc1
buffer_load_dwordx4 v[164:167], v0, s[32:35], s5 offen offset:1024 sc1
buffer_load_dwordx4 v[168:171], v0, s[32:35], s5 offen offset:2048 sc1
buffer_load_dwordx4 v[172:175], v0, s[32:35], s5 offen offset:3072 sc1
s_add_u32 s5, s4, 12288
buffer_load_dwordx4 v[176:179], v0, s[32:35], s5 offen sc1
buffer_load_dwordx4 v[180:183], v0, s[32:35], s5 offen offset:1024 sc1
buffer_load_dwordx4 v[184:187], v0, s[32:35], s5 offen offset:2048 sc1
buffer_load_dwordx4 v[188:191], v0, s[32:35], s5 offen offset:3072 sc1
s_add_u32 s5, s4, 20480
buffer_load_dwordx4 v[192:195], v0, s[32:35], s5 offen sc1
buffer_load_dwordx4 v[196:199], v0, s[32:35], s5 offen offset:1024 sc1
buffer_load_dwordx4 v[200:203], v0, s[32:35], s5 offen offset:2048 sc1
buffer_load_dwordx4 v[204:207], v0, s[32:35], s5 offen offset:3072 sc1
s_branch L_s2
L_s1h:
s_add_u32 s7, s49, 4096
v_mfma_f32_32x32x16_bf16 v[64:79], a[16:19], v[96:99], v[80:95]
v_mfma_f32_32x32x16_bf16 v[64:79], a[20:23], v[100:103], v[64:79]
s_barrier
v_bfe_u32 v30, v3, 2, 2
v_lshrrev_b32 v31, 5, v3
v_lshl_add_u32 v30, v31, 3, v30
v_lshlrev_b32 v1, 7, v30
v_bfe_u32 v30, v3, 4, 1
v_lshl_add_u32 v1, v30, 5, v1
v_and_b32 v30, 3, v3
v_lshl_add_u32 v1, v30, 3, v1
v_bfe_u32 v30, v3, 3, 1
v_lshl_add_u32 v1, v30, 6, v1
v_xor_b32 v2, 64, v1
ds_read_b64_tr_b16 a[160:161], v1 offset:0
ds_read_b64_tr_b16 a[162:163], v1 offset:512
ds_read_b64_tr_b16 a[164:165], v2 offset:0
ds_read_b64_tr_b16 a[166:167], v2 offset:512
ds_read_b64_tr_b16 a[168:169], v1 offset:2048
ds_read_b64_tr_b16 a[170:171], v1 offset:2560
ds_read_b64_tr_b16 a[172:173], v2 offset:2048
ds_read_b64_tr_b16 a[174:175], v2 offset:2560
ds_read_b64_tr_b16 a[176:177], v1 offset:4096
ds_read_b64_tr_b16 a[178:179], v1 offset:4608
ds_read_b64_tr_b16 a[180:181], v2 offset:4096
ds_read_b64_tr_b16 a[182:183], v2 offset:4608
v_cvt_pk_bf16_f32 v96, v64, v65
v_cvt_pk_bf16_f32 v97, v66, v67
v_cvt_pk_bf16_f32 v98, v68, v69
v_cvt_pk_bf16_f32 v99, v70, v71
v_cvt_pk_bf16_f32 v100, v72, v73
v_cvt_pk_bf16_f32 v101, v74, v75
v_cvt_pk_bf16_f32 v102, v76, v77
v_cvt_pk_bf16_f32 v103, v78, v79
v_mfma_f32_32x32x16_bf16 v[64:79], a[16:19], v[104:107], v[80:95]
v_mfma_f32_32x32x16_bf16 v[64:79], a[20:23], v[108:111], v[64:79]
s_waitcnt lgkmcnt(8)
v_mfma_f32_32x32x16_bf16 v[32:47], a[160:163], v[96:99], 0
ds_read_b64_tr_b16 a[184:185], v1 offset:6144
ds_read_b64_tr_b16 a[186:187], v1 offset:6656
v_mfma_f32_32x32x16_bf16 v[48:63], a[164:167], v[96:99], 0
ds_read_b64_tr_b16 a[188:189], v2 offset:6144
ds_read_b64_tr_b16 a[190:191], v2 offset:6656
s_waitcnt lgkmcnt(8)
v_mfma_f32_32x32x16_bf16 v[32:47], a[168:171], v[100:103], v[32:47]
ds_read_b64_tr_b16 a[160:161], v1 offset:8192
ds_read_b64_tr_b16 a[162:163], v1 offset:8704
s_nop 0
v_cvt_pk_bf16_f32 v104, v64, v65
v_cvt_pk_bf16_f32 v105, v66, v67
v_cvt_pk_bf16_f32 v106, v68, v69
v_cvt_pk_bf16_f32 v107, v70, v71
v_mfma_f32_32x32x16_bf16 v[48:63], a[172:175], v[100:103], v[48:63]
ds_read_b64_tr_b16 a[164:165], v2 offset:8192
ds_read_b64_tr_b16 a[166:167], v2 offset:8704
v_cvt_pk_bf16_f32 v108, v72, v73
v_cvt_pk_bf16_f32 v109, v74, v75
v_cvt_pk_bf16_f32 v110, v76, v77
v_cvt_pk_bf16_f32 v111, v78, v79
v_mfma_f32_32x32x16_bf16 v[64:79], a[16:19], v[112:115], v[80:95]
v_mfma_f32_32x32x16_bf16 v[64:79], a[20:23], v[116:119], v[64:79]
s_waitcnt lgkmcnt(8)
v_mfma_f32_32x32x16_bf16 v[32:47], a[176:179], v[104:107], v[32:47]
ds_read_b64_tr_b16 a[168:169], v1 offset:10240
ds_read_b64_tr_b16 a[170:171], v1 offset:10752
v_mfma_f32_32x32x16_bf16 v[48:63], a[180:183], v[104:107], v[48:63]
ds_read_b64_tr_b16 a[172:173], v2 offset:10240
ds_read_b64_tr_b16 a[174:175], v2 offset:10752
s_waitcnt lgkmcnt(8)
v_mfma_f32_32x32x16_bf16 v[32:47], a[184:187], v[108:111], v[32:47]
ds_read_b64_tr_b16 a[176:177], v1 offset:12288
ds_read_b64_tr_b16 a[178:179], v1 offset:12800
s_nop 0
v_cvt_pk_bf16_f32 v112, v64, v65
v_cvt_pk_bf16_f32 v113, v66, v67
v_cvt_pk_bf16_f32 v114, v68, v69
v_cvt_pk_bf16_f32 v115, v70, v71
v_mfma_f32_32x32x16_bf16 v[48:63], a[188:191], v[108:111], v[48:63]
ds_read_b64_tr_b16 a[180:181], v2 offset:12288
ds_read_b64_tr_b16 a[182:183], v2 offset:12800
v_cvt_pk_bf16_f32 v116, v72, v73
v_cvt_pk_bf16_f32 v117, v74, v75
v_cvt_pk_bf16_f32 v118, v76, v77
v_cvt_pk_bf16_f32 v119, v78, v79
v_mfma_f32_32x32x16_bf16 v[64:79], a[16:19], v[120:123], v[80:95]
v_mfma_f32_32x32x16_bf16 v[64:79], a[20:23], v[124:127], v[64:79]
s_waitcnt lgkmcnt(8)
v_mfma_f32_32x32x16_bf16 v[32:47], a[160:163], v[112:115], v[32:47]
ds_read_b64_tr_b16 a[184:185], v1 offset:14336
ds_read_b64_tr_b16 a[186:187], v1 offset:14848
v_mfma_f32_32x32x16_bf16 v[48:63], a[164:167], v[112:115], v[48:63]
ds_read_b64_tr_b16 a[188:189], v2 offset:14336
ds_read_b64_tr_b16 a[190:191], v2 offset:14848
s_waitcnt lgkmcnt(8)
v_mfma_f32_32x32x16_bf16 v[32:47], a[168:171], v[116:119], v[32:47]
s_waitcnt vmcnt(8)
s_barrier
ds_read_b64_tr_b16 a[160:161], v1 offset:16384
ds_read_b64_tr_b16 a[162:163], v1 offset:16896
v_cvt_pk_bf16_f32 v120, v64, v65
v_cvt_pk_bf16_f32 v121, v66, v67
v_cvt_pk_bf16_f32 v122, v68, v69
v_cvt_pk_bf16_f32 v123, v70, v71
v_mfma_f32_32x32x16_bf16 v[48:63], a[172:175], v[116:119], v[48:63]
ds_read_b64_tr_b16 a[164:165], v2 offset:16384
ds_read_b64_tr_b16 a[166:167], v2 offset:16896
v_cvt_pk_bf16_f32 v124, v72, v73
v_cvt_pk_bf16_f32 v125, v74, v75
v_cvt_pk_bf16_f32 v126, v76, v77
v_cvt_pk_bf16_f32 v127, v78, v79
v_mfma_f32_32x32x16_bf16 v[64:79], a[16:19], v[128:131], v[80:95]
s_add_u32 m0, s41, 65536
s_add_u32 s51, s63, 8
s_sub_u32 s52, s51, 10
s_cselect_b32 s51, s51, s52
s_mul_i32 s52, s51, s53
s_add_u32 s52, s52, s46
v_mfma_f32_32x32x16_bf16 v[64:79], a[20:23], v[132:135], v[64:79]
buffer_load_dwordx4 v4, s[12:15], s52 offen lds
s_waitcnt lgkmcnt(8)
v_mfma_f32_32x32x16_bf16 v[32:47], a[176:179], v[120:123], v[32:47]
ds_read_b64_tr_b16 a[168:169], v1 offset:18432
ds_read_b64_tr_b16 a[170:171], v1 offset:18944
buffer_load_dwordx4 v5, s[12:15], s52 offen offset:1024 lds
v_mfma_f32_32x32x16_bf16 v[48:63], a[180:183], v[120:123], v[48:63]
ds_read_b64_tr_b16 a[172:173], v2 offset:18432
ds_read_b64_tr_b16 a[174:175], v2 offset:18944
s_waitcnt lgkmcnt(8)
v_mfma_f32_32x32x16_bf16 v[32:47], a[184:187], v[124:127], v[32:47]
ds_read_b64_tr_b16 a[176:177], v1 offset:20480
ds_read_b64_tr_b16 a[178:179], v1 offset:20992
v_cvt_pk_bf16_f32 v128, v64, v65
v_cvt_pk_bf16_f32 v129, v66, v67
v_cvt_pk_bf16_f32 v130, v68, v69
v_cvt_pk_bf16_f32 v131, v70, v71
v_mfma_f32_32x32x16_bf16 v[48:63], a[188:191], v[124:127], v[48:63]
ds_read_b64_tr_b16 a[180:181], v2 offset:20480
ds_read_b64_tr_b16 a[182:183], v2 offset:20992
v_cvt_pk_bf16_f32 v132, v72, v73
v_cvt_pk_bf16_f32 v133, v74, v75
v_cvt_pk_bf16_f32 v134, v76, v77
v_cvt_pk_bf16_f32 v135, v78, v79
v_mfma_f32_32x32x16_bf16 v[64:79], a[16:19], v[136:139], v[80:95]
buffer_load_dwordx4 v6, s[12:15], s52 offen offset:2048 lds
v_mov_b32 v26, 1
v_mfma_f32_32x32x16_bf16 v[64:79], a[20:23], v[140:143], v[64:79]
buffer_load_dwordx4 v7, s[12:15], s52 offen offset:3072 lds
s_add_u32 m0, s41, 81920
s_waitcnt lgkmcnt(8)
v_mfma_f32_32x32x16_bf16 v[32:47], a[160:163], v[128:131], v[32:47]
ds_read_b64_tr_b16 a[184:185], v1 offset:22528
ds_read_b64_tr_b16 a[186:187], v1 offset:23040
s_mul_i32 s52, s63, s53
s_add_u32 s52, s52, s46
s_add_u32 s52, s52, 128
v_mfma_f32_32x32x16_bf16 v[48:63], a[164:167], v[128:131], v[48:63]
ds_read_b64_tr_b16 a[188:189], v2 offset:22528
ds_read_b64_tr_b16 a[190:191], v2 offset:23040
buffer_atomic_add v26, v13, s[36:39], s2 offen sc0 sc1
s_waitcnt lgkmcnt(8)
v_mfma_f32_32x32x16_bf16 v[32:47], a[168:171], v[132:135], v[32:47]
ds_read_b64_tr_b16 a[160:161], v1 offset:24576
ds_read_b64_tr_b16 a[162:163], v1 offset:25088
v_cvt_pk_bf16_f32 v136, v64, v65
v_cvt_pk_bf16_f32 v137, v66, v67
v_cvt_pk_bf16_f32 v138, v68, v69
v_cvt_pk_bf16_f32 v139, v70, v71
v_mfma_f32_32x32x16_bf16 v[48:63], a[172:175], v[132:135], v[48:63]
ds_read_b64_tr_b16 a[164:165], v2 offset:24576
ds_read_b64_tr_b16 a[166:167], v2 offset:25088
v_cvt_pk_bf16_f32 v140, v72, v73
v_cvt_pk_bf16_f32 v141, v74, v75
v_cvt_pk_bf16_f32 v142, v76, v77
v_cvt_pk_bf16_f32 v143, v78, v79
v_mfma_f32_32x32x16_bf16 v[64:79], a[16:19], v[144:147], v[80:95]
buffer_load_dwordx4 v4, s[12:15], s52 offen lds
v_mfma_f32_32x32x16_bf16 v[64:79], a[20:23], v[148:151], v[64:79]
buffer_load_dwordx4 v5, s[12:15], s52 offen offset:1024 lds
s_waitcnt lgkmcnt(8)
v_mfma_f32_32x32x16_bf16 v[32:47], a[176:179], v[136:139], v[32:47]
ds_read_b64_tr_b16 a[168:169], v1 offset:26624
ds_read_b64_tr_b16 a[170:171], v1 offset:27136
buffer_load_dwordx4 v6, s[12:15], s52 offen offset:2048 lds
v_mfma_f32_32x32x16_bf16 v[48:63], a[180:183], v[136:139], v[48:63]
ds_read_b64_tr_b16 a[172:173], v2 offset:26624
ds_read_b64_tr_b16 a[174:175], v2 offset:27136
s_waitcnt lgkmcnt(8)
v_mfma_f32_32x32x16_bf16 v[32:47], a[184:187], v[140:143], v[32:47]
ds_read_b64_tr_b16 a[176:177], v1 offset:28672
ds_read_b64_tr_b16 a[178:179], v1 offset:29184
v_cvt_pk_bf16_f32 v144, v64, v65
v_cvt_pk_bf16_f32 v145, v66, v67
v_cvt_pk_bf16_f32 v146, v68, v69
v_cvt_pk_bf16_f32 v147, v70, v71
v_mfma_f32_32x32x16_bf16 v[48:63], a[188:191], v[140:143], v[48:63]
ds_read_b64_tr_b16 a[180:181], v2 offset:28672
ds_read_b64_tr_b16 a[182:183], v2 offset:29184
v_cvt_pk_bf16_f32 v148, v72, v73
v_cvt_pk_bf16_f32 v149, v74, v75
v_cvt_pk_bf16_f32 v150, v76, v77
v_cvt_pk_bf16_f32 v151, v78, v79
v_mfma_f32_32x32x16_bf16 v[64:79], a[16:19], v[152:155], v[80:95]
buffer_load_dwordx4 v7, s[12:15], s52 offen offset:3072 lds
v_mfma_f32_32x32x16_bf16 v[64:79], a[20:23], v[156:159], v[64:79]
s_waitcnt lgkmcnt(8)
v_mfma_f32_32x32x16_bf16 v[32:47], a[160:163], v[144:147], v[32:47]
ds_read_b64_tr_b16 a[184:185], v1 offset:30720
ds_read_b64_tr_b16 a[186:187], v1 offset:31232
v_mul_f32 v20, v20, v8
v_mul_f32 v20, v20, v8
v_add_f32 v20, 0x3727c5ac, v20
v_mfma_f32_32x32x16_bf16 v[48:63], a[164:167], v[144:147], v[48:63]
ds_read_b64_tr_b16 a[188:189], v2 offset:30720
ds_read_b64_tr_b16 a[190:191], v2 offset:31232
v_rsq_f32 v22, v20
s_nop 0
v_mul_f32 v22, v22, v8
s_waitcnt lgkmcnt(8)
v_mfma_f32_32x32x16_bf16 v[32:47], a[168:171], v[148:151], v[32:47]
s_waitcnt vmcnt(13)
s_barrier
ds_read_b64_tr_b16 a[160:161], v1 offset:32768
ds_read_b64_tr_b16 a[162:163], v1 offset:33280
v_cvt_pk_bf16_f32 v152, v64, v65
v_cvt_pk_bf16_f32 v153, v66, v67
v_cvt_pk_bf16_f32 v154, v68, v69
v_cvt_pk_bf16_f32 v155, v70, v71
v_mfma_f32_32x32x16_bf16 v[48:63], a[172:175], v[148:151], v[48:63]
ds_read_b64_tr_b16 a[164:165], v2 offset:32768
ds_read_b64_tr_b16 a[166:167], v2 offset:33280
v_cvt_pk_bf16_f32 v156, v72, v73
v_cvt_pk_bf16_f32 v157, v74, v75
v_cvt_pk_bf16_f32 v158, v76, v77
v_cvt_pk_bf16_f32 v159, v78, v79
v_mfma_f32_32x32x16_bf16 v[64:79], a[16:19], v[160:163], v[80:95]
s_add_u32 m0, s41, 98304
s_add_u32 s51, s63, 2
s_sub_u32 s52, s51, 10
s_cselect_b32 s51, s51, s52
s_mul_i32 s52, s51, s53
s_add_u32 s52, s52, s46
v_mfma_f32_32x32x16_bf16 v[64:79], a[20:23], v[164:167], v[64:79]
s_add_u32 s52, s52, 128
buffer_load_dwordx4 v4, s[12:15], s52 offen lds
v_rcp_f32 v12, v22
v_mul_f32 v10, 0xc0135761, v22
v_mul_f32 v21, v22, v22
v_mul_f32 v21, v21, v22
v_mul_f32 v11, 0xbdd2d3e8, v21
s_waitcnt lgkmcnt(8)
v_mfma_f32_32x32x16_bf16 v[32:47], a[176:179], v[152:155], v[32:47]
ds_read_b64_tr_b16 a[168:169], v1 offset:34816
ds_read_b64_tr_b16 a[170:171], v1 offset:35328
buffer_load_dwordx4 v5, s[12:15], s52 offen offset:1024 lds
v_mfma_f32_32x32x16_bf16 v[48:63], a[180:183], v[152:155], v[48:63]
ds_read_b64_tr_b16 a[172:173], v2 offset:34816
ds_read_b64_tr_b16 a[174:175], v2 offset:35328
s_mov_b32 s3, s62
s_lshl_b32 s3, s3, 2
s_add_u32 s3, s3, s60
s_waitcnt lgkmcnt(8)
v_mfma_f32_32x32x16_bf16 v[32:47], a[184:187], v[156:159], v[32:47]
ds_read_b64_tr_b16 a[176:177], v1 offset:36864
ds_read_b64_tr_b16 a[178:179], v1 offset:37376
v_cvt_pk_bf16_f32 v160, v64, v65
v_cvt_pk_bf16_f32 v161, v66, v67
v_cvt_pk_bf16_f32 v162, v68, v69
v_cvt_pk_bf16_f32 v163, v70, v71
v_mfma_f32_32x32x16_bf16 v[48:63], a[188:191], v[156:159], v[48:63]
ds_read_b64_tr_b16 a[180:181], v2 offset:36864
ds_read_b64_tr_b16 a[182:183], v2 offset:37376
v_cvt_pk_bf16_f32 v164, v72, v73
v_cvt_pk_bf16_f32 v165, v74, v75
v_cvt_pk_bf16_f32 v166, v76, v77
v_cvt_pk_bf16_f32 v167, v78, v79
v_mfma_f32_32x32x16_bf16 v[64:79], a[16:19], v[168:171], v[80:95]
buffer_load_dwordx4 v6, s[12:15], s52 offen offset:2048 lds
s_lshl_b32 s3, s3, 4
s_lshr_b32 s4, s44, 2
v_mfma_f32_32x32x16_bf16 v[64:79], a[20:23], v[172:175], v[64:79]
buffer_load_dwordx4 v7, s[12:15], s52 offen offset:3072 lds
s_add_u32 m0, s41, 114688
s_add_u32 s3, s3, s4
s_lshl_b32 s3, s3, 2
s_add_u32 s3, s3, s40
s_mul_i32 s3, s3, 896
v_min_u32 v28, 6, v3
v_add_lshl_u32 v28, v28, 0, 7
buffer_load_dword a223, v28, s[16:19], s3 offen
s_waitcnt lgkmcnt(8)
v_mfma_f32_32x32x16_bf16 v[32:47], a[160:163], v[160:163], v[32:47]
ds_read_b64_tr_b16 a[184:185], v1 offset:38912
ds_read_b64_tr_b16 a[186:187], v1 offset:39424
s_add_u32 s51, s63, 4
s_sub_u32 s52, s51, 10
s_cselect_b32 s51, s51, s52
s_mul_i32 s52, s51, s53
v_mfma_f32_32x32x16_bf16 v[48:63], a[164:167], v[160:163], v[48:63]
ds_read_b64_tr_b16 a[188:189], v2 offset:38912
ds_read_b64_tr_b16 a[190:191], v2 offset:39424
s_add_u32 s52, s52, s46
s_add_u32 s52, s52, 128
s_max_u32 s3, s62, 1
s_waitcnt lgkmcnt(8)
v_mfma_f32_32x32x16_bf16 v[32:47], a[168:171], v[164:167], v[32:47]
ds_read_b64_tr_b16 a[160:161], v1 offset:40960
ds_read_b64_tr_b16 a[162:163], v1 offset:41472
v_cvt_pk_bf16_f32 v168, v64, v65
v_cvt_pk_bf16_f32 v169, v66, v67
v_cvt_pk_bf16_f32 v170, v68, v69
v_cvt_pk_bf16_f32 v171, v70, v71
v_mfma_f32_32x32x16_bf16 v[48:63], a[172:175], v[164:167], v[48:63]
ds_read_b64_tr_b16 a[164:165], v2 offset:40960
ds_read_b64_tr_b16 a[166:167], v2 offset:41472
v_cvt_pk_bf16_f32 v172, v72, v73
v_cvt_pk_bf16_f32 v173, v74, v75
v_cvt_pk_bf16_f32 v174, v76, v77
v_cvt_pk_bf16_f32 v175, v78, v79
v_mfma_f32_32x32x16_bf16 v[64:79], a[16:19], v[176:179], v[80:95]
buffer_load_dwordx4 v4, s[12:15], s52 offen lds
s_sub_u32 s3, s3, 1
s_lshl_b32 s3, s3, 2
v_mfma_f32_32x32x16_bf16 v[64:79], a[20:23], v[180:183], v[64:79]
buffer_load_dwordx4 v5, s[12:15], s52 offen offset:1024 lds
s_add_u32 s3, s3, s60
s_lshl_b32 s3, s3, 4
s_lshr_b32 s4, s44, 2
s_add_u32 s3, s3, s4
s_lshl_b32 s3, s3, 2
s_add_u32 s3, s3, s40
s_mul_i32 s3, s3, 3200
v_min_u32 v28, 24, v3
v_add_lshl_u32 v28, v28, 0, 7
buffer_load_dword a223, v28, s[20:23], s3 offen
s_waitcnt lgkmcnt(8)
v_mfma_f32_32x32x16_bf16 v[32:47], a[176:179], v[168:171], v[32:47]
ds_read_b64_tr_b16 a[168:169], v1 offset:43008
ds_read_b64_tr_b16 a[170:171], v1 offset:43520
buffer_load_dwordx4 v6, s[12:15], s52 offen offset:2048 lds
v_mfma_f32_32x32x16_bf16 v[48:63], a[180:183], v[168:171], v[48:63]
ds_read_b64_tr_b16 a[172:173], v2 offset:43008
ds_read_b64_tr_b16 a[174:175], v2 offset:43520
s_waitcnt lgkmcnt(8)
v_mfma_f32_32x32x16_bf16 v[32:47], a[184:187], v[172:175], v[32:47]
ds_read_b64_tr_b16 a[176:177], v1 offset:45056
ds_read_b64_tr_b16 a[178:179], v1 offset:45568
v_cvt_pk_bf16_f32 v176, v64, v65
v_cvt_pk_bf16_f32 v177, v66, v67
v_cvt_pk_bf16_f32 v178, v68, v69
v_cvt_pk_bf16_f32 v179, v70, v71
v_mfma_f32_32x32x16_bf16 v[48:63], a[188:191], v[172:175], v[48:63]
ds_read_b64_tr_b16 a[180:181], v2 offset:45056
ds_read_b64_tr_b16 a[182:183], v2 offset:45568
v_cvt_pk_bf16_f32 v180, v72, v73
v_cvt_pk_bf16_f32 v181, v74, v75
v_cvt_pk_bf16_f32 v182, v76, v77
v_cvt_pk_bf16_f32 v183, v78, v79
v_mfma_f32_32x32x16_bf16 v[64:79], a[16:19], v[184:187], v[80:95]
buffer_load_dwordx4 v7, s[12:15], s52 offen offset:3072 lds
v_mfma_f32_32x32x16_bf16 v[64:79], a[20:23], v[188:191], v[64:79]
s_waitcnt lgkmcnt(8)
v_mfma_f32_32x32x16_bf16 v[32:47], a[160:163], v[176:179], v[32:47]
ds_read_b64_tr_b16 a[184:185], v1 offset:47104
ds_read_b64_tr_b16 a[186:187], v1 offset:47616
v_mfma_f32_32x32x16_bf16 v[48:63], a[164:167], v[176:179], v[48:63]
ds_read_b64_tr_b16 a[188:189], v2 offset:47104
ds_read_b64_tr_b16 a[190:191], v2 offset:47616
s_waitcnt lgkmcnt(8)
v_mfma_f32_32x32x16_bf16 v[32:47], a[168:171], v[180:183], v[32:47]
s_waitcnt vmcnt(19)
s_barrier
ds_read_b64_tr_b16 a[160:161], v1 offset:49152
ds_read_b64_tr_b16 a[162:163], v1 offset:49664
v_cvt_pk_bf16_f32 v184, v64, v65
v_cvt_pk_bf16_f32 v185, v66, v67
v_cvt_pk_bf16_f32 v186, v68, v69
v_cvt_pk_bf16_f32 v187, v70, v71
v_mfma_f32_32x32x16_bf16 v[48:63], a[172:175], v[180:183], v[48:63]
ds_read_b64_tr_b16 a[164:165], v2 offset:49152
ds_read_b64_tr_b16 a[166:167], v2 offset:49664
v_cvt_pk_bf16_f32 v188, v72, v73
v_cvt_pk_bf16_f32 v189, v74, v75
v_cvt_pk_bf16_f32 v190, v76, v77
v_cvt_pk_bf16_f32 v191, v78, v79
v_mfma_f32_32x32x16_bf16 v[64:79], a[16:19], v[192:195], v[80:95]
s_add_u32 m0, s41, 131072
s_add_u32 s51, s63, 6
s_sub_u32 s52, s51, 10
s_cselect_b32 s51, s51, s52
s_mul_i32 s52, s51, s53
s_add_u32 s52, s52, s46
v_mfma_f32_32x32x16_bf16 v[64:79], a[20:23], v[196:199], v[64:79]
s_add_u32 s52, s52, 128
buffer_load_dwordx4 v4, s[12:15], s52 offen lds
s_waitcnt lgkmcnt(8)
v_mfma_f32_32x32x16_bf16 v[32:47], a[176:179], v[184:187], v[32:47]
ds_read_b64_tr_b16 a[168:169], v1 offset:51200
ds_read_b64_tr_b16 a[170:171], v1 offset:51712
buffer_load_dwordx4 v5, s[12:15], s52 offen offset:1024 lds
v_mfma_f32_32x32x16_bf16 v[48:63], a[180:183], v[184:187], v[48:63]
ds_read_b64_tr_b16 a[172:173], v2 offset:51200
ds_read_b64_tr_b16 a[174:175], v2 offset:51712
s_waitcnt vmcnt(16)
v_cmp_eq_u32 vcc, 12, v26
v_mov_b32 v27, 1073741824
s_nop 0
v_cndmask_b32 v27, v27, v13, vcc
s_waitcnt lgkmcnt(8)
v_mfma_f32_32x32x16_bf16 v[32:47], a[184:187], v[188:191], v[32:47]
ds_read_b64_tr_b16 a[176:177], v1 offset:53248
ds_read_b64_tr_b16 a[178:179], v1 offset:53760
v_cvt_pk_bf16_f32 v192, v64, v65
v_cvt_pk_bf16_f32 v193, v66, v67
v_cvt_pk_bf16_f32 v194, v68, v69
v_cvt_pk_bf16_f32 v195, v70, v71
v_mfma_f32_32x32x16_bf16 v[48:63], a[188:191], v[188:191], v[48:63]
ds_read_b64_tr_b16 a[180:181], v2 offset:53248
ds_read_b64_tr_b16 a[182:183], v2 offset:53760
v_cvt_pk_bf16_f32 v196, v72, v73
v_cvt_pk_bf16_f32 v197, v74, v75
v_cvt_pk_bf16_f32 v198, v76, v77
v_cvt_pk_bf16_f32 v199, v78, v79
v_mfma_f32_32x32x16_bf16 v[64:79], a[16:19], v[200:203], v[80:95]
buffer_load_dwordx4 v6, s[12:15], s52 offen offset:2048 lds
v_mfma_f32_32x32x16_bf16 v[64:79], a[20:23], v[204:207], v[64:79]
buffer_load_dwordx4 v7, s[12:15], s52 offen offset:3072 lds
s_add_u32 m0, s41, 0
buffer_store_dword v14, v27, s[36:39], s2 offen offset:128 sc1
s_waitcnt lgkmcnt(8)
v_mfma_f32_32x32x16_bf16 v[32:47], a[160:163], v[192:195], v[32:47]
ds_read_b64_tr_b16 a[184:185], v1 offset:55296
ds_read_b64_tr_b16 a[186:187], v1 offset:55808
s_add_u32 s51, s63, 8
s_sub_u32 s52, s51, 10
s_cselect_b32 s51, s51, s52
s_mul_i32 s52, s51, s53
v_mfma_f32_32x32x16_bf16 v[48:63], a[164:167], v[192:195], v[48:63]
ds_read_b64_tr_b16 a[188:189], v2 offset:55296
ds_read_b64_tr_b16 a[190:191], v2 offset:55808
s_add_u32 s52, s52, s46
s_add_u32 s52, s52, 128
s_waitcnt lgkmcnt(8)
v_mfma_f32_32x32x16_bf16 v[32:47], a[168:171], v[196:199], v[32:47]
ds_read_b64_tr_b16 a[160:161], v1 offset:57344
ds_read_b64_tr_b16 a[162:163], v1 offset:57856
v_cvt_pk_bf16_f32 v200, v64, v65
v_cvt_pk_bf16_f32 v201, v66, v67
v_cvt_pk_bf16_f32 v202, v68, v69
v_cvt_pk_bf16_f32 v203, v70, v71
v_mfma_f32_32x32x16_bf16 v[48:63], a[172:175], v[196:199], v[48:63]
ds_read_b64_tr_b16 a[164:165], v2 offset:57344
ds_read_b64_tr_b16 a[166:167], v2 offset:57856
v_cvt_pk_bf16_f32 v204, v72, v73
v_cvt_pk_bf16_f32 v205, v74, v75
v_cvt_pk_bf16_f32 v206, v76, v77
v_cvt_pk_bf16_f32 v207, v78, v79
v_mfma_f32_32x32x16_bf16 v[64:79], a[16:19], v[208:211], v[80:95]
buffer_load_dwordx4 v4, s[12:15], s52 offen lds
v_mfma_f32_32x32x16_bf16 v[64:79], a[20:23], v[212:215], v[64:79]
buffer_load_dwordx4 v5, s[12:15], s52 offen offset:1024 lds
s_waitcnt lgkmcnt(8)
v_mfma_f32_32x32x16_bf16 v[32:47], a[176:179], v[200:203], v[32:47]
ds_read_b64_tr_b16 a[168:169], v1 offset:59392
ds_read_b64_tr_b16 a[170:171], v1 offset:59904
buffer_load_dwordx4 v6, s[12:15], s52 offen offset:2048 lds
v_mfma_f32_32x32x16_bf16 v[48:63], a[180:183], v[200:203], v[48:63]
ds_read_b64_tr_b16 a[172:173], v2 offset:59392
ds_read_b64_tr_b16 a[174:175], v2 offset:59904
s_waitcnt lgkmcnt(8)
v_mfma_f32_32x32x16_bf16 v[32:47], a[184:187], v[204:207], v[32:47]
ds_read_b64_tr_b16 a[176:177], v1 offset:61440
ds_read_b64_tr_b16 a[178:179], v1 offset:61952
v_cvt_pk_bf16_f32 v208, v64, v65
v_cvt_pk_bf16_f32 v209, v66, v67
v_cvt_pk_bf16_f32 v210, v68, v69
v_cvt_pk_bf16_f32 v211, v70, v71
v_mfma_f32_32x32x16_bf16 v[48:63], a[188:191], v[204:207], v[48:63]
ds_read_b64_tr_b16 a[180:181], v2 offset:61440
ds_read_b64_tr_b16 a[182:183], v2 offset:61952
v_cvt_pk_bf16_f32 v212, v72, v73
v_cvt_pk_bf16_f32 v213, v74, v75
v_cvt_pk_bf16_f32 v214, v76, v77
v_cvt_pk_bf16_f32 v215, v78, v79
v_mfma_f32_32x32x16_bf16 v[64:79], a[16:19], v[216:219], v[80:95]
buffer_load_dwordx4 v7, s[12:15], s52 offen offset:3072 lds
v_mfma_f32_32x32x16_bf16 v[64:79], a[20:23], v[220:223], v[64:79]
s_waitcnt lgkmcnt(8)
v_mfma_f32_32x32x16_bf16 v[32:47], a[160:163], v[208:211], v[32:47]
ds_read_b64_tr_b16 a[184:185], v1 offset:63488
ds_read_b64_tr_b16 a[186:187], v1 offset:64000
v_mfma_f32_32x32x16_bf16 v[48:63], a[164:167], v[208:211], v[48:63]
ds_read_b64_tr_b16 a[188:189], v2 offset:63488
ds_read_b64_tr_b16 a[190:191], v2 offset:64000
s_waitcnt lgkmcnt(8)
v_mfma_f32_32x32x16_bf16 v[32:47], a[168:171], v[212:215], v[32:47]
s_barrier
v_add_u32 v1, 65536, v1
v_add_u32 v2, 65536, v2
ds_read_b64_tr_b16 a[160:161], v1 offset:0
ds_read_b64_tr_b16 a[162:163], v1 offset:512
v_cvt_pk_bf16_f32 v216, v64, v65
v_cvt_pk_bf16_f32 v217, v66, v67
v_cvt_pk_bf16_f32 v218, v68, v69
v_cvt_pk_bf16_f32 v219, v70, v71
v_mfma_f32_32x32x16_bf16 v[48:63], a[172:175], v[212:215], v[48:63]
ds_read_b64_tr_b16 a[164:165], v2 offset:0
ds_read_b64_tr_b16 a[166:167], v2 offset:512
v_cvt_pk_bf16_f32 v220, v72, v73
v_cvt_pk_bf16_f32 v221, v74, v75
v_cvt_pk_bf16_f32 v222, v76, v77
v_cvt_pk_bf16_f32 v223, v78, v79
v_mfma_f32_32x32x16_bf16 v[64:79], a[16:19], v[224:227], v[80:95]
v_lshrrev_b32 v4, 2, v3
v_and_b32 v5, 3, v3
v_lshlrev_b32 v5, 4, v5
v_mad_u32_u24 v4, v4, s45, v5
s_lshl_b32 s53, s45, 4
s_sub_u32 s53, s53, 1024
v_mfma_f32_32x32x16_bf16 v[64:79], a[20:23], v[228:231], v[64:79]
v_add_u32 v5, s53, v4
v_add_u32 v6, s53, v5
v_add_u32 v7, s53, v6
s_lshl_b32 s53, s45, 6
s_add_u32 m0, s41, 16384
s_add_u32 s51, s63, s40
s_add_u32 s51, s51, 0
s_sub_u32 s52, s51, 10
s_cselect_b32 s51, s51, s52
s_mul_i32 s52, s51, s53
s_add_u32 s52, s52, s48
buffer_load_dwordx4 v4, s[12:15], s52 offen lds
s_waitcnt lgkmcnt(8)
v_mfma_f32_32x32x16_bf16 v[32:47], a[176:179], v[216:219], v[32:47]
ds_read_b64_tr_b16 a[168:169], v1 offset:2048
ds_read_b64_tr_b16 a[170:171], v1 offset:2560
v_mfma_f32_32x32x16_bf16 v[48:63], a[180:183], v[216:219], v[48:63]
ds_read_b64_tr_b16 a[172:173], v2 offset:2048
ds_read_b64_tr_b16 a[174:175], v2 offset:2560
s_waitcnt lgkmcnt(8)
v_mfma_f32_32x32x16_bf16 v[32:47], a[184:187], v[220:223], v[32:47]
ds_read_b64_tr_b16 a[176:177], v1 offset:4096
ds_read_b64_tr_b16 a[178:179], v1 offset:4608
v_cvt_pk_bf16_f32 v224, v64, v65
v_cvt_pk_bf16_f32 v225, v66, v67
v_cvt_pk_bf16_f32 v226, v68, v69
v_cvt_pk_bf16_f32 v227, v70, v71
v_mfma_f32_32x32x16_bf16 v[48:63], a[188:191], v[220:223], v[48:63]
ds_read_b64_tr_b16 a[180:181], v2 offset:4096
ds_read_b64_tr_b16 a[182:183], v2 offset:4608
v_cvt_pk_bf16_f32 v228, v72, v73
v_cvt_pk_bf16_f32 v229, v74, v75
v_cvt_pk_bf16_f32 v230, v76, v77
v_cvt_pk_bf16_f32 v231, v78, v79
v_mfma_f32_32x32x16_bf16 v[64:79], a[16:19], v[232:235], v[80:95]
buffer_load_dwordx4 v5, s[12:15], s52 offen offset:1024 lds
v_mfma_f32_32x32x16_bf16 v[64:79], a[20:23], v[236:239], v[64:79]
s_waitcnt lgkmcnt(8)
v_mfma_f32_32x32x16_bf16 v[32:47], a[160:163], v[224:227], v[32:47]
ds_read_b64_tr_b16 a[184:185], v1 offset:6144
ds_read_b64_tr_b16 a[186:187], v1 offset:6656
v_mfma_f32_32x32x16_bf16 v[48:63], a[164:167], v[224:227], v[48:63]
ds_read_b64_tr_b16 a[188:189], v2 offset:6144
ds_read_b64_tr_b16 a[190:191], v2 offset:6656
s_waitcnt lgkmcnt(8)
v_mfma_f32_32x32x16_bf16 v[32:47], a[168:171], v[228:231], v[32:47]
ds_read_b64_tr_b16 a[160:161], v1 offset:8192
ds_read_b64_tr_b16 a[162:163], v1 offset:8704
s_nop 0
v_cvt_pk_bf16_f32 v232, v64, v65
v_cvt_pk_bf16_f32 v233, v66, v67
v_cvt_pk_bf16_f32 v234, v68, v69
v_cvt_pk_bf16_f32 v235, v70, v71
v_mfma_f32_32x32x16_bf16 v[48:63], a[172:175], v[228:231], v[48:63]
ds_read_b64_tr_b16 a[164:165], v2 offset:8192
ds_read_b64_tr_b16 a[166:167], v2 offset:8704
v_cvt_pk_bf16_f32 v236, v72, v73
v_cvt_pk_bf16_f32 v237, v74, v75
v_cvt_pk_bf16_f32 v238, v76, v77
v_cvt_pk_bf16_f32 v239, v78, v79
v_mfma_f32_32x32x16_bf16 v[64:79], a[16:19], v[240:243], v[80:95]
buffer_load_dwordx4 v6, s[12:15], s52 offen offset:2048 lds
v_mfma_f32_32x32x16_bf16 v[64:79], a[20:23], v[244:247], v[64:79]
s_waitcnt lgkmcnt(8)
v_mfma_f32_32x32x16_bf16 v[32:47], a[176:179], v[232:235], v[32:47]
ds_read_b64_tr_b16 a[168:169], v1 offset:10240
ds_read_b64_tr_b16 a[170:171], v1 offset:10752
buffer_load_dwordx4 v7, s[12:15], s52 offen offset:3072 lds
v_mfma_f32_32x32x16_bf16 v[48:63], a[180:183], v[232:235], v[48:63]
ds_read_b64_tr_b16 a[172:173], v2 offset:10240
ds_read_b64_tr_b16 a[174:175], v2 offset:10752
s_waitcnt lgkmcnt(8)
v_mfma_f32_32x32x16_bf16 v[32:47], a[184:187], v[236:239], v[32:47]
ds_read_b64_tr_b16 a[176:177], v1 offset:12288
ds_read_b64_tr_b16 a[178:179], v1 offset:12800
v_cvt_pk_bf16_f32 v240, v64, v65
v_cvt_pk_bf16_f32 v241, v66, v67
v_cvt_pk_bf16_f32 v242, v68, v69
v_cvt_pk_bf16_f32 v243, v70, v71
v_mfma_f32_32x32x16_bf16 v[48:63], a[188:191], v[236:239], v[48:63]
ds_read_b64_tr_b16 a[180:181], v2 offset:12288
ds_read_b64_tr_b16 a[182:183], v2 offset:12800
v_cvt_pk_bf16_f32 v244, v72, v73
v_cvt_pk_bf16_f32 v245, v74, v75
v_cvt_pk_bf16_f32 v246, v76, v77
v_cvt_pk_bf16_f32 v247, v78, v79
v_mfma_f32_32x32x16_bf16 v[64:79], a[16:19], v[248:251], v[80:95]
v_mfma_f32_32x32x16_bf16 v[64:79], a[20:23], v[252:255], v[64:79]
s_waitcnt lgkmcnt(8)
v_mfma_f32_32x32x16_bf16 v[32:47], a[160:163], v[240:243], v[32:47]
ds_read_b64_tr_b16 a[184:185], v1 offset:14336
ds_read_b64_tr_b16 a[186:187], v1 offset:14848
v_mfma_f32_32x32x16_bf16 v[48:63], a[164:167], v[240:243], v[48:63]
ds_read_b64_tr_b16 a[188:189], v2 offset:14336
ds_read_b64_tr_b16 a[190:191], v2 offset:14848
s_waitcnt lgkmcnt(8)
v_mfma_f32_32x32x16_bf16 v[32:47], a[168:171], v[244:247], v[32:47]
s_waitcnt vmcnt(23)
s_barrier
ds_read_b64_tr_b16 a[160:161], v1 offset:16384
ds_read_b64_tr_b16 a[162:163], v1 offset:16896
v_cvt_pk_bf16_f32 v248, v64, v65
v_cvt_pk_bf16_f32 v249, v66, v67
v_cvt_pk_bf16_f32 v250, v68, v69
v_cvt_pk_bf16_f32 v251, v70, v71
v_mfma_f32_32x32x16_bf16 v[48:63], a[172:175], v[244:247], v[48:63]
ds_read_b64_tr_b16 a[164:165], v2 offset:16384
ds_read_b64_tr_b16 a[166:167], v2 offset:16896
v_cvt_pk_bf16_f32 v252, v72, v73
v_cvt_pk_bf16_f32 v253, v74, v75
v_cvt_pk_bf16_f32 v254, v76, v77
v_cvt_pk_bf16_f32 v255, v78, v79
s_waitcnt lgkmcnt(8)
v_mfma_f32_32x32x16_bf16 v[32:47], a[176:179], v[248:251], v[32:47]
ds_read_b64_tr_b16 a[168:169], v1 offset:18432
ds_read_b64_tr_b16 a[170:171], v1 offset:18944
s_add_u32 m0, s41, 32768
s_add_u32 s51, s63, s40
s_add_u32 s51, s51, 4
s_sub_u32 s52, s51, 10
s_cselect_b32 s51, s51, s52
v_mfma_f32_32x32x16_bf16 v[48:63], a[180:183], v[248:251], v[48:63]
ds_read_b64_tr_b16 a[172:173], v2 offset:18432
ds_read_b64_tr_b16 a[174:175], v2 offset:18944
s_mul_i32 s52, s51, s53
s_add_u32 s52, s52, s48
buffer_load_dwordx4 v4, s[12:15], s52 offen lds
s_waitcnt lgkmcnt(8)
v_mfma_f32_32x32x16_bf16 v[32:47], a[184:187], v[252:255], v[32:47]
ds_read_b64_tr_b16 a[176:177], v1 offset:20480
ds_read_b64_tr_b16 a[178:179], v1 offset:20992
buffer_load_dwordx4 v5, s[12:15], s52 offen offset:1024 lds
v_mfma_f32_32x32x16_bf16 v[48:63], a[188:191], v[252:255], v[48:63]
ds_read_b64_tr_b16 a[180:181], v2 offset:20480
ds_read_b64_tr_b16 a[182:183], v2 offset:20992
buffer_load_dwordx4 v6, s[12:15], s52 offen offset:2048 lds
buffer_load_dwordx4 v7, s[12:15], s52 offen offset:3072 lds
s_waitcnt lgkmcnt(8)
v_mfma_f32_32x32x16_bf16 v[64:79], a[160:163], v[96:99], 0
ds_read_b64_tr_b16 a[184:185], v1 offset:22528
ds_read_b64_tr_b16 a[186:187], v1 offset:23040
v_mfma_f32_32x32x16_bf16 v[80:95], a[164:167], v[96:99], 0
ds_read_b64_tr_b16 a[188:189], v2 offset:22528
ds_read_b64_tr_b16 a[190:191], v2 offset:23040
s_waitcnt lgkmcnt(8)
v_mfma_f32_32x32x16_bf16 v[64:79], a[168:171], v[100:103], v[64:79]
ds_read_b64_tr_b16 a[160:161], v1 offset:24576
ds_read_b64_tr_b16 a[162:163], v1 offset:25088
v_mul_f32 v16, v32, v32
v_mul_f32 v17, v33, v33
v_mul_f32 v18, v34, v34
v_mul_f32 v19, v35, v35
v_fma_f32 v16, v16, v11, v10
v_fma_f32 v17, v17, v11, v10
v_fma_f32 v18, v18, v11, v10
v_mfma_f32_32x32x16_bf16 v[80:95], a[172:175], v[100:103], v[80:95]
ds_read_b64_tr_b16 a[164:165], v2 offset:24576
ds_read_b64_tr_b16 a[166:167], v2 offset:25088
v_fma_f32 v19, v19, v11, v10
v_mul_f32 v16, v16, v32
v_mul_f32 v17, v17, v33
v_mul_f32 v18, v18, v34
v_mul_f32 v19, v19, v35
s_waitcnt lgkmcnt(8)
v_mfma_f32_32x32x16_bf16 v[64:79], a[176:179], v[104:107], v[64:79]
ds_read_b64_tr_b16 a[168:169], v1 offset:26624
ds_read_b64_tr_b16 a[170:171], v1 offset:27136
v_exp_f32 v16, v16
v_exp_f32 v17, v17
v_exp_f32 v18, v18
v_exp_f32 v19, v19
v_mfma_f32_32x32x16_bf16 v[80:95], a[180:183], v[104:107], v[80:95]
ds_read_b64_tr_b16 a[172:173], v2 offset:26624
ds_read_b64_tr_b16 a[174:175], v2 offset:27136
v_fma_f32 v16, v16, v12, v12
v_fma_f32 v17, v17, v12, v12
v_fma_f32 v18, v18, v12, v12
v_fma_f32 v19, v19, v12, v12
v_rcp_f32 v16, v16
s_waitcnt lgkmcnt(8)
v_mfma_f32_32x32x16_bf16 v[64:79], a[184:187], v[108:111], v[64:79]
ds_read_b64_tr_b16 a[176:177], v1 offset:28672
ds_read_b64_tr_b16 a[178:179], v1 offset:29184
v_rcp_f32 v17, v17
v_rcp_f32 v18, v18
v_rcp_f32 v19, v19
v_mul_f32 v32, v32, v16
v_mfma_f32_32x32x16_bf16 v[80:95], a[188:191], v[108:111], v[80:95]
ds_read_b64_tr_b16 a[180:181], v2 offset:28672
ds_read_b64_tr_b16 a[182:183], v2 offset:29184
v_mul_f32 v33, v33, v17
v_mul_f32 v34, v34, v18
v_mul_f32 v35, v35, v19
v_mul_f32 v16, v36, v36
v_mul_f32 v17, v37, v37
s_waitcnt lgkmcnt(8)
v_mfma_f32_32x32x16_bf16 v[64:79], a[160:163], v[112:115], v[64:79]
ds_read_b64_tr_b16 a[184:185], v1 offset:30720
ds_read_b64_tr_b16 a[186:187], v1 offset:31232
v_mul_f32 v18, v38, v38
v_mul_f32 v19, v39, v39
v_fma_f32 v16, v16, v11, v10
v_fma_f32 v17, v17, v11, v10
v_fma_f32 v18, v18, v11, v10
v_fma_f32 v19, v19, v11, v10
v_mul_f32 v16, v16, v36
v_mfma_f32_32x32x16_bf16 v[80:95], a[164:167], v[112:115], v[80:95]
ds_read_b64_tr_b16 a[188:189], v2 offset:30720
ds_read_b64_tr_b16 a[190:191], v2 offset:31232
v_mul_f32 v17, v17, v37
v_mul_f32 v18, v18, v38
v_mul_f32 v19, v19, v39
v_exp_f32 v16, v16
v_exp_f32 v17, v17
s_waitcnt lgkmcnt(8)
v_mfma_f32_32x32x16_bf16 v[64:79], a[168:171], v[116:119], v[64:79]
s_waitcnt vmcnt(23)
s_barrier
ds_read_b64_tr_b16 a[160:161], v1 offset:32768
ds_read_b64_tr_b16 a[162:163], v1 offset:33280
s_add_u32 m0, s41, 49152
s_add_u32 s51, s63, s40
v_exp_f32 v18, v18
v_mfma_f32_32x32x16_bf16 v[80:95], a[172:175], v[116:119], v[80:95]
ds_read_b64_tr_b16 a[164:165], v2 offset:32768
ds_read_b64_tr_b16 a[166:167], v2 offset:33280
s_add_u32 s51, s51, 8
s_sub_u32 s52, s51, 10
s_cselect_b32 s51, s51, s52
v_exp_f32 v19, v19
v_fma_f32 v16, v16, v12, v12
s_waitcnt lgkmcnt(8)
v_mfma_f32_32x32x16_bf16 v[64:79], a[176:179], v[120:123], v[64:79]
ds_read_b64_tr_b16 a[168:169], v1 offset:34816
ds_read_b64_tr_b16 a[170:171], v1 offset:35328
s_mul_i32 s52, s51, s53
s_add_u32 s52, s52, s48
s_cmp_lt_u32 s40, 2
s_cselect_b32 s52, s52, 1073741824
v_fma_f32 v17, v17, v12, v12
v_fma_f32 v18, v18, v12, v12
v_fma_f32 v19, v19, v12, v12
v_mfma_f32_32x32x16_bf16 v[80:95], a[180:183], v[120:123], v[80:95]
ds_read_b64_tr_b16 a[172:173], v2 offset:34816
ds_read_b64_tr_b16 a[174:175], v2 offset:35328
buffer_load_dwordx4 v4, s[12:15], s52 offen lds
v_rcp_f32 v16, v16
s_waitcnt lgkmcnt(8)
v_mfma_f32_32x32x16_bf16 v[64:79], a[184:187], v[124:127], v[64:79]
ds_read_b64_tr_b16 a[176:177], v1 offset:36864
ds_read_b64_tr_b16 a[178:179], v1 offset:37376
buffer_load_dwordx4 v5, s[12:15], s52 offen offset:1024 lds
v_rcp_f32 v17, v17
v_rcp_f32 v18, v18
v_mfma_f32_32x32x16_bf16 v[80:95], a[188:191], v[124:127], v[80:95]
ds_read_b64_tr_b16 a[180:181], v2 offset:36864
ds_read_b64_tr_b16 a[182:183], v2 offset:37376
v_rcp_f32 v19, v19
v_mul_f32 v36, v36, v16
v_mul_f32 v37, v37, v17
v_mul_f32 v38, v38, v18
v_mul_f32 v39, v39, v19
s_waitcnt lgkmcnt(8)
v_mfma_f32_32x32x16_bf16 v[64:79], a[160:163], v[128:131], v[64:79]
ds_read_b64_tr_b16 a[184:185], v1 offset:38912
ds_read_b64_tr_b16 a[186:187], v1 offset:39424
buffer_load_dwordx4 v6, s[12:15], s52 offen offset:2048 lds
v_cvt_pk_bf16_f32 v32, v32, v33
v_cvt_pk_bf16_f32 v33, v34, v35
v_cvt_pk_bf16_f32 v34, v36, v37
v_mfma_f32_32x32x16_bf16 v[80:95], a[164:167], v[128:131], v[80:95]
ds_read_b64_tr_b16 a[188:189], v2 offset:38912
ds_read_b64_tr_b16 a[190:191], v2 offset:39424
v_cvt_pk_bf16_f32 v35, v38, v39
s_waitcnt lgkmcnt(8)
v_mfma_f32_32x32x16_bf16 v[64:79], a[168:171], v[132:135], v[64:79]
ds_read_b64_tr_b16 a[160:161], v1 offset:40960
ds_read_b64_tr_b16 a[162:163], v1 offset:41472
buffer_load_dwordx4 v7, s[12:15], s52 offen offset:3072 lds
buffer_store_dwordx4 v[32:35], v0, s[32:35], s49 offen sc1
v_mfma_f32_32x32x16_bf16 v[80:95], a[172:175], v[132:135], v[80:95]
ds_read_b64_tr_b16 a[164:165], v2 offset:40960
ds_read_b64_tr_b16 a[166:167], v2 offset:41472
s_movk_i32 s96, 1280
v_lshrrev_b32 v4, 3, v3
s_lshl_b32 s53, s40, 5
v_mul_f32 v16, v40, v40
s_waitcnt lgkmcnt(8)
v_mfma_f32_32x32x16_bf16 v[64:79], a[176:179], v[136:139], v[64:79]
ds_read_b64_tr_b16 a[168:169], v1 offset:43008
ds_read_b64_tr_b16 a[170:171], v1 offset:43520
s_lshr_b32 s52, s40, 1
s_mul_i32 s52, s52, 128
s_add_u32 s53, s53, s52
v_add_u32 v4, s53, v4
v_bfe_u32 v5, v3, 4, 1
v_lshlrev_b32 v5, 2, v5
v_and_b32 v6, 7, v3
v_xor_b32 v5, v5, v6
v_lshlrev_b32 v5, 4, v5
v_mad_u32_u24 v4, v4, s96, v5
s_lshl_b32 s53, s96, 3
s_sub_u32 s53, s53, 1024
v_add_u32 v4, s56, v4
v_add_u32 v5, s53, v4
v_add_u32 v6, s53, v5
v_add_u32 v7, s53, v6
s_lshl_b32 s53, s96, 6
s_add_u32 m0, s41, 65536
s_add_u32 s52, s55, 0
buffer_load_dwordx4 v4, s[16:19], s52 offen lds
v_mfma_f32_32x32x16_bf16 v[80:95], a[180:183], v[136:139], v[80:95]
ds_read_b64_tr_b16 a[172:173], v2 offset:43008
ds_read_b64_tr_b16 a[174:175], v2 offset:43520
buffer_load_dwordx4 v5, s[16:19], s52 offen offset:1024 lds
v_mul_f32 v17, v41, v41
v_mul_f32 v18, v42, v42
v_mul_f32 v19, v43, v43
s_waitcnt lgkmcnt(8)
v_mfma_f32_32x32x16_bf16 v[64:79], a[184:187], v[140:143], v[64:79]
ds_read_b64_tr_b16 a[176:177], v1 offset:45056
ds_read_b64_tr_b16 a[178:179], v1 offset:45568
buffer_load_dwordx4 v6, s[16:19], s52 offen offset:2048 lds
v_fma_f32 v16, v16, v11, v10
v_fma_f32 v17, v17, v11, v10
v_fma_f32 v18, v18, v11, v10
v_mfma_f32_32x32x16_bf16 v[80:95], a[188:191], v[140:143], v[80:95]
ds_read_b64_tr_b16 a[180:181], v2 offset:45056
ds_read_b64_tr_b16 a[182:183], v2 offset:45568
v_fma_f32 v19, v19, v11, v10
v_mul_f32 v16, v16, v40
v_mul_f32 v17, v17, v41
v_mul_f32 v18, v18, v42
v_mul_f32 v19, v19, v43
s_waitcnt lgkmcnt(8)
v_mfma_f32_32x32x16_bf16 v[64:79], a[160:163], v[144:147], v[64:79]
ds_read_b64_tr_b16 a[184:185], v1 offset:47104
ds_read_b64_tr_b16 a[186:187], v1 offset:47616
buffer_load_dwordx4 v7, s[16:19], s52 offen offset:3072 lds
v_exp_f32 v16, v16
v_exp_f32 v17, v17
v_mfma_f32_32x32x16_bf16 v[80:95], a[164:167], v[144:147], v[80:95]
ds_read_b64_tr_b16 a[188:189], v2 offset:47104
ds_read_b64_tr_b16 a[190:191], v2 offset:47616
v_exp_f32 v18, v18
v_exp_f32 v19, v19
v_fma_f32 v16, v16, v12, v12
v_fma_f32 v17, v17, v12, v12
s_waitcnt lgkmcnt(8)
v_mfma_f32_32x32x16_bf16 v[64:79], a[168:171], v[148:151], v[64:79]
s_waitcnt vmcnt(26)
s_barrier
ds_read_b64_tr_b16 a[160:161], v1 offset:49152
ds_read_b64_tr_b16 a[162:163], v1 offset:49664
s_add_u32 m0, s41, 81920
s_add_u32 s52, s55, 409600
v_fma_f32 v18, v18, v12, v12
v_fma_f32 v19, v19, v12, v12
v_rcp_f32 v16, v16
v_mfma_f32_32x32x16_bf16 v[80:95], a[172:175], v[148:151], v[80:95]
ds_read_b64_tr_b16 a[164:165], v2 offset:49152
ds_read_b64_tr_b16 a[166:167], v2 offset:49664
v_rcp_f32 v17, v17
v_rcp_f32 v18, v18
v_rcp_f32 v19, v19
s_waitcnt lgkmcnt(8)
v_mfma_f32_32x32x16_bf16 v[64:79], a[176:179], v[152:155], v[64:79]
ds_read_b64_tr_b16 a[168:169], v1 offset:51200
ds_read_b64_tr_b16 a[170:171], v1 offset:51712
buffer_load_dwordx4 v4, s[16:19], s52 offen lds
v_mul_f32 v40, v40, v16
v_mul_f32 v41, v41, v17
v_mul_f32 v42, v42, v18
v_mfma_f32_32x32x16_bf16 v[80:95], a[180:183], v[152:155], v[80:95]
ds_read_b64_tr_b16 a[172:173], v2 offset:51200
ds_read_b64_tr_b16 a[174:175], v2 offset:51712
v_mul_f32 v43, v43, v19
v_mul_f32 v16, v44, v44
v_mul_f32 v17, v45, v45
v_mul_f32 v18, v46, v46
v_mul_f32 v19, v47, v47
s_waitcnt lgkmcnt(8)
v_mfma_f32_32x32x16_bf16 v[64:79], a[184:187], v[156:159], v[64:79]
ds_read_b64_tr_b16 a[176:177], v1 offset:53248
ds_read_b64_tr_b16 a[178:179], v1 offset:53760
buffer_load_dwordx4 v5, s[16:19], s52 offen offset:1024 lds
v_fma_f32 v16, v16, v11, v10
v_fma_f32 v17, v17, v11, v10
v_fma_f32 v18, v18, v11, v10
v_fma_f32 v19, v19, v11, v10
v_mfma_f32_32x32x16_bf16 v[80:95], a[188:191], v[156:159], v[80:95]
ds_read_b64_tr_b16 a[180:181], v2 offset:53248
ds_read_b64_tr_b16 a[182:183], v2 offset:53760
v_mul_f32 v16, v16, v44
v_mul_f32 v17, v17, v45
v_mul_f32 v18, v18, v46
v_mul_f32 v19, v19, v47
v_exp_f32 v16, v16
s_waitcnt lgkmcnt(8)
v_mfma_f32_32x32x16_bf16 v[64:79], a[160:163], v[160:163], v[64:79]
ds_read_b64_tr_b16 a[184:185], v1 offset:55296
ds_read_b64_tr_b16 a[186:187], v1 offset:55808
v_exp_f32 v17, v17
v_exp_f32 v18, v18
v_exp_f32 v19, v19
v_fma_f32 v16, v16, v12, v12
v_mfma_f32_32x32x16_bf16 v[80:95], a[164:167], v[160:163], v[80:95]
ds_read_b64_tr_b16 a[188:189], v2 offset:55296
ds_read_b64_tr_b16 a[190:191], v2 offset:55808
v_fma_f32 v17, v17, v12, v12
v_fma_f32 v18, v18, v12, v12
v_fma_f32 v19, v19, v12, v12
v_rcp_f32 v16, v16
s_waitcnt lgkmcnt(8)
v_mfma_f32_32x32x16_bf16 v[64:79], a[168:171], v[164:167], v[64:79]
ds_read_b64_tr_b16 a[160:161], v1 offset:57344
ds_read_b64_tr_b16 a[162:163], v1 offset:57856
buffer_load_dwordx4 v6, s[16:19], s52 offen offset:2048 lds
v_rcp_f32 v17, v17
v_rcp_f32 v18, v18
v_mfma_f32_32x32x16_bf16 v[80:95], a[172:175], v[164:167], v[80:95]
ds_read_b64_tr_b16 a[164:165], v2 offset:57344
ds_read_b64_tr_b16 a[166:167], v2 offset:57856
v_rcp_f32 v19, v19
v_mul_f32 v44, v44, v16
v_mul_f32 v45, v45, v17
v_mul_f32 v46, v46, v18
v_mul_f32 v47, v47, v19
s_waitcnt lgkmcnt(8)
v_mfma_f32_32x32x16_bf16 v[64:79], a[176:179], v[168:171], v[64:79]
ds_read_b64_tr_b16 a[168:169], v1 offset:59392
ds_read_b64_tr_b16 a[170:171], v1 offset:59904
buffer_load_dwordx4 v7, s[16:19], s52 offen offset:3072 lds
v_cvt_pk_bf16_f32 v40, v40, v41
v_cvt_pk_bf16_f32 v41, v42, v43
v_cvt_pk_bf16_f32 v42, v44, v45
v_mfma_f32_32x32x16_bf16 v[80:95], a[180:183], v[168:171], v[80:95]
ds_read_b64_tr_b16 a[172:173], v2 offset:59392
ds_read_b64_tr_b16 a[174:175], v2 offset:59904
v_cvt_pk_bf16_f32 v43, v46, v47
buffer_store_dwordx4 v[40:43], v0, s[32:35], s49 offen offset:1024 sc1
s_waitcnt lgkmcnt(8)
v_mfma_f32_32x32x16_bf16 v[64:79], a[184:187], v[172:175], v[64:79]
ds_read_b64_tr_b16 a[176:177], v1 offset:61440
ds_read_b64_tr_b16 a[178:179], v1 offset:61952
v_mul_f32 v16, v48, v48
v_mul_f32 v17, v49, v49
v_mfma_f32_32x32x16_bf16 v[80:95], a[188:191], v[172:175], v[80:95]
ds_read_b64_tr_b16 a[180:181], v2 offset:61440
ds_read_b64_tr_b16 a[182:183], v2 offset:61952
v_mul_f32 v18, v50, v50
v_mul_f32 v19, v51, v51
v_fma_f32 v16, v16, v11, v10
v_fma_f32 v17, v17, v11, v10
v_fma_f32 v18, v18, v11, v10
v_fma_f32 v19, v19, v11, v10
s_waitcnt lgkmcnt(8)
v_mfma_f32_32x32x16_bf16 v[64:79], a[160:163], v[176:179], v[64:79]
ds_read_b64_tr_b16 a[184:185], v1 offset:63488
ds_read_b64_tr_b16 a[186:187], v1 offset:64000
s_getpc_b64 s[86:87]
L_pc12:
s_lshl_b32 s3, s42, 3
s_xor_b32 s3, s3, s43
s_lshl_b32 s3, s3, 2
v_mul_f32 v16, v16, v48
v_mul_f32 v17, v17, v49
v_mul_f32 v18, v18, v50
v_mfma_f32_32x32x16_bf16 v[80:95], a[164:167], v[176:179], v[80:95]
ds_read_b64_tr_b16 a[188:189], v2 offset:63488
ds_read_b64_tr_b16 a[190:191], v2 offset:64000
s_add_u32 s3, s3, s40
s_mul_i32 s3, s3, 8
s_and_b32 s3, s3, 1023
v_mul_f32 v19, v19, v51
v_exp_f32 v16, v16
s_waitcnt lgkmcnt(8)
v_mfma_f32_32x32x16_bf16 v[64:79], a[168:171], v[180:183], v[64:79]
s_waitcnt vmcnt(27)
s_barrier
v_add_u32 v1, 65536, v1
v_add_u32 v2, 65536, v2
ds_read_b64_tr_b16 a[160:161], v1 offset:0
ds_read_b64_tr_b16 a[162:163], v1 offset:512
v_exp_f32 v17, v17
v_mfma_f32_32x32x16_bf16 v[80:95], a[172:175], v[180:183], v[80:95]
ds_read_b64_tr_b16 a[164:165], v2 offset:0
ds_read_b64_tr_b16 a[166:167], v2 offset:512
s_add_u32 m0, s41, 98304
s_add_u32 s52, s55, 81920
v_min_u32 v26, 7, v3
v_add_lshl_u32 v26, v26, s3, 7
v_min_u32 v26, L_codeend-L_pc12-4, v26
v_and_b32 v26, -4, v26
global_load_dword a223, v26, s[86:87]
s_waitcnt lgkmcnt(8)
v_mfma_f32_32x32x16_bf16 v[64:79], a[176:179], v[184:187], v[64:79]
ds_read_b64_tr_b16 a[168:169], v1 offset:2048
ds_read_b64_tr_b16 a[170:171], v1 offset:2560
buffer_load_dwordx4 v4, s[16:19], s52 offen lds
v_exp_f32 v18, v18
v_exp_f32 v19, v19
v_mfma_f32_32x32x16_bf16 v[80:95], a[180:183], v[184:187], v[80:95]
ds_read_b64_tr_b16 a[172:173], v2 offset:2048
ds_read_b64_tr_b16 a[174:175], v2 offset:2560
v_fma_f32 v16, v16, v12, v12
v_fma_f32 v17, v17, v12, v12
v_fma_f32 v18, v18, v12, v12
v_fma_f32 v19, v19, v12, v12
v_rcp_f32 v16, v16
s_waitcnt lgkmcnt(8)
v_mfma_f32_32x32x16_bf16 v[64:79], a[184:187], v[188:191], v[64:79]
ds_read_b64_tr_b16 a[176:177], v1 offset:4096
ds_read_b64_tr_b16 a[178:179], v1 offset:4608
buffer_load_dwordx4 v5, s[16:19], s52 offen offset:1024 lds
v_rcp_f32 v17, v17
v_rcp_f32 v18, v18
v_mfma_f32_32x32x16_bf16 v[80:95], a[188:191], v[188:191], v[80:95]
ds_read_b64_tr_b16 a[180:181], v2 offset:4096
ds_read_b64_tr_b16 a[182:183], v2 offset:4608
v_rcp_f32 v19, v19
v_mul_f32 v48, v48, v16
v_mul_f32 v49, v49, v17
v_mul_f32 v50, v50, v18
s_waitcnt lgkmcnt(8)
v_mfma_f32_32x32x16_bf16 v[64:79], a[160:163], v[192:195], v[64:79]
ds_read_b64_tr_b16 a[184:185], v1 offset:6144
ds_read_b64_tr_b16 a[186:187], v1 offset:6656
v_mul_f32 v51, v51, v19
v_mul_f32 v16, v52, v52
v_mul_f32 v17, v53, v53
v_mul_f32 v18, v54, v54
v_mul_f32 v19, v55, v55
v_fma_f32 v16, v16, v11, v10
v_fma_f32 v17, v17, v11, v10
v_mfma_f32_32x32x16_bf16 v[80:95], a[164:167], v[192:195], v[80:95]
ds_read_b64_tr_b16 a[188:189], v2 offset:6144
ds_read_b64_tr_b16 a[190:191], v2 offset:6656
v_fma_f32 v18, v18, v11, v10
v_fma_f32 v19, v19, v11, v10
v_mul_f32 v16, v16, v52
v_mul_f32 v17, v17, v53
v_mul_f32 v18, v18, v54
v_mul_f32 v19, v19, v55
s_waitcnt lgkmcnt(8)
v_mfma_f32_32x32x16_bf16 v[64:79], a[168:171], v[196:199], v[64:79]
ds_read_b64_tr_b16 a[160:161], v1 offset:8192
ds_read_b64_tr_b16 a[162:163], v1 offset:8704
buffer_load_dwordx4 v6, s[16:19], s52 offen offset:2048 lds
v_exp_f32 v16, v16
v_exp_f32 v17, v17
v_mfma_f32_32x32x16_bf16 v[80:95], a[172:175], v[196:199], v[80:95]
ds_read_b64_tr_b16 a[164:165], v2 offset:8192
ds_read_b64_tr_b16 a[166:167], v2 offset:8704
v_exp_f32 v18, v18
v_exp_f32 v19, v19
v_fma_f32 v16, v16, v12, v12
s_waitcnt lgkmcnt(8)
v_mfma_f32_32x32x16_bf16 v[64:79], a[176:179], v[200:203], v[64:79]
ds_read_b64_tr_b16 a[168:169], v1 offset:10240
ds_read_b64_tr_b16 a[170:171], v1 offset:10752
buffer_load_dwordx4 v7, s[16:19], s52 offen offset:3072 lds
v_fma_f32 v17, v17, v12, v12
v_fma_f32 v18, v18, v12, v12
v_fma_f32 v19, v19, v12, v12
v_mfma_f32_32x32x16_bf16 v[80:95], a[180:183], v[200:203], v[80:95]
ds_read_b64_tr_b16 a[172:173], v2 offset:10240
ds_read_b64_tr_b16 a[174:175], v2 offset:10752
v_bfe_u32 v30, v3, 2, 2
v_lshrrev_b32 v31, 5, v3
v_lshl_add_u32 v30, v31, 3, v30
v_rcp_f32 v16, v16
v_rcp_f32 v17, v17
s_waitcnt lgkmcnt(8)
v_mfma_f32_32x32x16_bf16 v[64:79], a[184:187], v[204:207], v[64:79]
ds_read_b64_tr_b16 a[176:177], v1 offset:12288
ds_read_b64_tr_b16 a[178:179], v1 offset:12800
v_lshlrev_b32 v31, 6, v30
v_bfe_u32 v30, v3, 4, 1
v_lshl_add_u32 v31, v30, 5, v31
v_and_b32 v30, 3, v3
v_rcp_f32 v18, v18
v_mfma_f32_32x32x16_bf16 v[80:95], a[188:191], v[204:207], v[80:95]
ds_read_b64_tr_b16 a[180:181], v2 offset:12288
ds_read_b64_tr_b16 a[182:183], v2 offset:12800
v_lshl_add_u32 v31, v30, 3, v31
v_rcp_f32 v19, v19
v_mul_f32 v52, v52, v16
v_mul_f32 v53, v53, v17
v_mul_f32 v54, v54, v18
v_mul_f32 v55, v55, v19
s_waitcnt lgkmcnt(8)
v_mfma_f32_32x32x16_bf16 v[64:79], a[160:163], v[208:211], v[64:79]
ds_read_b64_tr_b16 a[184:185], v1 offset:14336
ds_read_b64_tr_b16 a[186:187], v1 offset:14848
v_cvt_pk_bf16_f32 v48, v48, v49
v_cvt_pk_bf16_f32 v49, v50, v51
v_cvt_pk_bf16_f32 v50, v52, v53
v_cvt_pk_bf16_f32 v51, v54, v55
v_mfma_f32_32x32x16_bf16 v[80:95], a[164:167], v[208:211], v[80:95]
ds_read_b64_tr_b16 a[188:189], v2 offset:14336
ds_read_b64_tr_b16 a[190:191], v2 offset:14848
buffer_store_dwordx4 v[48:51], v0, s[32:35], s49 offen offset:2048 sc1
s_waitcnt lgkmcnt(8)
v_mfma_f32_32x32x16_bf16 v[64:79], a[168:171], v[212:215], v[64:79]
s_waitcnt vmcnt(28)
s_barrier
v_subrev_u32 v1, 131072, v1
v_subrev_u32 v2, 131072, v2
ds_read_b64_tr_b16 a[160:161], v1 offset:0
ds_read_b64_tr_b16 a[162:163], v1 offset:512
v_mul_f32 v16, v56, v56
v_mfma_f32_32x32x16_bf16 v[80:95], a[172:175], v[212:215], v[80:95]
ds_read_b64_tr_b16 a[164:165], v2 offset:0
ds_read_b64_tr_b16 a[166:167], v2 offset:512
s_add_u32 m0, s41, 114688
s_add_u32 s52, s55, 491520
v_mul_f32 v17, v57, v57
v_mul_f32 v18, v58, v58
v_mul_f32 v19, v59, v59
v_fma_f32 v16, v16, v11, v10
s_waitcnt lgkmcnt(8)
v_mfma_f32_32x32x16_bf16 v[64:79], a[176:179], v[216:219], v[64:79]
ds_read_b64_tr_b16 a[168:169], v1 offset:2048
ds_read_b64_tr_b16 a[170:171], v1 offset:2560
buffer_load_dwordx4 v4, s[16:19], s52 offen lds
v_fma_f32 v17, v17, v11, v10
v_fma_f32 v18, v18, v11, v10
v_fma_f32 v19, v19, v11, v10
v_mul_f32 v16, v16, v56
v_mfma_f32_32x32x16_bf16 v[80:95], a[180:183], v[216:219], v[80:95]
ds_read_b64_tr_b16 a[172:173], v2 offset:2048
ds_read_b64_tr_b16 a[174:175], v2 offset:2560
v_mul_f32 v17, v17, v57
v_mul_f32 v18, v18, v58
v_mul_f32 v19, v19, v59
v_exp_f32 v16, v16
s_waitcnt lgkmcnt(8)
v_mfma_f32_32x32x16_bf16 v[64:79], a[184:187], v[220:223], v[64:79]
ds_read_b64_tr_b16 a[176:177], v1 offset:4096
ds_read_b64_tr_b16 a[178:179], v1 offset:4608
buffer_load_dwordx4 v5, s[16:19], s52 offen offset:1024 lds
v_exp_f32 v17, v17
v_exp_f32 v18, v18
v_mfma_f32_32x32x16_bf16 v[80:95], a[188:191], v[220:223], v[80:95]
ds_read_b64_tr_b16 a[180:181], v2 offset:4096
ds_read_b64_tr_b16 a[182:183], v2 offset:4608
buffer_load_dword v29, off, s[36:39], 0 offset:128 sc1
v_exp_f32 v19, v19
s_waitcnt lgkmcnt(8)
v_mfma_f32_32x32x16_bf16 v[64:79], a[160:163], v[224:227], v[64:79]
ds_read_b64_tr_b16 a[184:185], v1 offset:6144
ds_read_b64_tr_b16 a[186:187], v1 offset:6656
v_fma_f32 v16, v16, v12, v12
v_fma_f32 v17, v17, v12, v12
v_fma_f32 v18, v18, v12, v12
v_fma_f32 v19, v19, v12, v12
v_rcp_f32 v16, v16
v_rcp_f32 v17, v17
v_mfma_f32_32x32x16_bf16 v[80:95], a[164:167], v[224:227], v[80:95]
ds_read_b64_tr_b16 a[188:189], v2 offset:6144
ds_read_b64_tr_b16 a[190:191], v2 offset:6656
v_rcp_f32 v18, v18
v_rcp_f32 v19, v19
v_mul_f32 v56, v56, v16
s_waitcnt lgkmcnt(8)
v_mfma_f32_32x32x16_bf16 v[64:79], a[168:171], v[228:231], v[64:79]
ds_read_b64_tr_b16 a[160:161], v1 offset:8192
ds_read_b64_tr_b16 a[162:163], v1 offset:8704
buffer_load_dwordx4 v6, s[16:19], s52 offen offset:2048 lds
v_mul_f32 v57, v57, v17
v_mul_f32 v58, v58, v18
v_mul_f32 v59, v59, v19
v_mfma_f32_32x32x16_bf16 v[80:95], a[172:175], v[228:231], v[80:95]
ds_read_b64_tr_b16 a[164:165], v2 offset:8192
ds_read_b64_tr_b16 a[166:167], v2 offset:8704
v_mul_f32 v16, v60, v60
v_mul_f32 v17, v61, v61
v_mul_f32 v18, v62, v62
v_mul_f32 v19, v63, v63
v_fma_f32 v16, v16, v11, v10
v_fma_f32 v17, v17, v11, v10
s_waitcnt lgkmcnt(8)
v_mfma_f32_32x32x16_bf16 v[64:79], a[176:179], v[232:235], v[64:79]
ds_read_b64_tr_b16 a[168:169], v1 offset:10240
ds_read_b64_tr_b16 a[170:171], v1 offset:10752
buffer_load_dwordx4 v7, s[16:19], s52 offen offset:3072 lds
v_fma_f32 v18, v18, v11, v10
v_fma_f32 v19, v19, v11, v10
v_mul_f32 v16, v16, v60
v_mul_f32 v17, v17, v61
v_mfma_f32_32x32x16_bf16 v[80:95], a[180:183], v[232:235], v[80:95]
ds_read_b64_tr_b16 a[172:173], v2 offset:10240
ds_read_b64_tr_b16 a[174:175], v2 offset:10752
v_mul_f32 v18, v18, v62
v_mul_f32 v19, v19, v63
v_exp_f32 v16, v16
v_exp_f32 v17, v17
s_waitcnt lgkmcnt(8)
v_mfma_f32_32x32x16_bf16 v[64:79], a[184:187], v[236:239], v[64:79]
ds_read_b64_tr_b16 a[176:177], v1 offset:12288
ds_read_b64_tr_b16 a[178:179], v1 offset:12800
v_exp_f32 v18, v18
v_exp_f32 v19, v19
v_fma_f32 v16, v16, v12, v12
v_fma_f32 v17, v17, v12, v12
v_fma_f32 v18, v18, v12, v12
v_mfma_f32_32x32x16_bf16 v[80:95], a[188:191], v[236:239], v[80:95]
ds_read_b64_tr_b16 a[180:181], v2 offset:12288
ds_read_b64_tr_b16 a[182:183], v2 offset:12800
v_fma_f32 v19, v19, v12, v12
v_rcp_f32 v16, v16
v_rcp_f32 v17, v17
s_waitcnt lgkmcnt(8)
v_mfma_f32_32x32x16_bf16 v[64:79], a[160:163], v[240:243], v[64:79]
ds_read_b64_tr_b16 a[184:185], v1 offset:14336
ds_read_b64_tr_b16 a[186:187], v1 offset:14848
v_rcp_f32 v18, v18
v_rcp_f32 v19, v19
v_mul_f32 v60, v60, v16
v_mul_f32 v61, v61, v17
v_mul_f32 v62, v62, v18
v_mfma_f32_32x32x16_bf16 v[80:95], a[164:167], v[240:243], v[80:95]
ds_read_b64_tr_b16 a[188:189], v2 offset:14336
ds_read_b64_tr_b16 a[190:191], v2 offset:14848
v_mul_f32 v63, v63, v19
v_cvt_pk_bf16_f32 v56, v56, v57
v_cvt_pk_bf16_f32 v57, v58, v59
v_cvt_pk_bf16_f32 v58, v60, v61
v_cvt_pk_bf16_f32 v59, v62, v63
s_waitcnt lgkmcnt(8)
v_mfma_f32_32x32x16_bf16 v[64:79], a[168:171], v[244:247], v[64:79]
s_waitcnt vmcnt(29)
s_barrier
v_add_u32 v1, 0, v31
ds_read_b64_tr_b16 a[160:161], v1 offset:16384
ds_read_b64_tr_b16 a[162:163], v1 offset:16640
s_movk_i32 s96, 1280
v_mfma_f32_32x32x16_bf16 v[80:95], a[172:175], v[244:247], v[80:95]
v_lshrrev_b32 v4, 3, v3
s_lshl_b32 s53, s40, 5
s_lshr_b32 s52, s40, 1
s_mul_i32 s52, s52, 256
s_add_u32 s53, s53, s52
buffer_store_dwordx4 v[56:59], v0, s[32:35], s49 offen offset:3072 sc1
s_waitcnt lgkmcnt(6)
v_mfma_f32_32x32x16_bf16 v[64:79], a[176:179], v[248:251], v[64:79]
ds_read_b64_tr_b16 a[168:169], v1 offset:17408
ds_read_b64_tr_b16 a[170:171], v1 offset:17664
v_add_u32 v4, s53, v4
v_bfe_u32 v5, v3, 4, 1
v_lshlrev_b32 v5, 2, v5
v_and_b32 v6, 7, v3
v_mfma_f32_32x32x16_bf16 v[80:95], a[180:183], v[248:251], v[80:95]
v_xor_b32 v5, v5, v6
v_lshlrev_b32 v5, 4, v5
v_mad_u32_u24 v4, v4, s96, v5
s_lshl_b32 s53, s96, 3
s_sub_u32 s53, s53, 1024
v_add_u32 v4, s56, v4
v_add_u32 v5, s53, v4
v_add_u32 v6, s53, v5
v_add_u32 v7, s53, v6
s_lshl_b32 s53, s96, 6
s_add_u32 m0, s41, 131072
s_add_u32 s52, s55, 163840
buffer_load_dwordx4 v4, s[16:19], s52 offen lds
s_waitcnt lgkmcnt(4)
v_mfma_f32_32x32x16_bf16 v[64:79], a[184:187], v[252:255], v[64:79]
ds_read_b64_tr_b16 a[176:177], v1 offset:18432
ds_read_b64_tr_b16 a[178:179], v1 offset:18688
buffer_load_dwordx4 v5, s[16:19], s52 offen offset:1024 lds
v_mfma_f32_32x32x16_bf16 v[80:95], a[188:191], v[252:255], v[80:95]
buffer_load_dwordx4 v6, s[16:19], s52 offen offset:2048 lds
buffer_load_dwordx4 v7, s[16:19], s52 offen offset:3072 lds
s_waitcnt vmcnt(7)
v_cmp_gt_u32 vcc, 1, v29
s_nop 1
s_cbranch_vccnz L_pw9
L_pr11:
s_waitcnt lgkmcnt(4)
v_mfma_f32_32x32x16_bf16 v[32:47], a[160:163], v[96:99], 0
ds_read_b64_tr_b16 a[184:185], v1 offset:19456
ds_read_b64_tr_b16 a[186:187], v1 offset:19712
s_waitcnt lgkmcnt(4)
v_mfma_f32_32x32x16_bf16 v[32:47], a[168:171], v[100:103], v[32:47]
ds_read_b64_tr_b16 a[160:161], v1 offset:20480
ds_read_b64_tr_b16 a[162:163], v1 offset:20736
s_waitcnt lgkmcnt(4)
v_mfma_f32_32x32x16_bf16 v[32:47], a[176:179], v[104:107], v[32:47]
ds_read_b64_tr_b16 a[168:169], v1 offset:21504
ds_read_b64_tr_b16 a[170:171], v1 offset:21760
v_mul_f32 v16, v64, v64
v_mul_f32 v17, v65, v65
v_mul_f32 v18, v66, v66
v_mul_f32 v19, v67, v67
v_fma_f32 v16, v16, v11, v10
v_fma_f32 v17, v17, v11, v10
v_fma_f32 v18, v18, v11, v10
v_fma_f32 v19, v19, v11, v10
v_mul_f32 v16, v16, v64
v_mul_f32 v17, v17, v65
v_mul_f32 v18, v18, v66
v_mul_f32 v19, v19, v67
v_exp_f32 v16, v16
s_waitcnt lgkmcnt(4)
v_mfma_f32_32x32x16_bf16 v[32:47], a[184:187], v[108:111], v[32:47]
ds_read_b64_tr_b16 a[176:177], v1 offset:22528
ds_read_b64_tr_b16 a[178:179], v1 offset:22784
v_exp_f32 v17, v17
v_exp_f32 v18, v18
v_exp_f32 v19, v19
v_fma_f32 v16, v16, v12, v12
v_fma_f32 v17, v17, v12, v12
v_fma_f32 v18, v18, v12, v12
v_fma_f32 v19, v19, v12, v12
v_rcp_f32 v16, v16
s_waitcnt lgkmcnt(4)
v_mfma_f32_32x32x16_bf16 v[32:47], a[160:163], v[112:115], v[32:47]
ds_read_b64_tr_b16 a[184:185], v1 offset:23552
ds_read_b64_tr_b16 a[186:187], v1 offset:23808
v_rcp_f32 v17, v17
v_rcp_f32 v18, v18
v_rcp_f32 v19, v19
v_mul_f32 v64, v64, v16
v_mul_f32 v65, v65, v17
v_mul_f32 v66, v66, v18
v_mul_f32 v67, v67, v19
v_mul_f32 v16, v68, v68
v_mul_f32 v17, v69, v69
v_mul_f32 v18, v70, v70
s_waitcnt lgkmcnt(4)
v_mfma_f32_32x32x16_bf16 v[32:47], a[168:171], v[116:119], v[32:47]
ds_read_b64_tr_b16 a[160:161], v1 offset:24576
ds_read_b64_tr_b16 a[162:163], v1 offset:24832
v_mul_f32 v19, v71, v71
v_fma_f32 v16, v16, v11, v10
v_fma_f32 v17, v17, v11, v10
v_fma_f32 v18, v18, v11, v10
v_fma_f32 v19, v19, v11, v10
v_mul_f32 v16, v16, v68
v_mul_f32 v17, v17, v69
v_mul_f32 v18, v18, v70
v_mul_f32 v19, v19, v71
v_exp_f32 v16, v16
v_exp_f32 v17, v17
s_waitcnt lgkmcnt(4)
v_mfma_f32_32x32x16_bf16 v[32:47], a[176:179], v[120:123], v[32:47]
ds_read_b64_tr_b16 a[168:169], v1 offset:25600
ds_read_b64_tr_b16 a[170:171], v1 offset:25856
v_exp_f32 v18, v18
v_exp_f32 v19, v19
v_fma_f32 v16, v16, v12, v12
v_fma_f32 v17, v17, v12, v12
v_fma_f32 v18, v18, v12, v12
v_fma_f32 v19, v19, v12, v12
v_rcp_f32 v16, v16
v_rcp_f32 v17, v17
v_rcp_f32 v18, v18
s_waitcnt lgkmcnt(4)
v_mfma_f32_32x32x16_bf16 v[32:47], a[184:187], v[124:127], v[32:47]
ds_read_b64_tr_b16 a[176:177], v1 offset:26624
ds_read_b64_tr_b16 a[178:179], v1 offset:26880
v_rcp_f32 v19, v19
v_mul_f32 v68, v68, v16
v_mul_f32 v69, v69, v17
v_mul_f32 v70, v70, v18
v_mul_f32 v71, v71, v19
v_cvt_pk_bf16_f32 v64, v64, v65
v_cvt_pk_bf16_f32 v65, v66, v67
v_cvt_pk_bf16_f32 v66, v68, v69
v_cvt_pk_bf16_f32 v67, v70, v71
s_waitcnt lgkmcnt(4)
v_mfma_f32_32x32x16_bf16 v[32:47], a[160:163], v[128:131], v[32:47]
ds_read_b64_tr_b16 a[184:185], v1 offset:27648
ds_read_b64_tr_b16 a[186:187], v1 offset:27904
buffer_store_dwordx4 v[64:67], v0, s[32:35], s7 offen sc1
v_mul_f32 v16, v72, v72
v_mul_f32 v17, v73, v73
v_mul_f32 v18, v74, v74
v_mul_f32 v19, v75, v75
v_fma_f32 v16, v16, v11, v10
v_fma_f32 v17, v17, v11, v10
s_waitcnt lgkmcnt(4)
v_mfma_f32_32x32x16_bf16 v[32:47], a[168:171], v[132:135], v[32:47]
ds_read_b64_tr_b16 a[160:161], v1 offset:28672
ds_read_b64_tr_b16 a[162:163], v1 offset:28928
v_fma_f32 v18, v18, v11, v10
v_fma_f32 v19, v19, v11, v10
v_mul_f32 v16, v16, v72
v_mul_f32 v17, v17, v73
v_mul_f32 v18, v18, v74
v_mul_f32 v19, v19, v75
v_exp_f32 v16, v16
v_exp_f32 v17, v17
v_exp_f32 v18, v18
v_exp_f32 v19, v19
s_waitcnt lgkmcnt(4)
v_mfma_f32_32x32x16_bf16 v[32:47], a[176:179], v[136:139], v[32:47]
ds_read_b64_tr_b16 a[168:169], v1 offset:29696
ds_read_b64_tr_b16 a[170:171], v1 offset:29952
v_fma_f32 v16, v16, v12, v12
v_fma_f32 v17, v17, v12, v12
v_fma_f32 v18, v18, v12, v12
v_fma_f32 v19, v19, v12, v12
v_rcp_f32 v16, v16
v_rcp_f32 v17, v17
v_rcp_f32 v18, v18
v_rcp_f32 v19, v19
s_waitcnt lgkmcnt(4)
v_mfma_f32_32x32x16_bf16 v[32:47], a[184:187], v[140:143], v[32:47]
ds_read_b64_tr_b16 a[176:177], v1 offset:30720
ds_read_b64_tr_b16 a[178:179], v1 offset:30976
v_mul_f32 v72, v72, v16
v_mul_f32 v73, v73, v17
v_mul_f32 v74, v74, v18
v_mul_f32 v75, v75, v19
v_mul_f32 v16, v76, v76
v_mul_f32 v17, v77, v77
v_mul_f32 v18, v78, v78
v_mul_f32 v19, v79, v79
v_fma_f32 v16, v16, v11, v10
v_fma_f32 v17, v17, v11, v10
v_fma_f32 v18, v18, v11, v10
v_fma_f32 v19, v19, v11, v10
v_mul_f32 v16, v16, v76
s_waitcnt lgkmcnt(4)
v_mfma_f32_32x32x16_bf16 v[32:47], a[160:163], v[144:147], v[32:47]
ds_read_b64_tr_b16 a[184:185], v1 offset:31744
ds_read_b64_tr_b16 a[186:187], v1 offset:32000
s_waitcnt vmcnt(5)
v_mul_f32 v17, v17, v77
v_mul_f32 v18, v18, v78
v_mul_f32 v19, v19, v79
v_exp_f32 v16, v16
v_exp_f32 v17, v17
v_exp_f32 v18, v18
v_exp_f32 v19, v19
v_fma_f32 v16, v16, v12, v12
v_fma_f32 v17, v17, v12, v12
s_waitcnt lgkmcnt(4)
v_mfma_f32_32x32x16_bf16 v[32:47], a[168:171], v[148:151], v[32:47]
s_barrier
ds_read_b64_tr_b16 a[160:161], v1 offset:32768
ds_read_b64_tr_b16 a[162:163], v1 offset:33024
buffer_atomic_add v14, v13, s[32:35], s79 offen sc1
v_fma_f32 v18, v18, v12, v12
v_fma_f32 v19, v19, v12, v12
v_rcp_f32 v16, v16
v_rcp_f32 v17, v17
v_rcp_f32 v18, v18
s_waitcnt lgkmcnt(4)
v_mfma_f32_32x32x16_bf16 v[32:47], a[176:179], v[152:155], v[32:47]
ds_read_b64_tr_b16 a[168:169], v1 offset:33792
ds_read_b64_tr_b16 a[170:171], v1 offset:34048
v_rcp_f32 v19, v19
v_mul_f32 v76, v76, v16
v_mul_f32 v77, v77, v17
v_mul_f32 v78, v78, v18
v_mul_f32 v79, v79, v19
v_cvt_pk_bf16_f32 v72, v72, v73
v_cvt_pk_bf16_f32 v73, v74, v75
v_cvt_pk_bf16_f32 v74, v76, v77
v_cvt_pk_bf16_f32 v75, v78, v79
s_waitcnt lgkmcnt(4)
v_mfma_f32_32x32x16_bf16 v[32:47], a[184:187], v[156:159], v[32:47]
ds_read_b64_tr_b16 a[176:177], v1 offset:34816
ds_read_b64_tr_b16 a[178:179], v1 offset:35072
buffer_store_dwordx4 v[72:75], v0, s[32:35], s7 offen offset:1024 sc1
v_mul_f32 v16, v80, v80
v_mul_f32 v17, v81, v81
v_mul_f32 v18, v82, v82
v_mul_f32 v19, v83, v83
v_fma_f32 v16, v16, v11, v10
v_fma_f32 v17, v17, v11, v10
s_waitcnt lgkmcnt(4)
v_mfma_f32_32x32x16_bf16 v[32:47], a[160:163], v[160:163], v[32:47]
ds_read_b64_tr_b16 a[184:185], v1 offset:35840
ds_read_b64_tr_b16 a[186:187], v1 offset:36096
v_fma_f32 v18, v18, v11, v10
v_fma_f32 v19, v19, v11, v10
v_mul_f32 v16, v16, v80
v_mul_f32 v17, v17, v81
v_mul_f32 v18, v18, v82
v_mul_f32 v19, v19, v83
v_exp_f32 v16, v16
v_exp_f32 v17, v17
v_exp_f32 v18, v18
v_exp_f32 v19, v19
s_waitcnt lgkmcnt(4)
v_mfma_f32_32x32x16_bf16 v[32:47], a[168:171], v[164:167], v[32:47]
ds_read_b64_tr_b16 a[160:161], v1 offset:36864
ds_read_b64_tr_b16 a[162:163], v1 offset:37120
v_fma_f32 v16, v16, v12, v12
v_fma_f32 v17, v17, v12, v12
v_fma_f32 v18, v18, v12, v12
v_fma_f32 v19, v19, v12, v12
v_rcp_f32 v16, v16
v_rcp_f32 v17, v17
v_rcp_f32 v18, v18
v_rcp_f32 v19, v19
v_mul_f32 v80, v80, v16
s_waitcnt lgkmcnt(4)
v_mfma_f32_32x32x16_bf16 v[32:47], a[176:179], v[168:171], v[32:47]
ds_read_b64_tr_b16 a[168:169], v1 offset:37888
ds_read_b64_tr_b16 a[170:171], v1 offset:38144
v_mul_f32 v81, v81, v17
v_mul_f32 v82, v82, v18
v_mul_f32 v83, v83, v19
v_mul_f32 v16, v84, v84
v_mul_f32 v17, v85, v85
v_mul_f32 v18, v86, v86
v_mul_f32 v19, v87, v87
v_fma_f32 v16, v16, v11, v10
v_fma_f32 v17, v17, v11, v10
v_fma_f32 v18, v18, v11, v10
v_fma_f32 v19, v19, v11, v10
v_mul_f32 v16, v16, v84
v_mul_f32 v17, v17, v85
s_waitcnt lgkmcnt(4)
v_mfma_f32_32x32x16_bf16 v[32:47], a[184:187], v[172:175], v[32:47]
ds_read_b64_tr_b16 a[176:177], v1 offset:38912
ds_read_b64_tr_b16 a[178:179], v1 offset:39168
v_mul_f32 v18, v18, v86
v_mul_f32 v19, v19, v87
v_exp_f32 v16, v16
v_exp_f32 v17, v17
v_exp_f32 v18, v18
v_exp_f32 v19, v19
v_fma_f32 v16, v16, v12, v12
v_fma_f32 v17, v17, v12, v12
v_fma_f32 v18, v18, v12, v12
s_waitcnt lgkmcnt(4)
v_mfma_f32_32x32x16_bf16 v[32:47], a[160:163], v[176:179], v[32:47]
ds_read_b64_tr_b16 a[184:185], v1 offset:39936
ds_read_b64_tr_b16 a[186:187], v1 offset:40192
v_accvgpr_read_b32 v20, a204
v_accvgpr_read_b32 v21, a205
v_accvgpr_read_b32 v22, a206
v_fma_f32 v19, v19, v12, v12
v_rcp_f32 v16, v16
v_rcp_f32 v17, v17
v_rcp_f32 v18, v18
v_rcp_f32 v19, v19
v_mul_f32 v84, v84, v16
s_waitcnt lgkmcnt(4)
v_mfma_f32_32x32x16_bf16 v[32:47], a[168:171], v[180:183], v[32:47]
ds_read_b64_tr_b16 a[160:161], v1 offset:40960
ds_read_b64_tr_b16 a[162:163], v1 offset:41216
v_accvgpr_read_b32 v23, a207
s_add_u32 m0, s41, 147456
s_nop 0
buffer_load_dwordx4 v20, s[8:11], s55 offen lds
buffer_load_dwordx4 v21, s[8:11], s55 offen offset:1024 lds
buffer_load_dwordx4 v22, s[8:11], s55 offen offset:2048 lds
buffer_load_dwordx4 v23, s[8:11], s55 offen offset:3072 lds
s_waitcnt lgkmcnt(4)
v_mfma_f32_32x32x16_bf16 v[32:47], a[176:179], v[184:187], v[32:47]
ds_read_b64_tr_b16 a[168:169], v1 offset:41984
ds_read_b64_tr_b16 a[170:171], v1 offset:42240
v_mul_f32 v85, v85, v17
v_mul_f32 v86, v86, v18
v_mul_f32 v87, v87, v19
v_cvt_pk_bf16_f32 v80, v80, v81
v_cvt_pk_bf16_f32 v81, v82, v83
v_cvt_pk_bf16_f32 v82, v84, v85
v_cvt_pk_bf16_f32 v83, v86, v87
buffer_store_dwordx4 v[80:83], v0, s[32:35], s7 offen offset:2048 sc1
s_waitcnt lgkmcnt(4)
v_mfma_f32_32x32x16_bf16 v[32:47], a[184:187], v[188:191], v[32:47]
ds_read_b64_tr_b16 a[176:177], v1 offset:43008
ds_read_b64_tr_b16 a[178:179], v1 offset:43264
v_mul_f32 v16, v88, v88
v_mul_f32 v17, v89, v89
v_mul_f32 v18, v90, v90
v_mul_f32 v19, v91, v91
v_fma_f32 v16, v16, v11, v10
v_fma_f32 v17, v17, v11, v10
v_fma_f32 v18, v18, v11, v10
v_fma_f32 v19, v19, v11, v10
v_mul_f32 v16, v16, v88
s_waitcnt lgkmcnt(4)
v_mfma_f32_32x32x16_bf16 v[32:47], a[160:163], v[192:195], v[32:47]
ds_read_b64_tr_b16 a[184:185], v1 offset:44032
ds_read_b64_tr_b16 a[186:187], v1 offset:44288
v_mul_f32 v17, v17, v89
v_mul_f32 v18, v18, v90
v_mul_f32 v19, v19, v91
v_exp_f32 v16, v16
v_exp_f32 v17, v17
v_exp_f32 v18, v18
v_exp_f32 v19, v19
v_fma_f32 v16, v16, v12, v12
v_fma_f32 v17, v17, v12, v12
s_waitcnt lgkmcnt(4)
v_mfma_f32_32x32x16_bf16 v[32:47], a[168:171], v[196:199], v[32:47]
ds_read_b64_tr_b16 a[160:161], v1 offset:45056
ds_read_b64_tr_b16 a[162:163], v1 offset:45312
v_fma_f32 v18, v18, v12, v12
v_fma_f32 v19, v19, v12, v12
v_rcp_f32 v16, v16
v_rcp_f32 v17, v17
v_rcp_f32 v18, v18
v_rcp_f32 v19, v19
v_mul_f32 v88, v88, v16
v_mul_f32 v89, v89, v17
v_mul_f32 v90, v90, v18
s_waitcnt lgkmcnt(4)
v_mfma_f32_32x32x16_bf16 v[32:47], a[176:179], v[200:203], v[32:47]
ds_read_b64_tr_b16 a[168:169], v1 offset:46080
ds_read_b64_tr_b16 a[170:171], v1 offset:46336
v_mul_f32 v91, v91, v19
v_mul_f32 v16, v92, v92
v_mul_f32 v17, v93, v93
v_mul_f32 v18, v94, v94
v_mul_f32 v19, v95, v95
v_fma_f32 v16, v16, v11, v10
v_fma_f32 v17, v17, v11, v10
v_fma_f32 v18, v18, v11, v10
v_fma_f32 v19, v19, v11, v10
v_mul_f32 v16, v16, v92
v_mul_f32 v17, v17, v93
v_mul_f32 v18, v18, v94
v_mul_f32 v19, v19, v95
s_waitcnt lgkmcnt(4)
v_mfma_f32_32x32x16_bf16 v[32:47], a[184:187], v[204:207], v[32:47]
ds_read_b64_tr_b16 a[176:177], v1 offset:47104
ds_read_b64_tr_b16 a[178:179], v1 offset:47360
v_exp_f32 v16, v16
v_exp_f32 v17, v17
v_exp_f32 v18, v18
v_exp_f32 v19, v19
v_fma_f32 v16, v16, v12, v12
v_fma_f32 v17, v17, v12, v12
v_fma_f32 v18, v18, v12, v12
v_fma_f32 v19, v19, v12, v12
v_rcp_f32 v16, v16
s_waitcnt lgkmcnt(4)
v_mfma_f32_32x32x16_bf16 v[32:47], a[160:163], v[208:211], v[32:47]
ds_read_b64_tr_b16 a[184:185], v1 offset:48128
ds_read_b64_tr_b16 a[186:187], v1 offset:48384
v_rcp_f32 v17, v17
v_rcp_f32 v18, v18
v_rcp_f32 v19, v19
v_mul_f32 v92, v92, v16
v_mul_f32 v93, v93, v17
v_mul_f32 v94, v94, v18
v_mul_f32 v95, v95, v19
v_cvt_pk_bf16_f32 v88, v88, v89
v_cvt_pk_bf16_f32 v89, v90, v91
v_cvt_pk_bf16_f32 v90, v92, v93
s_waitcnt lgkmcnt(4)
v_mfma_f32_32x32x16_bf16 v[32:47], a[168:171], v[212:215], v[32:47]
s_barrier
ds_read_b64_tr_b16 a[160:161], v1 offset:49152
ds_read_b64_tr_b16 a[162:163], v1 offset:49408
v_cvt_pk_bf16_f32 v91, v94, v95
buffer_store_dwordx4 v[88:91], v0, s[32:35], s7 offen offset:3072 sc1
s_waitcnt lgkmcnt(4)
v_mfma_f32_32x32x16_bf16 v[32:47], a[176:179], v[216:219], v[32:47]
ds_read_b64_tr_b16 a[168:169], v1 offset:50176
ds_read_b64_tr_b16 a[170:171], v1 offset:50432
s_lshl_b32 s6, s54, 9
s_waitcnt lgkmcnt(4)
v_mfma_f32_32x32x16_bf16 v[32:47], a[184:187], v[220:223], v[32:47]
ds_read_b64_tr_b16 a[176:177], v1 offset:51200
ds_read_b64_tr_b16 a[178:179], v1 offset:51456
buffer_load_dword v29, off, s[32:35], s6 sc1
s_mul_i32 s4, s54, 40960
s_add_u32 s4, s4, 655360
s_mul_i32 s3, s61, 5
s_cmp_eq_u32 s61, 0
s_cselect_b32 s4, 1073741824, s4
s_waitcnt lgkmcnt(4)
v_mfma_f32_32x32x16_bf16 v[32:47], a[160:163], v[224:227], v[32:47]
ds_read_b64_tr_b16 a[184:185], v1 offset:52224
ds_read_b64_tr_b16 a[186:187], v1 offset:52480
s_waitcnt lgkmcnt(4)
v_mfma_f32_32x32x16_bf16 v[32:47], a[168:171], v[228:231], v[32:47]
ds_read_b64_tr_b16 a[160:161], v1 offset:53248
ds_read_b64_tr_b16 a[162:163], v1 offset:53504
s_waitcnt lgkmcnt(4)
v_mfma_f32_32x32x16_bf16 v[32:47], a[176:179], v[232:235], v[32:47]
ds_read_b64_tr_b16 a[168:169], v1 offset:54272
ds_read_b64_tr_b16 a[170:171], v1 offset:54528
s_waitcnt lgkmcnt(4)
v_mfma_f32_32x32x16_bf16 v[32:47], a[184:187], v[236:239], v[32:47]
ds_read_b64_tr_b16 a[176:177], v1 offset:55296
ds_read_b64_tr_b16 a[178:179], v1 offset:55552
s_waitcnt lgkmcnt(4)
v_mfma_f32_32x32x16_bf16 v[32:47], a[160:163], v[240:243], v[32:47]
ds_read_b64_tr_b16 a[184:185], v1 offset:56320
ds_read_b64_tr_b16 a[186:187], v1 offset:56576
s_waitcnt lgkmcnt(4)
v_mfma_f32_32x32x16_bf16 v[32:47], a[168:171], v[244:247], v[32:47]
s_waitcnt lgkmcnt(2)
v_mfma_f32_32x32x16_bf16 v[32:47], a[176:179], v[248:251], v[32:47]
s_waitcnt lgkmcnt(0)
v_mfma_f32_32x32x16_bf16 v[32:47], a[184:187], v[252:255], v[32:47]
s_waitcnt vmcnt(1)
buffer_atomic_add v14, v13, s[32:35], s79 offen offset:128 sc1
s_nop 9
v_pk_mul_f32 v[16:17], v[32:33], v[32:33]
v_pk_mul_f32 v[18:19], v[34:35], v[34:35]
v_pk_fma_f32 v[16:17], v[16:17], v[10:11], v[10:11] op_sel:[0,1,0] op_sel_hi:[1,1,0]
v_pk_fma_f32 v[18:19], v[18:19], v[10:11], v[10:11] op_sel:[0,1,0] op_sel_hi:[1,1,0]
v_pk_mul_f32 v[16:17], v[16:17], v[32:33]
v_pk_mul_f32 v[18:19], v[18:19], v[34:35]
v_exp_f32 v16, v16
v_exp_f32 v17, v17
v_exp_f32 v18, v18
v_exp_f32 v19, v19
v_pk_fma_f32 v[16:17], v[16:17], v[12:13], v[12:13] op_sel_hi:[1,0,0]
v_pk_fma_f32 v[18:19], v[18:19], v[12:13], v[12:13] op_sel_hi:[1,0,0]
v_rcp_f32 v16, v16
v_rcp_f32 v17, v17
v_rcp_f32 v18, v18
v_rcp_f32 v19, v19
v_pk_mul_f32 v[32:33], v[32:33], v[16:17]
v_pk_mul_f32 v[34:35], v[34:35], v[18:19]
v_pk_mul_f32 v[16:17], v[36:37], v[36:37]
v_pk_mul_f32 v[18:19], v[38:39], v[38:39]
v_pk_fma_f32 v[16:17], v[16:17], v[10:11], v[10:11] op_sel:[0,1,0] op_sel_hi:[1,1,0]
v_pk_fma_f32 v[18:19], v[18:19], v[10:11], v[10:11] op_sel:[0,1,0] op_sel_hi:[1,1,0]
v_pk_mul_f32 v[16:17], v[16:17], v[36:37]
v_pk_mul_f32 v[18:19], v[18:19], v[38:39]
v_exp_f32 v16, v16
v_exp_f32 v17, v17
v_exp_f32 v18, v18
v_exp_f32 v19, v19
v_pk_fma_f32 v[16:17], v[16:17], v[12:13], v[12:13] op_sel_hi:[1,0,0]
v_pk_fma_f32 v[18:19], v[18:19], v[12:13], v[12:13] op_sel_hi:[1,0,0]
v_rcp_f32 v16, v16
v_rcp_f32 v17, v17
v_rcp_f32 v18, v18
v_rcp_f32 v19, v19
v_pk_mul_f32 v[36:37], v[36:37], v[16:17]
v_pk_mul_f32 v[38:39], v[38:39], v[18:19]
v_cvt_pk_bf16_f32 v32, v32, v33
v_cvt_pk_bf16_f32 v33, v34, v35
v_cvt_pk_bf16_f32 v34, v36, v37
v_cvt_pk_bf16_f32 v35, v38, v39
buffer_store_dwordx4 v[32:35], v0, s[32:35], s50 offen sc1
v_pk_mul_f32 v[16:17], v[40:41], v[40:41]
v_pk_mul_f32 v[18:19], v[42:43], v[42:43]
v_pk_fma_f32 v[16:17], v[16:17], v[10:11], v[10:11] op_sel:[0,1,0] op_sel_hi:[1,1,0]
v_pk_fma_f32 v[18:19], v[18:19], v[10:11], v[10:11] op_sel:[0,1,0] op_sel_hi:[1,1,0]
v_pk_mul_f32 v[16:17], v[16:17], v[40:41]
v_pk_mul_f32 v[18:19], v[18:19], v[42:43]
v_exp_f32 v16, v16
v_exp_f32 v17, v17
v_exp_f32 v18, v18
v_exp_f32 v19, v19
v_pk_fma_f32 v[16:17], v[16:17], v[12:13], v[12:13] op_sel_hi:[1,0,0]
v_pk_fma_f32 v[18:19], v[18:19], v[12:13], v[12:13] op_sel_hi:[1,0,0]
v_rcp_f32 v16, v16
v_rcp_f32 v17, v17
v_rcp_f32 v18, v18
v_rcp_f32 v19, v19
v_pk_mul_f32 v[40:41], v[40:41], v[16:17]
v_pk_mul_f32 v[42:43], v[42:43], v[18:19]
v_pk_mul_f32 v[16:17], v[44:45], v[44:45]
v_pk_mul_f32 v[18:19], v[46:47], v[46:47]
v_pk_fma_f32 v[16:17], v[16:17], v[10:11], v[10:11] op_sel:[0,1,0] op_sel_hi:[1,1,0]
v_pk_fma_f32 v[18:19], v[18:19], v[10:11], v[10:11] op_sel:[0,1,0] op_sel_hi:[1,1,0]
v_pk_mul_f32 v[16:17], v[16:17], v[44:45]
v_pk_mul_f32 v[18:19], v[18:19], v[46:47]
v_exp_f32 v16, v16
v_exp_f32 v17, v17
v_exp_f32 v18, v18
v_exp_f32 v19, v19
v_pk_fma_f32 v[16:17], v[16:17], v[12:13], v[12:13] op_sel_hi:[1,0,0]
v_pk_fma_f32 v[18:19], v[18:19], v[12:13], v[12:13] op_sel_hi:[1,0,0]
v_rcp_f32 v16, v16
v_rcp_f32 v17, v17
v_rcp_f32 v18, v18
v_rcp_f32 v19, v19
v_pk_mul_f32 v[44:45], v[44:45], v[16:17]
v_pk_mul_f32 v[46:47], v[46:47], v[18:19]
v_cvt_pk_bf16_f32 v40, v40, v41
v_cvt_pk_bf16_f32 v41, v42, v43
v_cvt_pk_bf16_f32 v42, v44, v45
v_cvt_pk_bf16_f32 v43, v46, v47
buffer_store_dwordx4 v[40:43], v0, s[32:35], s50 offen offset:1024 sc1
s_waitcnt vmcnt(3)
v_cmp_gt_u32 vcc, s3, v29
s_nop 1
s_cbranch_vccnz L_pw13
L_pr15:
s_add_u32 s5, s4, 0
buffer_load_dwordx4 v[160:163], v0, s[32:35], s5 offen sc1
buffer_load_dwordx4 v[164:167], v0, s[32:35], s5 offen offset:1024 sc1
buffer_load_dwordx4 v[168:171], v0, s[32:35], s5 offen offset:2048 sc1
buffer_load_dwordx4 v[172:175], v0, s[32:35], s5 offen offset:3072 sc1
s_add_u32 s5, s4, 12288
buffer_load_dwordx4 v[176:179], v0, s[32:35], s5 offen sc1
buffer_load_dwordx4 v[180:183], v0, s[32:35], s5 offen offset:1024 sc1
buffer_load_dwordx4 v[184:187], v0, s[32:35], s5 offen offset:2048 sc1
buffer_load_dwordx4 v[188:191], v0, s[32:35], s5 offen offset:3072 sc1
s_add_u32 s5, s4, 20480
buffer_load_dwordx4 v[192:195], v0, s[32:35], s5 offen sc1
buffer_load_dwordx4 v[196:199], v0, s[32:35], s5 offen offset:1024 sc1
buffer_load_dwordx4 v[200:203], v0, s[32:35], s5 offen offset:2048 sc1
buffer_load_dwordx4 v[204:207], v0, s[32:35], s5 offen offset:3072 sc1
s_branch L_s2
L_s1v:
v_lshrrev_b32 v24, 5, v3
v_mul_u32_u24 v24, 9728, v24
v_add_u32 v24, v24, v0
v_add_u32 v25, 20480, v24
v_mfma_f32_32x32x16_bf16 v[64:79], a[16:19], v[96:99], v[80:95]
v_mfma_f32_32x32x16_bf16 v[64:79], a[20:23], v[100:103], v[64:79]
s_barrier
v_bfe_u32 v30, v3, 2, 2
v_lshrrev_b32 v31, 5, v3
v_lshl_add_u32 v30, v31, 3, v30
v_lshlrev_b32 v1, 7, v30
v_bfe_u32 v30, v3, 4, 1
v_lshl_add_u32 v1, v30, 5, v1
v_and_b32 v30, 3, v3
v_lshl_add_u32 v1, v30, 3, v1
v_bfe_u32 v30, v3, 3, 1
v_lshl_add_u32 v1, v30, 6, v1
v_xor_b32 v2, 64, v1
ds_read_b64_tr_b16 a[160:161], v1 offset:0
ds_read_b64_tr_b16 a[162:163], v1 offset:512
ds_read_b64_tr_b16 a[164:165], v2 offset:0
ds_read_b64_tr_b16 a[166:167], v2 offset:512
ds_read_b64_tr_b16 a[168:169], v1 offset:2048
ds_read_b64_tr_b16 a[170:171], v1 offset:2560
ds_read_b64_tr_b16 a[172:173], v2 offset:2048
ds_read_b64_tr_b16 a[174:175], v2 offset:2560
ds_read_b64_tr_b16 a[176:177], v1 offset:4096
ds_read_b64_tr_b16 a[178:179], v1 offset:4608
ds_read_b64_tr_b16 a[180:181], v2 offset:4096
ds_read_b64_tr_b16 a[182:183], v2 offset:4608
v_cvt_pk_bf16_f32 v96, v64, v65
v_cvt_pk_bf16_f32 v97, v66, v67
v_cvt_pk_bf16_f32 v98, v68, v69
v_cvt_pk_bf16_f32 v99, v70, v71
v_cvt_pk_bf16_f32 v100, v72, v73
v_cvt_pk_bf16_f32 v101, v74, v75
v_cvt_pk_bf16_f32 v102, v76, v77
v_cvt_pk_bf16_f32 v103, v78, v79
v_mfma_f32_32x32x16_bf16 v[64:79], a[16:19], v[104:107], v[80:95]
v_mfma_f32_32x32x16_bf16 v[64:79], a[20:23], v[108:111], v[64:79]
s_waitcnt lgkmcnt(8)
v_mfma_f32_32x32x16_bf16 v[32:47], v[96:99], a[160:163], 0
ds_read_b64_tr_b16 a[184:185], v1 offset:6144
ds_read_b64_tr_b16 a[186:187], v1 offset:6656
v_mfma_f32_32x32x16_bf16 v[48:63], v[96:99], a[164:167], 0
ds_read_b64_tr_b16 a[188:189], v2 offset:6144
ds_read_b64_tr_b16 a[190:191], v2 offset:6656
s_waitcnt lgkmcnt(8)
v_mfma_f32_32x32x16_bf16 v[32:47], v[100:103], a[168:171], v[32:47]
ds_read_b64_tr_b16 a[160:161], v1 offset:8192
ds_read_b64_tr_b16 a[162:163], v1 offset:8704
s_nop 0
v_cvt_pk_bf16_f32 v104, v64, v65
v_cvt_pk_bf16_f32 v105, v66, v67
v_cvt_pk_bf16_f32 v106, v68, v69
v_cvt_pk_bf16_f32 v107, v70, v71
v_mfma_f32_32x32x16_bf16 v[48:63], v[100:103], a[172:175], v[48:63]
ds_read_b64_tr_b16 a[164:165], v2 offset:8192
ds_read_b64_tr_b16 a[166:167], v2 offset:8704
v_cvt_pk_bf16_f32 v108, v72, v73
v_cvt_pk_bf16_f32 v109, v74, v75
v_cvt_pk_bf16_f32 v110, v76, v77
v_cvt_pk_bf16_f32 v111, v78, v79
v_mfma_f32_32x32x16_bf16 v[64:79], a[16:19], v[112:115], v[80:95]
v_mfma_f32_32x32x16_bf16 v[64:79], a[20:23], v[116:119], v[64:79]
s_waitcnt lgkmcnt(8)
v_mfma_f32_32x32x16_bf16 v[32:47], v[104:107], a[176:179], v[32:47]
ds_read_b64_tr_b16 a[168:169], v1 offset:10240
ds_read_b64_tr_b16 a[170:171], v1 offset:10752
v_mfma_f32_32x32x16_bf16 v[48:63], v[104:107], a[180:183], v[48:63]
ds_read_b64_tr_b16 a[172:173], v2 offset:10240
ds_read_b64_tr_b16 a[174:175], v2 offset:10752
s_waitcnt lgkmcnt(8)
v_mfma_f32_32x32x16_bf16 v[32:47], v[108:111], a[184:187], v[32:47]
ds_read_b64_tr_b16 a[176:177], v1 offset:12288
ds_read_b64_tr_b16 a[178:179], v1 offset:12800
s_nop 0
v_cvt_pk_bf16_f32 v112, v64, v65
v_cvt_pk_bf16_f32 v113, v66, v67
v_cvt_pk_bf16_f32 v114, v68, v69
v_cvt_pk_bf16_f32 v115, v70, v71
v_mfma_f32_32x32x16_bf16 v[48:63], v[108:111], a[188:191], v[48:63]
ds_read_b64_tr_b16 a[180:181], v2 offset:12288
ds_read_b64_tr_b16 a[182:183], v2 offset:12800
v_cvt_pk_bf16_f32 v116, v72, v73
v_cvt_pk_bf16_f32 v117, v74, v75
v_cvt_pk_bf16_f32 v118, v76, v77
v_cvt_pk_bf16_f32 v119, v78, v79
v_mfma_f32_32x32x16_bf16 v[64:79], a[16:19], v[120:123], v[80:95]
v_mfma_f32_32x32x16_bf16 v[64:79], a[20:23], v[124:127], v[64:79]
s_waitcnt lgkmcnt(8)
v_mfma_f32_32x32x16_bf16 v[32:47], v[112:115], a[160:163], v[32:47]
ds_read_b64_tr_b16 a[184:185], v1 offset:14336
ds_read_b64_tr_b16 a[186:187], v1 offset:14848
v_mfma_f32_32x32x16_bf16 v[48:63], v[112:115], a[164:167], v[48:63]
ds_read_b64_tr_b16 a[188:189], v2 offset:14336
ds_read_b64_tr_b16 a[190:191], v2 offset:14848
s_waitcnt lgkmcnt(8)
v_mfma_f32_32x32x16_bf16 v[32:47], v[116:119], a[168:171], v[32:47]
s_waitcnt vmcnt(8)
s_barrier
ds_read_b64_tr_b16 a[160:161], v1 offset:16384
ds_read_b64_tr_b16 a[162:163], v1 offset:16896
v_cvt_pk_bf16_f32 v120, v64, v65
v_cvt_pk_bf16_f32 v121, v66, v67
v_cvt_pk_bf16_f32 v122, v68, v69
v_cvt_pk_bf16_f32 v123, v70, v71
v_mfma_f32_32x32x16_bf16 v[48:63], v[116:119], a[172:175], v[48:63]
ds_read_b64_tr_b16 a[164:165], v2 offset:16384
ds_read_b64_tr_b16 a[166:167], v2 offset:16896
v_cvt_pk_bf16_f32 v124, v72, v73
v_cvt_pk_bf16_f32 v125, v74, v75
v_cvt_pk_bf16_f32 v126, v76, v77
v_cvt_pk_bf16_f32 v127, v78, v79
v_mfma_f32_32x32x16_bf16 v[64:79], a[16:19], v[128:131], v[80:95]
s_add_u32 m0, s41, 65536
s_add_u32 s51, s63, 8
s_sub_u32 s52, s51, 10
s_cselect_b32 s51, s51, s52
s_mul_i32 s52, s51, s53
s_add_u32 s52, s52, s46
v_mfma_f32_32x32x16_bf16 v[64:79], a[20:23], v[132:135], v[64:79]
buffer_load_dwordx4 v4, s[12:15], s52 offen lds
s_waitcnt lgkmcnt(8)
v_mfma_f32_32x32x16_bf16 v[32:47], v[120:123], a[176:179], v[32:47]
ds_read_b64_tr_b16 a[168:169], v1 offset:18432
ds_read_b64_tr_b16 a[170:171], v1 offset:18944
buffer_load_dwordx4 v5, s[12:15], s52 offen offset:1024 lds
v_mfma_f32_32x32x16_bf16 v[48:63], v[120:123], a[180:183], v[48:63]
ds_read_b64_tr_b16 a[172:173], v2 offset:18432
ds_read_b64_tr_b16 a[174:175], v2 offset:18944
s_waitcnt lgkmcnt(8)
v_mfma_f32_32x32x16_bf16 v[32:47], v[124:127], a[184:187], v[32:47]
ds_read_b64_tr_b16 a[176:177], v1 offset:20480
ds_read_b64_tr_b16 a[178:179], v1 offset:20992
v_cvt_pk_bf16_f32 v128, v64, v65
v_cvt_pk_bf16_f32 v129, v66, v67
v_cvt_pk_bf16_f32 v130, v68, v69
v_cvt_pk_bf16_f32 v131, v70, v71
v_mfma_f32_32x32x16_bf16 v[48:63], v[124:127], a[188:191], v[48:63]
ds_read_b64_tr_b16 a[180:181], v2 offset:20480
ds_read_b64_tr_b16 a[182:183], v2 offset:20992
v_cvt_pk_bf16_f32 v132, v72, v73
v_cvt_pk_bf16_f32 v133, v74, v75
v_cvt_pk_bf16_f32 v134, v76, v77
v_cvt_pk_bf16_f32 v135, v78, v79
v_mfma_f32_32x32x16_bf16 v[64:79], a[16:19], v[136:139], v[80:95]
buffer_load_dwordx4 v6, s[12:15], s52 offen offset:2048 lds
v_mov_b32 v26, 1
v_mfma_f32_32x32x16_bf16 v[64:79], a[20:23], v[140:143], v[64:79]
buffer_load_dwordx4 v7, s[12:15], s52 offen offset:3072 lds
s_add_u32 m0, s41, 81920
s_waitcnt lgkmcnt(8)
v_mfma_f32_32x32x16_bf16 v[32:47], v[128:131], a[160:163], v[32:47]
ds_read_b64_tr_b16 a[184:185], v1 offset:22528
ds_read_b64_tr_b16 a[186:187], v1 offset:23040
s_mul_i32 s52, s63, s53
s_add_u32 s52, s52, s46
s_add_u32 s52, s52, 128
v_mfma_f32_32x32x16_bf16 v[48:63], v[128:131], a[164:167], v[48:63]
ds_read_b64_tr_b16 a[188:189], v2 offset:22528
ds_read_b64_tr_b16 a[190:191], v2 offset:23040
buffer_atomic_add v26, v13, s[36:39], s2 offen sc0 sc1
s_waitcnt lgkmcnt(8)
v_mfma_f32_32x32x16_bf16 v[32:47], v[132:135], a[168:171], v[32:47]
ds_read_b64_tr_b16 a[160:161], v1 offset:24576
ds_read_b64_tr_b16 a[162:163], v1 offset:25088
v_cvt_pk_bf16_f32 v136, v64, v65
v_cvt_pk_bf16_f32 v137, v66, v67
v_cvt_pk_bf16_f32 v138, v68, v69
v_cvt_pk_bf16_f32 v139, v70, v71
v_mfma_f32_32x32x16_bf16 v[48:63], v[132:135], a[172:175], v[48:63]
ds_read_b64_tr_b16 a[164:165], v2 offset:24576
ds_read_b64_tr_b16 a[166:167], v2 offset:25088
v_cvt_pk_bf16_f32 v140, v72, v73
v_cvt_pk_bf16_f32 v141, v74, v75
v_cvt_pk_bf16_f32 v142, v76, v77
v_cvt_pk_bf16_f32 v143, v78, v79
v_mfma_f32_32x32x16_bf16 v[64:79], a[16:19], v[144:147], v[80:95]
buffer_load_dwordx4 v4, s[12:15], s52 offen lds
v_mfma_f32_32x32x16_bf16 v[64:79], a[20:23], v[148:151], v[64:79]
buffer_load_dwordx4 v5, s[12:15], s52 offen offset:1024 lds
s_waitcnt lgkmcnt(8)
v_mfma_f32_32x32x16_bf16 v[32:47], v[136:139], a[176:179], v[32:47]
ds_read_b64_tr_b16 a[168:169], v1 offset:26624
ds_read_b64_tr_b16 a[170:171], v1 offset:27136
buffer_load_dwordx4 v6, s[12:15], s52 offen offset:2048 lds
v_mfma_f32_32x32x16_bf16 v[48:63], v[136:139], a[180:183], v[48:63]
ds_read_b64_tr_b16 a[172:173], v2 offset:26624
ds_read_b64_tr_b16 a[174:175], v2 offset:27136
s_waitcnt lgkmcnt(8)
v_mfma_f32_32x32x16_bf16 v[32:47], v[140:143], a[184:187], v[32:47]
ds_read_b64_tr_b16 a[176:177], v1 offset:28672
ds_read_b64_tr_b16 a[178:179], v1 offset:29184
v_cvt_pk_bf16_f32 v144, v64, v65
v_cvt_pk_bf16_f32 v145, v66, v67
v_cvt_pk_bf16_f32 v146, v68, v69
v_cvt_pk_bf16_f32 v147, v70, v71
v_mfma_f32_32x32x16_bf16 v[48:63], v[140:143], a[188:191], v[48:63]
ds_read_b64_tr_b16 a[180:181], v2 offset:28672
ds_read_b64_tr_b16 a[182:183], v2 offset:29184
v_cvt_pk_bf16_f32 v148, v72, v73
v_cvt_pk_bf16_f32 v149, v74, v75
v_cvt_pk_bf16_f32 v150, v76, v77
v_cvt_pk_bf16_f32 v151, v78, v79
v_mfma_f32_32x32x16_bf16 v[64:79], a[16:19], v[152:155], v[80:95]
buffer_load_dwordx4 v7, s[12:15], s52 offen offset:3072 lds
v_mfma_f32_32x32x16_bf16 v[64:79], a[20:23], v[156:159], v[64:79]
s_waitcnt lgkmcnt(8)
v_mfma_f32_32x32x16_bf16 v[32:47], v[144:147], a[160:163], v[32:47]
ds_read_b64_tr_b16 a[184:185], v1 offset:30720
ds_read_b64_tr_b16 a[186:187], v1 offset:31232
v_and_b32 v21, 31, v3
v_lshlrev_b32 v21, 2, v21
s_add_u32 s3, s41, 147456
v_add_u32 v21, s3, v21
v_mfma_f32_32x32x16_bf16 v[48:63], v[144:147], a[164:167], v[48:63]
ds_read_b64_tr_b16 a[188:189], v2 offset:30720
ds_read_b64_tr_b16 a[190:191], v2 offset:31232
ds_write_b32 v21, v8
v_lshrrev_b32 v22, 5, v3
v_lshl_add_u32 v22, v22, 4, s3
s_waitcnt lgkmcnt(9)
v_mfma_f32_32x32x16_bf16 v[32:47], v[148:151], a[168:171], v[32:47]
s_waitcnt vmcnt(13)
s_barrier
ds_read_b64_tr_b16 a[160:161], v1 offset:32768
ds_read_b64_tr_b16 a[162:163], v1 offset:33280
v_cvt_pk_bf16_f32 v152, v64, v65
v_cvt_pk_bf16_f32 v153, v66, v67
v_cvt_pk_bf16_f32 v154, v68, v69
v_cvt_pk_bf16_f32 v155, v70, v71
v_mfma_f32_32x32x16_bf16 v[48:63], v[148:151], a[172:175], v[48:63]
ds_read_b64_tr_b16 a[164:165], v2 offset:32768
ds_read_b64_tr_b16 a[166:167], v2 offset:33280
v_cvt_pk_bf16_f32 v156, v72, v73
v_cvt_pk_bf16_f32 v157, v74, v75
v_cvt_pk_bf16_f32 v158, v76, v77
v_cvt_pk_bf16_f32 v159, v78, v79
v_mfma_f32_32x32x16_bf16 v[64:79], a[16:19], v[160:163], v[80:95]
s_add_u32 m0, s41, 98304
s_add_u32 s51, s63, 2
s_sub_u32 s52, s51, 10
s_cselect_b32 s51, s51, s52
s_mul_i32 s52, s51, s53
s_add_u32 s52, s52, s46
v_mfma_f32_32x32x16_bf16 v[64:79], a[20:23], v[164:167], v[64:79]
s_add_u32 s52, s52, 128
buffer_load_dwordx4 v4, s[12:15], s52 offen lds
ds_read_b128 a[0:3], v22 offset:0
ds_read_b128 a[4:7], v22 offset:32
ds_read_b128 a[8:11], v22 offset:64
ds_read_b128 a[12:15], v22 offset:96
s_waitcnt lgkmcnt(13)
v_mfma_f32_32x32x16_bf16 v[32:47], v[152:155], a[176:179], v[32:47]
ds_read_b64_tr_b16 a[168:169], v1 offset:34816
ds_read_b64_tr_b16 a[170:171], v1 offset:35328
buffer_load_dwordx4 v5, s[12:15], s52 offen offset:1024 lds
v_mfma_f32_32x32x16_bf16 v[48:63], v[152:155], a[180:183], v[48:63]
ds_read_b64_tr_b16 a[172:173], v2 offset:34816
ds_read_b64_tr_b16 a[174:175], v2 offset:35328
s_mov_b32 s3, s62
s_lshl_b32 s3, s3, 2
s_add_u32 s3, s3, s60
s_waitcnt lgkmcnt(13)
v_mfma_f32_32x32x16_bf16 v[32:47], v[156:159], a[184:187], v[32:47]
ds_read_b64_tr_b16 a[176:177], v1 offset:36864
ds_read_b64_tr_b16 a[178:179], v1 offset:37376
v_cvt_pk_bf16_f32 v160, v64, v65
v_cvt_pk_bf16_f32 v161, v66, v67
v_cvt_pk_bf16_f32 v162, v68, v69
v_cvt_pk_bf16_f32 v163, v70, v71
v_mfma_f32_32x32x16_bf16 v[48:63], v[156:159], a[188:191], v[48:63]
ds_read_b64_tr_b16 a[180:181], v2 offset:36864
ds_read_b64_tr_b16 a[182:183], v2 offset:37376
v_cvt_pk_bf16_f32 v164, v72, v73
v_cvt_pk_bf16_f32 v165, v74, v75
v_cvt_pk_bf16_f32 v166, v76, v77
v_cvt_pk_bf16_f32 v167, v78, v79
v_mfma_f32_32x32x16_bf16 v[64:79], a[16:19], v[168:171], v[80:95]
buffer_load_dwordx4 v6, s[12:15], s52 offen offset:2048 lds
s_lshl_b32 s3, s3, 4
s_lshr_b32 s4, s44, 2
v_mfma_f32_32x32x16_bf16 v[64:79], a[20:23], v[172:175], v[64:79]
buffer_load_dwordx4 v7, s[12:15], s52 offen offset:3072 lds
s_add_u32 m0, s41, 114688
s_add_u32 s3, s3, s4
s_lshl_b32 s3, s3, 2
s_add_u32 s3, s3, s40
s_mul_i32 s3, s3, 896
v_min_u32 v28, 6, v3
v_add_lshl_u32 v28, v28, 0, 7
buffer_load_dword a223, v28, s[16:19], s3 offen
s_waitcnt lgkmcnt(12)
v_mfma_f32_32x32x16_bf16 v[32:47], v[160:163], a[160:163], v[32:47]
ds_read_b64_tr_b16 a[184:185], v1 offset:38912
ds_read_b64_tr_b16 a[186:187], v1 offset:39424
s_add_u32 s51, s63, 4
s_sub_u32 s52, s51, 10
s_cselect_b32 s51, s51, s52
s_mul_i32 s52, s51, s53
v_mfma_f32_32x32x16_bf16 v[48:63], v[160:163], a[164:167], v[48:63]
ds_read_b64_tr_b16 a[188:189], v2 offset:38912
ds_read_b64_tr_b16 a[190:191], v2 offset:39424
s_add_u32 s52, s52, s46
s_add_u32 s52, s52, 128
s_max_u32 s3, s62, 1
s_waitcnt lgkmcnt(8)
v_mfma_f32_32x32x16_bf16 v[32:47], v[164:167], a[168:171], v[32:47]
ds_read_b64_tr_b16 a[160:161], v1 offset:40960
ds_read_b64_tr_b16 a[162:163], v1 offset:41472
v_cvt_pk_bf16_f32 v168, v64, v65
v_cvt_pk_bf16_f32 v169, v66, v67
v_cvt_pk_bf16_f32 v170, v68, v69
v_cvt_pk_bf16_f32 v171, v70, v71
v_mfma_f32_32x32x16_bf16 v[48:63], v[164:167], a[172:175], v[48:63]
ds_read_b64_tr_b16 a[164:165], v2 offset:40960
ds_read_b64_tr_b16 a[166:167], v2 offset:41472
v_cvt_pk_bf16_f32 v172, v72, v73
v_cvt_pk_bf16_f32 v173, v74, v75
v_cvt_pk_bf16_f32 v174, v76, v77
v_cvt_pk_bf16_f32 v175, v78, v79
v_mfma_f32_32x32x16_bf16 v[64:79], a[16:19], v[176:179], v[80:95]
buffer_load_dwordx4 v4, s[12:15], s52 offen lds
s_sub_u32 s3, s3, 1
s_lshl_b32 s3, s3, 2
v_mfma_f32_32x32x16_bf16 v[64:79], a[20:23], v[180:183], v[64:79]
buffer_load_dwordx4 v5, s[12:15], s52 offen offset:1024 lds
s_add_u32 s3, s3, s60
s_lshl_b32 s3, s3, 4
s_lshr_b32 s4, s44, 2
s_add_u32 s3, s3, s4
s_lshl_b32 s3, s3, 2
s_add_u32 s3, s3, s40
s_mul_i32 s3, s3, 3200
v_min_u32 v28, 24, v3
v_add_lshl_u32 v28, v28, 0, 7
buffer_load_dword a223, v28, s[20:23], s3 offen
s_waitcnt lgkmcnt(8)
v_mfma_f32_32x32x16_bf16 v[32:47], v[168:171], a[176:179], v[32:47]
ds_read_b64_tr_b16 a[168:169], v1 offset:43008
ds_read_b64_tr_b16 a[170:171], v1 offset:43520
buffer_load_dwordx4 v6, s[12:15], s52 offen offset:2048 lds
v_mfma_f32_32x32x16_bf16 v[48:63], v[168:171], a[180:183], v[48:63]
ds_read_b64_tr_b16 a[172:173], v2 offset:43008
ds_read_b64_tr_b16 a[174:175], v2 offset:43520
s_waitcnt lgkmcnt(8)
v_mfma_f32_32x32x16_bf16 v[32:47], v[172:175], a[184:187], v[32:47]
ds_read_b64_tr_b16 a[176:177], v1 offset:45056
ds_read_b64_tr_b16 a[178:179], v1 offset:45568
v_cvt_pk_bf16_f32 v176, v64, v65
v_cvt_pk_bf16_f32 v177, v66, v67
v_cvt_pk_bf16_f32 v178, v68, v69
v_cvt_pk_bf16_f32 v179, v70, v71
v_mfma_f32_32x32x16_bf16 v[48:63], v[172:175], a[188:191], v[48:63]
ds_read_b64_tr_b16 a[180:181], v2 offset:45056
ds_read_b64_tr_b16 a[182:183], v2 offset:45568
v_cvt_pk_bf16_f32 v180, v72, v73
v_cvt_pk_bf16_f32 v181, v74, v75
v_cvt_pk_bf16_f32 v182, v76, v77
v_cvt_pk_bf16_f32 v183, v78, v79
v_mfma_f32_32x32x16_bf16 v[64:79], a[16:19], v[184:187], v[80:95]
buffer_load_dwordx4 v7, s[12:15], s52 offen offset:3072 lds
v_mfma_f32_32x32x16_bf16 v[64:79], a[20:23], v[188:191], v[64:79]
s_waitcnt lgkmcnt(8)
v_mfma_f32_32x32x16_bf16 v[32:47], v[176:179], a[160:163], v[32:47]
ds_read_b64_tr_b16 a[184:185], v1 offset:47104
ds_read_b64_tr_b16 a[186:187], v1 offset:47616
v_mfma_f32_32x32x16_bf16 v[48:63], v[176:179], a[164:167], v[48:63]
ds_read_b64_tr_b16 a[188:189], v2 offset:47104
ds_read_b64_tr_b16 a[190:191], v2 offset:47616
s_waitcnt lgkmcnt(8)
v_mfma_f32_32x32x16_bf16 v[32:47], v[180:183], a[168:171], v[32:47]
s_waitcnt vmcnt(19)
s_barrier
ds_read_b64_tr_b16 a[160:161], v1 offset:49152
ds_read_b64_tr_b16 a[162:163], v1 offset:49664
v_cvt_pk_bf16_f32 v184, v64, v65
v_cvt_pk_bf16_f32 v185, v66, v67
v_cvt_pk_bf16_f32 v186, v68, v69
v_cvt_pk_bf16_f32 v187, v70, v71
v_mfma_f32_32x32x16_bf16 v[48:63], v[180:183], a[172:175], v[48:63]
ds_read_b64_tr_b16 a[164:165], v2 offset:49152
ds_read_b64_tr_b16 a[166:167], v2 offset:49664
v_cvt_pk_bf16_f32 v188, v72, v73
v_cvt_pk_bf16_f32 v189, v74, v75
v_cvt_pk_bf16_f32 v190, v76, v77
v_cvt_pk_bf16_f32 v191, v78, v79
v_mfma_f32_32x32x16_bf16 v[64:79], a[16:19], v[192:195], v[80:95]
s_add_u32 m0, s41, 131072
s_add_u32 s51, s63, 6
s_sub_u32 s52, s51, 10
s_cselect_b32 s51, s51, s52
s_mul_i32 s52, s51, s53
s_add_u32 s52, s52, s46
v_mfma_f32_32x32x16_bf16 v[64:79], a[20:23], v[196:199], v[64:79]
s_add_u32 s52, s52, 128
buffer_load_dwordx4 v4, s[12:15], s52 offen lds
s_waitcnt lgkmcnt(8)
v_mfma_f32_32x32x16_bf16 v[32:47], v[184:187], a[176:179], v[32:47]
ds_read_b64_tr_b16 a[168:169], v1 offset:51200
ds_read_b64_tr_b16 a[170:171], v1 offset:51712
buffer_load_dwordx4 v5, s[12:15], s52 offen offset:1024 lds
v_mfma_f32_32x32x16_bf16 v[48:63], v[184:187], a[180:183], v[48:63]
ds_read_b64_tr_b16 a[172:173], v2 offset:51200
ds_read_b64_tr_b16 a[174:175], v2 offset:51712
s_waitcnt vmcnt(16)
v_cmp_eq_u32 vcc, 12, v26
v_mov_b32 v27, 1073741824
s_nop 0
v_cndmask_b32 v27, v27, v13, vcc
s_waitcnt lgkmcnt(8)
v_mfma_f32_32x32x16_bf16 v[32:47], v[188:191], a[184:187], v[32:47]
ds_read_b64_tr_b16 a[176:177], v1 offset:53248
ds_read_b64_tr_b16 a[178:179], v1 offset:53760
v_cvt_pk_bf16_f32 v192, v64, v65
v_cvt_pk_bf16_f32 v193, v66, v67
v_cvt_pk_bf16_f32 v194, v68, v69
v_cvt_pk_bf16_f32 v195, v70, v71
v_mfma_f32_32x32x16_bf16 v[48:63], v[188:191], a[188:191], v[48:63]
ds_read_b64_tr_b16 a[180:181], v2 offset:53248
ds_read_b64_tr_b16 a[182:183], v2 offset:53760
v_cvt_pk_bf16_f32 v196, v72, v73
v_cvt_pk_bf16_f32 v197, v74, v75
v_cvt_pk_bf16_f32 v198, v76, v77
v_cvt_pk_bf16_f32 v199, v78, v79
v_mfma_f32_32x32x16_bf16 v[64:79], a[16:19], v[200:203], v[80:95]
buffer_load_dwordx4 v6, s[12:15], s52 offen offset:2048 lds
v_mfma_f32_32x32x16_bf16 v[64:79], a[20:23], v[204:207], v[64:79]
buffer_load_dwordx4 v7, s[12:15], s52 offen offset:3072 lds
s_add_u32 m0, s41, 0
buffer_store_dword v14, v27, s[36:39], s2 offen offset:128 sc1
s_waitcnt lgkmcnt(8)
v_mfma_f32_32x32x16_bf16 v[32:47], v[192:195], a[160:163], v[32:47]
ds_read_b64_tr_b16 a[184:185], v1 offset:55296
ds_read_b64_tr_b16 a[186:187], v1 offset:55808
s_add_u32 s51, s63, 8
s_sub_u32 s52, s51, 10
s_cselect_b32 s51, s51, s52
s_mul_i32 s52, s51, s53
v_mfma_f32_32x32x16_bf16 v[48:63], v[192:195], a[164:167], v[48:63]
ds_read_b64_tr_b16 a[188:189], v2 offset:55296
ds_read_b64_tr_b16 a[190:191], v2 offset:55808
s_add_u32 s52, s52, s46
s_add_u32 s52, s52, 128
s_waitcnt lgkmcnt(8)
v_mfma_f32_32x32x16_bf16 v[32:47], v[196:199], a[168:171], v[32:47]
ds_read_b64_tr_b16 a[160:161], v1 offset:57344
ds_read_b64_tr_b16 a[162:163], v1 offset:57856
v_cvt_pk_bf16_f32 v200, v64, v65
v_cvt_pk_bf16_f32 v201, v66, v67
v_cvt_pk_bf16_f32 v202, v68, v69
v_cvt_pk_bf16_f32 v203, v70, v71
v_mfma_f32_32x32x16_bf16 v[48:63], v[196:199], a[172:175], v[48:63]
ds_read_b64_tr_b16 a[164:165], v2 offset:57344
ds_read_b64_tr_b16 a[166:167], v2 offset:57856
v_cvt_pk_bf16_f32 v204, v72, v73
v_cvt_pk_bf16_f32 v205, v74, v75
v_cvt_pk_bf16_f32 v206, v76, v77
v_cvt_pk_bf16_f32 v207, v78, v79
v_mfma_f32_32x32x16_bf16 v[64:79], a[16:19], v[208:211], v[80:95]
buffer_load_dwordx4 v4, s[12:15], s52 offen lds
v_mfma_f32_32x32x16_bf16 v[64:79], a[20:23], v[212:215], v[64:79]
buffer_load_dwordx4 v5, s[12:15], s52 offen offset:1024 lds
s_waitcnt lgkmcnt(8)
v_mfma_f32_32x32x16_bf16 v[32:47], v[200:203], a[176:179], v[32:47]
ds_read_b64_tr_b16 a[168:169], v1 offset:59392
ds_read_b64_tr_b16 a[170:171], v1 offset:59904
buffer_load_dwordx4 v6, s[12:15], s52 offen offset:2048 lds
v_mfma_f32_32x32x16_bf16 v[48:63], v[200:203], a[180:183], v[48:63]
ds_read_b64_tr_b16 a[172:173], v2 offset:59392
ds_read_b64_tr_b16 a[174:175], v2 offset:59904
s_waitcnt lgkmcnt(8)
v_mfma_f32_32x32x16_bf16 v[32:47], v[204:207], a[184:187], v[32:47]
ds_read_b64_tr_b16 a[176:177], v1 offset:61440
ds_read_b64_tr_b16 a[178:179], v1 offset:61952
v_cvt_pk_bf16_f32 v208, v64, v65
v_cvt_pk_bf16_f32 v209, v66, v67
v_cvt_pk_bf16_f32 v210, v68, v69
v_cvt_pk_bf16_f32 v211, v70, v71
v_mfma_f32_32x32x16_bf16 v[48:63], v[204:207], a[188:191], v[48:63]
ds_read_b64_tr_b16 a[180:181], v2 offset:61440
ds_read_b64_tr_b16 a[182:183], v2 offset:61952
v_cvt_pk_bf16_f32 v212, v72, v73
v_cvt_pk_bf16_f32 v213, v74, v75
v_cvt_pk_bf16_f32 v214, v76, v77
v_cvt_pk_bf16_f32 v215, v78, v79
v_mfma_f32_32x32x16_bf16 v[64:79], a[16:19], v[216:219], v[80:95]
buffer_load_dwordx4 v7, s[12:15], s52 offen offset:3072 lds
v_mfma_f32_32x32x16_bf16 v[64:79], a[20:23], v[220:223], v[64:79]
s_waitcnt lgkmcnt(8)
v_mfma_f32_32x32x16_bf16 v[32:47], v[208:211], a[160:163], v[32:47]
ds_read_b64_tr_b16 a[184:185], v1 offset:63488
ds_read_b64_tr_b16 a[186:187], v1 offset:64000
v_mfma_f32_32x32x16_bf16 v[48:63], v[208:211], a[164:167], v[48:63]
ds_read_b64_tr_b16 a[188:189], v2 offset:63488
ds_read_b64_tr_b16 a[190:191], v2 offset:64000
s_waitcnt lgkmcnt(8)
v_mfma_f32_32x32x16_bf16 v[32:47], v[212:215], a[168:171], v[32:47]
s_barrier
v_add_u32 v1, 65536, v1
v_add_u32 v2, 65536, v2
ds_read_b64_tr_b16 a[160:161], v1 offset:0
ds_read_b64_tr_b16 a[162:163], v1 offset:512
v_cvt_pk_bf16_f32 v216, v64, v65
v_cvt_pk_bf16_f32 v217, v66, v67
v_cvt_pk_bf16_f32 v218, v68, v69
v_cvt_pk_bf16_f32 v219, v70, v71
v_mfma_f32_32x32x16_bf16 v[48:63], v[212:215], a[172:175], v[48:63]
ds_read_b64_tr_b16 a[164:165], v2 offset:0
ds_read_b64_tr_b16 a[166:167], v2 offset:512
v_cvt_pk_bf16_f32 v220, v72, v73
v_cvt_pk_bf16_f32 v221, v74, v75
v_cvt_pk_bf16_f32 v222, v76, v77
v_cvt_pk_bf16_f32 v223, v78, v79
v_mfma_f32_32x32x16_bf16 v[64:79], a[16:19], v[224:227], v[80:95]
v_lshrrev_b32 v4, 2, v3
v_and_b32 v5, 3, v3
v_lshlrev_b32 v5, 4, v5
v_mad_u32_u24 v4, v4, s45, v5
s_lshl_b32 s53, s45, 4
s_sub_u32 s53, s53, 1024
v_mfma_f32_32x32x16_bf16 v[64:79], a[20:23], v[228:231], v[64:79]
v_add_u32 v5, s53, v4
v_add_u32 v6, s53, v5
v_add_u32 v7, s53, v6
s_lshl_b32 s53, s45, 6
s_add_u32 m0, s41, 16384
s_add_u32 s51, s63, s40
s_add_u32 s51, s51, 0
s_sub_u32 s52, s51, 10
s_cselect_b32 s51, s51, s52
s_mul_i32 s52, s51, s53
s_add_u32 s52, s52, s48
buffer_load_dwordx4 v4, s[12:15], s52 offen lds
s_waitcnt lgkmcnt(8)
v_mfma_f32_32x32x16_bf16 v[32:47], v[216:219], a[176:179], v[32:47]
ds_read_b64_tr_b16 a[168:169], v1 offset:2048
ds_read_b64_tr_b16 a[170:171], v1 offset:2560
v_mfma_f32_32x32x16_bf16 v[48:63], v[216:219], a[180:183], v[48:63]
ds_read_b64_tr_b16 a[172:173], v2 offset:2048
ds_read_b64_tr_b16 a[174:175], v2 offset:2560
s_waitcnt lgkmcnt(8)
v_mfma_f32_32x32x16_bf16 v[32:47], v[220:223], a[184:187], v[32:47]
ds_read_b64_tr_b16 a[176:177], v1 offset:4096
ds_read_b64_tr_b16 a[178:179], v1 offset:4608
v_cvt_pk_bf16_f32 v224, v64, v65
v_cvt_pk_bf16_f32 v225, v66, v67
v_cvt_pk_bf16_f32 v226, v68, v69
v_cvt_pk_bf16_f32 v227, v70, v71
v_mfma_f32_32x32x16_bf16 v[48:63], v[220:223], a[188:191], v[48:63]
ds_read_b64_tr_b16 a[180:181], v2 offset:4096
ds_read_b64_tr_b16 a[182:183], v2 offset:4608
v_cvt_pk_bf16_f32 v228, v72, v73
v_cvt_pk_bf16_f32 v229, v74, v75
v_cvt_pk_bf16_f32 v230, v76, v77
v_cvt_pk_bf16_f32 v231, v78, v79
v_mfma_f32_32x32x16_bf16 v[64:79], a[16:19], v[232:235], v[80:95]
buffer_load_dwordx4 v5, s[12:15], s52 offen offset:1024 lds
v_mfma_f32_32x32x16_bf16 v[64:79], a[20:23], v[236:239], v[64:79]
s_waitcnt lgkmcnt(8)
v_mfma_f32_32x32x16_bf16 v[32:47], v[224:227], a[160:163], v[32:47]
ds_read_b64_tr_b16 a[184:185], v1 offset:6144
ds_read_b64_tr_b16 a[186:187], v1 offset:6656
v_mfma_f32_32x32x16_bf16 v[48:63], v[224:227], a[164:167], v[48:63]
ds_read_b64_tr_b16 a[188:189], v2 offset:6144
ds_read_b64_tr_b16 a[190:191], v2 offset:6656
s_waitcnt lgkmcnt(8)
v_mfma_f32_32x32x16_bf16 v[32:47], v[228:231], a[168:171], v[32:47]
ds_read_b64_tr_b16 a[160:161], v1 offset:8192
ds_read_b64_tr_b16 a[162:163], v1 offset:8704
s_nop 0
v_cvt_pk_bf16_f32 v232, v64, v65
v_cvt_pk_bf16_f32 v233, v66, v67
v_cvt_pk_bf16_f32 v234, v68, v69
v_cvt_pk_bf16_f32 v235, v70, v71
v_mfma_f32_32x32x16_bf16 v[48:63], v[228:231], a[172:175], v[48:63]
ds_read_b64_tr_b16 a[164:165], v2 offset:8192
ds_read_b64_tr_b16 a[166:167], v2 offset:8704
v_cvt_pk_bf16_f32 v236, v72, v73
v_cvt_pk_bf16_f32 v237, v74, v75
v_cvt_pk_bf16_f32 v238, v76, v77
v_cvt_pk_bf16_f32 v239, v78, v79
v_mfma_f32_32x32x16_bf16 v[64:79], a[16:19], v[240:243], v[80:95]
buffer_load_dwordx4 v6, s[12:15], s52 offen offset:2048 lds
v_mfma_f32_32x32x16_bf16 v[64:79], a[20:23], v[244:247], v[64:79]
s_waitcnt lgkmcnt(8)
v_mfma_f32_32x32x16_bf16 v[32:47], v[232:235], a[176:179], v[32:47]
ds_read_b64_tr_b16 a[168:169], v1 offset:10240
ds_read_b64_tr_b16 a[170:171], v1 offset:10752
buffer_load_dwordx4 v7, s[12:15], s52 offen offset:3072 lds
v_mfma_f32_32x32x16_bf16 v[48:63], v[232:235], a[180:183], v[48:63]
ds_read_b64_tr_b16 a[172:173], v2 offset:10240
ds_read_b64_tr_b16 a[174:175], v2 offset:10752
s_waitcnt lgkmcnt(8)
v_mfma_f32_32x32x16_bf16 v[32:47], v[236:239], a[184:187], v[32:47]
ds_read_b64_tr_b16 a[176:177], v1 offset:12288
ds_read_b64_tr_b16 a[178:179], v1 offset:12800
v_cvt_pk_bf16_f32 v240, v64, v65
v_cvt_pk_bf16_f32 v241, v66, v67
v_cvt_pk_bf16_f32 v242, v68, v69
v_cvt_pk_bf16_f32 v243, v70, v71
v_mfma_f32_32x32x16_bf16 v[48:63], v[236:239], a[188:191], v[48:63]
ds_read_b64_tr_b16 a[180:181], v2 offset:12288
ds_read_b64_tr_b16 a[182:183], v2 offset:12800
v_cvt_pk_bf16_f32 v244, v72, v73
v_cvt_pk_bf16_f32 v245, v74, v75
v_cvt_pk_bf16_f32 v246, v76, v77
v_cvt_pk_bf16_f32 v247, v78, v79
v_mfma_f32_32x32x16_bf16 v[64:79], a[16:19], v[248:251], v[80:95]
v_mfma_f32_32x32x16_bf16 v[64:79], a[20:23], v[252:255], v[64:79]
s_waitcnt lgkmcnt(8)
v_mfma_f32_32x32x16_bf16 v[32:47], v[240:243], a[160:163], v[32:47]
ds_read_b64_tr_b16 a[184:185], v1 offset:14336
ds_read_b64_tr_b16 a[186:187], v1 offset:14848
v_mfma_f32_32x32x16_bf16 v[48:63], v[240:243], a[164:167], v[48:63]
ds_read_b64_tr_b16 a[188:189], v2 offset:14336
ds_read_b64_tr_b16 a[190:191], v2 offset:14848
s_waitcnt lgkmcnt(8)
v_mfma_f32_32x32x16_bf16 v[32:47], v[244:247], a[168:171], v[32:47]
s_waitcnt vmcnt(23)
s_barrier
ds_read_b64_tr_b16 a[160:161], v1 offset:16384
ds_read_b64_tr_b16 a[162:163], v1 offset:16896
v_cvt_pk_bf16_f32 v248, v64, v65
v_cvt_pk_bf16_f32 v249, v66, v67
v_cvt_pk_bf16_f32 v250, v68, v69
v_cvt_pk_bf16_f32 v251, v70, v71
v_mfma_f32_32x32x16_bf16 v[48:63], v[244:247], a[172:175], v[48:63]
ds_read_b64_tr_b16 a[164:165], v2 offset:16384
ds_read_b64_tr_b16 a[166:167], v2 offset:16896
v_cvt_pk_bf16_f32 v252, v72, v73
v_cvt_pk_bf16_f32 v253, v74, v75
v_cvt_pk_bf16_f32 v254, v76, v77
v_cvt_pk_bf16_f32 v255, v78, v79
s_waitcnt lgkmcnt(8)
v_mfma_f32_32x32x16_bf16 v[32:47], v[248:251], a[176:179], v[32:47]
ds_read_b64_tr_b16 a[168:169], v1 offset:18432
ds_read_b64_tr_b16 a[170:171], v1 offset:18944
s_add_u32 m0, s41, 32768
s_add_u32 s51, s63, s40
s_add_u32 s51, s51, 4
s_sub_u32 s52, s51, 10
s_cselect_b32 s51, s51, s52
v_mfma_f32_32x32x16_bf16 v[48:63], v[248:251], a[180:183], v[48:63]
ds_read_b64_tr_b16 a[172:173], v2 offset:18432
ds_read_b64_tr_b16 a[174:175], v2 offset:18944
s_mul_i32 s52, s51, s53
s_add_u32 s52, s52, s48
buffer_load_dwordx4 v4, s[12:15], s52 offen lds
s_waitcnt lgkmcnt(8)
v_mfma_f32_32x32x16_bf16 v[32:47], v[252:255], a[184:187], v[32:47]
ds_read_b64_tr_b16 a[176:177], v1 offset:20480
ds_read_b64_tr_b16 a[178:179], v1 offset:20992
buffer_load_dwordx4 v5, s[12:15], s52 offen offset:1024 lds
v_mfma_f32_32x32x16_bf16 v[48:63], v[252:255], a[188:191], v[48:63]
ds_read_b64_tr_b16 a[180:181], v2 offset:20480
ds_read_b64_tr_b16 a[182:183], v2 offset:20992
buffer_load_dwordx4 v6, s[12:15], s52 offen offset:2048 lds
buffer_load_dwordx4 v7, s[12:15], s52 offen offset:3072 lds
s_waitcnt lgkmcnt(8)
v_mfma_f32_32x32x16_bf16 v[64:79], v[96:99], a[160:163], 0
ds_read_b64_tr_b16 a[184:185], v1 offset:22528
ds_read_b64_tr_b16 a[186:187], v1 offset:23040
v_mfma_f32_32x32x16_bf16 v[80:95], v[96:99], a[164:167], 0
ds_read_b64_tr_b16 a[188:189], v2 offset:22528
ds_read_b64_tr_b16 a[190:191], v2 offset:23040
s_waitcnt lgkmcnt(8)
v_mfma_f32_32x32x16_bf16 v[64:79], v[100:103], a[168:171], v[64:79]
ds_read_b64_tr_b16 a[160:161], v1 offset:24576
ds_read_b64_tr_b16 a[162:163], v1 offset:25088
v_accvgpr_read_b32 v16, a0
v_accvgpr_read_b32 v17, a1
v_accvgpr_read_b32 v18, a2
v_accvgpr_read_b32 v19, a3
v_mfma_f32_32x32x16_bf16 v[80:95], v[100:103], a[172:175], v[80:95]
ds_read_b64_tr_b16 a[164:165], v2 offset:24576
ds_read_b64_tr_b16 a[166:167], v2 offset:25088
v_mul_f32 v32, v16, v32
v_mul_f32 v33, v17, v33
v_mul_f32 v34, v18, v34
v_mul_f32 v35, v19, v35
s_waitcnt lgkmcnt(8)
v_mfma_f32_32x32x16_bf16 v[64:79], v[104:107], a[176:179], v[64:79]
ds_read_b64_tr_b16 a[168:169], v1 offset:26624
ds_read_b64_tr_b16 a[170:171], v1 offset:27136
v_accvgpr_read_b32 v16, a4
v_accvgpr_read_b32 v17, a5
v_accvgpr_read_b32 v18, a6
v_accvgpr_read_b32 v19, a7
v_mfma_f32_32x32x16_bf16 v[80:95], v[104:107], a[180:183], v[80:95]
ds_read_b64_tr_b16 a[172:173], v2 offset:26624
ds_read_b64_tr_b16 a[174:175], v2 offset:27136
v_mul_f32 v36, v16, v36
v_mul_f32 v37, v17, v37
v_mul_f32 v38, v18, v38
s_waitcnt lgkmcnt(8)
v_mfma_f32_32x32x16_bf16 v[64:79], v[108:111], a[184:187], v[64:79]
ds_read_b64_tr_b16 a[176:177], v1 offset:28672
ds_read_b64_tr_b16 a[178:179], v1 offset:29184
v_mul_f32 v39, v19, v39
v_cvt_pk_bf16_f32 v32, v32, v33
v_cvt_pk_bf16_f32 v33, v34, v35
v_cvt_pk_bf16_f32 v34, v36, v37
v_cvt_pk_bf16_f32 v35, v38, v39
v_mfma_f32_32x32x16_bf16 v[80:95], v[108:111], a[188:191], v[80:95]
ds_read_b64_tr_b16 a[180:181], v2 offset:28672
ds_read_b64_tr_b16 a[182:183], v2 offset:29184
s_waitcnt lgkmcnt(8)
v_mfma_f32_32x32x16_bf16 v[64:79], v[112:115], a[160:163], v[64:79]
ds_read_b64_tr_b16 a[184:185], v1 offset:30720
ds_read_b64_tr_b16 a[186:187], v1 offset:31232
buffer_store_dwordx4 v[32:35], v24, s[32:35], s49 offen sc1
v_mfma_f32_32x32x16_bf16 v[80:95], v[112:115], a[164:167], v[80:95]
ds_read_b64_tr_b16 a[188:189], v2 offset:30720
ds_read_b64_tr_b16 a[190:191], v2 offset:31232
v_accvgpr_read_b32 v16, a8
s_waitcnt lgkmcnt(8)
v_mfma_f32_32x32x16_bf16 v[64:79], v[116:119], a[168:171], v[64:79]
s_waitcnt vmcnt(24)
s_barrier
ds_read_b64_tr_b16 a[160:161], v1 offset:32768
ds_read_b64_tr_b16 a[162:163], v1 offset:33280
s_add_u32 m0, s41, 49152
s_add_u32 s51, s63, s40
v_mfma_f32_32x32x16_bf16 v[80:95], v[116:119], a[172:175], v[80:95]
ds_read_b64_tr_b16 a[164:165], v2 offset:32768
ds_read_b64_tr_b16 a[166:167], v2 offset:33280
s_add_u32 s51, s51, 8
s_sub_u32 s52, s51, 10
s_cselect_b32 s51, s51, s52
s_waitcnt lgkmcnt(8)
v_mfma_f32_32x32x16_bf16 v[64:79], v[120:123], a[176:179], v[64:79]
ds_read_b64_tr_b16 a[168:169], v1 offset:34816
ds_read_b64_tr_b16 a[170:171], v1 offset:35328
s_mul_i32 s52, s51, s53
s_add_u32 s52, s52, s48
s_cmp_lt_u32 s40, 2
s_cselect_b32 s52, s52, 1073741824
v_accvgpr_read_b32 v17, a9
v_mfma_f32_32x32x16_bf16 v[80:95], v[120:123], a[180:183], v[80:95]
ds_read_b64_tr_b16 a[172:173], v2 offset:34816
ds_read_b64_tr_b16 a[174:175], v2 offset:35328
buffer_load_dwordx4 v4, s[12:15], s52 offen lds
s_waitcnt lgkmcnt(8)
v_mfma_f32_32x32x16_bf16 v[64:79], v[124:127], a[184:187], v[64:79]
ds_read_b64_tr_b16 a[176:177], v1 offset:36864
ds_read_b64_tr_b16 a[178:179], v1 offset:37376
buffer_load_dwordx4 v5, s[12:15], s52 offen offset:1024 lds
v_accvgpr_read_b32 v18, a10
v_mfma_f32_32x32x16_bf16 v[80:95], v[124:127], a[188:191], v[80:95]
ds_read_b64_tr_b16 a[180:181], v2 offset:36864
ds_read_b64_tr_b16 a[182:183], v2 offset:37376
v_accvgpr_read_b32 v19, a11
v_mul_f32 v40, v16, v40
v_mul_f32 v41, v17, v41
s_waitcnt lgkmcnt(8)
v_mfma_f32_32x32x16_bf16 v[64:79], v[128:131], a[160:163], v[64:79]
ds_read_b64_tr_b16 a[184:185], v1 offset:38912
ds_read_b64_tr_b16 a[186:187], v1 offset:39424
buffer_load_dwordx4 v6, s[12:15], s52 offen offset:2048 lds
v_mul_f32 v42, v18, v42
v_mfma_f32_32x32x16_bf16 v[80:95], v[128:131], a[164:167], v[80:95]
ds_read_b64_tr_b16 a[188:189], v2 offset:38912
ds_read_b64_tr_b16 a[190:191], v2 offset:39424
v_mul_f32 v43, v19, v43
v_accvgpr_read_b32 v16, a12
v_accvgpr_read_b32 v17, a13
s_waitcnt lgkmcnt(8)
v_mfma_f32_32x32x16_bf16 v[64:79], v[132:135], a[168:171], v[64:79]
ds_read_b64_tr_b16 a[160:161], v1 offset:40960
ds_read_b64_tr_b16 a[162:163], v1 offset:41472
buffer_load_dwordx4 v7, s[12:15], s52 offen offset:3072 lds
v_accvgpr_read_b32 v18, a14
v_mfma_f32_32x32x16_bf16 v[80:95], v[132:135], a[172:175], v[80:95]
ds_read_b64_tr_b16 a[164:165], v2 offset:40960
ds_read_b64_tr_b16 a[166:167], v2 offset:41472
s_movk_i32 s96, 1280
v_lshrrev_b32 v4, 3, v3
s_lshl_b32 s53, s40, 5
s_waitcnt lgkmcnt(8)
v_mfma_f32_32x32x16_bf16 v[64:79], v[136:139], a[176:179], v[64:79]
ds_read_b64_tr_b16 a[168:169], v1 offset:43008
ds_read_b64_tr_b16 a[170:171], v1 offset:43520
s_lshr_b32 s52, s40, 1
s_mul_i32 s52, s52, 128
s_add_u32 s53, s53, s52
v_add_u32 v4, s53, v4
v_bfe_u32 v5, v3, 4, 1
v_lshlrev_b32 v5, 2, v5
v_and_b32 v6, 7, v3
v_xor_b32 v5, v5, v6
v_lshlrev_b32 v5, 4, v5
v_mad_u32_u24 v4, v4, s96, v5
s_lshl_b32 s53, s96, 3
s_sub_u32 s53, s53, 1024
v_add_u32 v4, s56, v4
v_add_u32 v5, s53, v4
v_add_u32 v6, s53, v5
v_add_u32 v7, s53, v6
s_lshl_b32 s53, s96, 6
s_add_u32 m0, s41, 65536
s_add_u32 s52, s55, 0
buffer_load_dwordx4 v4, s[16:19], s52 offen lds
v_mfma_f32_32x32x16_bf16 v[80:95], v[136:139], a[180:183], v[80:95]
ds_read_b64_tr_b16 a[172:173], v2 offset:43008
ds_read_b64_tr_b16 a[174:175], v2 offset:43520
buffer_load_dwordx4 v5, s[16:19], s52 offen offset:1024 lds
s_waitcnt lgkmcnt(8)
v_mfma_f32_32x32x16_bf16 v[64:79], v[140:143], a[184:187], v[64:79]
ds_read_b64_tr_b16 a[176:177], v1 offset:45056
ds_read_b64_tr_b16 a[178:179], v1 offset:45568
buffer_load_dwordx4 v6, s[16:19], s52 offen offset:2048 lds
v_accvgpr_read_b32 v19, a15
v_mfma_f32_32x32x16_bf16 v[80:95], v[140:143], a[188:191], v[80:95]
ds_read_b64_tr_b16 a[180:181], v2 offset:45056
ds_read_b64_tr_b16 a[182:183], v2 offset:45568
v_mul_f32 v44, v16, v44
v_mul_f32 v45, v17, v45
v_mul_f32 v46, v18, v46
v_mul_f32 v47, v19, v47
s_waitcnt lgkmcnt(8)
v_mfma_f32_32x32x16_bf16 v[64:79], v[144:147], a[160:163], v[64:79]
ds_read_b64_tr_b16 a[184:185], v1 offset:47104
ds_read_b64_tr_b16 a[186:187], v1 offset:47616
buffer_load_dwordx4 v7, s[16:19], s52 offen offset:3072 lds
v_mfma_f32_32x32x16_bf16 v[80:95], v[144:147], a[164:167], v[80:95]
ds_read_b64_tr_b16 a[188:189], v2 offset:47104
ds_read_b64_tr_b16 a[190:191], v2 offset:47616
v_cvt_pk_bf16_f32 v40, v40, v41
v_cvt_pk_bf16_f32 v41, v42, v43
v_cvt_pk_bf16_f32 v42, v44, v45
v_cvt_pk_bf16_f32 v43, v46, v47
s_waitcnt lgkmcnt(8)
v_mfma_f32_32x32x16_bf16 v[64:79], v[148:151], a[168:171], v[64:79]
s_waitcnt vmcnt(26)
s_barrier
ds_read_b64_tr_b16 a[160:161], v1 offset:49152
ds_read_b64_tr_b16 a[162:163], v1 offset:49664
s_add_u32 m0, s41, 81920
s_add_u32 s52, s55, 409600
v_mfma_f32_32x32x16_bf16 v[80:95], v[148:151], a[172:175], v[80:95]
ds_read_b64_tr_b16 a[164:165], v2 offset:49152
ds_read_b64_tr_b16 a[166:167], v2 offset:49664
s_waitcnt lgkmcnt(8)
v_mfma_f32_32x32x16_bf16 v[64:79], v[152:155], a[176:179], v[64:79]
ds_read_b64_tr_b16 a[168:169], v1 offset:51200
ds_read_b64_tr_b16 a[170:171], v1 offset:51712
buffer_load_dwordx4 v4, s[16:19], s52 offen lds
v_mfma_f32_32x32x16_bf16 v[80:95], v[152:155], a[180:183], v[80:95]
ds_read_b64_tr_b16 a[172:173], v2 offset:51200
ds_read_b64_tr_b16 a[174:175], v2 offset:51712
buffer_store_dwordx4 v[40:43], v25, s[32:35], s49 offen sc1
s_waitcnt lgkmcnt(8)
v_mfma_f32_32x32x16_bf16 v[64:79], v[156:159], a[184:187], v[64:79]
ds_read_b64_tr_b16 a[176:177], v1 offset:53248
ds_read_b64_tr_b16 a[178:179], v1 offset:53760
buffer_load_dwordx4 v5, s[16:19], s52 offen offset:1024 lds
v_mfma_f32_32x32x16_bf16 v[80:95], v[156:159], a[188:191], v[80:95]
ds_read_b64_tr_b16 a[180:181], v2 offset:53248
ds_read_b64_tr_b16 a[182:183], v2 offset:53760
v_accvgpr_read_b32 v16, a0
v_accvgpr_read_b32 v17, a1
s_waitcnt lgkmcnt(8)
v_mfma_f32_32x32x16_bf16 v[64:79], v[160:163], a[160:163], v[64:79]
ds_read_b64_tr_b16 a[184:185], v1 offset:55296
ds_read_b64_tr_b16 a[186:187], v1 offset:55808
v_accvgpr_read_b32 v18, a2
v_accvgpr_read_b32 v19, a3
v_mul_f32 v48, v16, v48
v_mul_f32 v49, v17, v49
v_mfma_f32_32x32x16_bf16 v[80:95], v[160:163], a[164:167], v[80:95]
ds_read_b64_tr_b16 a[188:189], v2 offset:55296
ds_read_b64_tr_b16 a[190:191], v2 offset:55808
v_mul_f32 v50, v18, v50
v_mul_f32 v51, v19, v51
v_accvgpr_read_b32 v16, a4
s_waitcnt lgkmcnt(8)
v_mfma_f32_32x32x16_bf16 v[64:79], v[164:167], a[168:171], v[64:79]
ds_read_b64_tr_b16 a[160:161], v1 offset:57344
ds_read_b64_tr_b16 a[162:163], v1 offset:57856
buffer_load_dwordx4 v6, s[16:19], s52 offen offset:2048 lds
v_accvgpr_read_b32 v17, a5
v_mfma_f32_32x32x16_bf16 v[80:95], v[164:167], a[172:175], v[80:95]
ds_read_b64_tr_b16 a[164:165], v2 offset:57344
ds_read_b64_tr_b16 a[166:167], v2 offset:57856
v_accvgpr_read_b32 v18, a6
v_accvgpr_read_b32 v19, a7
v_mul_f32 v52, v16, v52
v_mul_f32 v53, v17, v53
s_waitcnt lgkmcnt(8)
v_mfma_f32_32x32x16_bf16 v[64:79], v[168:171], a[176:179], v[64:79]
ds_read_b64_tr_b16 a[168:169], v1 offset:59392
ds_read_b64_tr_b16 a[170:171], v1 offset:59904
buffer_load_dwordx4 v7, s[16:19], s52 offen offset:3072 lds
v_mfma_f32_32x32x16_bf16 v[80:95], v[168:171], a[180:183], v[80:95]
ds_read_b64_tr_b16 a[172:173], v2 offset:59392
ds_read_b64_tr_b16 a[174:175], v2 offset:59904
v_mul_f32 v54, v18, v54
v_mul_f32 v55, v19, v55
v_cvt_pk_bf16_f32 v48, v48, v49
v_cvt_pk_bf16_f32 v49, v50, v51
s_waitcnt lgkmcnt(8)
v_mfma_f32_32x32x16_bf16 v[64:79], v[172:175], a[184:187], v[64:79]
ds_read_b64_tr_b16 a[176:177], v1 offset:61440
ds_read_b64_tr_b16 a[178:179], v1 offset:61952
v_cvt_pk_bf16_f32 v50, v52, v53
v_cvt_pk_bf16_f32 v51, v54, v55
v_mfma_f32_32x32x16_bf16 v[80:95], v[172:175], a[188:191], v[80:95]
ds_read_b64_tr_b16 a[180:181], v2 offset:61440
ds_read_b64_tr_b16 a[182:183], v2 offset:61952
buffer_store_dwordx4 v[48:51], v24, s[32:35], s49 offen offset:512 sc1
s_waitcnt lgkmcnt(8)
v_mfma_f32_32x32x16_bf16 v[64:79], v[176:179], a[160:163], v[64:79]
ds_read_b64_tr_b16 a[184:185], v1 offset:63488
ds_read_b64_tr_b16 a[186:187], v1 offset:64000
s_getpc_b64 s[86:87]
L_pc19:
s_lshl_b32 s3, s42, 3
s_xor_b32 s3, s3, s43
s_lshl_b32 s3, s3, 2
v_mfma_f32_32x32x16_bf16 v[80:95], v[176:179], a[164:167], v[80:95]
ds_read_b64_tr_b16 a[188:189], v2 offset:63488
ds_read_b64_tr_b16 a[190:191], v2 offset:64000
s_add_u32 s3, s3, s40
s_mul_i32 s3, s3, 8
s_and_b32 s3, s3, 1023
s_waitcnt lgkmcnt(8)
v_mfma_f32_32x32x16_bf16 v[64:79], v[180:183], a[168:171], v[64:79]
s_waitcnt vmcnt(28)
s_barrier
v_add_u32 v1, 65536, v1
v_add_u32 v2, 65536, v2
ds_read_b64_tr_b16 a[160:161], v1 offset:0
ds_read_b64_tr_b16 a[162:163], v1 offset:512
v_mfma_f32_32x32x16_bf16 v[80:95], v[180:183], a[172:175], v[80:95]
ds_read_b64_tr_b16 a[164:165], v2 offset:0
ds_read_b64_tr_b16 a[166:167], v2 offset:512
s_add_u32 m0, s41, 98304
s_add_u32 s52, s55, 81920
v_min_u32 v26, 7, v3
v_add_lshl_u32 v26, v26, s3, 7
v_min_u32 v26, L_codeend-L_pc19-4, v26
v_and_b32 v26, -4, v26
global_load_dword a223, v26, s[86:87]
s_waitcnt lgkmcnt(8)
v_mfma_f32_32x32x16_bf16 v[64:79], v[184:187], a[176:179], v[64:79]
ds_read_b64_tr_b16 a[168:169], v1 offset:2048
ds_read_b64_tr_b16 a[170:171], v1 offset:2560
buffer_load_dwordx4 v4, s[16:19], s52 offen lds
v_mfma_f32_32x32x16_bf16 v[80:95], v[184:187], a[180:183], v[80:95]
ds_read_b64_tr_b16 a[172:173], v2 offset:2048
ds_read_b64_tr_b16 a[174:175], v2 offset:2560
v_accvgpr_read_b32 v16, a8
s_waitcnt lgkmcnt(8)
v_mfma_f32_32x32x16_bf16 v[64:79], v[188:191], a[184:187], v[64:79]
ds_read_b64_tr_b16 a[176:177], v1 offset:4096
ds_read_b64_tr_b16 a[178:179], v1 offset:4608
buffer_load_dwordx4 v5, s[16:19], s52 offen offset:1024 lds
v_accvgpr_read_b32 v17, a9
v_mfma_f32_32x32x16_bf16 v[80:95], v[188:191], a[188:191], v[80:95]
ds_read_b64_tr_b16 a[180:181], v2 offset:4096
ds_read_b64_tr_b16 a[182:183], v2 offset:4608
v_accvgpr_read_b32 v18, a10
v_accvgpr_read_b32 v19, a11
v_mul_f32 v56, v16, v56
s_waitcnt lgkmcnt(8)
v_mfma_f32_32x32x16_bf16 v[64:79], v[192:195], a[160:163], v[64:79]
ds_read_b64_tr_b16 a[184:185], v1 offset:6144
ds_read_b64_tr_b16 a[186:187], v1 offset:6656
v_mul_f32 v57, v17, v57
v_mul_f32 v58, v18, v58
v_mul_f32 v59, v19, v59
v_accvgpr_read_b32 v16, a12
v_mfma_f32_32x32x16_bf16 v[80:95], v[192:195], a[164:167], v[80:95]
ds_read_b64_tr_b16 a[188:189], v2 offset:6144
ds_read_b64_tr_b16 a[190:191], v2 offset:6656
v_accvgpr_read_b32 v17, a13
v_accvgpr_read_b32 v18, a14
v_accvgpr_read_b32 v19, a15
v_mul_f32 v60, v16, v60
s_waitcnt lgkmcnt(8)
v_mfma_f32_32x32x16_bf16 v[64:79], v[196:199], a[168:171], v[64:79]
ds_read_b64_tr_b16 a[160:161], v1 offset:8192
ds_read_b64_tr_b16 a[162:163], v1 offset:8704
buffer_load_dwordx4 v6, s[16:19], s52 offen offset:2048 lds
v_mfma_f32_32x32x16_bf16 v[80:95], v[196:199], a[172:175], v[80:95]
ds_read_b64_tr_b16 a[164:165], v2 offset:8192
ds_read_b64_tr_b16 a[166:167], v2 offset:8704
v_mul_f32 v61, v17, v61
v_mul_f32 v62, v18, v62
v_mul_f32 v63, v19, v63
v_cvt_pk_bf16_f32 v56, v56, v57
s_waitcnt lgkmcnt(8)
v_mfma_f32_32x32x16_bf16 v[64:79], v[200:203], a[176:179], v[64:79]
ds_read_b64_tr_b16 a[168:169], v1 offset:10240
ds_read_b64_tr_b16 a[170:171], v1 offset:10752
buffer_load_dwordx4 v7, s[16:19], s52 offen offset:3072 lds
v_cvt_pk_bf16_f32 v57, v58, v59
v_mfma_f32_32x32x16_bf16 v[80:95], v[200:203], a[180:183], v[80:95]
ds_read_b64_tr_b16 a[172:173], v2 offset:10240
ds_read_b64_tr_b16 a[174:175], v2 offset:10752
v_bfe_u32 v30, v3, 2, 2
v_lshrrev_b32 v31, 5, v3
v_lshl_add_u32 v30, v31, 3, v30
s_waitcnt lgkmcnt(8)
v_mfma_f32_32x32x16_bf16 v[64:79], v[204:207], a[184:187], v[64:79]
ds_read_b64_tr_b16 a[176:177], v1 offset:12288
ds_read_b64_tr_b16 a[178:179], v1 offset:12800
v_lshlrev_b32 v31, 6, v30
v_bfe_u32 v30, v3, 4, 1
v_lshl_add_u32 v31, v30, 5, v31
v_and_b32 v30, 3, v3
v_mfma_f32_32x32x16_bf16 v[80:95], v[204:207], a[188:191], v[80:95]
ds_read_b64_tr_b16 a[180:181], v2 offset:12288
ds_read_b64_tr_b16 a[182:183], v2 offset:12800
v_lshl_add_u32 v31, v30, 3, v31
v_cvt_pk_bf16_f32 v58, v60, v61
v_cvt_pk_bf16_f32 v59, v62, v63
s_waitcnt lgkmcnt(8)
v_mfma_f32_32x32x16_bf16 v[64:79], v[208:211], a[160:163], v[64:79]
ds_read_b64_tr_b16 a[184:185], v1 offset:14336
ds_read_b64_tr_b16 a[186:187], v1 offset:14848
v_mfma_f32_32x32x16_bf16 v[80:95], v[208:211], a[164:167], v[80:95]
ds_read_b64_tr_b16 a[188:189], v2 offset:14336
ds_read_b64_tr_b16 a[190:191], v2 offset:14848
buffer_store_dwordx4 v[56:59], v25, s[32:35], s49 offen offset:512 sc1
s_waitcnt lgkmcnt(8)
v_mfma_f32_32x32x16_bf16 v[64:79], v[212:215], a[168:171], v[64:79]
s_waitcnt vmcnt(29)
s_barrier
v_subrev_u32 v1, 131072, v1
v_subrev_u32 v2, 131072, v2
ds_read_b64_tr_b16 a[160:161], v1 offset:0
ds_read_b64_tr_b16 a[162:163], v1 offset:512
v_mfma_f32_32x32x16_bf16 v[80:95], v[212:215], a[172:175], v[80:95]
ds_read_b64_tr_b16 a[164:165], v2 offset:0
ds_read_b64_tr_b16 a[166:167], v2 offset:512
s_add_u32 m0, s41, 114688
s_add_u32 s52, s55, 491520
s_waitcnt lgkmcnt(8)
v_mfma_f32_32x32x16_bf16 v[64:79], v[216:219], a[176:179], v[64:79]
ds_read_b64_tr_b16 a[168:169], v1 offset:2048
ds_read_b64_tr_b16 a[170:171], v1 offset:2560
buffer_load_dwordx4 v4, s[16:19], s52 offen lds
v_mfma_f32_32x32x16_bf16 v[80:95], v[216:219], a[180:183], v[80:95]
ds_read_b64_tr_b16 a[172:173], v2 offset:2048
ds_read_b64_tr_b16 a[174:175], v2 offset:2560
s_waitcnt lgkmcnt(8)
v_mfma_f32_32x32x16_bf16 v[64:79], v[220:223], a[184:187], v[64:79]
ds_read_b64_tr_b16 a[176:177], v1 offset:4096
ds_read_b64_tr_b16 a[178:179], v1 offset:4608
buffer_load_dwordx4 v5, s[16:19], s52 offen offset:1024 lds
v_mfma_f32_32x32x16_bf16 v[80:95], v[220:223], a[188:191], v[80:95]
ds_read_b64_tr_b16 a[180:181], v2 offset:4096
ds_read_b64_tr_b16 a[182:183], v2 offset:4608
buffer_load_dword v29, off, s[36:39], 0 offset:128 sc1
s_waitcnt lgkmcnt(8)
v_mfma_f32_32x32x16_bf16 v[64:79], v[224:227], a[160:163], v[64:79]
ds_read_b64_tr_b16 a[184:185], v1 offset:6144
ds_read_b64_tr_b16 a[186:187], v1 offset:6656
v_mfma_f32_32x32x16_bf16 v[80:95], v[224:227], a[164:167], v[80:95]
ds_read_b64_tr_b16 a[188:189], v2 offset:6144
ds_read_b64_tr_b16 a[190:191], v2 offset:6656
s_waitcnt lgkmcnt(8)
v_mfma_f32_32x32x16_bf16 v[64:79], v[228:231], a[168:171], v[64:79]
ds_read_b64_tr_b16 a[160:161], v1 offset:8192
ds_read_b64_tr_b16 a[162:163], v1 offset:8704
buffer_load_dwordx4 v6, s[16:19], s52 offen offset:2048 lds
v_mfma_f32_32x32x16_bf16 v[80:95], v[228:231], a[172:175], v[80:95]
ds_read_b64_tr_b16 a[164:165], v2 offset:8192
ds_read_b64_tr_b16 a[166:167], v2 offset:8704
s_waitcnt lgkmcnt(8)
v_mfma_f32_32x32x16_bf16 v[64:79], v[232:235], a[176:179], v[64:79]
ds_read_b64_tr_b16 a[168:169], v1 offset:10240
ds_read_b64_tr_b16 a[170:171], v1 offset:10752
buffer_load_dwordx4 v7, s[16:19], s52 offen offset:3072 lds
v_mfma_f32_32x32x16_bf16 v[80:95], v[232:235], a[180:183], v[80:95]
ds_read_b64_tr_b16 a[172:173], v2 offset:10240
ds_read_b64_tr_b16 a[174:175], v2 offset:10752
s_waitcnt lgkmcnt(8)
v_mfma_f32_32x32x16_bf16 v[64:79], v[236:239], a[184:187], v[64:79]
ds_read_b64_tr_b16 a[176:177], v1 offset:12288
ds_read_b64_tr_b16 a[178:179], v1 offset:12800
v_mfma_f32_32x32x16_bf16 v[80:95], v[236:239], a[188:191], v[80:95]
ds_read_b64_tr_b16 a[180:181], v2 offset:12288
ds_read_b64_tr_b16 a[182:183], v2 offset:12800
s_waitcnt lgkmcnt(8)
v_mfma_f32_32x32x16_bf16 v[64:79], v[240:243], a[160:163], v[64:79]
ds_read_b64_tr_b16 a[184:185], v1 offset:14336
ds_read_b64_tr_b16 a[186:187], v1 offset:14848
v_mfma_f32_32x32x16_bf16 v[80:95], v[240:243], a[164:167], v[80:95]
ds_read_b64_tr_b16 a[188:189], v2 offset:14336
ds_read_b64_tr_b16 a[190:191], v2 offset:14848
s_waitcnt lgkmcnt(8)
v_mfma_f32_32x32x16_bf16 v[64:79], v[244:247], a[168:171], v[64:79]
s_waitcnt vmcnt(30)
s_barrier
v_add_u32 v1, 0, v31
ds_read_b64_tr_b16 a[160:161], v1 offset:16384
ds_read_b64_tr_b16 a[162:163], v1 offset:16640
s_movk_i32 s96, 1280
v_mfma_f32_32x32x16_bf16 v[80:95], v[244:247], a[172:175], v[80:95]
v_lshrrev_b32 v4, 3, v3
s_lshl_b32 s53, s40, 5
s_lshr_b32 s52, s40, 1
s_mul_i32 s52, s52, 256
s_add_u32 s53, s53, s52
s_waitcnt lgkmcnt(6)
v_mfma_f32_32x32x16_bf16 v[64:79], v[248:251], a[176:179], v[64:79]
ds_read_b64_tr_b16 a[168:169], v1 offset:17408
ds_read_b64_tr_b16 a[170:171], v1 offset:17664
v_add_u32 v4, s53, v4
v_bfe_u32 v5, v3, 4, 1
v_lshlrev_b32 v5, 2, v5
v_and_b32 v6, 7, v3
v_mfma_f32_32x32x16_bf16 v[80:95], v[248:251], a[180:183], v[80:95]
v_xor_b32 v5, v5, v6
v_lshlrev_b32 v5, 4, v5
v_mad_u32_u24 v4, v4, s96, v5
s_lshl_b32 s53, s96, 3
s_sub_u32 s53, s53, 1024
v_add_u32 v4, s56, v4
v_add_u32 v5, s53, v4
v_add_u32 v6, s53, v5
v_add_u32 v7, s53, v6
s_lshl_b32 s53, s96, 6
s_add_u32 m0, s41, 131072
s_add_u32 s52, s55, 163840
buffer_load_dwordx4 v4, s[16:19], s52 offen lds
s_waitcnt lgkmcnt(4)
v_mfma_f32_32x32x16_bf16 v[64:79], v[252:255], a[184:187], v[64:79]
ds_read_b64_tr_b16 a[176:177], v1 offset:18432
ds_read_b64_tr_b16 a[178:179], v1 offset:18688
buffer_load_dwordx4 v5, s[16:19], s52 offen offset:1024 lds
v_mfma_f32_32x32x16_bf16 v[80:95], v[252:255], a[188:191], v[80:95]
buffer_load_dwordx4 v6, s[16:19], s52 offen offset:2048 lds
buffer_load_dwordx4 v7, s[16:19], s52 offen offset:3072 lds
s_waitcnt vmcnt(6)
v_cmp_gt_u32 vcc, 1, v29
s_nop 1
s_cbranch_vccnz L_pw16
L_pr18:
s_waitcnt lgkmcnt(4)
v_mfma_f32_32x32x16_bf16 v[32:47], v[96:99], a[160:163], 0
ds_read_b64_tr_b16 a[184:185], v1 offset:19456
ds_read_b64_tr_b16 a[186:187], v1 offset:19712
s_waitcnt lgkmcnt(4)
v_mfma_f32_32x32x16_bf16 v[32:47], v[100:103], a[168:171], v[32:47]
ds_read_b64_tr_b16 a[160:161], v1 offset:20480
ds_read_b64_tr_b16 a[162:163], v1 offset:20736
s_waitcnt lgkmcnt(4)
v_mfma_f32_32x32x16_bf16 v[32:47], v[104:107], a[176:179], v[32:47]
ds_read_b64_tr_b16 a[168:169], v1 offset:21504
ds_read_b64_tr_b16 a[170:171], v1 offset:21760
v_accvgpr_read_b32 v16, a0
v_accvgpr_read_b32 v17, a1
v_accvgpr_read_b32 v18, a2
v_accvgpr_read_b32 v19, a3
v_mul_f32 v64, v16, v64
s_waitcnt lgkmcnt(4)
v_mfma_f32_32x32x16_bf16 v[32:47], v[108:111], a[184:187], v[32:47]
ds_read_b64_tr_b16 a[176:177], v1 offset:22528
ds_read_b64_tr_b16 a[178:179], v1 offset:22784
v_mul_f32 v65, v17, v65
v_mul_f32 v66, v18, v66
v_mul_f32 v67, v19, v67
v_accvgpr_read_b32 v16, a4
s_waitcnt lgkmcnt(4)
v_mfma_f32_32x32x16_bf16 v[32:47], v[112:115], a[160:163], v[32:47]
ds_read_b64_tr_b16 a[184:185], v1 offset:23552
ds_read_b64_tr_b16 a[186:187], v1 offset:23808
v_accvgpr_read_b32 v17, a5
v_accvgpr_read_b32 v18, a6
v_accvgpr_read_b32 v19, a7
v_mul_f32 v68, v16, v68
v_mul_f32 v69, v17, v69
s_waitcnt lgkmcnt(4)
v_mfma_f32_32x32x16_bf16 v[32:47], v[116:119], a[168:171], v[32:47]
ds_read_b64_tr_b16 a[160:161], v1 offset:24576
ds_read_b64_tr_b16 a[162:163], v1 offset:24832
v_mul_f32 v70, v18, v70
v_mul_f32 v71, v19, v71
v_cvt_pk_bf16_f32 v64, v64, v65
v_cvt_pk_bf16_f32 v65, v66, v67
v_cvt_pk_bf16_f32 v66, v68, v69
s_waitcnt lgkmcnt(4)
v_mfma_f32_32x32x16_bf16 v[32:47], v[120:123], a[176:179], v[32:47]
ds_read_b64_tr_b16 a[168:169], v1 offset:25600
ds_read_b64_tr_b16 a[170:171], v1 offset:25856
v_cvt_pk_bf16_f32 v67, v70, v71
s_waitcnt lgkmcnt(4)
v_mfma_f32_32x32x16_bf16 v[32:47], v[124:127], a[184:187], v[32:47]
ds_read_b64_tr_b16 a[176:177], v1 offset:26624
ds_read_b64_tr_b16 a[178:179], v1 offset:26880
buffer_store_dwordx4 v[64:67], v24, s[32:35], s49 offen offset:1024 sc1
s_waitcnt lgkmcnt(4)
v_mfma_f32_32x32x16_bf16 v[32:47], v[128:131], a[160:163], v[32:47]
ds_read_b64_tr_b16 a[184:185], v1 offset:27648
ds_read_b64_tr_b16 a[186:187], v1 offset:27904
v_accvgpr_read_b32 v16, a8
v_accvgpr_read_b32 v17, a9
v_accvgpr_read_b32 v18, a10
s_waitcnt lgkmcnt(4)
v_mfma_f32_32x32x16_bf16 v[32:47], v[132:135], a[168:171], v[32:47]
ds_read_b64_tr_b16 a[160:161], v1 offset:28672
ds_read_b64_tr_b16 a[162:163], v1 offset:28928
v_accvgpr_read_b32 v19, a11
v_mul_f32 v72, v16, v72
v_mul_f32 v73, v17, v73
v_mul_f32 v74, v18, v74
v_mul_f32 v75, v19, v75
s_waitcnt lgkmcnt(4)
v_mfma_f32_32x32x16_bf16 v[32:47], v[136:139], a[176:179], v[32:47]
ds_read_b64_tr_b16 a[168:169], v1 offset:29696
ds_read_b64_tr_b16 a[170:171], v1 offset:29952
v_accvgpr_read_b32 v16, a12
v_accvgpr_read_b32 v17, a13
v_accvgpr_read_b32 v18, a14
v_accvgpr_read_b32 v19, a15
s_waitcnt lgkmcnt(4)
v_mfma_f32_32x32x16_bf16 v[32:47], v[140:143], a[184:187], v[32:47]
ds_read_b64_tr_b16 a[176:177], v1 offset:30720
ds_read_b64_tr_b16 a[178:179], v1 offset:30976
v_mul_f32 v76, v16, v76
v_mul_f32 v77, v17, v77
v_mul_f32 v78, v18, v78
v_mul_f32 v79, v19, v79
v_cvt_pk_bf16_f32 v72, v72, v73
s_waitcnt lgkmcnt(4)
v_mfma_f32_32x32x16_bf16 v[32:47], v[144:147], a[160:163], v[32:47]
ds_read_b64_tr_b16 a[184:185], v1 offset:31744
ds_read_b64_tr_b16 a[186:187], v1 offset:32000
v_cvt_pk_bf16_f32 v73, v74, v75
v_cvt_pk_bf16_f32 v74, v76, v77
v_cvt_pk_bf16_f32 v75, v78, v79
s_waitcnt lgkmcnt(4)
v_mfma_f32_32x32x16_bf16 v[32:47], v[148:151], a[168:171], v[32:47]
s_barrier
ds_read_b64_tr_b16 a[160:161], v1 offset:32768
ds_read_b64_tr_b16 a[162:163], v1 offset:33024
s_waitcnt lgkmcnt(4)
v_mfma_f32_32x32x16_bf16 v[32:47], v[152:155], a[176:179], v[32:47]
ds_read_b64_tr_b16 a[168:169], v1 offset:33792
ds_read_b64_tr_b16 a[170:171], v1 offset:34048
buffer_store_dwordx4 v[72:75], v25, s[32:35], s49 offen offset:1024 sc1
s_waitcnt lgkmcnt(4)
v_mfma_f32_32x32x16_bf16 v[32:47], v[156:159], a[184:187], v[32:47]
ds_read_b64_tr_b16 a[176:177], v1 offset:34816
ds_read_b64_tr_b16 a[178:179], v1 offset:35072
v_accvgpr_read_b32 v16, a0
v_accvgpr_read_b32 v17, a1
v_accvgpr_read_b32 v18, a2
v_accvgpr_read_b32 v19, a3
s_waitcnt lgkmcnt(4)
v_mfma_f32_32x32x16_bf16 v[32:47], v[160:163], a[160:163], v[32:47]
ds_read_b64_tr_b16 a[184:185], v1 offset:35840
ds_read_b64_tr_b16 a[186:187], v1 offset:36096
v_mul_f32 v80, v16, v80
v_mul_f32 v81, v17, v81
v_mul_f32 v82, v18, v82
v_mul_f32 v83, v19, v83
v_accvgpr_read_b32 v16, a4
s_waitcnt lgkmcnt(4)
v_mfma_f32_32x32x16_bf16 v[32:47], v[164:167], a[168:171], v[32:47]
ds_read_b64_tr_b16 a[160:161], v1 offset:36864
ds_read_b64_tr_b16 a[162:163], v1 offset:37120
v_accvgpr_read_b32 v17, a5
v_accvgpr_read_b32 v18, a6
v_accvgpr_read_b32 v19, a7
v_mul_f32 v84, v16, v84
s_waitcnt lgkmcnt(4)
v_mfma_f32_32x32x16_bf16 v[32:47], v[168:171], a[176:179], v[32:47]
ds_read_b64_tr_b16 a[168:169], v1 offset:37888
ds_read_b64_tr_b16 a[170:171], v1 offset:38144
v_mul_f32 v85, v17, v85
v_mul_f32 v86, v18, v86
v_mul_f32 v87, v19, v87
v_cvt_pk_bf16_f32 v80, v80, v81
v_cvt_pk_bf16_f32 v81, v82, v83
s_waitcnt lgkmcnt(4)
v_mfma_f32_32x32x16_bf16 v[32:47], v[172:175], a[184:187], v[32:47]
ds_read_b64_tr_b16 a[176:177], v1 offset:38912
ds_read_b64_tr_b16 a[178:179], v1 offset:39168
v_cvt_pk_bf16_f32 v82, v84, v85
v_cvt_pk_bf16_f32 v83, v86, v87
s_waitcnt lgkmcnt(4)
v_mfma_f32_32x32x16_bf16 v[32:47], v[176:179], a[160:163], v[32:47]
ds_read_b64_tr_b16 a[184:185], v1 offset:39936
ds_read_b64_tr_b16 a[186:187], v1 offset:40192
v_accvgpr_read_b32 v20, a204
v_accvgpr_read_b32 v21, a205
v_accvgpr_read_b32 v22, a206
s_waitcnt lgkmcnt(4)
v_mfma_f32_32x32x16_bf16 v[32:47], v[180:183], a[168:171], v[32:47]
ds_read_b64_tr_b16 a[160:161], v1 offset:40960
ds_read_b64_tr_b16 a[162:163], v1 offset:41216
v_accvgpr_read_b32 v23, a207
s_add_u32 m0, s41, 147456
s_nop 0
buffer_load_dwordx4 v20, s[8:11], s55 offen lds
buffer_load_dwordx4 v21, s[8:11], s55 offen offset:1024 lds
buffer_load_dwordx4 v22, s[8:11], s55 offen offset:2048 lds
buffer_load_dwordx4 v23, s[8:11], s55 offen offset:3072 lds
s_waitcnt lgkmcnt(4)
v_mfma_f32_32x32x16_bf16 v[32:47], v[184:187], a[176:179], v[32:47]
ds_read_b64_tr_b16 a[168:169], v1 offset:41984
ds_read_b64_tr_b16 a[170:171], v1 offset:42240
buffer_store_dwordx4 v[80:83], v24, s[32:35], s49 offen offset:1536 sc1
s_waitcnt lgkmcnt(4)
v_mfma_f32_32x32x16_bf16 v[32:47], v[188:191], a[184:187], v[32:47]
ds_read_b64_tr_b16 a[176:177], v1 offset:43008
ds_read_b64_tr_b16 a[178:179], v1 offset:43264
v_accvgpr_read_b32 v16, a8
v_accvgpr_read_b32 v17, a9
v_accvgpr_read_b32 v18, a10
v_accvgpr_read_b32 v19, a11
s_waitcnt lgkmcnt(4)
v_mfma_f32_32x32x16_bf16 v[32:47], v[192:195], a[160:163], v[32:47]
ds_read_b64_tr_b16 a[184:185], v1 offset:44032
ds_read_b64_tr_b16 a[186:187], v1 offset:44288
v_mul_f32 v88, v16, v88
v_mul_f32 v89, v17, v89
v_mul_f32 v90, v18, v90
v_mul_f32 v91, v19, v91
s_waitcnt lgkmcnt(4)
v_mfma_f32_32x32x16_bf16 v[32:47], v[196:199], a[168:171], v[32:47]
ds_read_b64_tr_b16 a[160:161], v1 offset:45056
ds_read_b64_tr_b16 a[162:163], v1 offset:45312
v_accvgpr_read_b32 v16, a12
v_accvgpr_read_b32 v17, a13
v_accvgpr_read_b32 v18, a14
v_accvgpr_read_b32 v19, a15
v_mul_f32 v92, v16, v92
s_waitcnt lgkmcnt(4)
v_mfma_f32_32x32x16_bf16 v[32:47], v[200:203], a[176:179], v[32:47]
ds_read_b64_tr_b16 a[168:169], v1 offset:46080
ds_read_b64_tr_b16 a[170:171], v1 offset:46336
v_mul_f32 v93, v17, v93
v_mul_f32 v94, v18, v94
v_mul_f32 v95, v19, v95
v_cvt_pk_bf16_f32 v88, v88, v89
v_cvt_pk_bf16_f32 v89, v90, v91
s_waitcnt lgkmcnt(4)
v_mfma_f32_32x32x16_bf16 v[32:47], v[204:207], a[184:187], v[32:47]
ds_read_b64_tr_b16 a[176:177], v1 offset:47104
ds_read_b64_tr_b16 a[178:179], v1 offset:47360
v_cvt_pk_bf16_f32 v90, v92, v93
v_cvt_pk_bf16_f32 v91, v94, v95
s_waitcnt lgkmcnt(4)
v_mfma_f32_32x32x16_bf16 v[32:47], v[208:211], a[160:163], v[32:47]
ds_read_b64_tr_b16 a[184:185], v1 offset:48128
ds_read_b64_tr_b16 a[186:187], v1 offset:48384
buffer_store_dwordx4 v[88:91], v25, s[32:35], s49 offen offset:1536 sc1
s_waitcnt lgkmcnt(4)
v_mfma_f32_32x32x16_bf16 v[32:47], v[212:215], a[168:171], v[32:47]
s_barrier
ds_read_b64_tr_b16 a[160:161], v1 offset:49152
ds_read_b64_tr_b16 a[162:163], v1 offset:49408
s_waitcnt lgkmcnt(4)
v_mfma_f32_32x32x16_bf16 v[32:47], v[216:219], a[176:179], v[32:47]
ds_read_b64_tr_b16 a[168:169], v1 offset:50176
ds_read_b64_tr_b16 a[170:171], v1 offset:50432
s_lshl_b32 s6, s54, 9
s_waitcnt lgkmcnt(4)
v_mfma_f32_32x32x16_bf16 v[32:47], v[220:223], a[184:187], v[32:47]
ds_read_b64_tr_b16 a[176:177], v1 offset:51200
ds_read_b64_tr_b16 a[178:179], v1 offset:51456
buffer_load_dword v29, off, s[32:35], s6 sc1
s_mul_i32 s4, s54, 40960
s_add_u32 s4, s4, 655360
s_mul_i32 s3, s61, 5
s_cmp_eq_u32 s61, 0
s_cselect_b32 s4, 1073741824, s4
s_waitcnt lgkmcnt(4)
v_mfma_f32_32x32x16_bf16 v[32:47], v[224:227], a[160:163], v[32:47]
ds_read_b64_tr_b16 a[184:185], v1 offset:52224
ds_read_b64_tr_b16 a[186:187], v1 offset:52480
s_waitcnt lgkmcnt(4)
v_mfma_f32_32x32x16_bf16 v[32:47], v[228:231], a[168:171], v[32:47]
ds_read_b64_tr_b16 a[160:161], v1 offset:53248
ds_read_b64_tr_b16 a[162:163], v1 offset:53504
s_waitcnt lgkmcnt(4)
v_mfma_f32_32x32x16_bf16 v[32:47], v[232:235], a[176:179], v[32:47]
ds_read_b64_tr_b16 a[168:169], v1 offset:54272
ds_read_b64_tr_b16 a[170:171], v1 offset:54528
s_waitcnt lgkmcnt(4)
v_mfma_f32_32x32x16_bf16 v[32:47], v[236:239], a[184:187], v[32:47]
ds_read_b64_tr_b16 a[176:177], v1 offset:55296
ds_read_b64_tr_b16 a[178:179], v1 offset:55552
s_waitcnt lgkmcnt(4)
v_mfma_f32_32x32x16_bf16 v[32:47], v[240:243], a[160:163], v[32:47]
ds_read_b64_tr_b16 a[184:185], v1 offset:56320
ds_read_b64_tr_b16 a[186:187], v1 offset:56576
s_waitcnt lgkmcnt(4)
v_mfma_f32_32x32x16_bf16 v[32:47], v[244:247], a[168:171], v[32:47]
s_waitcnt lgkmcnt(2)
v_mfma_f32_32x32x16_bf16 v[32:47], v[248:251], a[176:179], v[32:47]
s_waitcnt lgkmcnt(0)
v_mfma_f32_32x32x16_bf16 v[32:47], v[252:255], a[184:187], v[32:47]
v_accvgpr_read_b32 v16, a0
v_accvgpr_read_b32 v17, a1
v_accvgpr_read_b32 v18, a2
v_accvgpr_read_b32 v19, a3
s_nop 7
v_mul_f32 v32, v16, v32
v_mul_f32 v33, v17, v33
v_mul_f32 v34, v18, v34
v_mul_f32 v35, v19, v35
v_accvgpr_read_b32 v16, a4
v_accvgpr_read_b32 v17, a5
v_accvgpr_read_b32 v18, a6
v_accvgpr_read_b32 v19, a7
v_mul_f32 v36, v16, v36
v_mul_f32 v37, v17, v37
v_mul_f32 v38, v18, v38
v_mul_f32 v39, v19, v39
v_cvt_pk_bf16_f32 v32, v32, v33
v_cvt_pk_bf16_f32 v33, v34, v35
v_cvt_pk_bf16_f32 v34, v36, v37
v_cvt_pk_bf16_f32 v35, v38, v39
buffer_store_dwordx4 v[32:35], v24, s[32:35], s50 offen sc1
v_accvgpr_read_b32 v16, a8
v_accvgpr_read_b32 v17, a9
v_accvgpr_read_b32 v18, a10
v_accvgpr_read_b32 v19, a11
v_mul_f32 v40, v16, v40
v_mul_f32 v41, v17, v41
v_mul_f32 v42, v18, v42
v_mul_f32 v43, v19, v43
v_accvgpr_read_b32 v16, a12
v_accvgpr_read_b32 v17, a13
v_accvgpr_read_b32 v18, a14
v_accvgpr_read_b32 v19, a15
v_mul_f32 v44, v16, v44
v_mul_f32 v45, v17, v45
v_mul_f32 v46, v18, v46
v_mul_f32 v47, v19, v47
v_cvt_pk_bf16_f32 v40, v40, v41
v_cvt_pk_bf16_f32 v41, v42, v43
v_cvt_pk_bf16_f32 v42, v44, v45
v_cvt_pk_bf16_f32 v43, v46, v47
buffer_store_dwordx4 v[40:43], v25, s[32:35], s50 offen sc1
s_waitcnt vmcnt(2)
v_cmp_gt_u32 vcc, s3, v29
s_nop 1
s_cbranch_vccnz L_pw20
L_pr22:
s_add_u32 s5, s4, 0
buffer_load_dwordx4 v[160:163], v0, s[32:35], s5 offen sc1
buffer_load_dwordx4 v[164:167], v0, s[32:35], s5 offen offset:1024 sc1
buffer_load_dwordx4 v[168:171], v0, s[32:35], s5 offen offset:2048 sc1
buffer_load_dwordx4 v[172:175], v0, s[32:35], s5 offen offset:3072 sc1
s_add_u32 s5, s4, 12288
buffer_load_dwordx4 v[176:179], v0, s[32:35], s5 offen sc1
buffer_load_dwordx4 v[180:183], v0, s[32:35], s5 offen offset:1024 sc1
buffer_load_dwordx4 v[184:187], v0, s[32:35], s5 offen offset:2048 sc1
buffer_load_dwordx4 v[188:191], v0, s[32:35], s5 offen offset:3072 sc1
s_add_u32 s5, s4, 20480
buffer_load_dwordx4 v[192:195], v0, s[32:35], s5 offen sc1
buffer_load_dwordx4 v[196:199], v0, s[32:35], s5 offen offset:1024 sc1
buffer_load_dwordx4 v[200:203], v0, s[32:35], s5 offen offset:2048 sc1
buffer_load_dwordx4 v[204:207], v0, s[32:35], s5 offen offset:3072 sc1
L_s2:
s_cmp_eq_u32 s40, 3
s_cbranch_scc1 L_s2w3
s_cmp_eq_u32 s61, 0
s_cbranch_scc1 L_s2id
s_lshl_b32 s3, s54, 8
s_add_u32 s3, s3, 114688
v_and_b32 v100, 31, v3
v_lshlrev_b32 v100, 3, v100
buffer_load_dwordx2 v[8:9], v100, s[32:35], s3 offen sc1
s_barrier
v_bfe_u32 v30, v3, 2, 2
v_lshrrev_b32 v31, 5, v3
v_lshl_add_u32 v30, v31, 2, v30
v_lshlrev_b32 v1, 7, v30
v_bfe_u32 v30, v3, 4, 1
v_lshl_add_u32 v1, v30, 5, v1
v_and_b32 v30, 3, v3
v_lshl_add_u32 v1, v30, 3, v1
v_bfe_u32 v30, v3, 3, 1
v_lshl_add_u32 v1, v30, 6, v1
v_add_u32 v1, 65536, v1
v_xor_b32 v2, 64, v1
ds_read_b64_tr_b16 a[160:161], v1 offset:0
ds_read_b64_tr_b16 a[162:163], v1 offset:1024
ds_read_b64_tr_b16 a[164:165], v2 offset:0
ds_read_b64_tr_b16 a[166:167], v2 offset:1024
ds_read_b64_tr_b16 a[168:169], v1 offset:2048
ds_read_b64_tr_b16 a[170:171], v1 offset:3072
ds_read_b64_tr_b16 a[172:173], v2 offset:2048
ds_read_b64_tr_b16 a[174:175], v2 offset:3072
ds_read_b64_tr_b16 a[176:177], v1 offset:4096
ds_read_b64_tr_b16 a[178:179], v1 offset:5120
ds_read_b64_tr_b16 a[180:181], v2 offset:4096
ds_read_b64_tr_b16 a[182:183], v2 offset:5120
s_waitcnt lgkmcnt(8)
s_waitcnt vmcnt(12)
v_mfma_f32_32x32x16_bf16 v[32:47], a[160:163], v[160:163], 0
ds_read_b64_tr_b16 a[184:185], v1 offset:6144
ds_read_b64_tr_b16 a[186:187], v1 offset:7168
s_add_u32 s5, s4, 32768
v_mfma_f32_32x32x16_bf16 v[48:63], a[164:167], v[160:163], 0
ds_read_b64_tr_b16 a[188:189], v2 offset:6144
ds_read_b64_tr_b16 a[190:191], v2 offset:7168
s_waitcnt lgkmcnt(8)
s_waitcnt vmcnt(11)
v_mfma_f32_32x32x16_bf16 v[32:47], a[168:171], v[164:167], v[32:47]
ds_read_b64_tr_b16 a[160:161], v1 offset:8192
ds_read_b64_tr_b16 a[162:163], v1 offset:9216
buffer_load_dwordx4 v[208:211], v0, s[32:35], s5 offen sc1
v_mfma_f32_32x32x16_bf16 v[48:63], a[172:175], v[164:167], v[48:63]
ds_read_b64_tr_b16 a[164:165], v2 offset:8192
ds_read_b64_tr_b16 a[166:167], v2 offset:9216
buffer_atomic_add v14, v13, s[32:35], s47 offen sc1
s_waitcnt lgkmcnt(8)
s_waitcnt vmcnt(12)
v_mfma_f32_32x32x16_bf16 v[32:47], a[176:179], v[168:171], v[32:47]
ds_read_b64_tr_b16 a[168:169], v1 offset:10240
ds_read_b64_tr_b16 a[170:171], v1 offset:11264
buffer_load_dwordx4 v[212:215], v0, s[32:35], s5 offen offset:1024 sc1
v_mfma_f32_32x32x16_bf16 v[48:63], a[180:183], v[168:171], v[48:63]
ds_read_b64_tr_b16 a[172:173], v2 offset:10240
ds_read_b64_tr_b16 a[174:175], v2 offset:11264
s_waitcnt lgkmcnt(8)
s_waitcnt vmcnt(12)
v_mfma_f32_32x32x16_bf16 v[32:47], a[184:187], v[172:175], v[32:47]
ds_read_b64_tr_b16 a[176:177], v1 offset:12288
ds_read_b64_tr_b16 a[178:179], v1 offset:13312
buffer_load_dwordx4 v[216:219], v0, s[32:35], s5 offen offset:2048 sc1
v_mfma_f32_32x32x16_bf16 v[48:63], a[188:191], v[172:175], v[48:63]
ds_read_b64_tr_b16 a[180:181], v2 offset:12288
ds_read_b64_tr_b16 a[182:183], v2 offset:13312
s_waitcnt lgkmcnt(8)
s_waitcnt vmcnt(12)
v_mfma_f32_32x32x16_bf16 v[32:47], a[160:163], v[176:179], v[32:47]
ds_read_b64_tr_b16 a[184:185], v1 offset:14336
ds_read_b64_tr_b16 a[186:187], v1 offset:15360
buffer_load_dwordx4 v[220:223], v0, s[32:35], s5 offen offset:3072 sc1
v_mfma_f32_32x32x16_bf16 v[48:63], a[164:167], v[176:179], v[48:63]
ds_read_b64_tr_b16 a[188:189], v2 offset:14336
ds_read_b64_tr_b16 a[190:191], v2 offset:15360
s_waitcnt lgkmcnt(8)
s_waitcnt vmcnt(12)
v_mfma_f32_32x32x16_bf16 v[32:47], a[168:171], v[180:183], v[32:47]
s_barrier
ds_read_b64_tr_b16 a[160:161], v1 offset:16384
ds_read_b64_tr_b16 a[162:163], v1 offset:17408
v_mfma_f32_32x32x16_bf16 v[48:63], a[172:175], v[180:183], v[48:63]
ds_read_b64_tr_b16 a[164:165], v2 offset:16384
ds_read_b64_tr_b16 a[166:167], v2 offset:17408
buffer_load_dword v29, off, s[32:35], s6 offset:128 sc1
s_waitcnt lgkmcnt(8)
s_waitcnt vmcnt(12)
v_mfma_f32_32x32x16_bf16 v[32:47], a[176:179], v[184:187], v[32:47]
ds_read_b64_tr_b16 a[168:169], v1 offset:18432
ds_read_b64_tr_b16 a[170:171], v1 offset:19456
v_mfma_f32_32x32x16_bf16 v[48:63], a[180:183], v[184:187], v[48:63]
ds_read_b64_tr_b16 a[172:173], v2 offset:18432
ds_read_b64_tr_b16 a[174:175], v2 offset:19456
s_waitcnt lgkmcnt(8)
s_waitcnt vmcnt(11)
v_mfma_f32_32x32x16_bf16 v[32:47], a[184:187], v[188:191], v[32:47]
ds_read_b64_tr_b16 a[176:177], v1 offset:20480
ds_read_b64_tr_b16 a[178:179], v1 offset:21504
v_mfma_f32_32x32x16_bf16 v[48:63], a[188:191], v[188:191], v[48:63]
ds_read_b64_tr_b16 a[180:181], v2 offset:20480
ds_read_b64_tr_b16 a[182:183], v2 offset:21504
s_waitcnt lgkmcnt(8)
s_waitcnt vmcnt(10)
v_mfma_f32_32x32x16_bf16 v[32:47], a[160:163], v[192:195], v[32:47]
ds_read_b64_tr_b16 a[184:185], v1 offset:22528
ds_read_b64_tr_b16 a[186:187], v1 offset:23552
v_mfma_f32_32x32x16_bf16 v[48:63], a[164:167], v[192:195], v[48:63]
ds_read_b64_tr_b16 a[188:189], v2 offset:22528
ds_read_b64_tr_b16 a[190:191], v2 offset:23552
s_waitcnt lgkmcnt(8)
s_waitcnt vmcnt(9)
v_mfma_f32_32x32x16_bf16 v[32:47], a[168:171], v[196:199], v[32:47]
ds_read_b64_tr_b16 a[160:161], v1 offset:24576
ds_read_b64_tr_b16 a[162:163], v1 offset:25600
s_waitcnt vmcnt(0)
v_cmp_gt_u32 vcc, 4, v29
s_nop 1
s_cbranch_vccnz L_pw23
L_pr25:
s_add_u32 s5, s4, 4096
v_mfma_f32_32x32x16_bf16 v[48:63], a[172:175], v[196:199], v[48:63]
ds_read_b64_tr_b16 a[164:165], v2 offset:24576
ds_read_b64_tr_b16 a[166:167], v2 offset:25600
s_waitcnt lgkmcnt(8)
v_mfma_f32_32x32x16_bf16 v[32:47], a[176:179], v[200:203], v[32:47]
ds_read_b64_tr_b16 a[168:169], v1 offset:26624
ds_read_b64_tr_b16 a[170:171], v1 offset:27648
buffer_load_dwordx4 v[224:227], v0, s[32:35], s5 offen sc1
v_mfma_f32_32x32x16_bf16 v[48:63], a[180:183], v[200:203], v[48:63]
ds_read_b64_tr_b16 a[172:173], v2 offset:26624
ds_read_b64_tr_b16 a[174:175], v2 offset:27648
buffer_load_dwordx4 v[228:231], v0, s[32:35], s5 offen offset:1024 sc1
s_waitcnt lgkmcnt(8)
v_mfma_f32_32x32x16_bf16 v[32:47], a[184:187], v[204:207], v[32:47]
ds_read_b64_tr_b16 a[176:177], v1 offset:28672
ds_read_b64_tr_b16 a[178:179], v1 offset:29696
buffer_load_dwordx4 v[232:235], v0, s[32:35], s5 offen offset:2048 sc1
v_and_b32 v101, 31, v3
v_lshlrev_b32 v100, 7, v101
v_bfe_u32 v101, v3, 1, 3
v_mfma_f32_32x32x16_bf16 v[48:63], a[188:191], v[204:207], v[48:63]
ds_read_b64_tr_b16 a[180:181], v2 offset:28672
ds_read_b64_tr_b16 a[182:183], v2 offset:29696
buffer_load_dwordx4 v[236:239], v0, s[32:35], s5 offen offset:3072 sc1
v_lshl_add_u32 v100, v101, 4, v100
v_lshrrev_b32 v101, 5, v3
s_waitcnt lgkmcnt(8)
v_mfma_f32_32x32x16_bf16 v[32:47], a[160:163], v[208:211], v[32:47]
ds_read_b64_tr_b16 a[184:185], v1 offset:30720
ds_read_b64_tr_b16 a[186:187], v1 offset:31744
s_add_u32 s5, s4, 16384
v_lshl_add_u32 v100, v101, 3, v100
v_add_u32 v100, s41, v100
v_add_u32 v100, 147456, v100
v_xor_b32 v101, 0, v100
ds_read_b64 v[104:105], v101
v_mfma_f32_32x32x16_bf16 v[48:63], a[164:167], v[208:211], v[48:63]
ds_read_b64_tr_b16 a[188:189], v2 offset:30720
ds_read_b64_tr_b16 a[190:191], v2 offset:31744
buffer_load_dwordx4 v[160:163], v0, s[32:35], s5 offen sc1
v_xor_b32 v101, 16, v100
ds_read_b64 v[106:107], v101
s_waitcnt lgkmcnt(10)
v_mfma_f32_32x32x16_bf16 v[32:47], a[168:171], v[212:215], v[32:47]
s_barrier
ds_read_b64_tr_b16 a[160:161], v1 offset:32768
ds_read_b64_tr_b16 a[162:163], v1 offset:33792
v_xor_b32 v101, 32, v100
ds_read_b64 v[108:109], v101
v_xor_b32 v101, 48, v100
ds_read_b64 v[110:111], v101
v_mfma_f32_32x32x16_bf16 v[48:63], a[172:175], v[212:215], v[48:63]
ds_read_b64_tr_b16 a[164:165], v2 offset:32768
ds_read_b64_tr_b16 a[166:167], v2 offset:33792
buffer_load_dwordx4 v[164:167], v0, s[32:35], s5 offen offset:1024 sc1
buffer_load_dwordx4 v[168:171], v0, s[32:35], s5 offen offset:2048 sc1
s_waitcnt lgkmcnt(12)
v_mfma_f32_32x32x16_bf16 v[32:47], a[176:179], v[216:219], v[32:47]
ds_read_b64_tr_b16 a[168:169], v1 offset:34816
ds_read_b64_tr_b16 a[170:171], v1 offset:35840
buffer_load_dwordx4 v[172:175], v0, s[32:35], s5 offen offset:3072 sc1
v_xor_b32 v101, 64, v100
ds_read_b64 v[112:113], v101
v_xor_b32 v101, 80, v100
v_mfma_f32_32x32x16_bf16 v[48:63], a[180:183], v[216:219], v[48:63]
ds_read_b64_tr_b16 a[172:173], v2 offset:34816
ds_read_b64_tr_b16 a[174:175], v2 offset:35840
s_add_u32 s5, s4, 24576
ds_read_b64 v[114:115], v101
v_xor_b32 v101, 96, v100
ds_read_b64 v[116:117], v101
v_xor_b32 v101, 112, v100
s_waitcnt lgkmcnt(14)
v_mfma_f32_32x32x16_bf16 v[32:47], a[184:187], v[220:223], v[32:47]
ds_read_b64_tr_b16 a[176:177], v1 offset:36864
ds_read_b64_tr_b16 a[178:179], v1 offset:37888
buffer_load_dwordx4 v[176:179], v0, s[32:35], s5 offen sc1
ds_read_b64 v[118:119], v101
v_lshlrev_b32 v120, 16, v104
v_and_b32 v121, 0xffff0000, v104
v_mfma_f32_32x32x16_bf16 v[48:63], a[188:191], v[220:223], v[48:63]
ds_read_b64_tr_b16 a[180:181], v2 offset:36864
ds_read_b64_tr_b16 a[182:183], v2 offset:37888
buffer_load_dwordx4 v[180:183], v0, s[32:35], s5 offen offset:1024 sc1
v_accvgpr_write_b32 a224, v104
v_fma_f32 v120, v120, v8, v9
s_waitcnt lgkmcnt(12)
s_waitcnt vmcnt(9)
v_mfma_f32_32x32x16_bf16 v[32:47], a[160:163], v[224:227], v[32:47]
ds_read_b64_tr_b16 a[184:185], v1 offset:38912
ds_read_b64_tr_b16 a[186:187], v1 offset:39936
buffer_load_dwordx4 v[184:187], v0, s[32:35], s5 offen offset:2048 sc1
v_fma_f32 v121, v121, v8, v9
v_lshlrev_b32 v122, 16, v105
v_and_b32 v123, 0xffff0000, v105
v_mfma_f32_32x32x16_bf16 v[48:63], a[164:167], v[224:227], v[48:63]
ds_read_b64_tr_b16 a[188:189], v2 offset:38912
ds_read_b64_tr_b16 a[190:191], v2 offset:39936
buffer_load_dwordx4 v[188:191], v0, s[32:35], s5 offen offset:3072 sc1
buffer_load_dword v29, off, s[32:35], s6 offset:256 sc1
s_waitcnt lgkmcnt(11)
s_waitcnt vmcnt(11)
v_mfma_f32_32x32x16_bf16 v[32:47], a[168:171], v[228:231], v[32:47]
ds_read_b64_tr_b16 a[160:161], v1 offset:40960
ds_read_b64_tr_b16 a[162:163], v1 offset:41984
s_add_u32 s5, s4, 36864
v_accvgpr_write_b32 a225, v105
v_fma_f32 v122, v122, v8, v9
v_fma_f32 v123, v123, v8, v9
v_lshlrev_b32 v124, 16, v106
v_and_b32 v125, 0xffff0000, v106
v_mfma_f32_32x32x16_bf16 v[48:63], a[172:175], v[228:231], v[48:63]
ds_read_b64_tr_b16 a[164:165], v2 offset:40960
ds_read_b64_tr_b16 a[166:167], v2 offset:41984
buffer_load_dwordx4 v[192:195], v0, s[32:35], s5 offen sc1
v_accvgpr_write_b32 a226, v106
v_fma_f32 v124, v124, v8, v9
s_waitcnt lgkmcnt(8)
s_waitcnt vmcnt(11)
v_mfma_f32_32x32x16_bf16 v[32:47], a[176:179], v[232:235], v[32:47]
ds_read_b64_tr_b16 a[168:169], v1 offset:43008
ds_read_b64_tr_b16 a[170:171], v1 offset:44032
buffer_load_dwordx4 v[196:199], v0, s[32:35], s5 offen offset:1024 sc1
v_fma_f32 v125, v125, v8, v9
v_lshlrev_b32 v126, 16, v107
v_and_b32 v127, 0xffff0000, v107
v_mfma_f32_32x32x16_bf16 v[48:63], a[180:183], v[232:235], v[48:63]
ds_read_b64_tr_b16 a[172:173], v2 offset:43008
ds_read_b64_tr_b16 a[174:175], v2 offset:44032
buffer_load_dwordx4 v[200:203], v0, s[32:35], s5 offen offset:2048 sc1
v_accvgpr_write_b32 a227, v107
s_waitcnt lgkmcnt(8)
s_waitcnt vmcnt(12)
v_mfma_f32_32x32x16_bf16 v[32:47], a[184:187], v[236:239], v[32:47]
ds_read_b64_tr_b16 a[176:177], v1 offset:45056
ds_read_b64_tr_b16 a[178:179], v1 offset:46080
buffer_load_dwordx4 v[204:207], v0, s[32:35], s5 offen offset:3072 sc1
v_fma_f32 v126, v126, v8, v9
v_fma_f32 v127, v127, v8, v9
v_lshlrev_b32 v128, 16, v108
v_mfma_f32_32x32x16_bf16 v[48:63], a[188:191], v[236:239], v[48:63]
ds_read_b64_tr_b16 a[180:181], v2 offset:45056
ds_read_b64_tr_b16 a[182:183], v2 offset:46080
v_accvgpr_read_b32 v20, a221
v_accvgpr_read_b32 v21, a222
buffer_load_dword v22, v20, s[32:35], 0 offen sc1
s_add_u32 s8, s32, 5898240
s_addc_u32 s9, s33, 0
s_add_u32 s12, s32, 8519680
s_addc_u32 s13, s33, 0
s_mov_b32 s14, 2621440
s_mul_i32 s3, s42, 5
s_add_u32 s3, s3, s40
s_lshl_b32 s3, s3, 10
s_mul_i32 s98, s43, 81920
s_add_u32 s98, s98, s3
s_add_u32 s99, s98, 3276800
s_waitcnt lgkmcnt(8)
s_waitcnt vmcnt(13)
v_mfma_f32_32x32x16_bf16 v[32:47], a[160:163], v[160:163], v[32:47]
ds_read_b64_tr_b16 a[184:185], v1 offset:47104
ds_read_b64_tr_b16 a[186:187], v1 offset:48128
s_waitcnt vmcnt(5)
v_cmp_gt_u32 vcc, 4, v29
s_nop 1
s_cbranch_vccnz L_pw26
L_pr28:
s_add_u32 s5, s4, 8192
v_and_b32 v129, 0xffff0000, v108
v_accvgpr_write_b32 a228, v108
v_fma_f32 v128, v128, v8, v9
v_mfma_f32_32x32x16_bf16 v[48:63], a[164:167], v[160:163], v[48:63]
ds_read_b64_tr_b16 a[188:189], v2 offset:47104
ds_read_b64_tr_b16 a[190:191], v2 offset:48128
v_fma_f32 v129, v129, v8, v9
v_lshlrev_b32 v130, 16, v109
v_and_b32 v131, 0xffff0000, v109
v_accvgpr_write_b32 a229, v109
v_fma_f32 v130, v130, v8, v9
v_fma_f32 v131, v131, v8, v9
s_waitcnt lgkmcnt(8)
v_mfma_f32_32x32x16_bf16 v[32:47], a[168:171], v[164:167], v[32:47]
s_barrier
ds_read_b64_tr_b16 a[160:161], v1 offset:49152
ds_read_b64_tr_b16 a[162:163], v1 offset:50176
v_lshlrev_b32 v132, 16, v110
v_and_b32 v133, 0xffff0000, v110
v_accvgpr_write_b32 a230, v110
v_fma_f32 v132, v132, v8, v9
v_mfma_f32_32x32x16_bf16 v[48:63], a[172:175], v[164:167], v[48:63]
ds_read_b64_tr_b16 a[164:165], v2 offset:49152
ds_read_b64_tr_b16 a[166:167], v2 offset:50176
buffer_load_dwordx4 v[208:211], v0, s[32:35], s5 offen sc1
buffer_load_dwordx4 v[212:215], v0, s[32:35], s5 offen offset:1024 sc1
s_waitcnt lgkmcnt(8)
v_mfma_f32_32x32x16_bf16 v[32:47], a[176:179], v[168:171], v[32:47]
ds_read_b64_tr_b16 a[168:169], v1 offset:51200
ds_read_b64_tr_b16 a[170:171], v1 offset:52224
buffer_load_dwordx4 v[216:219], v0, s[32:35], s5 offen offset:2048 sc1
v_fma_f32 v133, v133, v8, v9
v_lshlrev_b32 v134, 16, v111
v_and_b32 v135, 0xffff0000, v111
v_mfma_f32_32x32x16_bf16 v[48:63], a[180:183], v[168:171], v[48:63]
ds_read_b64_tr_b16 a[172:173], v2 offset:51200
ds_read_b64_tr_b16 a[174:175], v2 offset:52224
buffer_load_dwordx4 v[220:223], v0, s[32:35], s5 offen offset:3072 sc1
v_accvgpr_write_b32 a231, v111
v_fma_f32 v134, v134, v8, v9
s_waitcnt lgkmcnt(8)
v_mfma_f32_32x32x16_bf16 v[32:47], a[184:187], v[172:175], v[32:47]
ds_read_b64_tr_b16 a[176:177], v1 offset:53248
ds_read_b64_tr_b16 a[178:179], v1 offset:54272
s_add_u32 s5, s4, 28672
v_fma_f32 v135, v135, v8, v9
v_lshlrev_b32 v136, 16, v112
v_and_b32 v137, 0xffff0000, v112
v_accvgpr_write_b32 a232, v112
v_fma_f32 v136, v136, v8, v9
v_mfma_f32_32x32x16_bf16 v[48:63], a[188:191], v[172:175], v[48:63]
ds_read_b64_tr_b16 a[180:181], v2 offset:53248
ds_read_b64_tr_b16 a[182:183], v2 offset:54272
buffer_load_dwordx4 v[224:227], v0, s[32:35], s5 offen sc1
v_fma_f32 v137, v137, v8, v9
v_lshlrev_b32 v138, 16, v113
s_waitcnt lgkmcnt(8)
v_mfma_f32_32x32x16_bf16 v[32:47], a[160:163], v[176:179], v[32:47]
ds_read_b64_tr_b16 a[184:185], v1 offset:55296
ds_read_b64_tr_b16 a[186:187], v1 offset:56320
buffer_load_dwordx4 v[228:231], v0, s[32:35], s5 offen offset:1024 sc1
v_and_b32 v139, 0xffff0000, v113
v_accvgpr_write_b32 a233, v113
v_fma_f32 v138, v138, v8, v9
v_mfma_f32_32x32x16_bf16 v[48:63], a[164:167], v[176:179], v[48:63]
ds_read_b64_tr_b16 a[188:189], v2 offset:55296
ds_read_b64_tr_b16 a[190:191], v2 offset:56320
buffer_load_dwordx4 v[232:235], v0, s[32:35], s5 offen offset:2048 sc1
v_fma_f32 v139, v139, v8, v9
s_waitcnt lgkmcnt(8)
v_mfma_f32_32x32x16_bf16 v[32:47], a[168:171], v[180:183], v[32:47]
ds_read_b64_tr_b16 a[160:161], v1 offset:57344
ds_read_b64_tr_b16 a[162:163], v1 offset:58368
buffer_load_dwordx4 v[236:239], v0, s[32:35], s5 offen offset:3072 sc1
v_lshlrev_b32 v140, 16, v114
v_and_b32 v141, 0xffff0000, v114
v_accvgpr_write_b32 a234, v114
v_mfma_f32_32x32x16_bf16 v[48:63], a[172:175], v[180:183], v[48:63]
ds_read_b64_tr_b16 a[164:165], v2 offset:57344
ds_read_b64_tr_b16 a[166:167], v2 offset:58368
s_waitcnt vmcnt(8)
v_cmp_gt_u32 vcc, v21, v22
s_nop 1
s_cbranch_vccnz L_pw29
L_pr31:
v_fma_f32 v140, v140, v8, v9
v_fma_f32 v141, v141, v8, v9
v_lshlrev_b32 v142, 16, v115
v_and_b32 v143, 0xffff0000, v115
s_waitcnt lgkmcnt(8)
v_mfma_f32_32x32x16_bf16 v[32:47], a[176:179], v[184:187], v[32:47]
ds_read_b64_tr_b16 a[168:169], v1 offset:59392
ds_read_b64_tr_b16 a[170:171], v1 offset:60416
buffer_load_dwordx4 v[64:67], v0, s[32:35], s99 offen sc1
v_accvgpr_write_b32 a235, v115
v_fma_f32 v142, v142, v8, v9
v_mfma_f32_32x32x16_bf16 v[48:63], a[180:183], v[184:187], v[48:63]
ds_read_b64_tr_b16 a[172:173], v2 offset:59392
ds_read_b64_tr_b16 a[174:175], v2 offset:60416
v_fma_f32 v143, v143, v8, v9
v_lshlrev_b32 v144, 16, v116
v_and_b32 v145, 0xffff0000, v116
v_accvgpr_write_b32 a236, v116
v_fma_f32 v144, v144, v8, v9
v_fma_f32 v145, v145, v8, v9
s_waitcnt lgkmcnt(8)
v_mfma_f32_32x32x16_bf16 v[32:47], a[184:187], v[188:191], v[32:47]
ds_read_b64_tr_b16 a[176:177], v1 offset:61440
ds_read_b64_tr_b16 a[178:179], v1 offset:62464
buffer_load_dwordx4 v[68:71], v0, s[32:35], s99 offen offset:1024 sc1
v_lshlrev_b32 v146, 16, v117
v_and_b32 v147, 0xffff0000, v117
v_mfma_f32_32x32x16_bf16 v[48:63], a[188:191], v[188:191], v[48:63]
ds_read_b64_tr_b16 a[180:181], v2 offset:61440
ds_read_b64_tr_b16 a[182:183], v2 offset:62464
s_add_u32 s99, s99, 40960
v_accvgpr_write_b32 a237, v117
v_fma_f32 v146, v146, v8, v9
v_fma_f32 v147, v147, v8, v9
v_lshlrev_b32 v148, 16, v118
v_and_b32 v149, 0xffff0000, v118
s_waitcnt lgkmcnt(8)
v_mfma_f32_32x32x16_bf16 v[32:47], a[160:163], v[192:195], v[32:47]
ds_read_b64_tr_b16 a[184:185], v1 offset:63488
ds_read_b64_tr_b16 a[186:187], v1 offset:64512
buffer_load_dwordx4 v[72:75], v0, s[32:35], s99 offen sc1
v_accvgpr_write_b32 a238, v118
v_fma_f32 v148, v148, v8, v9
v_fma_f32 v149, v149, v8, v9
v_mfma_f32_32x32x16_bf16 v[48:63], a[164:167], v[192:195], v[48:63]
ds_read_b64_tr_b16 a[188:189], v2 offset:63488
ds_read_b64_tr_b16 a[190:191], v2 offset:64512
v_lshlrev_b32 v150, 16, v119
v_and_b32 v151, 0xffff0000, v119
v_accvgpr_write_b32 a239, v119
v_fma_f32 v150, v150, v8, v9
v_fma_f32 v151, v151, v8, v9
s_waitcnt lgkmcnt(8)
v_mfma_f32_32x32x16_bf16 v[32:47], a[168:171], v[196:199], v[32:47]
s_barrier
v_add_u32 v1, 65536, v1
v_add_u32 v2, 65536, v2
ds_read_b64_tr_b16 a[160:161], v1 offset:0
ds_read_b64_tr_b16 a[162:163], v1 offset:1024
v_mov_b32 v104, 0
v_mov_b32 v105, 0
v_mfma_f32_32x32x16_bf16 v[48:63], a[172:175], v[196:199], v[48:63]
buffer_load_dwordx4 v[76:79], v0, s[32:35], s99 offen offset:1024 sc1
v_mov_b32 v106, 0
v_mov_b32 v107, 0
v_and_b32 v100, 31, v3
v_lshlrev_b32 v100, 3, v100
s_waitcnt lgkmcnt(6)
v_mfma_f32_32x32x16_bf16 v[32:47], a[176:179], v[200:203], v[32:47]
ds_read_b64_tr_b16 a[168:169], v1 offset:2048
ds_read_b64_tr_b16 a[170:171], v1 offset:3072
v_mfma_f32_32x32x16_bf16 v[48:63], a[180:183], v[200:203], v[48:63]
s_waitcnt lgkmcnt(4)
v_mfma_f32_32x32x16_bf16 v[32:47], a[184:187], v[204:207], v[32:47]
ds_read_b64_tr_b16 a[176:177], v1 offset:4096
ds_read_b64_tr_b16 a[178:179], v1 offset:5120
s_add_u32 s99, s98, 4294680576
v_mfma_f32_32x32x16_bf16 v[48:63], a[188:191], v[204:207], v[48:63]
buffer_load_dwordx4 a[8:11], v0, s[8:11], s99 offen sc1
s_waitcnt lgkmcnt(4)
s_waitcnt vmcnt(12)
v_mfma_f32_32x32x16_bf16 v[32:47], a[160:163], v[208:211], v[32:47]
ds_read_b64_tr_b16 a[184:185], v1 offset:6144
ds_read_b64_tr_b16 a[186:187], v1 offset:7168
s_waitcnt lgkmcnt(4)
s_waitcnt vmcnt(11)
v_mfma_f32_32x32x16_bf16 v[32:47], a[168:171], v[212:215], v[32:47]
ds_read_b64_tr_b16 a[160:161], v1 offset:8192
ds_read_b64_tr_b16 a[162:163], v1 offset:9216
buffer_load_dwordx4 a[12:15], v0, s[8:11], s99 offen offset:1024 sc1
s_waitcnt lgkmcnt(4)
s_waitcnt vmcnt(11)
v_mfma_f32_32x32x16_bf16 v[32:47], a[176:179], v[216:219], v[32:47]
ds_read_b64_tr_b16 a[168:169], v1 offset:10240
ds_read_b64_tr_b16 a[170:171], v1 offset:11264
s_mul_i32 s7, s54, 40960
s_lshl_b32 s5, s55, 5
s_add_u32 s7, s7, s5
s_add_u32 s7, s7, 11141120
s_waitcnt lgkmcnt(4)
s_waitcnt vmcnt(10)
v_mfma_f32_32x32x16_bf16 v[32:47], a[184:187], v[220:223], v[32:47]
ds_read_b64_tr_b16 a[176:177], v1 offset:12288
ds_read_b64_tr_b16 a[178:179], v1 offset:13312
s_add_u32 s99, s98, 4294721536
buffer_load_dwordx4 a[16:19], v0, s[8:11], s99 offen sc1
s_waitcnt lgkmcnt(4)
s_waitcnt vmcnt(10)
v_mfma_f32_32x32x16_bf16 v[32:47], a[160:163], v[224:227], v[32:47]
ds_read_b64_tr_b16 a[184:185], v1 offset:14336
ds_read_b64_tr_b16 a[186:187], v1 offset:15360
s_waitcnt lgkmcnt(4)
s_waitcnt vmcnt(9)
v_mfma_f32_32x32x16_bf16 v[32:47], a[168:171], v[228:231], v[32:47]
ds_read_b64_tr_b16 a[160:161], v2 offset:0
ds_read_b64_tr_b16 a[162:163], v2 offset:1024
buffer_load_dwordx4 a[20:23], v0, s[8:11], s99 offen offset:1024 sc1
s_waitcnt lgkmcnt(4)
s_waitcnt vmcnt(9)
v_mfma_f32_32x32x16_bf16 v[32:47], a[176:179], v[232:235], v[32:47]
ds_read_b64_tr_b16 a[168:169], v2 offset:2048
ds_read_b64_tr_b16 a[170:171], v2 offset:3072
s_add_u32 s99, s98, 4294762496
buffer_load_dwordx4 a[24:27], v0, s[8:11], s99 offen sc1
s_waitcnt lgkmcnt(4)
s_waitcnt vmcnt(9)
v_mfma_f32_32x32x16_bf16 v[32:47], a[184:187], v[236:239], v[32:47]
ds_read_b64_tr_b16 a[176:177], v2 offset:4096
ds_read_b64_tr_b16 a[178:179], v2 offset:5120
s_waitcnt lgkmcnt(4)
v_mfma_f32_32x32x16_bf16 v[48:63], a[160:163], v[208:211], v[48:63]
ds_read_b64_tr_b16 a[184:185], v2 offset:6144
ds_read_b64_tr_b16 a[186:187], v2 offset:7168
buffer_load_dwordx4 a[28:31], v0, s[8:11], s99 offen offset:1024 sc1
s_waitcnt lgkmcnt(4)
v_mfma_f32_32x32x16_bf16 v[48:63], a[168:171], v[212:215], v[48:63]
ds_read_b64_tr_b16 a[160:161], v2 offset:8192
ds_read_b64_tr_b16 a[162:163], v2 offset:9216
s_add_u32 s99, s98, 4294803456
buffer_load_dwordx4 a[32:35], v0, s[8:11], s99 offen sc1
v_add_f32 v32, v32, v120
v_add_f32 v33, v33, v121
v_add_f32 v34, v34, v122
v_add_f32 v35, v35, v123
v_add_f32 v36, v36, v124
v_add_f32 v37, v37, v125
v_add_f32 v38, v38, v126
v_add_f32 v39, v39, v127
v_add_f32 v104, v104, v32
s_waitcnt lgkmcnt(4)
v_mfma_f32_32x32x16_bf16 v[48:63], a[176:179], v[216:219], v[48:63]
ds_read_b64_tr_b16 a[168:169], v2 offset:10240
ds_read_b64_tr_b16 a[170:171], v2 offset:11264
v_fmac_f32 v106, v32, v32
v_add_f32 v105, v105, v33
v_fmac_f32 v107, v33, v33
v_add_f32 v104, v104, v34
v_fmac_f32 v106, v34, v34
v_add_f32 v105, v105, v35
v_fmac_f32 v107, v35, v35
v_add_f32 v104, v104, v36
v_fmac_f32 v106, v36, v36
v_add_f32 v105, v105, v37
v_fmac_f32 v107, v37, v37
v_add_f32 v104, v104, v38
v_fmac_f32 v106, v38, v38
v_add_f32 v105, v105, v39
s_waitcnt lgkmcnt(4)
v_mfma_f32_32x32x16_bf16 v[48:63], a[184:187], v[220:223], v[48:63]
ds_read_b64_tr_b16 a[176:177], v2 offset:12288
ds_read_b64_tr_b16 a[178:179], v2 offset:13312
buffer_load_dwordx4 a[36:39], v0, s[8:11], s99 offen offset:1024 sc1
v_fmac_f32 v107, v39, v39
v_cvt_pk_bf16_f32 v32, v32, v33
v_cvt_pk_bf16_f32 v33, v34, v35
v_cvt_pk_bf16_f32 v34, v36, v37
v_cvt_pk_bf16_f32 v35, v38, v39
buffer_store_dwordx4 v[32:35], v0, s[32:35], s7 offen sc1
s_waitcnt lgkmcnt(4)
v_mfma_f32_32x32x16_bf16 v[48:63], a[160:163], v[224:227], v[48:63]
ds_read_b64_tr_b16 a[184:185], v2 offset:14336
ds_read_b64_tr_b16 a[186:187], v2 offset:15360
v_lshrrev_b32 v18, 5, v3
v_mul_u32_u24 v18, 9728, v18
v_add_u32 v18, v18, v0
v_accvgpr_write_b32 a240, v32
v_accvgpr_write_b32 a241, v33
v_accvgpr_write_b32 a242, v34
v_accvgpr_write_b32 a243, v35
v_add_f32 v40, v40, v128
v_add_f32 v41, v41, v129
s_waitcnt lgkmcnt(4)
v_mfma_f32_32x32x16_bf16 v[48:63], a[168:171], v[228:231], v[48:63]
v_add_u32 v19, 20480, v18
s_lshl_b32 s3, s42, 2
s_add_u32 s3, s3, s40
s_mul_i32 s3, s3, 320
s_mul_i32 s49, s43, 81920
s_add_u32 s49, s49, s3
s_mov_b32 s4, 0xfffff
s_mov_b32 s5, 0xfffff
v_add_f32 v42, v42, v130
v_add_f32 v43, v43, v131
v_add_f32 v44, v44, v132
v_add_f32 v45, v45, v133
v_add_f32 v46, v46, v134
v_add_f32 v47, v47, v135
v_add_f32 v104, v104, v40
v_fmac_f32 v106, v40, v40
s_waitcnt lgkmcnt(2)
v_mfma_f32_32x32x16_bf16 v[48:63], a[176:179], v[232:235], v[48:63]
v_add_f32 v105, v105, v41
v_fmac_f32 v107, v41, v41
v_add_f32 v104, v104, v42
v_fmac_f32 v106, v42, v42
v_add_f32 v105, v105, v43
v_fmac_f32 v107, v43, v43
v_add_f32 v104, v104, v44
v_fmac_f32 v106, v44, v44
v_add_f32 v105, v105, v45
v_fmac_f32 v107, v45, v45
v_add_f32 v104, v104, v46
v_fmac_f32 v106, v46, v46
v_add_f32 v105, v105, v47
v_fmac_f32 v107, v47, v47
v_cvt_pk_bf16_f32 v40, v40, v41
s_waitcnt lgkmcnt(0)
v_mfma_f32_32x32x16_bf16 v[48:63], a[184:187], v[236:239], v[48:63]
v_cvt_pk_bf16_f32 v41, v42, v43
v_cvt_pk_bf16_f32 v42, v44, v45
v_cvt_pk_bf16_f32 v43, v46, v47
buffer_store_dwordx4 v[40:43], v0, s[32:35], s7 offen offset:1024 sc1
v_accvgpr_write_b32 a244, v40
v_accvgpr_write_b32 a245, v41
v_accvgpr_write_b32 a246, v42
v_accvgpr_write_b32 a247, v43
s_barrier
s_add_u32 s99, s98, 4294844416
buffer_load_dwordx4 a[40:43], v0, s[8:11], s99 offen sc1
buffer_load_dwordx4 a[44:47], v0, s[8:11], s99 offen offset:1024 sc1
v_pk_add_f32 v[48:49], v[48:49], v[136:137]
v_pk_add_f32 v[50:51], v[50:51], v[138:139]
v_pk_add_f32 v[52:53], v[52:53], v[140:141]
v_pk_add_f32 v[54:55], v[54:55], v[142:143]
v_pk_add_f32 v[104:105], v[104:105], v[48:49]
v_pk_fma_f32 v[106:107], v[48:49], v[48:49], v[106:107]
v_pk_add_f32 v[104:105], v[104:105], v[50:51]
v_pk_fma_f32 v[106:107], v[50:51], v[50:51], v[106:107]
v_pk_add_f32 v[104:105], v[104:105], v[52:53]
v_pk_fma_f32 v[106:107], v[52:53], v[52:53], v[106:107]
v_pk_add_f32 v[104:105], v[104:105], v[54:55]
v_pk_fma_f32 v[106:107], v[54:55], v[54:55], v[106:107]
v_cvt_pk_bf16_f32 v48, v48, v49
v_cvt_pk_bf16_f32 v49, v50, v51
v_cvt_pk_bf16_f32 v50, v52, v53
v_cvt_pk_bf16_f32 v51, v54, v55
buffer_store_dwordx4 v[48:51], v0, s[32:35], s7 offen offset:2048 sc1
v_accvgpr_write_b32 a248, v48
v_accvgpr_write_b32 a249, v49
v_accvgpr_write_b32 a250, v50
v_accvgpr_write_b32 a251, v51
v_pk_add_f32 v[56:57], v[56:57], v[144:145]
v_pk_add_f32 v[58:59], v[58:59], v[146:147]
v_pk_add_f32 v[60:61], v[60:61], v[148:149]
v_pk_add_f32 v[62:63], v[62:63], v[150:151]
v_pk_add_f32 v[104:105], v[104:105], v[56:57]
v_pk_fma_f32 v[106:107], v[56:57], v[56:57], v[106:107]
v_pk_add_f32 v[104:105], v[104:105], v[58:59]
v_pk_fma_f32 v[106:107], v[58:59], v[58:59], v[106:107]
v_pk_add_f32 v[104:105], v[104:105], v[60:61]
v_pk_fma_f32 v[106:107], v[60:61], v[60:61], v[106:107]
v_pk_add_f32 v[104:105], v[104:105], v[62:63]
v_pk_fma_f32 v[106:107], v[62:63], v[62:63], v[106:107]
v_cvt_pk_bf16_f32 v56, v56, v57
v_cvt_pk_bf16_f32 v57, v58, v59
v_cvt_pk_bf16_f32 v58, v60, v61
v_cvt_pk_bf16_f32 v59, v62, v63
buffer_store_dwordx4 v[56:59], v0, s[32:35], s7 offen offset:3072 sc1
v_accvgpr_write_b32 a252, v56
v_accvgpr_write_b32 a253, v57
v_accvgpr_write_b32 a254, v58
v_accvgpr_write_b32 a255, v59
s_add_u32 s99, s98, 4294885376
buffer_load_dwordx4 a[48:51], v0, s[8:11], s99 offen sc1
buffer_load_dwordx4 a[52:55], v0, s[8:11], s99 offen offset:1024 sc1
v_add_f32 v104, v104, v105
v_add_f32 v105, v106, v107
v_mov_b32 v106, v104
s_nop 1
v_permlane32_swap_b32 v104, v106
v_add_f32 v104, v104, v106
v_mov_b32 v107, v105
s_nop 1
v_permlane32_swap_b32 v105, v107
v_add_f32 v105, v105, v107
s_mul_i32 s7, s54, 1280
s_add_u32 s7, s7, s55
s_lshl_b32 s7, s7, 1
s_add_u32 s7, s7, 131072
s_add_u32 s47, s6, 384
buffer_store_dwordx2 v[104:105], v100, s[32:35], s7 offen sc1
s_branch L_att
L_s2w3:
s_waitcnt vmcnt(12)
buffer_atomic_add v14, v13, s[32:35], s47 offen sc1
s_mov_b32 s47, 1073741824
s_barrier
s_lshl_b32 s3, s60, 4
s_lshr_b32 s4, s44, 2
s_add_u32 s3, s3, s4
s_mul_i32 s4, s3, 57
s_lshr_b32 s4, s4, 9
s_mul_i32 s5, s4, 9
s_sub_u32 s5, s3, s5
s_xor_b32 s7, s62, 0
s_sub_u32 s7, s7, 1
s_lshl_b32 s76, s7, 7
s_add_u32 s76, s76, 98304
s_mul_i32 s7, s7, 9
s_add_u32 s5, s5, s7
s_lshl_b32 s74, s5, 11
s_lshl_b32 s7, s4, 2
s_add_u32 s74, s74, s7
s_add_u32 s74, s74, 327680
s_mul_i32 s4, s4, 442368
s_lshl_b32 s5, s5, 7
s_add_u32 s4, s4, s5
s_cmp_eq_u32 s57, 1280
s_cselect_b32 s3, 99, s3
s_cmp_lt_u32 s3, 45
s_cselect_b32 s4, s4, 1073741824
s_cselect_b32 s74, s74, 1073741824
s_cselect_b32 s76, s76, 1073741824
v_lshrrev_b32 v96, 3, v3
v_mul_u32_u24 v96, 3456, v96
v_bfe_u32 v97, v3, 4, 1
v_lshlrev_b32 v97, 2, v97
v_xor_b32 v97, v97, v3
v_and_b32 v97, 7, v97
v_lshl_add_u32 v96, v97, 4, v96
s_mov_b32 m0, 49152
s_nop 0
buffer_load_dwordx4 v96, s[20:23], s4 offen lds
s_add_u32 s4, s4, 27648
s_add_u32 m0, m0, 1024
s_nop 0
buffer_load_dwordx4 v96, s[20:23], s4 offen lds
s_add_u32 s4, s4, 27648
s_add_u32 m0, m0, 1024
s_nop 0
buffer_load_dwordx4 v96, s[20:23], s4 offen lds
s_add_u32 s4, s4, 27648
s_add_u32 m0, m0, 1024
s_nop 0
buffer_load_dwordx4 v96, s[20:23], s4 offen lds
s_add_u32 s4, s4, 27648
s_add_u32 m0, m0, 1024
s_nop 0
buffer_load_dwordx4 v96, s[20:23], s4 offen lds
s_add_u32 s4, s4, 27648
s_add_u32 m0, m0, 1024
s_nop 0
buffer_load_dwordx4 v96, s[20:23], s4 offen lds
s_add_u32 s4, s4, 27648
s_add_u32 m0, m0, 1024
s_nop 0
buffer_load_dwordx4 v96, s[20:23], s4 offen lds
s_add_u32 s4, s4, 27648
s_add_u32 m0, m0, 1024
s_nop 0
buffer_load_dwordx4 v96, s[20:23], s4 offen lds
s_add_u32 s4, s4, 27648
s_add_u32 m0, m0, 1024
s_nop 0
buffer_load_dwordx4 v96, s[20:23], s4 offen lds
s_add_u32 s4, s4, 27648
s_add_u32 m0, m0, 1024
s_nop 0
buffer_load_dwordx4 v96, s[20:23], s4 offen lds
s_add_u32 s4, s4, 27648
s_add_u32 m0, m0, 1024
s_nop 0
buffer_load_dwordx4 v96, s[20:23], s4 offen lds
s_add_u32 s4, s4, 27648
s_add_u32 m0, m0, 1024
s_nop 0
buffer_load_dwordx4 v96, s[20:23], s4 offen lds
s_add_u32 s4, s4, 27648
s_add_u32 m0, m0, 1024
s_nop 0
buffer_load_dwordx4 v96, s[20:23], s4 offen lds
s_add_u32 s4, s4, 27648
s_add_u32 m0, m0, 1024
s_nop 0
buffer_load_dwordx4 v96, s[20:23], s4 offen lds
s_add_u32 s4, s4, 27648
s_add_u32 m0, m0, 1024
s_nop 0
buffer_load_dwordx4 v96, s[20:23], s4 offen lds
s_add_u32 s4, s4, 27648
s_add_u32 m0, m0, 1024
s_nop 0
buffer_load_dwordx4 v96, s[20:23], s4 offen lds
s_barrier
s_barrier
v_bfe_u32 v30, v3, 2, 2
v_lshrrev_b32 v31, 5, v3
v_lshl_add_u32 v30, v31, 2, v30
v_lshlrev_b32 v1, 7, v30
v_bfe_u32 v30, v3, 4, 1
v_lshl_add_u32 v1, v30, 5, v1
v_and_b32 v30, 3, v3
v_lshl_add_u32 v1, v30, 3, v1
v_bfe_u32 v30, v3, 3, 1
v_lshl_add_u32 v1, v30, 6, v1
v_xor_b32 v2, 64, v1
s_waitcnt vmcnt(0)
ds_read_b64_tr_b16 v[104:105], v1 offset:49152
ds_read_b64_tr_b16 v[106:107], v1 offset:50176
ds_read_b64_tr_b16 v[108:109], v1 offset:51200
ds_read_b64_tr_b16 v[110:111], v1 offset:52224
ds_read_b64_tr_b16 v[112:113], v1 offset:53248
ds_read_b64_tr_b16 v[114:115], v1 offset:54272
ds_read_b64_tr_b16 v[116:117], v1 offset:55296
ds_read_b64_tr_b16 v[118:119], v1 offset:56320
ds_read_b64_tr_b16 v[120:121], v1 offset:57344
ds_read_b64_tr_b16 v[122:123], v1 offset:58368
ds_read_b64_tr_b16 v[124:125], v1 offset:59392
ds_read_b64_tr_b16 v[126:127], v1 offset:60416
ds_read_b64_tr_b16 v[128:129], v1 offset:61440
ds_read_b64_tr_b16 v[130:131], v1 offset:62464
ds_read_b64_tr_b16 v[132:133], v1 offset:63488
ds_read_b64_tr_b16 v[134:135], v1 offset:64512
s_waitcnt lgkmcnt(14)
v_mfma_f32_16x16x32_bf16 v[98:101], a[192:195], v[104:107], 0
s_waitcnt lgkmcnt(12)
v_mfma_f32_16x16x32_bf16 v[98:101], a[192:195], v[108:111], v[98:101]
s_waitcnt lgkmcnt(10)
v_mfma_f32_16x16x32_bf16 v[98:101], a[192:195], v[112:115], v[98:101]
s_waitcnt lgkmcnt(8)
v_mfma_f32_16x16x32_bf16 v[98:101], a[192:195], v[116:119], v[98:101]
s_waitcnt lgkmcnt(6)
v_mfma_f32_16x16x32_bf16 v[98:101], a[192:195], v[120:123], v[98:101]
s_waitcnt lgkmcnt(4)
v_mfma_f32_16x16x32_bf16 v[98:101], a[192:195], v[124:127], v[98:101]
s_waitcnt lgkmcnt(2)
v_mfma_f32_16x16x32_bf16 v[98:101], a[192:195], v[128:131], v[98:101]
s_waitcnt lgkmcnt(0)
v_mfma_f32_16x16x32_bf16 v[98:101], a[192:195], v[132:135], v[98:101]
ds_read_b64_tr_b16 v[104:105], v2 offset:49152
ds_read_b64_tr_b16 v[106:107], v2 offset:50176
ds_read_b64_tr_b16 v[108:109], v2 offset:51200
ds_read_b64_tr_b16 v[110:111], v2 offset:52224
ds_read_b64_tr_b16 v[112:113], v2 offset:53248
ds_read_b64_tr_b16 v[114:115], v2 offset:54272
ds_read_b64_tr_b16 v[116:117], v2 offset:55296
ds_read_b64_tr_b16 v[118:119], v2 offset:56320
ds_read_b64_tr_b16 v[120:121], v2 offset:57344
ds_read_b64_tr_b16 v[122:123], v2 offset:58368
ds_read_b64_tr_b16 v[124:125], v2 offset:59392
ds_read_b64_tr_b16 v[126:127], v2 offset:60416
ds_read_b64_tr_b16 v[128:129], v2 offset:61440
ds_read_b64_tr_b16 v[130:131], v2 offset:62464
ds_read_b64_tr_b16 v[132:133], v2 offset:63488
ds_read_b64_tr_b16 v[134:135], v2 offset:64512
s_waitcnt lgkmcnt(14)
v_mfma_f32_16x16x32_bf16 v[140:143], a[192:195], v[104:107], 0
s_waitcnt lgkmcnt(12)
v_mfma_f32_16x16x32_bf16 v[140:143], a[192:195], v[108:111], v[140:143]
s_waitcnt lgkmcnt(10)
v_mfma_f32_16x16x32_bf16 v[140:143], a[192:195], v[112:115], v[140:143]
s_waitcnt lgkmcnt(8)
v_mfma_f32_16x16x32_bf16 v[140:143], a[192:195], v[116:119], v[140:143]
s_waitcnt lgkmcnt(6)
v_mfma_f32_16x16x32_bf16 v[140:143], a[192:195], v[120:123], v[140:143]
s_waitcnt lgkmcnt(4)
v_mfma_f32_16x16x32_bf16 v[140:143], a[192:195], v[124:127], v[140:143]
s_waitcnt lgkmcnt(2)
v_mfma_f32_16x16x32_bf16 v[140:143], a[192:195], v[128:131], v[140:143]
s_waitcnt lgkmcnt(0)
v_mfma_f32_16x16x32_bf16 v[140:143], a[192:195], v[132:135], v[140:143]
v_lshrrev_b32 v96, 5, v3
v_lshlrev_b32 v96, 4, v96
v_and_or_b32 v96, v3, 15, v96
v_lshlrev_b32 v96, 5, v96
v_bfe_u32 v97, v3, 4, 1
v_lshl_add_u32 v96, v97, 30, v96
buffer_store_dword v98, v96, s[32:35], s74 offen sc1
s_nop 0
buffer_store_dword v140, v96, s[32:35], s74 offen offset:1024 sc1
v_accvgpr_read_b32 v20, a221
v_accvgpr_read_b32 v21, a222
buffer_load_dword v22, v20, s[32:35], 0 offen sc1
s_add_u32 s8, s32, 5898240
s_addc_u32 s9, s33, 0
s_add_u32 s12, s32, 8519680
s_addc_u32 s13, s33, 0
s_mov_b32 s14, 2621440
s_mul_i32 s3, s42, 5
s_add_u32 s3, s3, s40
s_lshl_b32 s3, s3, 10
s_mul_i32 s98, s43, 81920
s_add_u32 s98, s98, s3
s_add_u32 s99, s98, 3276800
s_barrier
s_waitcnt vmcnt(1)
buffer_atomic_add v14, v13, s[32:35], s76 offen sc1
s_waitcnt vmcnt(1)
v_cmp_gt_u32 vcc, v21, v22
s_nop 1
s_cbranch_vccnz L_pw32
L_pr34:
buffer_load_dwordx4 v[64:67], v0, s[32:35], s99 offen sc1
buffer_load_dwordx4 v[68:71], v0, s[32:35], s99 offen offset:1024 sc1
s_add_u32 s99, s99, 40960
buffer_load_dwordx4 v[72:75], v0, s[32:35], s99 offen sc1
buffer_load_dwordx4 v[76:79], v0, s[32:35], s99 offen offset:1024 sc1
s_add_u32 s99, s98, 4294680576
buffer_load_dwordx4 a[8:11], v0, s[8:11], s99 offen sc1
buffer_load_dwordx4 a[12:15], v0, s[8:11], s99 offen offset:1024 sc1
s_add_u32 s99, s98, 4294721536
buffer_load_dwordx4 a[16:19], v0, s[8:11], s99 offen sc1
buffer_load_dwordx4 a[20:23], v0, s[8:11], s99 offen offset:1024 sc1
s_add_u32 s99, s98, 4294762496
buffer_load_dwordx4 a[24:27], v0, s[8:11], s99 offen sc1
buffer_load_dwordx4 a[28:31], v0, s[8:11], s99 offen offset:1024 sc1
s_add_u32 s99, s98, 4294803456
buffer_load_dwordx4 a[32:35], v0, s[8:11], s99 offen sc1
buffer_load_dwordx4 a[36:39], v0, s[8:11], s99 offen offset:1024 sc1
s_barrier
v_lshrrev_b32 v18, 5, v3
v_mul_u32_u24 v18, 9728, v18
v_add_u32 v18, v18, v0
v_add_u32 v19, 20480, v18
s_lshl_b32 s3, s42, 2
s_add_u32 s3, s3, s40
s_mul_i32 s3, s3, 320
s_mul_i32 s49, s43, 81920
s_add_u32 s49, s49, s3
s_mov_b32 s4, 0xfffff
s_mov_b32 s5, 0xfffff
s_barrier
s_add_u32 s99, s98, 4294844416
buffer_load_dwordx4 a[40:43], v0, s[8:11], s99 offen sc1
buffer_load_dwordx4 a[44:47], v0, s[8:11], s99 offen offset:1024 sc1
s_add_u32 s99, s98, 4294885376
buffer_load_dwordx4 a[48:51], v0, s[8:11], s99 offen sc1
buffer_load_dwordx4 a[52:55], v0, s[8:11], s99 offen offset:1024 sc1
s_nop 0
s_branch L_att
L_s2id:
s_waitcnt vmcnt(12)
buffer_atomic_add v14, v13, s[32:35], s47 offen sc1
s_mov_b32 s47, 1073741824
s_barrier
s_barrier
s_barrier
v_accvgpr_read_b32 v20, a221
v_accvgpr_read_b32 v21, a222
buffer_load_dword v22, v20, s[32:35], 0 offen sc1
s_add_u32 s8, s32, 5898240
s_addc_u32 s9, s33, 0
s_add_u32 s12, s32, 8519680
s_addc_u32 s13, s33, 0
s_mov_b32 s14, 2621440
s_mul_i32 s3, s42, 5
s_add_u32 s3, s3, s40
s_lshl_b32 s3, s3, 10
s_mul_i32 s98, s43, 81920
s_add_u32 s98, s98, s3
s_add_u32 s99, s98, 3276800
s_barrier
s_waitcnt vmcnt(0)
v_cmp_gt_u32 vcc, v21, v22
s_nop 1
s_cbranch_vccnz L_pw35
L_pr37:
buffer_load_dwordx4 v[64:67], v0, s[32:35], s99 offen sc1
buffer_load_dwordx4 v[68:71], v0, s[32:35], s99 offen offset:1024 sc1
s_add_u32 s99, s99, 40960
buffer_load_dwordx4 v[72:75], v0, s[32:35], s99 offen sc1
buffer_load_dwordx4 v[76:79], v0, s[32:35], s99 offen offset:1024 sc1
s_add_u32 s99, s98, 4294680576
buffer_load_dwordx4 a[8:11], v0, s[8:11], s99 offen sc1
buffer_load_dwordx4 a[12:15], v0, s[8:11], s99 offen offset:1024 sc1
s_add_u32 s99, s98, 4294721536
buffer_load_dwordx4 a[16:19], v0, s[8:11], s99 offen sc1
buffer_load_dwordx4 a[20:23], v0, s[8:11], s99 offen offset:1024 sc1
s_add_u32 s99, s98, 4294762496
buffer_load_dwordx4 a[24:27], v0, s[8:11], s99 offen sc1
buffer_load_dwordx4 a[28:31], v0, s[8:11], s99 offen offset:1024 sc1
s_add_u32 s99, s98, 4294803456
buffer_load_dwordx4 a[32:35], v0, s[8:11], s99 offen sc1
buffer_load_dwordx4 a[36:39], v0, s[8:11], s99 offen offset:1024 sc1
s_barrier
v_lshrrev_b32 v18, 5, v3
v_mul_u32_u24 v18, 9728, v18
v_add_u32 v18, v18, v0
v_add_u32 v19, 20480, v18
s_lshl_b32 s3, s42, 2
s_add_u32 s3, s3, s40
s_mul_i32 s3, s3, 320
s_mul_i32 s49, s43, 81920
s_add_u32 s49, s49, s3
s_mov_b32 s4, 0xfffff
s_mov_b32 s5, 0xfffff
s_barrier
s_add_u32 s99, s98, 4294844416
buffer_load_dwordx4 a[40:43], v0, s[8:11], s99 offen sc1
buffer_load_dwordx4 a[44:47], v0, s[8:11], s99 offen offset:1024 sc1
s_add_u32 s99, s98, 4294885376
buffer_load_dwordx4 a[48:51], v0, s[8:11], s99 offen sc1
buffer_load_dwordx4 a[52:55], v0, s[8:11], s99 offen offset:1024 sc1
s_nop 0
L_att:
s_cmp_lt_u32 s43, 4
s_cbranch_scc1 L_atte
v_lshrrev_b32 v16, 5, v3
v_subrev_u32 v16, s40, v16
v_add_u32 v17, 0, v16
v_cmp_gt_u32 vcc, 5, v17
s_waitcnt vmcnt(15)
s_nop 0
v_cndmask_b32 v64, 0, v64, vcc
v_cndmask_b32 v65, 0, v65, vcc
s_waitcnt vmcnt(13)
v_cndmask_b32 v72, 0, v72, vcc
v_cndmask_b32 v73, 0, v73, vcc
v_add_u32 v17, 2, v16
v_cmp_gt_u32 vcc, 5, v17
s_nop 1
v_cndmask_b32 v66, 0, v66, vcc
v_cndmask_b32 v67, 0, v67, vcc
v_cndmask_b32 v74, 0, v74, vcc
v_cndmask_b32 v75, 0, v75, vcc
v_add_u32 v17, 4, v16
v_cmp_gt_u32 vcc, 5, v17
s_nop 1
v_cndmask_b32 v68, 0, v68, vcc
v_cndmask_b32 v69, 0, v69, vcc
s_waitcnt vmcnt(12)
v_cndmask_b32 v76, 0, v76, vcc
v_cndmask_b32 v77, 0, v77, vcc
v_add_u32 v17, 6, v16
v_cmp_gt_u32 vcc, 5, v17
s_nop 1
v_cndmask_b32 v70, 0, v70, vcc
v_cndmask_b32 v71, 0, v71, vcc
v_cndmask_b32 v78, 0, v78, vcc
v_cndmask_b32 v79, 0, v79, vcc
s_waitcnt vmcnt(11)
v_mfma_f32_32x32x16_bf16 v[112:127], a[8:11], v[64:67], 0
v_accvgpr_read_b32 v240, a208
v_accvgpr_read_b32 v241, a209
v_accvgpr_read_b32 v242, a210
v_accvgpr_read_b32 v243, a211
v_accvgpr_read_b32 v244, a212
v_accvgpr_read_b32 v245, a213
v_accvgpr_read_b32 v246, a214
v_accvgpr_read_b32 v247, a215
v_accvgpr_read_b32 v21, a216
v_accvgpr_read_b32 v22, a217
v_accvgpr_read_b32 v23, a218
v_mov_b32 v249, 0
s_waitcnt vmcnt(10)
v_mfma_f32_32x32x16_bf16 v[112:127], a[12:15], v[68:71], v[112:127]
v_mov_b32 v250, 0
v_mov_b32 v251, 0
s_mov_b32 s64, 0xffffffff
s_mov_b32 s65, 0xfffffff0
s_mov_b32 s66, 0xfffffffe
s_mov_b32 s67, 0xffffffe0
s_mov_b32 s68, 0xfffffffc
s_mov_b32 s69, 0xffffffc0
s_mov_b32 s70, 0xfffffff8
s_mov_b32 s71, 0xffffff80
s_mov_b32 s72, 0xffffff00
s_add_u32 s99, s98, 4294926336
buffer_load_dwordx4 a[56:59], v0, s[8:11], s99 offen sc1
buffer_load_dwordx4 a[60:63], v0, s[8:11], s99 offen offset:1024 sc1
s_waitcnt vmcnt(11)
v_mfma_f32_32x32x16_bf16 v[128:143], a[16:19], v[64:67], 0
s_mov_b32 s73, 0xfffff000
s_mov_b32 s74, 0xfffffe00
s_mov_b32 s75, 0xffffe000
s_mov_b32 s76, 0xfffffc00
s_mov_b32 s77, 0xffffc000
s_mov_b32 s78, 0xfffff800
s_mov_b32 s79, 0xffff8000
s_mov_b32 s80, 0xffff0000
s_mov_b32 s81, 0xfff00000
s_mov_b32 s82, 0xfffe0000
s_mov_b32 s83, 0xffe00000
s_mov_b32 s84, 0xfffc0000
s_waitcnt vmcnt(10)
v_mfma_f32_32x32x16_bf16 v[128:143], a[20:23], v[68:71], v[128:143]
s_mov_b32 s85, 0xffc00000
s_mov_b32 s86, 0xfff80000
s_mov_b32 s87, 0xff800000
s_mov_b32 s88, 0xff000000
s_mov_b32 s89, 0xf0000000
s_mov_b32 s90, 0xfe000000
s_mov_b32 s91, 0xe0000000
s_mov_b32 s92, 0xfc000000
s_mov_b32 s93, 0xc0000000
s_mov_b32 s94, 0xf8000000
s_mov_b32 s95, 0x80000000
s_add_u32 s99, s98, 4294639616
buffer_load_dwordx4 a[0:3], v0, s[8:11], s99 offen sc1
buffer_load_dwordx4 a[4:7], v0, s[8:11], s99 offen offset:1024 sc1
s_waitcnt vmcnt(11)
v_mfma_f32_32x32x16_bf16 v[144:159], a[24:27], v[64:67], 0
v_max_f32 v24, v112, v113
v_max_f32 v25, v114, v115
v_max3_f32 v24, v116, v117, v24
v_max3_f32 v25, v118, v119, v25
s_waitcnt vmcnt(10)
v_mfma_f32_32x32x16_bf16 v[144:159], a[28:31], v[68:71], v[144:159]
v_max3_f32 v24, v120, v121, v24
v_max3_f32 v25, v122, v123, v25
v_max3_f32 v24, v124, v125, v24
v_max3_f32 v25, v126, v127, v25
s_add_u32 s99, s98, 0
buffer_load_dwordx4 a[64:67], v0, s[8:11], s99 offen sc1
buffer_load_dwordx4 a[68:71], v0, s[8:11], s99 offen offset:1024 sc1
s_waitcnt vmcnt(11)
v_mfma_f32_32x32x16_bf16 v[160:175], a[32:35], v[64:67], 0
v_max3_f32 v24, v128, v129, v24
v_max3_f32 v25, v130, v131, v25
v_max3_f32 v24, v132, v133, v24
v_max3_f32 v25, v134, v135, v25
s_waitcnt vmcnt(10)
v_mfma_f32_32x32x16_bf16 v[160:175], a[36:39], v[68:71], v[160:175]
v_max3_f32 v24, v136, v137, v24
v_max3_f32 v25, v138, v139, v25
v_max3_f32 v24, v140, v141, v24
v_max3_f32 v25, v142, v143, v25
s_add_u32 s99, s98, 40960
buffer_load_dwordx4 a[72:75], v0, s[8:11], s99 offen sc1
buffer_load_dwordx4 a[76:79], v0, s[8:11], s99 offen offset:1024 sc1
s_waitcnt vmcnt(11)
v_mfma_f32_32x32x16_bf16 v[176:191], a[40:43], v[64:67], 0
v_max3_f32 v24, v144, v145, v24
v_max3_f32 v25, v146, v147, v25
v_max3_f32 v24, v148, v149, v24
v_max3_f32 v25, v150, v151, v25
s_waitcnt vmcnt(10)
v_mfma_f32_32x32x16_bf16 v[176:191], a[44:47], v[68:71], v[176:191]
v_max3_f32 v24, v152, v153, v24
v_max3_f32 v25, v154, v155, v25
v_max3_f32 v24, v156, v157, v24
v_max3_f32 v25, v158, v159, v25
s_add_u32 s99, s49, 4294680576
s_mov_b64 exec, s[4:5]
buffer_load_dwordx4 a[88:91], v18, s[12:15], s99 offen sc1
buffer_load_dwordx4 a[92:95], v19, s[12:15], s99 offen sc1
s_mov_b64 exec, -1
s_waitcnt vmcnt(11)
s_nop 2
v_mfma_f32_32x32x16_bf16 v[192:207], a[48:51], v[64:67], 0
v_max3_f32 v24, v160, v161, v24
v_max3_f32 v25, v162, v163, v25
v_max3_f32 v24, v164, v165, v24
v_max3_f32 v25, v166, v167, v25
s_waitcnt vmcnt(10)
v_mfma_f32_32x32x16_bf16 v[192:207], a[52:55], v[68:71], v[192:207]
v_max3_f32 v24, v168, v169, v24
v_max3_f32 v25, v170, v171, v25
v_max3_f32 v24, v172, v173, v24
v_max3_f32 v25, v174, v175, v25
s_add_u32 s99, s49, 4294721536
s_mov_b64 exec, s[4:5]
buffer_load_dwordx4 a[96:99], v18, s[12:15], s99 offen sc1
buffer_load_dwordx4 a[100:103], v19, s[12:15], s99 offen sc1
s_mov_b64 exec, -1
s_waitcnt vmcnt(11)
s_nop 2
v_mfma_f32_32x32x16_bf16 v[208:223], a[56:59], v[64:67], 0
v_max3_f32 v24, v176, v177, v24
v_max3_f32 v25, v178, v179, v25
v_max3_f32 v24, v180, v181, v24
v_max3_f32 v25, v182, v183, v25
s_waitcnt vmcnt(10)
v_mfma_f32_32x32x16_bf16 v[208:223], a[60:63], v[68:71], v[208:223]
v_max3_f32 v24, v184, v185, v24
v_max3_f32 v25, v186, v187, v25
v_max3_f32 v24, v188, v189, v24
v_max3_f32 v25, v190, v191, v25
s_add_u32 s99, s49, 4294762496
s_mov_b64 exec, s[4:5]
buffer_load_dwordx4 a[104:107], v18, s[12:15], s99 offen sc1
buffer_load_dwordx4 a[108:111], v19, s[12:15], s99 offen sc1
s_mov_b64 exec, -1
s_waitcnt vmcnt(11)
s_nop 2
v_mfma_f32_32x32x16_bf16 v[96:111], a[0:3], v[64:67], 0
v_max3_f32 v24, v192, v193, v24
v_max3_f32 v25, v194, v195, v25
v_max3_f32 v24, v196, v197, v24
v_max3_f32 v25, v198, v199, v25
s_waitcnt vmcnt(10)
v_mfma_f32_32x32x16_bf16 v[96:111], a[4:7], v[68:71], v[96:111]
v_max3_f32 v24, v200, v201, v24
v_max3_f32 v25, v202, v203, v25
v_max3_f32 v24, v204, v205, v24
v_max3_f32 v25, v206, v207, v25
s_add_u32 s99, s49, 4294803456
s_mov_b64 exec, s[4:5]
buffer_load_dwordx4 a[112:115], v18, s[12:15], s99 offen sc1
buffer_load_dwordx4 a[116:119], v19, s[12:15], s99 offen sc1
s_mov_b64 exec, -1
s_waitcnt vmcnt(11)
s_nop 2
v_mfma_f32_32x32x16_bf16 v[224:239], a[64:67], v[64:67], 0
v_max3_f32 v24, v208, v209, v24
v_max3_f32 v25, v210, v211, v25
v_max3_f32 v24, v212, v213, v24
v_max3_f32 v25, v214, v215, v25
s_waitcnt vmcnt(10)
v_mfma_f32_32x32x16_bf16 v[224:239], a[68:71], v[68:71], v[224:239]
v_max3_f32 v24, v216, v217, v24
v_max3_f32 v25, v218, v219, v25
v_max3_f32 v24, v220, v221, v24
v_max3_f32 v25, v222, v223, v25
s_add_u32 s99, s49, 4294844416
s_mov_b64 exec, s[4:5]
buffer_load_dwordx4 a[120:123], v18, s[12:15], s99 offen sc1
buffer_load_dwordx4 a[124:127], v19, s[12:15], s99 offen sc1
s_mov_b64 exec, -1
s_nop 2
v_cndmask_b32 v224, v96, v224, s[64:65]
v_cndmask_b32 v225, v97, v225, s[66:67]
v_cndmask_b32 v226, v98, v226, s[68:69]
v_cndmask_b32 v227, v99, v227, s[70:71]
v_cndmask_b32 v228, v100, v228, s[72:73]
v_cndmask_b32 v229, v101, v229, s[74:75]
v_cndmask_b32 v230, v102, v230, s[76:77]
v_cndmask_b32 v231, v103, v231, s[78:79]
v_cndmask_b32 v232, v104, v232, s[80:81]
v_cndmask_b32 v233, v105, v233, s[82:83]
v_cndmask_b32 v234, v106, v234, s[84:85]
v_cndmask_b32 v235, v107, v235, s[86:87]
v_cndmask_b32 v236, v108, v236, s[88:89]
v_cndmask_b32 v237, v109, v237, s[90:91]
v_cndmask_b32 v238, v110, v238, s[92:93]
v_cndmask_b32 v239, v111, v239, s[94:95]
v_max3_f32 v24, v224, v225, v24
v_max3_f32 v25, v226, v227, v25
v_max3_f32 v24, v228, v229, v24
v_max3_f32 v25, v230, v231, v25
v_max3_f32 v24, v232, v233, v24
v_max3_f32 v25, v234, v235, v25
v_max3_f32 v24, v236, v237, v24
v_max3_f32 v25, v238, v239, v25
v_max_f32 v24, v24, v25
v_mov_b32 v25, v24
s_nop 1
v_permlane32_swap_b32 v24, v25
v_max_f32 v24, v24, v25
v_sub_f32 v24, 0, v24
v_and_b32 v25, 0xffff0000, v24
v_sub_f32 v24, v24, v25
v_and_b32 v16, 0xffff0000, v24
v_sub_f32 v24, v24, v16
v_lshrrev_b32 v25, 16, v25
v_or_b32 v25, v25, v16
v_lshrrev_b32 v24, 16, v24
v_cmp_gt_u32 vcc, 32, v3
s_nop 1
v_cndmask_b32 v248, v24, v25, vcc
s_nop 1
v_mfma_f32_32x32x16_bf16 v[112:127], a[200:203], v[248:251], v[112:127]
v_mfma_f32_32x32x16_bf16 v[128:143], a[200:203], v[248:251], v[128:143]
v_mfma_f32_32x32x16_bf16 v[96:111], a[8:11], v[72:75], 0
v_mfma_f32_32x32x16_bf16 v[96:111], a[12:15], v[76:79], v[96:111]
s_add_u32 s99, s49, 4294885376
s_mov_b64 exec, s[4:5]
buffer_load_dwordx4 a[128:131], v18, s[12:15], s99 offen sc1
buffer_load_dwordx4 a[132:135], v19, s[12:15], s99 offen sc1
s_mov_b64 exec, -1
s_nop 3
v_mfma_f32_32x32x16_bf16 v[144:159], a[200:203], v[248:251], v[144:159]
v_exp_f32 v112, v112
v_exp_f32 v113, v113
v_exp_f32 v114, v114
v_exp_f32 v115, v115
v_exp_f32 v116, v116
v_exp_f32 v117, v117
v_exp_f32 v118, v118
v_exp_f32 v119, v119
v_cvt_pk_bf16_f32 v88, v112, v113
v_cvt_pk_bf16_f32 v89, v114, v115
v_cvt_pk_bf16_f32 v90, v116, v117
v_cvt_pk_bf16_f32 v91, v118, v119
v_exp_f32 v120, v120
v_exp_f32 v121, v121
v_exp_f32 v122, v122
v_exp_f32 v123, v123
v_exp_f32 v124, v124
v_exp_f32 v125, v125
v_exp_f32 v126, v126
v_exp_f32 v127, v127
v_cvt_pk_bf16_f32 v92, v120, v121
v_cvt_pk_bf16_f32 v93, v122, v123
v_cvt_pk_bf16_f32 v94, v124, v125
v_cvt_pk_bf16_f32 v95, v126, v127
s_add_u32 s99, s49, 4294926336
s_mov_b64 exec, s[4:5]
buffer_load_dwordx4 a[136:139], v18, s[12:15], s99 offen sc1
buffer_load_dwordx4 a[140:143], v19, s[12:15], s99 offen sc1
s_mov_b64 exec, -1
s_nop 3
v_mfma_f32_32x32x16_bf16 v[160:175], a[200:203], v[248:251], v[160:175]
v_exp_f32 v128, v128
v_exp_f32 v129, v129
v_exp_f32 v130, v130
v_exp_f32 v131, v131
s_waitcnt vmcnt(13)
v_mfma_f32_32x32x16_bf16 v[32:47], a[88:91], v[88:91], 0
v_exp_f32 v132, v132
v_exp_f32 v133, v133
v_exp_f32 v134, v134
v_exp_f32 v135, v135
s_waitcnt vmcnt(12)
v_mfma_f32_32x32x16_bf16 v[32:47], a[92:95], v[92:95], v[32:47]
v_cvt_pk_bf16_f32 v80, v128, v129
v_cvt_pk_bf16_f32 v81, v130, v131
v_cvt_pk_bf16_f32 v82, v132, v133
v_cvt_pk_bf16_f32 v83, v134, v135
v_exp_f32 v136, v136
v_exp_f32 v137, v137
v_mfma_f32_32x32x16_bf16 v[112:127], a[16:19], v[72:75], 0
v_exp_f32 v138, v138
v_exp_f32 v139, v139
v_exp_f32 v140, v140
v_exp_f32 v141, v141
v_mfma_f32_32x32x16_bf16 v[112:127], a[20:23], v[76:79], v[112:127]
v_exp_f32 v142, v142
v_exp_f32 v143, v143
v_cvt_pk_bf16_f32 v84, v136, v137
v_cvt_pk_bf16_f32 v85, v138, v139
v_cvt_pk_bf16_f32 v86, v140, v141
v_cvt_pk_bf16_f32 v87, v142, v143
s_add_u32 s99, s49, 4294639616
s_mov_b64 exec, s[4:5]
buffer_load_dwordx4 a[80:83], v18, s[12:15], s99 offen sc1
buffer_load_dwordx4 a[84:87], v19, s[12:15], s99 offen sc1
s_mov_b64 exec, -1
s_nop 3
v_mfma_f32_32x32x16_bf16 v[176:191], a[200:203], v[248:251], v[176:191]
v_max_f32 v24, v112, v113
v_max_f32 v25, v114, v115
v_max3_f32 v24, v116, v117, v24
v_max3_f32 v25, v118, v119, v25
v_max3_f32 v24, v120, v121, v24
v_max3_f32 v25, v122, v123, v25
v_max3_f32 v24, v124, v125, v24
v_max3_f32 v25, v126, v127, v25
v_exp_f32 v144, v144
s_waitcnt vmcnt(13)
v_mfma_f32_32x32x16_bf16 v[32:47], a[96:99], v[80:83], v[32:47]
v_exp_f32 v145, v145
v_exp_f32 v146, v146
v_exp_f32 v147, v147
v_exp_f32 v148, v148
v_exp_f32 v149, v149
s_waitcnt vmcnt(12)
v_mfma_f32_32x32x16_bf16 v[32:47], a[100:103], v[84:87], v[32:47]
v_exp_f32 v150, v150
v_exp_f32 v151, v151
v_cvt_pk_bf16_f32 v88, v144, v145
v_cvt_pk_bf16_f32 v89, v146, v147
v_cvt_pk_bf16_f32 v90, v148, v149
v_cvt_pk_bf16_f32 v91, v150, v151
v_exp_f32 v152, v152
v_mfma_f32_32x32x16_bf16 v[128:143], a[24:27], v[72:75], 0
v_exp_f32 v153, v153
v_exp_f32 v154, v154
v_exp_f32 v155, v155
v_exp_f32 v156, v156
v_exp_f32 v157, v157
v_mfma_f32_32x32x16_bf16 v[128:143], a[28:31], v[76:79], v[128:143]
v_exp_f32 v158, v158
v_exp_f32 v159, v159
v_cvt_pk_bf16_f32 v92, v152, v153
v_cvt_pk_bf16_f32 v93, v154, v155
v_cvt_pk_bf16_f32 v94, v156, v157
v_cvt_pk_bf16_f32 v95, v158, v159
s_add_u32 s99, s49, 0
s_mov_b64 exec, s[4:5]
buffer_load_dwordx4 a[144:147], v18, s[12:15], s99 offen sc1
buffer_load_dwordx4 a[148:151], v19, s[12:15], s99 offen sc1
s_mov_b64 exec, -1
buffer_atomic_add v14, v13, s[32:35], s47 offen sc1
s_nop 2
v_mfma_f32_32x32x16_bf16 v[192:207], a[200:203], v[248:251], v[192:207]
v_max3_f32 v24, v128, v129, v24
v_max3_f32 v25, v130, v131, v25
v_max3_f32 v24, v132, v133, v24
v_max3_f32 v25, v134, v135, v25
v_max3_f32 v24, v136, v137, v24
v_max3_f32 v25, v138, v139, v25
v_max3_f32 v24, v140, v141, v24
v_max3_f32 v25, v142, v143, v25
v_exp_f32 v160, v160
s_waitcnt vmcnt(14)
v_mfma_f32_32x32x16_bf16 v[32:47], a[104:107], v[88:91], v[32:47]
v_exp_f32 v161, v161
v_exp_f32 v162, v162
v_exp_f32 v163, v163
v_exp_f32 v164, v164
v_exp_f32 v165, v165
s_waitcnt vmcnt(13)
v_mfma_f32_32x32x16_bf16 v[32:47], a[108:111], v[92:95], v[32:47]
v_exp_f32 v166, v166
v_exp_f32 v167, v167
v_cvt_pk_bf16_f32 v80, v160, v161
v_cvt_pk_bf16_f32 v81, v162, v163
v_cvt_pk_bf16_f32 v82, v164, v165
v_cvt_pk_bf16_f32 v83, v166, v167
v_exp_f32 v168, v168
v_mfma_f32_32x32x16_bf16 v[144:159], a[32:35], v[72:75], 0
v_exp_f32 v169, v169
v_exp_f32 v170, v170
v_exp_f32 v171, v171
v_exp_f32 v172, v172
v_exp_f32 v173, v173
v_mfma_f32_32x32x16_bf16 v[144:159], a[36:39], v[76:79], v[144:159]
v_exp_f32 v174, v174
v_exp_f32 v175, v175
v_cvt_pk_bf16_f32 v84, v168, v169
v_cvt_pk_bf16_f32 v85, v170, v171
v_cvt_pk_bf16_f32 v86, v172, v173
v_cvt_pk_bf16_f32 v87, v174, v175
s_add_u32 s99, s49, 40960
s_mov_b64 exec, s[4:5]
buffer_load_dwordx4 a[152:155], v18, s[12:15], s99 offen sc1
buffer_load_dwordx4 a[156:159], v19, s[12:15], s99 offen sc1
s_mov_b64 exec, -1
s_nop 3
v_mfma_f32_32x32x16_bf16 v[208:223], a[200:203], v[248:251], v[208:223]
v_max3_f32 v24, v144, v145, v24
v_max3_f32 v25, v146, v147, v25
v_max3_f32 v24, v148, v149, v24
v_max3_f32 v25, v150, v151, v25
v_max3_f32 v24, v152, v153, v24
v_max3_f32 v25, v154, v155, v25
v_max3_f32 v24, v156, v157, v24
v_max3_f32 v25, v158, v159, v25
v_exp_f32 v176, v176
s_waitcnt vmcnt(14)
v_mfma_f32_32x32x16_bf16 v[32:47], a[112:115], v[80:83], v[32:47]
v_exp_f32 v177, v177
v_exp_f32 v178, v178
v_exp_f32 v179, v179
v_exp_f32 v180, v180
v_exp_f32 v181, v181
s_waitcnt vmcnt(13)
v_mfma_f32_32x32x16_bf16 v[32:47], a[116:119], v[84:87], v[32:47]
v_exp_f32 v182, v182
v_exp_f32 v183, v183
v_cvt_pk_bf16_f32 v88, v176, v177
v_cvt_pk_bf16_f32 v89, v178, v179
v_cvt_pk_bf16_f32 v90, v180, v181
v_cvt_pk_bf16_f32 v91, v182, v183
v_exp_f32 v184, v184
v_mfma_f32_32x32x16_bf16 v[160:175], a[40:43], v[72:75], 0
v_exp_f32 v185, v185
v_exp_f32 v186, v186
v_exp_f32 v187, v187
v_exp_f32 v188, v188
v_exp_f32 v189, v189
v_mfma_f32_32x32x16_bf16 v[160:175], a[44:47], v[76:79], v[160:175]
v_exp_f32 v190, v190
v_exp_f32 v191, v191
v_cvt_pk_bf16_f32 v92, v184, v185
v_cvt_pk_bf16_f32 v93, v186, v187
v_cvt_pk_bf16_f32 v94, v188, v189
v_cvt_pk_bf16_f32 v95, v190, v191
v_lshrrev_b32 v4, 3, v3
s_lshl_b32 s53, s40, 5
v_add_u32 v4, s53, v4
v_bfe_u32 v5, v3, 4, 1
v_lshlrev_b32 v5, 2, v5
v_and_b32 v6, 7, v3
v_xor_b32 v5, v5, v6
v_lshlrev_b32 v5, 4, v5
v_mad_u32_u24 v4, v4, s57, v5
s_lshl_b32 s53, s57, 3
s_sub_u32 s53, s53, 1024
v_add_u32 v5, s53, v4
v_add_u32 v6, s53, v5
v_add_u32 v7, s53, v6
s_lshl_b32 s53, s57, 6
s_mul_i32 s52, s63, s53
s_add_u32 s52, s52, s58
s_add_u32 m0, s41, 0
s_nop 0
buffer_load_dwordx4 v4, s[20:23], s52 offen lds
s_add_u32 m0, s41, 0
s_nop 0
buffer_load_dwordx4 v5, s[20:23], s52 offen offset:1024 lds
v_mfma_f32_32x32x16_bf16 v[224:239], a[200:203], v[248:251], v[224:239]
v_max3_f32 v24, v160, v161, v24
v_max3_f32 v25, v162, v163, v25
v_max3_f32 v24, v164, v165, v24
v_max3_f32 v25, v166, v167, v25
v_max3_f32 v24, v168, v169, v24
v_max3_f32 v25, v170, v171, v25
v_max3_f32 v24, v172, v173, v24
v_max3_f32 v25, v174, v175, v25
v_exp_f32 v192, v192
s_waitcnt vmcnt(14)
v_mfma_f32_32x32x16_bf16 v[32:47], a[120:123], v[88:91], v[32:47]
v_exp_f32 v193, v193
v_exp_f32 v194, v194
v_exp_f32 v195, v195
v_exp_f32 v196, v196
v_exp_f32 v197, v197
s_waitcnt vmcnt(13)
v_mfma_f32_32x32x16_bf16 v[32:47], a[124:127], v[92:95], v[32:47]
v_exp_f32 v198, v198
s_add_u32 m0, s41, 0
s_nop 0
buffer_load_dwordx4 v6, s[20:23], s52 offen offset:2048 lds
s_add_u32 m0, s41, 0
s_nop 0
buffer_load_dwordx4 v7, s[20:23], s52 offen offset:3072 lds
s_mov_b32 s3, s62
s_lshl_b32 s3, s3, 2
s_add_u32 s3, s3, s60
s_lshl_b32 s3, s3, 4
s_lshr_b32 s4, s44, 2
s_add_u32 s3, s3, s4
s_lshl_b32 s3, s3, 2
s_add_u32 s3, s3, s40
s_mul_i32 s3, s3, 2176
v_min_u32 v28, 16, v3
v_add_lshl_u32 v28, v28, 0, 7
buffer_load_dword a223, v28, s[24:27], s3 offen
v_exp_f32 v199, v199
v_cvt_pk_bf16_f32 v80, v192, v193
v_cvt_pk_bf16_f32 v81, v194, v195
v_cvt_pk_bf16_f32 v82, v196, v197
v_cvt_pk_bf16_f32 v83, v198, v199
v_exp_f32 v200, v200
v_mfma_f32_32x32x16_bf16 v[176:191], a[48:51], v[72:75], 0
v_exp_f32 v201, v201
v_exp_f32 v202, v202
v_exp_f32 v203, v203
v_exp_f32 v204, v204
v_exp_f32 v205, v205
v_mfma_f32_32x32x16_bf16 v[176:191], a[52:55], v[76:79], v[176:191]
v_exp_f32 v206, v206
v_exp_f32 v207, v207
v_cvt_pk_bf16_f32 v84, v200, v201
v_cvt_pk_bf16_f32 v85, v202, v203
v_cvt_pk_bf16_f32 v86, v204, v205
v_cvt_pk_bf16_f32 v87, v206, v207
s_add_u32 m0, s41, 16384
s_add_u32 s51, s63, 2
s_sub_u32 s52, s51, 10
s_cselect_b32 s51, s51, s52
s_mul_i32 s52, s51, s53
s_add_u32 s52, s52, s58
buffer_load_dwordx4 v4, s[20:23], s52 offen lds
buffer_load_dwordx4 v5, s[20:23], s52 offen offset:1024 lds
s_waitcnt vmcnt(17)
v_mfma_f32_32x32x16_bf16 v[32:47], a[128:131], v[80:83], v[32:47]
v_max3_f32 v24, v176, v177, v24
v_max3_f32 v25, v178, v179, v25
v_max3_f32 v24, v180, v181, v24
v_max3_f32 v25, v182, v183, v25
v_max3_f32 v24, v184, v185, v24
v_max3_f32 v25, v186, v187, v25
v_max3_f32 v24, v188, v189, v24
v_max3_f32 v25, v190, v191, v25
v_exp_f32 v208, v208
v_exp_f32 v209, v209
s_waitcnt vmcnt(16)
v_mfma_f32_32x32x16_bf16 v[32:47], a[132:135], v[84:87], v[32:47]
v_exp_f32 v210, v210
v_exp_f32 v211, v211
v_exp_f32 v212, v212
v_exp_f32 v213, v213
v_exp_f32 v214, v214
v_exp_f32 v215, v215
buffer_load_dwordx4 v6, s[20:23], s52 offen offset:2048 lds
buffer_load_dwordx4 v7, s[20:23], s52 offen offset:3072 lds
v_mfma_f32_32x32x16_bf16 v[192:207], a[56:59], v[72:75], 0
v_cvt_pk_bf16_f32 v88, v208, v209
v_cvt_pk_bf16_f32 v89, v210, v211
v_cvt_pk_bf16_f32 v90, v212, v213
v_cvt_pk_bf16_f32 v91, v214, v215
v_exp_f32 v216, v216
v_exp_f32 v217, v217
v_exp_f32 v218, v218
v_exp_f32 v219, v219
v_mfma_f32_32x32x16_bf16 v[192:207], a[60:63], v[76:79], v[192:207]
v_exp_f32 v220, v220
v_exp_f32 v221, v221
v_exp_f32 v222, v222
v_exp_f32 v223, v223
v_cvt_pk_bf16_f32 v92, v216, v217
v_cvt_pk_bf16_f32 v93, v218, v219
v_cvt_pk_bf16_f32 v94, v220, v221
v_cvt_pk_bf16_f32 v95, v222, v223
s_add_u32 m0, s41, 32768
s_add_u32 s51, s63, 4
s_sub_u32 s52, s51, 10
s_cselect_b32 s51, s51, s52
s_mul_i32 s52, s51, s53
s_add_u32 s52, s52, s58
buffer_load_dwordx4 v4, s[20:23], s52 offen lds
buffer_load_dwordx4 v5, s[20:23], s52 offen offset:1024 lds
s_waitcnt vmcnt(19)
v_mfma_f32_32x32x16_bf16 v[32:47], a[136:139], v[88:91], v[32:47]
v_max3_f32 v24, v192, v193, v24
v_max3_f32 v25, v194, v195, v25
v_max3_f32 v24, v196, v197, v24
v_max3_f32 v25, v198, v199, v25
v_max3_f32 v24, v200, v201, v24
v_max3_f32 v25, v202, v203, v25
v_max3_f32 v24, v204, v205, v24
v_max3_f32 v25, v206, v207, v25
v_exp_f32 v224, v224
v_exp_f32 v225, v225
s_waitcnt vmcnt(18)
v_mfma_f32_32x32x16_bf16 v[32:47], a[140:143], v[92:95], v[32:47]
v_exp_f32 v226, v226
v_exp_f32 v227, v227
v_exp_f32 v228, v228
v_exp_f32 v229, v229
v_exp_f32 v230, v230
v_exp_f32 v231, v231
buffer_load_dwordx4 v6, s[20:23], s52 offen offset:2048 lds
buffer_load_dwordx4 v7, s[20:23], s52 offen offset:3072 lds
v_mfma_f32_32x32x16_bf16 v[208:223], a[64:67], v[72:75], 0
v_cvt_pk_bf16_f32 v80, v224, v225
v_cvt_pk_bf16_f32 v81, v226, v227
v_cvt_pk_bf16_f32 v82, v228, v229
v_cvt_pk_bf16_f32 v83, v230, v231
v_exp_f32 v232, v232
v_exp_f32 v233, v233
v_exp_f32 v234, v234
v_exp_f32 v235, v235
v_mfma_f32_32x32x16_bf16 v[208:223], a[68:71], v[76:79], v[208:223]
v_exp_f32 v236, v236
v_exp_f32 v237, v237
v_exp_f32 v238, v238
v_exp_f32 v239, v239
v_cvt_pk_bf16_f32 v84, v232, v233
v_cvt_pk_bf16_f32 v85, v234, v235
v_cvt_pk_bf16_f32 v86, v236, v237
v_cvt_pk_bf16_f32 v87, v238, v239
v_mfma_f32_32x32x16_bf16 v[224:239], a[72:75], v[72:75], 0
v_mfma_f32_32x32x16_bf16 v[224:239], a[76:79], v[76:79], v[224:239]
v_bfi_b32 v88, v240, 0, v80
v_bfi_b32 v89, v241, 0, v81
v_bfi_b32 v90, v242, 0, v82
v_bfi_b32 v91, v243, 0, v83
v_bfi_b32 v92, v244, 0, v84
v_bfi_b32 v93, v245, 0, v85
v_bfi_b32 v94, v246, 0, v86
v_bfi_b32 v95, v247, 0, v87
s_waitcnt vmcnt(19)
v_mfma_f32_32x32x16_bf16 v[32:47], a[80:83], v[88:91], v[32:47]
v_and_b32 v80, v240, v80
v_and_b32 v81, v241, v81
v_and_b32 v82, v242, v82
v_and_b32 v83, v243, v83
s_waitcnt vmcnt(18)
v_mfma_f32_32x32x16_bf16 v[32:47], a[84:87], v[92:95], v[32:47]
v_and_b32 v84, v244, v84
v_and_b32 v85, v245, v85
v_and_b32 v86, v246, v86
v_and_b32 v87, v247, v87
s_add_u32 m0, s41, 49152
s_add_u32 s51, s63, 6
s_sub_u32 s52, s51, 10
s_cselect_b32 s51, s51, s52
s_mul_i32 s52, s51, s53
s_add_u32 s52, s52, s58
buffer_load_dwordx4 v4, s[20:23], s52 offen lds
buffer_load_dwordx4 v5, s[20:23], s52 offen offset:1024 lds
buffer_load_dwordx4 v6, s[20:23], s52 offen offset:2048 lds
buffer_load_dwordx4 v7, s[20:23], s52 offen offset:3072 lds
s_waitcnt vmcnt(21)
v_mfma_f32_32x32x16_bf16 v[32:47], a[144:147], v[80:83], v[32:47]
v_max3_f32 v24, v208, v209, v24
v_max3_f32 v25, v210, v211, v25
v_max3_f32 v24, v212, v213, v24
v_max3_f32 v25, v214, v215, v25
v_max3_f32 v24, v216, v217, v24
v_max3_f32 v25, v218, v219, v25
v_max3_f32 v24, v220, v221, v24
v_max3_f32 v25, v222, v223, v25
v_cndmask_b32 v224, v96, v224, s[64:65]
v_cndmask_b32 v225, v97, v225, s[66:67]
v_cndmask_b32 v226, v98, v226, s[68:69]
v_cndmask_b32 v227, v99, v227, s[70:71]
v_cndmask_b32 v228, v100, v228, s[72:73]
v_cndmask_b32 v229, v101, v229, s[74:75]
v_cndmask_b32 v230, v102, v230, s[76:77]
v_cndmask_b32 v231, v103, v231, s[78:79]
v_cndmask_b32 v232, v104, v232, s[80:81]
v_cndmask_b32 v233, v105, v233, s[82:83]
v_cndmask_b32 v234, v106, v234, s[84:85]
v_cndmask_b32 v235, v107, v235, s[86:87]
v_cndmask_b32 v236, v108, v236, s[88:89]
v_cndmask_b32 v237, v109, v237, s[90:91]
v_cndmask_b32 v238, v110, v238, s[92:93]
v_cndmask_b32 v239, v111, v239, s[94:95]
s_waitcnt vmcnt(20)
v_mfma_f32_32x32x16_bf16 v[32:47], a[148:151], v[84:87], v[32:47]
v_max3_f32 v24, v224, v225, v24
v_max3_f32 v25, v226, v227, v25
v_max3_f32 v24, v228, v229, v24
v_max3_f32 v25, v230, v231, v25
v_max3_f32 v24, v232, v233, v24
v_max3_f32 v25, v234, v235, v25
v_max3_f32 v24, v236, v237, v24
v_max3_f32 v25, v238, v239, v25
v_max_f32 v24, v24, v25
v_mov_b32 v25, v24
s_nop 1
v_permlane32_swap_b32 v24, v25
v_max_f32 v24, v24, v25
v_sub_f32 v24, 0, v24
v_and_b32 v25, 0xffff0000, v24
v_sub_f32 v24, v24, v25
v_and_b32 v16, 0xffff0000, v24
v_sub_f32 v24, v24, v16
v_lshrrev_b32 v25, 16, v25
v_or_b32 v25, v25, v16
v_lshrrev_b32 v24, 16, v24
v_cmp_gt_u32 vcc, 32, v3
s_nop 1
v_cndmask_b32 v248, v24, v25, vcc
s_nop 1
v_mfma_f32_32x32x16_bf16 v[112:127], a[200:203], v[248:251], v[112:127]
v_mfma_f32_32x32x16_bf16 v[128:143], a[200:203], v[248:251], v[128:143]
s_add_u32 m0, s41, 65536
s_add_u32 s51, s63, 8
s_sub_u32 s52, s51, 10
s_cselect_b32 s51, s51, s52
s_mul_i32 s52, s51, s53
s_add_u32 s52, s52, s58
buffer_load_dwordx4 v4, s[20:23], s52 offen lds
buffer_load_dwordx4 v5, s[20:23], s52 offen offset:1024 lds
buffer_load_dwordx4 v6, s[20:23], s52 offen offset:2048 lds
v_mfma_f32_32x32x16_bf16 v[144:159], a[200:203], v[248:251], v[144:159]
s_nop 0
v_exp_f32 v112, v112
v_exp_f32 v113, v113
v_exp_f32 v114, v114
v_exp_f32 v115, v115
v_exp_f32 v116, v116
v_exp_f32 v117, v117
v_exp_f32 v118, v118
v_exp_f32 v119, v119
v_cvt_pk_bf16_f32 v88, v112, v113
v_cvt_pk_bf16_f32 v89, v114, v115
v_cvt_pk_bf16_f32 v90, v116, v117
buffer_load_dwordx4 v7, s[20:23], s52 offen offset:3072 lds
s_cmp_eq_u32 s57, 1280
s_cselect_b32 s5, 0, 10
s_lshl_b32 s6, s44, 9
buffer_load_dword v29, off, s[32:35], s6 offset:384 sc1
s_mul_i32 s4, s44, 2560
s_add_u32 s4, s4, 131072
s_mul_i32 s98, s44, 40960
s_add_u32 s98, s98, 11141120
s_cmp_eq_u32 s57, 1280
s_cselect_b32 s4, 1073741824, s4
s_cselect_b32 s98, 1073741824, s98
v_lshrrev_b32 v18, 5, v3
v_mul_u32_u24 v18, 1024, v18
v_lshl_add_u32 v18, v3, 3, v18
s_getpc_b64 s[86:87]
L_pc41:
s_lshl_b32 s3, s42, 3
s_xor_b32 s3, s3, s43
s_lshl_b32 s3, s3, 2
s_add_u32 s3, s3, s40
s_mul_i32 s3, s3, 8
s_and_b32 s3, s3, 1023
v_min_u32 v26, 7, v3
v_add_lshl_u32 v26, v26, s3, 7
v_min_u32 v26, L_codeend-L_pc41-4, v26
v_and_b32 v26, -4, v26
global_load_dword a223, v26, s[86:87]
v_cvt_pk_bf16_f32 v91, v118, v119
v_exp_f32 v120, v120
v_exp_f32 v121, v121
v_exp_f32 v122, v122
v_exp_f32 v123, v123
v_exp_f32 v124, v124
v_exp_f32 v125, v125
v_exp_f32 v126, v126
v_exp_f32 v127, v127
v_cvt_pk_bf16_f32 v92, v120, v121
v_cvt_pk_bf16_f32 v93, v122, v123
v_cvt_pk_bf16_f32 v94, v124, v125
v_cvt_pk_bf16_f32 v95, v126, v127
s_lshl_b32 s83, s43, 1
v_add_u32 v17, s83, v3
v_lshlrev_b32 v17, 7, v17
v_add_u32 v17, 90112, v17
s_cmp_eq_u32 s40, 0
s_cselect_b32 s84, 2, 0
v_cmp_gt_u32 vcc, s84, v3
v_mov_b32 v19, 1073741824
s_mul_i32 s83, s83, 40
v_cndmask_b32 v19, v19, v17, vcc
s_mul_i32 s84, s42, 5
s_add_u32 s83, s83, s84
v_add_u32 v17, 147456, v0
s_lshl_b32 s84, s40, 10
v_add_u32 v17, s84, v17
s_add_u32 m0, s41, 81920
s_mul_i32 s52, s63, s53
s_add_u32 s52, s52, s58
s_add_u32 s52, s52, 128
buffer_load_dwordx4 v4, s[20:23], s52 offen lds
buffer_load_dwordx4 v5, s[20:23], s52 offen offset:1024 lds
v_mfma_f32_32x32x16_bf16 v[160:175], a[200:203], v[248:251], v[160:175]
v_exp_f32 v128, v128
v_exp_f32 v129, v129
v_exp_f32 v130, v130
v_exp_f32 v131, v131
v_exp_f32 v132, v132
v_exp_f32 v133, v133
v_exp_f32 v134, v134
v_mfma_f32_32x32x16_bf16 v[48:63], a[96:99], v[88:91], 0
v_exp_f32 v135, v135
v_cvt_pk_bf16_f32 v80, v128, v129
v_cvt_pk_bf16_f32 v81, v130, v131
v_cvt_pk_bf16_f32 v82, v132, v133
buffer_load_dwordx4 v6, s[20:23], s52 offen offset:2048 lds
buffer_load_dwordx4 v7, s[20:23], s52 offen offset:3072 lds
v_cvt_pk_bf16_f32 v83, v134, v135
v_exp_f32 v136, v136
v_exp_f32 v137, v137
v_exp_f32 v138, v138
v_exp_f32 v139, v139
v_mfma_f32_32x32x16_bf16 v[48:63], a[100:103], v[92:95], v[48:63]
v_exp_f32 v140, v140
v_exp_f32 v141, v141
v_exp_f32 v142, v142
v_exp_f32 v143, v143
v_cvt_pk_bf16_f32 v84, v136, v137
v_cvt_pk_bf16_f32 v85, v138, v139
v_cvt_pk_bf16_f32 v86, v140, v141
v_cvt_pk_bf16_f32 v87, v142, v143
s_add_u32 s84, s40, 0
s_cmp_gt_u32 s84, 4
s_cselect_b32 s80, 35, 0
s_add_u32 s80, s80, s84
s_add_u32 s80, s80, s83
s_lshl_b32 s80, s80, 10
s_add_u32 s80, s80, 13762560
s_cmp_gt_u32 s84, 9
s_cselect_b32 s80, 1073741824, s80
s_add_u32 s84, s40, 4
s_cmp_gt_u32 s84, 4
s_cselect_b32 s81, 35, 0
s_add_u32 s81, s81, s84
s_add_u32 s81, s81, s83
s_lshl_b32 s81, s81, 10
s_add_u32 s81, s81, 13762560
s_cmp_gt_u32 s84, 9
s_cselect_b32 s81, 1073741824, s81
s_add_u32 s84, s40, 8
s_cmp_gt_u32 s84, 4
s_cselect_b32 s82, 35, 0
s_add_u32 s82, s82, s84
s_add_u32 s82, s82, s83
s_lshl_b32 s82, s82, 10
s_add_u32 s82, s82, 13762560
s_cmp_gt_u32 s84, 9
s_cselect_b32 s82, 1073741824, s82
s_add_u32 m0, s41, 98304
s_add_u32 s51, s63, 2
s_sub_u32 s52, s51, 10
s_cselect_b32 s51, s51, s52
s_mul_i32 s52, s51, s53
s_add_u32 s52, s52, s58
s_add_u32 s52, s52, 128
buffer_load_dwordx4 v4, s[20:23], s52 offen lds
buffer_load_dwordx4 v5, s[20:23], s52 offen offset:1024 lds
v_mfma_f32_32x32x16_bf16 v[176:191], a[200:203], v[248:251], v[176:191]
v_rcp_f32 v16, v44
s_nop 0
v_mul_f32 v32, v32, v16
v_mul_f32 v33, v33, v16
v_mul_f32 v34, v34, v16
v_mul_f32 v35, v35, v16
v_mul_f32 v36, v36, v16
v_mul_f32 v37, v37, v16
v_mul_f32 v38, v38, v16
v_mul_f32 v39, v39, v16
v_mul_f32 v40, v40, v16
v_mul_f32 v41, v41, v16
v_mul_f32 v42, v42, v16
v_mul_f32 v43, v43, v16
v_cvt_pk_bf16_f32 v32, v32, v33
v_cvt_pk_bf16_f32 v33, v34, v35
v_cvt_pk_bf16_f32 v34, v36, v37
v_cvt_pk_bf16_f32 v35, v38, v39
v_cvt_pk_bf16_f32 v36, v40, v41
v_cvt_pk_bf16_f32 v37, v42, v43
ds_write_b64 v21, v[32:33] offset:0
v_mfma_f32_32x32x16_bf16 v[48:63], a[104:107], v[80:83], v[48:63]
ds_write_b64 v22, v[34:35] offset:0
ds_write_b64 v23, v[36:37] offset:0
buffer_load_dwordx4 v6, s[20:23], s52 offen offset:2048 lds
buffer_load_dwordx4 v7, s[20:23], s52 offen offset:3072 lds
v_exp_f32 v144, v144
v_exp_f32 v145, v145
v_exp_f32 v146, v146
v_exp_f32 v147, v147
v_exp_f32 v148, v148
v_exp_f32 v149, v149
v_exp_f32 v150, v150
v_exp_f32 v151, v151
v_cvt_pk_bf16_f32 v88, v144, v145
v_cvt_pk_bf16_f32 v89, v146, v147
v_cvt_pk_bf16_f32 v90, v148, v149
v_mfma_f32_32x32x16_bf16 v[48:63], a[108:111], v[84:87], v[48:63]
v_cvt_pk_bf16_f32 v91, v150, v151
v_exp_f32 v152, v152
v_exp_f32 v153, v153
v_exp_f32 v154, v154
v_exp_f32 v155, v155
v_exp_f32 v156, v156
v_exp_f32 v157, v157
v_exp_f32 v158, v158
v_exp_f32 v159, v159
v_cvt_pk_bf16_f32 v92, v152, v153
v_cvt_pk_bf16_f32 v93, v154, v155
v_cvt_pk_bf16_f32 v94, v156, v157
v_cvt_pk_bf16_f32 v95, v158, v159
s_xor_b32 s76, s62, 0
s_lshl_b32 s76, s76, 7
s_add_u32 s76, s76, 98176
buffer_load_dword v20, off, s[32:35], s76 sc1
s_lshl_b32 s74, s58, 4
s_add_u32 s74, s74, 327680
s_mov_b32 s78, 0xffff0000
s_waitcnt vmcnt(10)
v_cmp_gt_u32 vcc, s5, v29
s_nop 1
s_cbranch_vccnz L_pw38
L_pr40:
buffer_load_dwordx2 v[64:65], v18, s[32:35], s4 offen offset:0 sc1
buffer_load_dwordx2 v[66:67], v18, s[32:35], s4 offen offset:256 sc1
v_mfma_f32_32x32x16_bf16 v[192:207], a[200:203], v[248:251], v[192:207]
v_exp_f32 v160, v160
v_exp_f32 v161, v161
v_exp_f32 v162, v162
v_exp_f32 v163, v163
v_exp_f32 v164, v164
v_exp_f32 v165, v165
v_exp_f32 v166, v166
v_mfma_f32_32x32x16_bf16 v[48:63], a[112:115], v[88:91], v[48:63]
v_exp_f32 v167, v167
v_cvt_pk_bf16_f32 v80, v160, v161
v_cvt_pk_bf16_f32 v81, v162, v163
v_cvt_pk_bf16_f32 v82, v164, v165
buffer_load_dwordx2 v[68:69], v18, s[32:35], s4 offen offset:512 sc1
buffer_load_dwordx2 v[70:71], v18, s[32:35], s4 offen offset:768 sc1
buffer_load_dwordx2 v[72:73], v18, s[32:35], s4 offen offset:1024 sc1
v_cvt_pk_bf16_f32 v83, v166, v167
v_exp_f32 v168, v168
v_exp_f32 v169, v169
v_exp_f32 v170, v170
v_exp_f32 v171, v171
v_mfma_f32_32x32x16_bf16 v[48:63], a[116:119], v[92:95], v[48:63]
v_exp_f32 v172, v172
v_exp_f32 v173, v173
v_exp_f32 v174, v174
v_exp_f32 v175, v175
v_cvt_pk_bf16_f32 v84, v168, v169
v_cvt_pk_bf16_f32 v85, v170, v171
v_cvt_pk_bf16_f32 v86, v172, v173
v_cvt_pk_bf16_f32 v87, v174, v175
s_add_u32 s99, s63, 0
s_sub_u32 s3, s99, 10
s_cselect_b32 s99, s99, s3
s_lshl_b32 s99, s99, 12
s_add_u32 s99, s99, s98
buffer_load_dwordx4 a[0:3], v0, s[32:35], s99 offen sc1
v_mfma_f32_32x32x16_bf16 v[208:223], a[200:203], v[248:251], v[208:223]
v_exp_f32 v176, v176
v_exp_f32 v177, v177
v_exp_f32 v178, v178
v_exp_f32 v179, v179
v_exp_f32 v180, v180
v_exp_f32 v181, v181
v_exp_f32 v182, v182
v_mfma_f32_32x32x16_bf16 v[48:63], a[120:123], v[80:83], v[48:63]
v_exp_f32 v183, v183
v_cvt_pk_bf16_f32 v88, v176, v177
v_cvt_pk_bf16_f32 v89, v178, v179
v_cvt_pk_bf16_f32 v90, v180, v181
buffer_load_dwordx4 a[4:7], v0, s[32:35], s99 offen offset:1024 sc1
buffer_load_dwordx4 a[8:11], v0, s[32:35], s99 offen offset:2048 sc1
v_cvt_pk_bf16_f32 v91, v182, v183
v_exp_f32 v184, v184
v_exp_f32 v185, v185
v_exp_f32 v186, v186
v_exp_f32 v187, v187
v_mfma_f32_32x32x16_bf16 v[48:63], a[124:127], v[84:87], v[48:63]
v_exp_f32 v188, v188
v_exp_f32 v189, v189
v_exp_f32 v190, v190
v_exp_f32 v191, v191
v_cvt_pk_bf16_f32 v92, v184, v185
v_cvt_pk_bf16_f32 v93, v186, v187
v_cvt_pk_bf16_f32 v94, v188, v189
v_cvt_pk_bf16_f32 v95, v190, v191
buffer_load_dwordx4 a[12:15], v0, s[32:35], s99 offen offset:3072 sc1
v_mfma_f32_32x32x16_bf16 v[224:239], a[200:203], v[248:251], v[224:239]
v_exp_f32 v192, v192
v_exp_f32 v193, v193
v_exp_f32 v194, v194
v_exp_f32 v195, v195
v_exp_f32 v196, v196
v_exp_f32 v197, v197
v_exp_f32 v198, v198
v_mfma_f32_32x32x16_bf16 v[48:63], a[128:131], v[88:91], v[48:63]
v_exp_f32 v199, v199
v_cvt_pk_bf16_f32 v80, v192, v193
v_cvt_pk_bf16_f32 v81, v194, v195
v_cvt_pk_bf16_f32 v82, v196, v197
s_add_u32 s99, s63, 1
s_sub_u32 s3, s99, 10
s_cselect_b32 s99, s99, s3
s_lshl_b32 s99, s99, 12
s_add_u32 s99, s99, s98
buffer_load_dwordx4 a[16:19], v0, s[32:35], s99 offen sc1
v_cvt_pk_bf16_f32 v83, v198, v199
v_exp_f32 v200, v200
v_exp_f32 v201, v201
v_exp_f32 v202, v202
v_exp_f32 v203, v203
v_mfma_f32_32x32x16_bf16 v[48:63], a[132:135], v[92:95], v[48:63]
v_exp_f32 v204, v204
v_exp_f32 v205, v205
v_exp_f32 v206, v206
v_exp_f32 v207, v207
v_cvt_pk_bf16_f32 v84, v200, v201
v_cvt_pk_bf16_f32 v85, v202, v203
v_cvt_pk_bf16_f32 v86, v204, v205
v_cvt_pk_bf16_f32 v87, v206, v207
buffer_load_dwordx4 a[20:23], v0, s[32:35], s99 offen offset:1024 sc1
v_mfma_f32_32x32x16_bf16 v[48:63], a[136:139], v[80:83], v[48:63]
v_exp_f32 v208, v208
v_exp_f32 v209, v209
v_exp_f32 v210, v210
v_exp_f32 v211, v211
v_exp_f32 v212, v212
v_exp_f32 v213, v213
v_exp_f32 v214, v214
v_exp_f32 v215, v215
v_cvt_pk_bf16_f32 v88, v208, v209
v_cvt_pk_bf16_f32 v89, v210, v211
v_cvt_pk_bf16_f32 v90, v212, v213
v_cvt_pk_bf16_f32 v91, v214, v215
buffer_load_dwordx4 a[24:27], v0, s[32:35], s99 offen offset:2048 sc1
buffer_load_dwordx4 a[28:31], v0, s[32:35], s99 offen offset:3072 sc1
v_mfma_f32_32x32x16_bf16 v[48:63], a[140:143], v[84:87], v[48:63]
v_exp_f32 v216, v216
v_exp_f32 v217, v217
v_exp_f32 v218, v218
v_exp_f32 v219, v219
v_exp_f32 v220, v220
v_exp_f32 v221, v221
v_exp_f32 v222, v222
v_exp_f32 v223, v223
v_cvt_pk_bf16_f32 v92, v216, v217
v_cvt_pk_bf16_f32 v93, v218, v219
v_cvt_pk_bf16_f32 v94, v220, v221
v_cvt_pk_bf16_f32 v95, v222, v223
s_add_u32 s99, s63, 2
s_sub_u32 s3, s99, 10
s_cselect_b32 s99, s99, s3
s_lshl_b32 s99, s99, 12
s_add_u32 s99, s99, s98
buffer_load_dwordx4 a[32:35], v0, s[32:35], s99 offen sc1
v_mfma_f32_32x32x16_bf16 v[48:63], a[144:147], v[88:91], v[48:63]
v_exp_f32 v224, v224
v_exp_f32 v225, v225
v_exp_f32 v226, v226
v_exp_f32 v227, v227
v_exp_f32 v228, v228
v_exp_f32 v229, v229
v_exp_f32 v230, v230
v_exp_f32 v231, v231
v_cvt_pk_bf16_f32 v80, v224, v225
v_cvt_pk_bf16_f32 v81, v226, v227
v_cvt_pk_bf16_f32 v82, v228, v229
v_cvt_pk_bf16_f32 v83, v230, v231
buffer_load_dwordx4 a[36:39], v0, s[32:35], s99 offen offset:1024 sc1
v_mfma_f32_32x32x16_bf16 v[48:63], a[148:151], v[92:95], v[48:63]
v_exp_f32 v232, v232
v_exp_f32 v233, v233
v_exp_f32 v234, v234
v_exp_f32 v235, v235
v_exp_f32 v236, v236
v_exp_f32 v237, v237
v_exp_f32 v238, v238
v_exp_f32 v239, v239
v_cvt_pk_bf16_f32 v84, v232, v233
v_cvt_pk_bf16_f32 v85, v234, v235
v_cvt_pk_bf16_f32 v86, v236, v237
v_cvt_pk_bf16_f32 v87, v238, v239
v_bfi_b32 v88, v240, 0, v80
v_bfi_b32 v89, v241, 0, v81
v_bfi_b32 v90, v242, 0, v82
v_bfi_b32 v91, v243, 0, v83
v_bfi_b32 v92, v244, 0, v84
v_bfi_b32 v93, v245, 0, v85
v_bfi_b32 v94, v246, 0, v86
v_bfi_b32 v95, v247, 0, v87
v_mfma_f32_32x32x16_bf16 v[48:63], a[88:91], v[88:91], v[48:63]
v_and_b32 v80, v240, v80
v_and_b32 v81, v241, v81
v_and_b32 v82, v242, v82
v_and_b32 v83, v243, v83
v_mfma_f32_32x32x16_bf16 v[48:63], a[92:95], v[92:95], v[48:63]
v_and_b32 v84, v244, v84
v_and_b32 v85, v245, v85
v_and_b32 v86, v246, v86
v_and_b32 v87, v247, v87
buffer_load_dwordx4 a[40:43], v0, s[32:35], s99 offen offset:2048 sc1
buffer_load_dwordx4 a[44:47], v0, s[32:35], s99 offen offset:3072 sc1
v_mfma_f32_32x32x16_bf16 v[48:63], a[152:155], v[80:83], v[48:63]
v_mfma_f32_32x32x16_bf16 v[48:63], a[156:159], v[84:87], v[48:63]
s_nop 11
v_rcp_f32 v16, v60
s_nop 0
v_mul_f32 v48, v48, v16
v_mul_f32 v49, v49, v16
v_mul_f32 v50, v50, v16
v_mul_f32 v51, v51, v16
v_mul_f32 v52, v52, v16
v_mul_f32 v53, v53, v16
v_mul_f32 v54, v54, v16
v_mul_f32 v55, v55, v16
v_mul_f32 v56, v56, v16
v_mul_f32 v57, v57, v16
v_mul_f32 v58, v58, v16
v_mul_f32 v59, v59, v16
v_cvt_pk_bf16_f32 v48, v48, v49
v_cvt_pk_bf16_f32 v49, v50, v51
v_cvt_pk_bf16_f32 v50, v52, v53
v_cvt_pk_bf16_f32 v51, v54, v55
v_cvt_pk_bf16_f32 v52, v56, v57
v_cvt_pk_bf16_f32 v53, v58, v59
ds_write_b64 v21, v[48:49] offset:5120
ds_write_b64 v22, v[50:51] offset:5120
ds_write_b64 v23, v[52:53] offset:5120
s_waitcnt lgkmcnt(0)
s_barrier
ds_read_b128 v[76:79], v17 offset:0
ds_read_b128 v[80:83], v17 offset:4096
ds_read_b128 v[84:87], v17 offset:8192
s_waitcnt lgkmcnt(2)
buffer_store_dwordx4 v[76:79], v0, s[32:35], s80 offen sc1
s_waitcnt lgkmcnt(1)
buffer_store_dwordx4 v[80:83], v0, s[32:35], s81 offen sc1
s_waitcnt lgkmcnt(0)
buffer_store_dwordx4 v[84:87], v0, s[32:35], s82 offen sc1
s_cmp_eq_u32 s57, 1280
s_cbranch_scc1 L_s3o
s_lshl_b32 s3, s62, 2
s_add_u32 s3, s3, s60
s_cmp_lt_u32 s3, 7
s_cbranch_scc1 L_s3w3
L_s3w2:
v_bfe_u32 v30, v3, 2, 2
v_lshrrev_b32 v31, 5, v3
v_lshl_add_u32 v30, v31, 2, v30
v_lshlrev_b32 v1, 7, v30
v_bfe_u32 v30, v3, 4, 1
v_lshl_add_u32 v1, v30, 5, v1
v_and_b32 v30, 3, v3
v_lshl_add_u32 v1, v30, 3, v1
v_bfe_u32 v30, v3, 3, 1
v_lshl_add_u32 v1, v30, 6, v1
v_xor_b32 v2, 64, v1
ds_read_b64_tr_b16 a[160:161], v1 offset:0
ds_read_b64_tr_b16 a[162:163], v1 offset:1024
ds_read_b64_tr_b16 a[164:165], v2 offset:0
ds_read_b64_tr_b16 a[166:167], v2 offset:1024
ds_read_b64_tr_b16 a[168:169], v1 offset:2048
ds_read_b64_tr_b16 a[170:171], v1 offset:3072
ds_read_b64_tr_b16 a[172:173], v2 offset:2048
ds_read_b64_tr_b16 a[174:175], v2 offset:3072
ds_read_b64_tr_b16 a[176:177], v1 offset:4096
ds_read_b64_tr_b16 a[178:179], v1 offset:5120
ds_read_b64_tr_b16 a[180:181], v2 offset:4096
ds_read_b64_tr_b16 a[182:183], v2 offset:5120
s_waitcnt lgkmcnt(8)
s_waitcnt vmcnt(14)
v_mfma_f32_32x32x16_bf16 v[32:47], a[160:163], a[0:3], 0
ds_read_b64_tr_b16 a[184:185], v1 offset:6144
ds_read_b64_tr_b16 a[186:187], v1 offset:7168
s_add_u32 m0, s41, 114688
s_add_u32 s51, s63, 4
s_sub_u32 s52, s51, 10
s_cselect_b32 s51, s51, s52
v_mfma_f32_32x32x16_bf16 v[48:63], a[164:167], a[0:3], 0
ds_read_b64_tr_b16 a[188:189], v2 offset:6144
ds_read_b64_tr_b16 a[190:191], v2 offset:7168
s_mul_i32 s52, s51, s53
s_add_u32 s52, s52, s58
s_add_u32 s52, s52, 128
s_waitcnt lgkmcnt(8)
s_waitcnt vmcnt(13)
v_mfma_f32_32x32x16_bf16 v[32:47], a[168:171], a[4:7], v[32:47]
ds_read_b64_tr_b16 a[160:161], v1 offset:8192
ds_read_b64_tr_b16 a[162:163], v1 offset:9216
buffer_load_dwordx4 v4, s[20:23], s52 offen lds
v_mfma_f32_32x32x16_bf16 v[48:63], a[172:175], a[4:7], v[48:63]
ds_read_b64_tr_b16 a[164:165], v2 offset:8192
ds_read_b64_tr_b16 a[166:167], v2 offset:9216
s_add_u32 s99, s63, 3
s_sub_u32 s3, s99, 10
s_cselect_b32 s99, s99, s3
s_lshl_b32 s99, s99, 12
s_add_u32 s99, s99, s98
buffer_load_dwordx4 a[48:51], v0, s[32:35], s99 offen sc1
s_waitcnt lgkmcnt(8)
s_waitcnt vmcnt(14)
v_mfma_f32_32x32x16_bf16 v[32:47], a[176:179], a[8:11], v[32:47]
ds_read_b64_tr_b16 a[168:169], v1 offset:10240
ds_read_b64_tr_b16 a[170:171], v1 offset:11264
buffer_load_dwordx4 v5, s[20:23], s52 offen offset:1024 lds
v_mfma_f32_32x32x16_bf16 v[48:63], a[180:183], a[8:11], v[48:63]
ds_read_b64_tr_b16 a[172:173], v2 offset:10240
ds_read_b64_tr_b16 a[174:175], v2 offset:11264
buffer_load_dwordx4 a[52:55], v0, s[32:35], s99 offen offset:1024 sc1
s_mul_i32 s5, s44, 110592
s_add_u32 s5, s5, 19005440
s_lshl_b32 s4, s58, 5
s_add_u32 s64, s5, s4
s_add_u32 s65, s64, 4096
s_lshl_b32 s4, s59, 5
v_cmp_gt_u32 vcc, 45, v20
s_nop 1
s_cbranch_vccnz L_pw53
L_pr55:
v_and_b32 v21, 31, v3
v_lshlrev_b32 v21, 5, v21
v_lshrrev_b32 v22, 5, v3
v_lshl_add_u32 v21, v22, 4, v21
s_lshl_b32 s3, s59, 4
s_add_u32 s3, s3, 327680
buffer_load_dwordx4 v[100:103], v21, s[32:35], s74 offen offset:0 sc1
buffer_load_dwordx4 v[104:107], v21, s[32:35], s74 offen offset:1024 sc1
buffer_load_dwordx4 v[108:111], v21, s[32:35], s74 offen offset:2048 sc1
buffer_load_dwordx4 v[112:115], v21, s[32:35], s74 offen offset:3072 sc1
s_waitcnt lgkmcnt(8)
s_waitcnt vmcnt(19)
v_mfma_f32_32x32x16_bf16 v[32:47], a[184:187], a[12:15], v[32:47]
ds_read_b64_tr_b16 a[176:177], v1 offset:12288
ds_read_b64_tr_b16 a[178:179], v1 offset:13312
buffer_load_dwordx4 a[56:59], v0, s[32:35], s99 offen offset:2048 sc1
v_mfma_f32_32x32x16_bf16 v[48:63], a[188:191], a[12:15], v[48:63]
ds_read_b64_tr_b16 a[180:181], v2 offset:12288
ds_read_b64_tr_b16 a[182:183], v2 offset:13312
s_add_u32 s66, s5, s4
s_lshl_b32 s79, s44, 9
s_add_u32 s79, s79, 32768
s_add_u32 s47, s79, 128
v_add_f32 v64, v64, v66
v_add_f32 v65, v65, v67
s_waitcnt lgkmcnt(8)
s_waitcnt vmcnt(19)
v_mfma_f32_32x32x16_bf16 v[32:47], a[160:163], a[16:19], v[32:47]
ds_read_b64_tr_b16 a[184:185], v1 offset:14336
ds_read_b64_tr_b16 a[186:187], v1 offset:15360
buffer_load_dwordx4 v6, s[20:23], s52 offen offset:2048 lds
v_mfma_f32_32x32x16_bf16 v[48:63], a[164:167], a[16:19], v[48:63]
ds_read_b64_tr_b16 a[188:189], v2 offset:14336
ds_read_b64_tr_b16 a[190:191], v2 offset:15360
buffer_load_dwordx4 a[60:63], v0, s[32:35], s99 offen offset:3072 sc1
s_add_u32 s99, s63, 4
s_sub_u32 s3, s99, 10
s_cselect_b32 s99, s99, s3
s_lshl_b32 s99, s99, 12
s_add_u32 s99, s99, s98
buffer_load_dwordx4 a[64:67], v0, s[32:35], s99 offen sc1
s_waitcnt vmcnt(12)
s_waitcnt lgkmcnt(8)
v_mfma_f32_32x32x16_bf16 v[32:47], a[168:171], a[20:23], v[32:47]
s_barrier
ds_read_b64_tr_b16 a[160:161], v1 offset:16384
ds_read_b64_tr_b16 a[162:163], v1 offset:17408
v_add_f32 v64, v64, v68
v_add_f32 v65, v65, v69
v_mfma_f32_32x32x16_bf16 v[48:63], a[172:175], a[20:23], v[48:63]
ds_read_b64_tr_b16 a[164:165], v2 offset:16384
ds_read_b64_tr_b16 a[166:167], v2 offset:17408
v_add_f32 v64, v64, v70
v_add_f32 v65, v65, v71
v_add_f32 v64, v64, v72
v_add_f32 v65, v65, v73
s_waitcnt lgkmcnt(8)
v_mfma_f32_32x32x16_bf16 v[32:47], a[176:179], a[24:27], v[32:47]
ds_read_b64_tr_b16 a[168:169], v1 offset:18432
ds_read_b64_tr_b16 a[170:171], v1 offset:19456
buffer_load_dwordx4 v7, s[20:23], s52 offen offset:3072 lds
v_mfma_f32_32x32x16_bf16 v[48:63], a[180:183], a[24:27], v[48:63]
ds_read_b64_tr_b16 a[172:173], v2 offset:18432
ds_read_b64_tr_b16 a[174:175], v2 offset:19456
s_add_u32 m0, s41, 131072
s_add_u32 s51, s63, 6
s_sub_u32 s52, s51, 10
s_cselect_b32 s51, s51, s52
s_mul_i32 s52, s51, s53
s_add_u32 s52, s52, s58
s_add_u32 s52, s52, 128
buffer_load_dwordx4 v4, s[20:23], s52 offen lds
buffer_load_dwordx4 a[68:71], v0, s[32:35], s99 offen offset:1024 sc1
buffer_atomic_add v14, v19, s[32:35], 0 offen sc1
v_mov_b32 v66, v64
s_nop 1
v_permlane32_swap_b32 v64, v66
v_add_f32 v64, v64, v66
v_mov_b32 v67, v65
s_nop 1
v_permlane32_swap_b32 v65, v67
v_add_f32 v65, v65, v67
s_waitcnt lgkmcnt(8)
v_mfma_f32_32x32x16_bf16 v[32:47], a[184:187], a[28:31], v[32:47]
ds_read_b64_tr_b16 a[176:177], v1 offset:20480
ds_read_b64_tr_b16 a[178:179], v1 offset:21504
buffer_load_dwordx4 v5, s[20:23], s52 offen offset:1024 lds
v_mfma_f32_32x32x16_bf16 v[48:63], a[188:191], a[28:31], v[48:63]
ds_read_b64_tr_b16 a[180:181], v2 offset:20480
ds_read_b64_tr_b16 a[182:183], v2 offset:21504
buffer_load_dwordx4 a[72:75], v0, s[32:35], s99 offen offset:2048 sc1
s_waitcnt lgkmcnt(8)
v_mfma_f32_32x32x16_bf16 v[32:47], a[160:163], a[32:35], v[32:47]
ds_read_b64_tr_b16 a[184:185], v1 offset:22528
ds_read_b64_tr_b16 a[186:187], v1 offset:23552
buffer_load_dwordx4 a[76:79], v0, s[32:35], s99 offen offset:3072 sc1
v_mfma_f32_32x32x16_bf16 v[48:63], a[164:167], a[32:35], v[48:63]
ds_read_b64_tr_b16 a[188:189], v2 offset:22528
ds_read_b64_tr_b16 a[190:191], v2 offset:23552
v_mul_f32 v64, 0xbacccccd, v64
v_mul_f32 v65, 0x3acccccd, v65
v_fma_f32 v65, -v64, v64, v65
v_max_f32 v65, 0, v65
v_add_f32 v66, 0x3727c5ac, v65
v_rsq_f32 v8, v66
s_waitcnt lgkmcnt(8)
v_mfma_f32_32x32x16_bf16 v[32:47], a[168:171], a[36:39], v[32:47]
ds_read_b64_tr_b16 a[160:161], v1 offset:24576
ds_read_b64_tr_b16 a[162:163], v1 offset:25600
buffer_load_dwordx4 v6, s[20:23], s52 offen offset:2048 lds
v_mfma_f32_32x32x16_bf16 v[48:63], a[172:175], a[36:39], v[48:63]
ds_read_b64_tr_b16 a[164:165], v2 offset:24576
ds_read_b64_tr_b16 a[166:167], v2 offset:25600
s_add_u32 s99, s63, 5
s_sub_u32 s3, s99, 10
s_cselect_b32 s99, s99, s3
s_lshl_b32 s99, s99, 12
s_add_u32 s99, s99, s98
buffer_load_dwordx4 a[80:83], v0, s[32:35], s99 offen sc1
v_cmp_gt_u32 vcc, 32, v3
v_mul_f32 v9, v64, v8
s_nop 0
v_cndmask_b32 v64, 0, v64, vcc
v_and_b32 v66, 0xffff0000, v64
v_sub_f32 v67, v64, v66
v_lshrrev_b32 v64, 16, v64
s_waitcnt lgkmcnt(8)
v_mfma_f32_32x32x16_bf16 v[32:47], a[176:179], a[40:43], v[32:47]
ds_read_b64_tr_b16 a[168:169], v1 offset:26624
ds_read_b64_tr_b16 a[170:171], v1 offset:27648
buffer_load_dwordx4 v7, s[20:23], s52 offen offset:3072 lds
v_mfma_f32_32x32x16_bf16 v[48:63], a[180:183], a[40:43], v[48:63]
ds_read_b64_tr_b16 a[172:173], v2 offset:26624
ds_read_b64_tr_b16 a[174:175], v2 offset:27648
buffer_load_dwordx4 a[84:87], v0, s[32:35], s99 offen offset:1024 sc1
s_waitcnt lgkmcnt(8)
v_mfma_f32_32x32x16_bf16 v[32:47], a[184:187], a[44:47], v[32:47]
ds_read_b64_tr_b16 a[176:177], v1 offset:28672
ds_read_b64_tr_b16 a[178:179], v1 offset:29696
buffer_load_dwordx4 a[88:91], v0, s[32:35], s99 offen offset:2048 sc1
v_mfma_f32_32x32x16_bf16 v[48:63], a[188:191], a[44:47], v[48:63]
ds_read_b64_tr_b16 a[180:181], v2 offset:28672
ds_read_b64_tr_b16 a[182:183], v2 offset:29696
v_or_b32 v66, v66, v64
v_lshrrev_b32 v67, 16, v67
v_accvgpr_write_b32 a196, v66
v_accvgpr_write_b32 a197, v67
v_rcp_f32 v12, v8
v_mul_f32 v10, 0xc0135761, v8
s_waitcnt lgkmcnt(8)
s_waitcnt vmcnt(22)
v_mfma_f32_32x32x16_bf16 v[32:47], a[160:163], a[48:51], v[32:47]
ds_read_b64_tr_b16 a[184:185], v1 offset:30720
ds_read_b64_tr_b16 a[186:187], v1 offset:31744
buffer_load_dwordx4 a[92:95], v0, s[32:35], s99 offen offset:3072 sc1
v_mfma_f32_32x32x16_bf16 v[48:63], a[164:167], a[48:51], v[48:63]
ds_read_b64_tr_b16 a[188:189], v2 offset:30720
ds_read_b64_tr_b16 a[190:191], v2 offset:31744
v_mul_f32 v66, v8, v8
v_mul_f32 v66, v66, v8
v_mul_f32 v11, 0xbdd2d3e8, v66
v_mov_b32 v152, 0
v_mov_b32 v153, 0
s_waitcnt lgkmcnt(8)
s_waitcnt vmcnt(21)
v_mfma_f32_32x32x16_bf16 v[32:47], a[168:171], a[52:55], v[32:47]
s_barrier
ds_read_b64_tr_b16 a[160:161], v1 offset:32768
ds_read_b64_tr_b16 a[162:163], v1 offset:33792
s_add_u32 m0, s41, 0
s_add_u32 s51, s63, 8
v_mfma_f32_32x32x16_bf16 v[48:63], a[172:175], a[52:55], v[48:63]
ds_read_b64_tr_b16 a[164:165], v2 offset:32768
ds_read_b64_tr_b16 a[166:167], v2 offset:33792
s_sub_u32 s52, s51, 10
s_cselect_b32 s51, s51, s52
s_mul_i32 s52, s51, s53
s_add_u32 s99, s63, 6
s_sub_u32 s3, s99, 10
s_cselect_b32 s99, s99, s3
s_lshl_b32 s99, s99, 12
s_add_u32 s99, s99, s98
buffer_load_dwordx4 a[96:99], v0, s[32:35], s99 offen sc1
s_waitcnt lgkmcnt(8)
s_waitcnt vmcnt(17)
v_mfma_f32_32x32x16_bf16 v[32:47], a[176:179], a[56:59], v[32:47]
ds_read_b64_tr_b16 a[168:169], v1 offset:34816
ds_read_b64_tr_b16 a[170:171], v1 offset:35840
s_add_u32 s52, s52, s58
s_add_u32 s52, s52, 128
v_mfma_f32_32x32x16_bf16 v[48:63], a[180:183], a[56:59], v[48:63]
ds_read_b64_tr_b16 a[172:173], v2 offset:34816
ds_read_b64_tr_b16 a[174:175], v2 offset:35840
buffer_load_dwordx4 v4, s[20:23], s52 offen lds
buffer_load_dwordx4 a[100:103], v0, s[32:35], s99 offen offset:1024 sc1
s_waitcnt lgkmcnt(8)
s_waitcnt vmcnt(17)
v_mfma_f32_32x32x16_bf16 v[32:47], a[184:187], a[60:63], v[32:47]
ds_read_b64_tr_b16 a[176:177], v1 offset:36864
ds_read_b64_tr_b16 a[178:179], v1 offset:37888
buffer_load_dwordx4 v5, s[20:23], s52 offen offset:1024 lds
v_mfma_f32_32x32x16_bf16 v[48:63], a[188:191], a[60:63], v[48:63]
ds_read_b64_tr_b16 a[180:181], v2 offset:36864
ds_read_b64_tr_b16 a[182:183], v2 offset:37888
buffer_load_dwordx4 a[104:107], v0, s[32:35], s99 offen offset:2048 sc1
v_add_f32 v101, v101, v102
v_add_f32 v103, v103, v100
v_cmp_gt_u32 vcc, 32, v3
v_add_f32 v101, v101, v103
s_nop 0
v_cndmask_b32 v100, v100, v101, vcc
v_mov_b32 v101, v100
s_nop 1
v_permlane32_swap_b32 v100, v101
v_add_f32 v100, v100, v101
v_and_b32 v22, 0xffff0000, v100
v_sub_f32 v22, v100, v22
v_lshrrev_b32 v23, 16, v100
v_and_or_b32 v22, v22, s78, v23
v_mov_b32 v144, v22
v_mov_b32 v145, v23
s_waitcnt lgkmcnt(8)
s_waitcnt vmcnt(18)
v_mfma_f32_32x32x16_bf16 v[32:47], a[160:163], a[64:67], v[32:47]
ds_read_b64_tr_b16 a[184:185], v1 offset:38912
ds_read_b64_tr_b16 a[186:187], v1 offset:39936
buffer_load_dwordx4 a[108:111], v0, s[32:35], s99 offen offset:3072 sc1
v_mfma_f32_32x32x16_bf16 v[48:63], a[164:167], a[64:67], v[48:63]
ds_read_b64_tr_b16 a[188:189], v2 offset:38912
ds_read_b64_tr_b16 a[190:191], v2 offset:39936
s_add_u32 s99, s63, 7
s_sub_u32 s3, s99, 10
s_cselect_b32 s99, s99, s3
s_waitcnt lgkmcnt(8)
s_waitcnt vmcnt(16)
v_mfma_f32_32x32x16_bf16 v[32:47], a[168:171], a[68:71], v[32:47]
ds_read_b64_tr_b16 a[160:161], v1 offset:40960
ds_read_b64_tr_b16 a[162:163], v1 offset:41984
buffer_load_dwordx4 v6, s[20:23], s52 offen offset:2048 lds
v_mfma_f32_32x32x16_bf16 v[48:63], a[172:175], a[68:71], v[48:63]
ds_read_b64_tr_b16 a[164:165], v2 offset:40960
ds_read_b64_tr_b16 a[166:167], v2 offset:41984
s_lshl_b32 s99, s99, 12
s_add_u32 s99, s99, s98
buffer_load_dwordx4 a[112:115], v0, s[32:35], s99 offen sc1
s_waitcnt lgkmcnt(8)
s_waitcnt vmcnt(15)
v_mfma_f32_32x32x16_bf16 v[32:47], a[176:179], a[72:75], v[32:47]
ds_read_b64_tr_b16 a[168:169], v1 offset:43008
ds_read_b64_tr_b16 a[170:171], v1 offset:44032
buffer_load_dwordx4 v7, s[20:23], s52 offen offset:3072 lds
v_mfma_f32_32x32x16_bf16 v[48:63], a[180:183], a[72:75], v[48:63]
ds_read_b64_tr_b16 a[172:173], v2 offset:43008
ds_read_b64_tr_b16 a[174:175], v2 offset:44032
buffer_load_dwordx4 a[116:119], v0, s[32:35], s99 offen offset:1024 sc1
s_waitcnt lgkmcnt(8)
s_waitcnt vmcnt(16)
v_mfma_f32_32x32x16_bf16 v[32:47], a[184:187], a[76:79], v[32:47]
ds_read_b64_tr_b16 a[176:177], v1 offset:45056
ds_read_b64_tr_b16 a[178:179], v1 offset:46080
buffer_load_dwordx4 a[120:123], v0, s[32:35], s99 offen offset:2048 sc1
v_mfma_f32_32x32x16_bf16 v[48:63], a[188:191], a[76:79], v[48:63]
ds_read_b64_tr_b16 a[180:181], v2 offset:45056
ds_read_b64_tr_b16 a[182:183], v2 offset:46080
s_waitcnt lgkmcnt(8)
s_waitcnt vmcnt(15)
v_mfma_f32_32x32x16_bf16 v[32:47], a[160:163], a[80:83], v[32:47]
ds_read_b64_tr_b16 a[184:185], v1 offset:47104
ds_read_b64_tr_b16 a[186:187], v1 offset:48128
buffer_load_dwordx4 a[124:127], v0, s[32:35], s99 offen offset:3072 sc1
v_mfma_f32_32x32x16_bf16 v[48:63], a[164:167], a[80:83], v[48:63]
ds_read_b64_tr_b16 a[188:189], v2 offset:47104
ds_read_b64_tr_b16 a[190:191], v2 offset:48128
v_add_f32 v105, v105, v106
v_add_f32 v107, v107, v104
v_cmp_gt_u32 vcc, 32, v3
v_add_f32 v105, v105, v107
s_nop 0
v_cndmask_b32 v104, v104, v105, vcc
v_mov_b32 v105, v104
s_nop 1
v_permlane32_swap_b32 v104, v105
v_add_f32 v104, v104, v105
v_and_b32 v22, 0xffff0000, v104
v_sub_f32 v22, v104, v22
v_lshrrev_b32 v23, 16, v104
v_and_or_b32 v22, v22, s78, v23
v_mov_b32 v146, v22
v_mov_b32 v147, v23
s_waitcnt lgkmcnt(8)
s_waitcnt vmcnt(14)
v_mfma_f32_32x32x16_bf16 v[32:47], a[168:171], a[84:87], v[32:47]
s_barrier
ds_read_b64_tr_b16 a[160:161], v1 offset:49152
ds_read_b64_tr_b16 a[162:163], v1 offset:50176
s_movk_i32 s96, 1280
v_lshrrev_b32 v4, 3, v3
v_mfma_f32_32x32x16_bf16 v[48:63], a[172:175], a[84:87], v[48:63]
ds_read_b64_tr_b16 a[164:165], v2 offset:49152
ds_read_b64_tr_b16 a[166:167], v2 offset:50176
s_lshl_b32 s53, s40, 5
s_lshr_b32 s52, s40, 1
s_mul_i32 s52, s52, 64
s_add_u32 s99, s63, 8
s_sub_u32 s3, s99, 10
s_cselect_b32 s99, s99, s3
s_lshl_b32 s99, s99, 12
s_add_u32 s99, s99, s98
buffer_load_dwordx4 a[128:131], v0, s[32:35], s99 offen sc1
s_waitcnt lgkmcnt(8)
s_waitcnt vmcnt(14)
v_mfma_f32_32x32x16_bf16 v[32:47], a[176:179], a[88:91], v[32:47]
ds_read_b64_tr_b16 a[168:169], v1 offset:51200
ds_read_b64_tr_b16 a[170:171], v1 offset:52224
s_add_u32 s53, s53, s52
v_add_u32 v4, s53, v4
v_bfe_u32 v5, v3, 4, 1
v_lshlrev_b32 v5, 2, v5
v_mfma_f32_32x32x16_bf16 v[48:63], a[180:183], a[88:91], v[48:63]
ds_read_b64_tr_b16 a[172:173], v2 offset:51200
ds_read_b64_tr_b16 a[174:175], v2 offset:52224
v_and_b32 v6, 7, v3
v_xor_b32 v5, v5, v6
v_lshlrev_b32 v5, 4, v5
v_mad_u32_u24 v4, v4, s96, v5
s_lshl_b32 s53, s96, 3
s_sub_u32 s53, s53, 1024
v_add_u32 v4, s56, v4
v_add_u32 v5, s53, v4
v_add_u32 v6, s53, v5
v_add_u32 v7, s53, v6
s_lshl_b32 s53, s96, 6
s_add_u32 m0, s41, 147456
s_add_u32 s52, s55, 0
buffer_load_dwordx4 v4, s[24:27], s52 offen lds
buffer_load_dwordx4 a[132:135], v0, s[32:35], s99 offen offset:1024 sc1
s_waitcnt lgkmcnt(8)
s_waitcnt vmcnt(15)
v_mfma_f32_32x32x16_bf16 v[32:47], a[184:187], a[92:95], v[32:47]
ds_read_b64_tr_b16 a[176:177], v1 offset:53248
ds_read_b64_tr_b16 a[178:179], v1 offset:54272
buffer_load_dwordx4 v5, s[24:27], s52 offen offset:1024 lds
v_mfma_f32_32x32x16_bf16 v[48:63], a[188:191], a[92:95], v[48:63]
ds_read_b64_tr_b16 a[180:181], v2 offset:53248
ds_read_b64_tr_b16 a[182:183], v2 offset:54272
buffer_load_dwordx4 a[136:139], v0, s[32:35], s99 offen offset:2048 sc1
s_waitcnt lgkmcnt(8)
s_waitcnt vmcnt(16)
v_mfma_f32_32x32x16_bf16 v[32:47], a[160:163], a[96:99], v[32:47]
ds_read_b64_tr_b16 a[184:185], v1 offset:55296
ds_read_b64_tr_b16 a[186:187], v1 offset:56320
buffer_load_dwordx4 v6, s[24:27], s52 offen offset:2048 lds
v_mfma_f32_32x32x16_bf16 v[48:63], a[164:167], a[96:99], v[48:63]
ds_read_b64_tr_b16 a[188:189], v2 offset:55296
ds_read_b64_tr_b16 a[190:191], v2 offset:56320
buffer_load_dwordx4 a[140:143], v0, s[32:35], s99 offen offset:3072 sc1
s_waitcnt lgkmcnt(8)
s_waitcnt vmcnt(16)
v_mfma_f32_32x32x16_bf16 v[32:47], a[168:171], a[100:103], v[32:47]
ds_read_b64_tr_b16 a[160:161], v1 offset:57344
ds_read_b64_tr_b16 a[162:163], v1 offset:58368
buffer_load_dwordx4 v7, s[24:27], s52 offen offset:3072 lds
v_mfma_f32_32x32x16_bf16 v[48:63], a[172:175], a[100:103], v[48:63]
ds_read_b64_tr_b16 a[164:165], v2 offset:57344
ds_read_b64_tr_b16 a[166:167], v2 offset:58368
s_add_u32 m0, s41, 16384
s_add_u32 s52, s55, 1802240
s_add_u32 s99, s63, 9
s_sub_u32 s3, s99, 10
s_cselect_b32 s99, s99, s3
s_lshl_b32 s99, s99, 12
s_add_u32 s99, s99, s98
buffer_load_dwordx4 a[144:147], v0, s[32:35], s99 offen sc1
v_add_f32 v109, v109, v110
v_add_f32 v111, v111, v108
v_cmp_gt_u32 vcc, 32, v3
v_add_f32 v109, v109, v111
s_nop 0
v_cndmask_b32 v108, v108, v109, vcc
v_mov_b32 v109, v108
s_nop 1
v_permlane32_swap_b32 v108, v109
v_add_f32 v108, v108, v109
v_and_b32 v22, 0xffff0000, v108
v_sub_f32 v22, v108, v22
v_lshrrev_b32 v23, 16, v108
v_and_or_b32 v22, v22, s78, v23
v_mov_b32 v148, v22
v_mov_b32 v149, v23
s_waitcnt lgkmcnt(8)
s_waitcnt vmcnt(16)
v_mfma_f32_32x32x16_bf16 v[32:47], a[176:179], a[104:107], v[32:47]
ds_read_b64_tr_b16 a[168:169], v1 offset:59392
ds_read_b64_tr_b16 a[170:171], v1 offset:60416
buffer_load_dwordx4 v4, s[24:27], s52 offen lds
v_mfma_f32_32x32x16_bf16 v[48:63], a[180:183], a[104:107], v[48:63]
ds_read_b64_tr_b16 a[172:173], v2 offset:59392
ds_read_b64_tr_b16 a[174:175], v2 offset:60416
buffer_load_dwordx4 v5, s[24:27], s52 offen offset:1024 lds
buffer_load_dwordx4 a[148:151], v0, s[32:35], s99 offen offset:1024 sc1
s_waitcnt lgkmcnt(8)
s_waitcnt vmcnt(18)
v_mfma_f32_32x32x16_bf16 v[32:47], a[184:187], a[108:111], v[32:47]
ds_read_b64_tr_b16 a[176:177], v1 offset:61440
ds_read_b64_tr_b16 a[178:179], v1 offset:62464
buffer_load_dwordx4 v6, s[24:27], s52 offen offset:2048 lds
v_mfma_f32_32x32x16_bf16 v[48:63], a[188:191], a[108:111], v[48:63]
ds_read_b64_tr_b16 a[180:181], v2 offset:61440
ds_read_b64_tr_b16 a[182:183], v2 offset:62464
buffer_load_dwordx4 a[152:155], v0, s[32:35], s99 offen offset:2048 sc1
s_waitcnt lgkmcnt(8)
s_waitcnt vmcnt(18)
v_mfma_f32_32x32x16_bf16 v[32:47], a[160:163], a[112:115], v[32:47]
ds_read_b64_tr_b16 a[184:185], v1 offset:63488
ds_read_b64_tr_b16 a[186:187], v1 offset:64512
buffer_load_dwordx4 v7, s[24:27], s52 offen offset:3072 lds
v_mfma_f32_32x32x16_bf16 v[48:63], a[164:167], a[112:115], v[48:63]
ds_read_b64_tr_b16 a[188:189], v2 offset:63488
ds_read_b64_tr_b16 a[190:191], v2 offset:64512
buffer_load_dwordx4 a[156:159], v0, s[32:35], s99 offen offset:3072 sc1
s_waitcnt lgkmcnt(8)
s_waitcnt vmcnt(18)
v_mfma_f32_32x32x16_bf16 v[32:47], a[168:171], a[116:119], v[32:47]
s_barrier
v_add_u32 v1, 65536, v1
v_add_u32 v2, 65536, v2
ds_read_b64_tr_b16 a[160:161], v1 offset:0
ds_read_b64_tr_b16 a[162:163], v1 offset:1024
v_mfma_f32_32x32x16_bf16 v[48:63], a[172:175], a[116:119], v[48:63]
ds_read_b64_tr_b16 a[164:165], v2 offset:0
ds_read_b64_tr_b16 a[166:167], v2 offset:1024
s_add_u32 m0, s41, 32768
s_add_u32 s52, s55, 81920
v_add_f32 v113, v113, v114
s_waitcnt lgkmcnt(8)
s_waitcnt vmcnt(17)
v_mfma_f32_32x32x16_bf16 v[32:47], a[176:179], a[120:123], v[32:47]
ds_read_b64_tr_b16 a[168:169], v1 offset:2048
ds_read_b64_tr_b16 a[170:171], v1 offset:3072
buffer_load_dwordx4 v4, s[24:27], s52 offen lds
v_mfma_f32_32x32x16_bf16 v[48:63], a[180:183], a[120:123], v[48:63]
ds_read_b64_tr_b16 a[172:173], v2 offset:2048
ds_read_b64_tr_b16 a[174:175], v2 offset:3072
v_add_f32 v115, v115, v112
v_cmp_gt_u32 vcc, 32, v3
v_add_f32 v113, v113, v115
s_nop 0
v_cndmask_b32 v112, v112, v113, vcc
v_mov_b32 v113, v112
s_nop 1
v_permlane32_swap_b32 v112, v113
v_add_f32 v112, v112, v113
v_and_b32 v22, 0xffff0000, v112
v_sub_f32 v22, v112, v22
v_lshrrev_b32 v23, 16, v112
v_and_or_b32 v22, v22, s78, v23
v_mov_b32 v150, v22
v_mov_b32 v151, v23
s_waitcnt lgkmcnt(8)
s_waitcnt vmcnt(17)
v_mfma_f32_32x32x16_bf16 v[32:47], a[184:187], a[124:127], v[32:47]
ds_read_b64_tr_b16 a[176:177], v1 offset:4096
ds_read_b64_tr_b16 a[178:179], v1 offset:5120
buffer_load_dwordx4 v5, s[24:27], s52 offen offset:1024 lds
v_mfma_f32_32x32x16_bf16 v[48:63], a[188:191], a[124:127], v[48:63]
ds_read_b64_tr_b16 a[180:181], v2 offset:4096
ds_read_b64_tr_b16 a[182:183], v2 offset:5120
s_waitcnt lgkmcnt(8)
s_waitcnt vmcnt(17)
v_mfma_f32_32x32x16_bf16 v[32:47], a[160:163], a[128:131], v[32:47]
ds_read_b64_tr_b16 a[184:185], v1 offset:6144
ds_read_b64_tr_b16 a[186:187], v1 offset:7168
v_mfma_f32_32x32x16_bf16 v[48:63], a[164:167], a[128:131], v[48:63]
ds_read_b64_tr_b16 a[188:189], v2 offset:6144
ds_read_b64_tr_b16 a[190:191], v2 offset:7168
s_waitcnt lgkmcnt(8)
s_waitcnt vmcnt(15)
v_mfma_f32_32x32x16_bf16 v[32:47], a[168:171], a[132:135], v[32:47]
ds_read_b64_tr_b16 a[160:161], v1 offset:8192
ds_read_b64_tr_b16 a[162:163], v1 offset:9216
buffer_load_dwordx4 v6, s[24:27], s52 offen offset:2048 lds
v_mfma_f32_32x32x16_bf16 v[48:63], a[172:175], a[132:135], v[48:63]
ds_read_b64_tr_b16 a[164:165], v2 offset:8192
ds_read_b64_tr_b16 a[166:167], v2 offset:9216
s_waitcnt lgkmcnt(8)
s_waitcnt vmcnt(14)
v_mfma_f32_32x32x16_bf16 v[32:47], a[176:179], a[136:139], v[32:47]
ds_read_b64_tr_b16 a[168:169], v1 offset:10240
ds_read_b64_tr_b16 a[170:171], v1 offset:11264
v_mfma_f32_32x32x16_bf16 v[48:63], a[180:183], a[136:139], v[48:63]
ds_read_b64_tr_b16 a[172:173], v2 offset:10240
ds_read_b64_tr_b16 a[174:175], v2 offset:11264
s_waitcnt lgkmcnt(8)
s_waitcnt vmcnt(12)
v_mfma_f32_32x32x16_bf16 v[32:47], a[184:187], a[140:143], v[32:47]
ds_read_b64_tr_b16 a[176:177], v1 offset:12288
ds_read_b64_tr_b16 a[178:179], v1 offset:13312
buffer_load_dwordx4 v7, s[24:27], s52 offen offset:3072 lds
v_mfma_f32_32x32x16_bf16 v[48:63], a[188:191], a[140:143], v[48:63]
ds_read_b64_tr_b16 a[180:181], v2 offset:12288
ds_read_b64_tr_b16 a[182:183], v2 offset:13312
v_mfma_f32_32x32x16_bf16 v[32:47], v[144:147], a[196:199], v[32:47]
s_waitcnt lgkmcnt(8)
s_waitcnt vmcnt(11)
v_mfma_f32_32x32x16_bf16 v[32:47], a[160:163], a[144:147], v[32:47]
ds_read_b64_tr_b16 a[184:185], v1 offset:14336
ds_read_b64_tr_b16 a[186:187], v1 offset:15360
v_mfma_f32_32x32x16_bf16 v[48:63], a[164:167], a[144:147], v[48:63]
ds_read_b64_tr_b16 a[188:189], v2 offset:14336
ds_read_b64_tr_b16 a[190:191], v2 offset:15360
v_mfma_f32_32x32x16_bf16 v[48:63], v[146:149], a[196:199], v[48:63]
s_waitcnt lgkmcnt(8)
s_waitcnt vmcnt(8)
v_mfma_f32_32x32x16_bf16 v[32:47], a[168:171], a[148:151], v[32:47]
s_barrier
ds_read_b64_tr_b16 a[160:161], v1 offset:16384
ds_read_b64_tr_b16 a[162:163], v1 offset:17408
s_add_u32 m0, s41, 49152
s_add_u32 s52, s55, 409600
v_mfma_f32_32x32x16_bf16 v[48:63], a[172:175], a[148:151], v[48:63]
ds_read_b64_tr_b16 a[164:165], v2 offset:16384
ds_read_b64_tr_b16 a[166:167], v2 offset:17408
s_waitcnt lgkmcnt(8)
s_waitcnt vmcnt(6)
v_mfma_f32_32x32x16_bf16 v[32:47], a[176:179], a[152:155], v[32:47]
ds_read_b64_tr_b16 a[168:169], v1 offset:18432
ds_read_b64_tr_b16 a[170:171], v1 offset:19456
buffer_load_dwordx4 v4, s[24:27], s52 offen lds
v_mfma_f32_32x32x16_bf16 v[48:63], a[180:183], a[152:155], v[48:63]
ds_read_b64_tr_b16 a[172:173], v2 offset:18432
ds_read_b64_tr_b16 a[174:175], v2 offset:19456
buffer_load_dwordx4 v5, s[24:27], s52 offen offset:1024 lds
v_mfma_f32_32x32x16_bf16 v[64:79], v[148:151], a[196:199], 0
buffer_load_dwordx4 v6, s[24:27], s52 offen offset:2048 lds
s_waitcnt lgkmcnt(8)
s_waitcnt vmcnt(7)
v_mfma_f32_32x32x16_bf16 v[32:47], a[184:187], a[156:159], v[32:47]
ds_read_b64_tr_b16 a[176:177], v1 offset:20480
ds_read_b64_tr_b16 a[178:179], v1 offset:21504
buffer_load_dwordx4 v7, s[24:27], s52 offen offset:3072 lds
v_mfma_f32_32x32x16_bf16 v[48:63], a[188:191], a[156:159], v[48:63]
ds_read_b64_tr_b16 a[180:181], v2 offset:20480
ds_read_b64_tr_b16 a[182:183], v2 offset:21504
v_mfma_f32_32x32x16_bf16 v[80:95], v[150:153], a[196:199], 0
s_waitcnt lgkmcnt(8)
v_mfma_f32_32x32x16_bf16 v[64:79], a[160:163], a[0:3], v[64:79]
ds_read_b64_tr_b16 a[184:185], v1 offset:22528
ds_read_b64_tr_b16 a[186:187], v1 offset:23552
v_mfma_f32_32x32x16_bf16 v[80:95], a[164:167], a[0:3], v[80:95]
ds_read_b64_tr_b16 a[188:189], v2 offset:22528
ds_read_b64_tr_b16 a[190:191], v2 offset:23552
s_waitcnt lgkmcnt(8)
v_mfma_f32_32x32x16_bf16 v[64:79], a[168:171], a[4:7], v[64:79]
ds_read_b64_tr_b16 a[160:161], v1 offset:24576
ds_read_b64_tr_b16 a[162:163], v1 offset:25600
v_mul_f32 v16, v32, v32
v_mul_f32 v17, v33, v33
v_mul_f32 v18, v34, v34
v_mul_f32 v19, v35, v35
v_fma_f32 v16, v16, v11, v10
v_fma_f32 v17, v17, v11, v10
v_fma_f32 v18, v18, v11, v10
v_fma_f32 v19, v19, v11, v10
v_mfma_f32_32x32x16_bf16 v[80:95], a[172:175], a[4:7], v[80:95]
ds_read_b64_tr_b16 a[164:165], v2 offset:24576
ds_read_b64_tr_b16 a[166:167], v2 offset:25600
v_mul_f32 v16, v16, v32
v_mul_f32 v17, v17, v33
v_mul_f32 v18, v18, v34
v_mul_f32 v19, v19, v35
v_exp_f32 v16, v16
s_waitcnt lgkmcnt(8)
v_mfma_f32_32x32x16_bf16 v[64:79], a[176:179], a[8:11], v[64:79]
ds_read_b64_tr_b16 a[168:169], v1 offset:26624
ds_read_b64_tr_b16 a[170:171], v1 offset:27648
v_exp_f32 v17, v17
v_exp_f32 v18, v18
v_exp_f32 v19, v19
v_fma_f32 v16, v16, v12, v12
v_fma_f32 v17, v17, v12, v12
v_fma_f32 v18, v18, v12, v12
v_mfma_f32_32x32x16_bf16 v[80:95], a[180:183], a[8:11], v[80:95]
ds_read_b64_tr_b16 a[172:173], v2 offset:26624
ds_read_b64_tr_b16 a[174:175], v2 offset:27648
v_fma_f32 v19, v19, v12, v12
v_rcp_f32 v16, v16
v_rcp_f32 v17, v17
v_rcp_f32 v18, v18
s_waitcnt lgkmcnt(8)
v_mfma_f32_32x32x16_bf16 v[64:79], a[184:187], a[12:15], v[64:79]
ds_read_b64_tr_b16 a[176:177], v1 offset:28672
ds_read_b64_tr_b16 a[178:179], v1 offset:29696
v_rcp_f32 v19, v19
v_mul_f32 v32, v32, v16
v_mul_f32 v33, v33, v17
v_mul_f32 v34, v34, v18
v_mul_f32 v35, v35, v19
v_mul_f32 v16, v36, v36
v_mfma_f32_32x32x16_bf16 v[80:95], a[188:191], a[12:15], v[80:95]
ds_read_b64_tr_b16 a[180:181], v2 offset:28672
ds_read_b64_tr_b16 a[182:183], v2 offset:29696
v_mul_f32 v17, v37, v37
v_mul_f32 v18, v38, v38
v_mul_f32 v19, v39, v39
v_fma_f32 v16, v16, v11, v10
v_fma_f32 v17, v17, v11, v10
v_fma_f32 v18, v18, v11, v10
v_fma_f32 v19, v19, v11, v10
s_waitcnt lgkmcnt(8)
v_mfma_f32_32x32x16_bf16 v[64:79], a[160:163], a[16:19], v[64:79]
ds_read_b64_tr_b16 a[184:185], v1 offset:30720
ds_read_b64_tr_b16 a[186:187], v1 offset:31744
v_mul_f32 v16, v16, v36
v_mul_f32 v17, v17, v37
v_mul_f32 v18, v18, v38
v_mul_f32 v19, v19, v39
v_exp_f32 v16, v16
v_exp_f32 v17, v17
v_mfma_f32_32x32x16_bf16 v[80:95], a[164:167], a[16:19], v[80:95]
ds_read_b64_tr_b16 a[188:189], v2 offset:30720
ds_read_b64_tr_b16 a[190:191], v2 offset:31744
v_exp_f32 v18, v18
v_exp_f32 v19, v19
v_fma_f32 v16, v16, v12, v12
v_fma_f32 v17, v17, v12, v12
v_fma_f32 v18, v18, v12, v12
s_waitcnt lgkmcnt(8)
v_mfma_f32_32x32x16_bf16 v[64:79], a[168:171], a[20:23], v[64:79]
s_barrier
ds_read_b64_tr_b16 a[160:161], v1 offset:32768
ds_read_b64_tr_b16 a[162:163], v1 offset:33792
s_add_u32 m0, s41, 65536
s_add_u32 s52, s55, 819200
v_fma_f32 v19, v19, v12, v12
v_rcp_f32 v16, v16
v_mfma_f32_32x32x16_bf16 v[80:95], a[172:175], a[20:23], v[80:95]
ds_read_b64_tr_b16 a[164:165], v2 offset:32768
ds_read_b64_tr_b16 a[166:167], v2 offset:33792
v_rcp_f32 v17, v17
v_rcp_f32 v18, v18
v_rcp_f32 v19, v19
v_mul_f32 v36, v36, v16
v_mul_f32 v37, v37, v17
s_waitcnt lgkmcnt(8)
v_mfma_f32_32x32x16_bf16 v[64:79], a[176:179], a[24:27], v[64:79]
ds_read_b64_tr_b16 a[168:169], v1 offset:34816
ds_read_b64_tr_b16 a[170:171], v1 offset:35840
buffer_load_dwordx4 v4, s[24:27], s52 offen lds
v_mul_f32 v38, v38, v18
v_mul_f32 v39, v39, v19
v_cvt_pk_bf16_f32 v32, v32, v33
v_cvt_pk_bf16_f32 v33, v34, v35
v_mfma_f32_32x32x16_bf16 v[80:95], a[180:183], a[24:27], v[80:95]
ds_read_b64_tr_b16 a[172:173], v2 offset:34816
ds_read_b64_tr_b16 a[174:175], v2 offset:35840
v_cvt_pk_bf16_f32 v34, v36, v37
v_cvt_pk_bf16_f32 v35, v38, v39
s_waitcnt lgkmcnt(8)
v_mfma_f32_32x32x16_bf16 v[64:79], a[184:187], a[28:31], v[64:79]
ds_read_b64_tr_b16 a[176:177], v1 offset:36864
ds_read_b64_tr_b16 a[178:179], v1 offset:37888
buffer_load_dwordx4 v5, s[24:27], s52 offen offset:1024 lds
buffer_store_dwordx4 v[32:35], v0, s[32:35], s64 offen sc1
v_mfma_f32_32x32x16_bf16 v[80:95], a[188:191], a[28:31], v[80:95]
ds_read_b64_tr_b16 a[180:181], v2 offset:36864
ds_read_b64_tr_b16 a[182:183], v2 offset:37888
v_mul_f32 v16, v40, v40
v_mul_f32 v17, v41, v41
v_mul_f32 v18, v42, v42
v_mul_f32 v19, v43, v43
v_fma_f32 v16, v16, v11, v10
v_fma_f32 v17, v17, v11, v10
s_waitcnt lgkmcnt(8)
v_mfma_f32_32x32x16_bf16 v[64:79], a[160:163], a[32:35], v[64:79]
ds_read_b64_tr_b16 a[184:185], v1 offset:38912
ds_read_b64_tr_b16 a[186:187], v1 offset:39936
v_fma_f32 v18, v18, v11, v10
v_fma_f32 v19, v19, v11, v10
v_mul_f32 v16, v16, v40
v_mul_f32 v17, v17, v41
v_mul_f32 v18, v18, v42
v_mul_f32 v19, v19, v43
v_exp_f32 v16, v16
v_mfma_f32_32x32x16_bf16 v[80:95], a[164:167], a[32:35], v[80:95]
ds_read_b64_tr_b16 a[188:189], v2 offset:38912
ds_read_b64_tr_b16 a[190:191], v2 offset:39936
v_exp_f32 v17, v17
v_exp_f32 v18, v18
v_exp_f32 v19, v19
v_fma_f32 v16, v16, v12, v12
s_waitcnt lgkmcnt(8)
v_mfma_f32_32x32x16_bf16 v[64:79], a[168:171], a[36:39], v[64:79]
ds_read_b64_tr_b16 a[160:161], v1 offset:40960
ds_read_b64_tr_b16 a[162:163], v1 offset:41984
buffer_load_dwordx4 v6, s[24:27], s52 offen offset:2048 lds
v_fma_f32 v17, v17, v12, v12
v_fma_f32 v18, v18, v12, v12
v_fma_f32 v19, v19, v12, v12
v_rcp_f32 v16, v16
v_mfma_f32_32x32x16_bf16 v[80:95], a[172:175], a[36:39], v[80:95]
ds_read_b64_tr_b16 a[164:165], v2 offset:40960
ds_read_b64_tr_b16 a[166:167], v2 offset:41984
v_rcp_f32 v17, v17
v_rcp_f32 v18, v18
v_rcp_f32 v19, v19
s_waitcnt lgkmcnt(8)
v_mfma_f32_32x32x16_bf16 v[64:79], a[176:179], a[40:43], v[64:79]
ds_read_b64_tr_b16 a[168:169], v1 offset:43008
ds_read_b64_tr_b16 a[170:171], v1 offset:44032
buffer_load_dwordx4 v7, s[24:27], s52 offen offset:3072 lds
v_mul_f32 v40, v40, v16
v_mul_f32 v41, v41, v17
v_mul_f32 v42, v42, v18
v_mul_f32 v43, v43, v19
v_mfma_f32_32x32x16_bf16 v[80:95], a[180:183], a[40:43], v[80:95]
ds_read_b64_tr_b16 a[172:173], v2 offset:43008
ds_read_b64_tr_b16 a[174:175], v2 offset:44032
v_mul_f32 v16, v44, v44
v_mul_f32 v17, v45, v45
v_mul_f32 v18, v46, v46
v_mul_f32 v19, v47, v47
v_fma_f32 v16, v16, v11, v10
v_fma_f32 v17, v17, v11, v10
v_fma_f32 v18, v18, v11, v10
s_waitcnt lgkmcnt(8)
v_mfma_f32_32x32x16_bf16 v[64:79], a[184:187], a[44:47], v[64:79]
ds_read_b64_tr_b16 a[176:177], v1 offset:45056
ds_read_b64_tr_b16 a[178:179], v1 offset:46080
v_fma_f32 v19, v19, v11, v10
v_mul_f32 v16, v16, v44
v_mul_f32 v17, v17, v45
v_mul_f32 v18, v18, v46
v_mul_f32 v19, v19, v47
v_exp_f32 v16, v16
v_mfma_f32_32x32x16_bf16 v[80:95], a[188:191], a[44:47], v[80:95]
ds_read_b64_tr_b16 a[180:181], v2 offset:45056
ds_read_b64_tr_b16 a[182:183], v2 offset:46080
v_exp_f32 v17, v17
v_exp_f32 v18, v18
v_exp_f32 v19, v19
v_fma_f32 v16, v16, v12, v12
v_fma_f32 v17, v17, v12, v12
s_waitcnt lgkmcnt(8)
v_mfma_f32_32x32x16_bf16 v[64:79], a[160:163], a[48:51], v[64:79]
ds_read_b64_tr_b16 a[184:185], v1 offset:47104
ds_read_b64_tr_b16 a[186:187], v1 offset:48128
v_fma_f32 v18, v18, v12, v12
v_fma_f32 v19, v19, v12, v12
v_rcp_f32 v16, v16
v_rcp_f32 v17, v17
v_rcp_f32 v18, v18
v_mfma_f32_32x32x16_bf16 v[80:95], a[164:167], a[48:51], v[80:95]
ds_read_b64_tr_b16 a[188:189], v2 offset:47104
ds_read_b64_tr_b16 a[190:191], v2 offset:48128
v_rcp_f32 v19, v19
v_mul_f32 v44, v44, v16
v_mul_f32 v45, v45, v17
v_mul_f32 v46, v46, v18
v_mul_f32 v47, v47, v19
v_cvt_pk_bf16_f32 v40, v40, v41
s_waitcnt lgkmcnt(8)
v_mfma_f32_32x32x16_bf16 v[64:79], a[168:171], a[52:55], v[64:79]
s_barrier
ds_read_b64_tr_b16 a[160:161], v1 offset:49152
ds_read_b64_tr_b16 a[162:163], v1 offset:50176
s_add_u32 m0, s41, 81920
s_add_u32 s52, s55, 1146880
v_cvt_pk_bf16_f32 v41, v42, v43
v_cvt_pk_bf16_f32 v42, v44, v45
v_cvt_pk_bf16_f32 v43, v46, v47
v_mfma_f32_32x32x16_bf16 v[80:95], a[172:175], a[52:55], v[80:95]
ds_read_b64_tr_b16 a[164:165], v2 offset:49152
ds_read_b64_tr_b16 a[166:167], v2 offset:50176
buffer_store_dwordx4 v[40:43], v0, s[32:35], s64 offen offset:1024 sc1
s_waitcnt lgkmcnt(8)
v_mfma_f32_32x32x16_bf16 v[64:79], a[176:179], a[56:59], v[64:79]
ds_read_b64_tr_b16 a[168:169], v1 offset:51200
ds_read_b64_tr_b16 a[170:171], v1 offset:52224
buffer_load_dwordx4 v4, s[24:27], s52 offen lds
v_mul_f32 v16, v48, v48
v_mul_f32 v17, v49, v49
v_mfma_f32_32x32x16_bf16 v[80:95], a[180:183], a[56:59], v[80:95]
ds_read_b64_tr_b16 a[172:173], v2 offset:51200
ds_read_b64_tr_b16 a[174:175], v2 offset:52224
v_mul_f32 v18, v50, v50
v_mul_f32 v19, v51, v51
v_fma_f32 v16, v16, v11, v10
v_fma_f32 v17, v17, v11, v10
v_fma_f32 v18, v18, v11, v10
v_fma_f32 v19, v19, v11, v10
s_waitcnt lgkmcnt(8)
v_mfma_f32_32x32x16_bf16 v[64:79], a[184:187], a[60:63], v[64:79]
ds_read_b64_tr_b16 a[176:177], v1 offset:53248
ds_read_b64_tr_b16 a[178:179], v1 offset:54272
buffer_load_dwordx4 v5, s[24:27], s52 offen offset:1024 lds
v_mul_f32 v16, v16, v48
v_mul_f32 v17, v17, v49
v_mul_f32 v18, v18, v50
v_mul_f32 v19, v19, v51
v_mfma_f32_32x32x16_bf16 v[80:95], a[188:191], a[60:63], v[80:95]
ds_read_b64_tr_b16 a[180:181], v2 offset:53248
ds_read_b64_tr_b16 a[182:183], v2 offset:54272
v_exp_f32 v16, v16
v_exp_f32 v17, v17
v_exp_f32 v18, v18
v_exp_f32 v19, v19
s_waitcnt lgkmcnt(8)
v_mfma_f32_32x32x16_bf16 v[64:79], a[160:163], a[64:67], v[64:79]
ds_read_b64_tr_b16 a[184:185], v1 offset:55296
ds_read_b64_tr_b16 a[186:187], v1 offset:56320
v_fma_f32 v16, v16, v12, v12
v_fma_f32 v17, v17, v12, v12
v_fma_f32 v18, v18, v12, v12
v_fma_f32 v19, v19, v12, v12
v_rcp_f32 v16, v16
v_rcp_f32 v17, v17
v_mfma_f32_32x32x16_bf16 v[80:95], a[164:167], a[64:67], v[80:95]
ds_read_b64_tr_b16 a[188:189], v2 offset:55296
ds_read_b64_tr_b16 a[190:191], v2 offset:56320
v_rcp_f32 v18, v18
v_rcp_f32 v19, v19
v_mul_f32 v48, v48, v16
v_mul_f32 v49, v49, v17
s_waitcnt lgkmcnt(8)
v_mfma_f32_32x32x16_bf16 v[64:79], a[168:171], a[68:71], v[64:79]
ds_read_b64_tr_b16 a[160:161], v1 offset:57344
ds_read_b64_tr_b16 a[162:163], v1 offset:58368
buffer_load_dwordx4 v6, s[24:27], s52 offen offset:2048 lds
v_mul_f32 v50, v50, v18
v_mul_f32 v51, v51, v19
v_mul_f32 v16, v52, v52
v_mul_f32 v17, v53, v53
v_mul_f32 v18, v54, v54
v_mfma_f32_32x32x16_bf16 v[80:95], a[172:175], a[68:71], v[80:95]
ds_read_b64_tr_b16 a[164:165], v2 offset:57344
ds_read_b64_tr_b16 a[166:167], v2 offset:58368
v_mul_f32 v19, v55, v55
v_fma_f32 v16, v16, v11, v10
v_fma_f32 v17, v17, v11, v10
v_fma_f32 v18, v18, v11, v10
v_fma_f32 v19, v19, v11, v10
v_mul_f32 v16, v16, v52
v_mul_f32 v17, v17, v53
s_waitcnt lgkmcnt(8)
v_mfma_f32_32x32x16_bf16 v[64:79], a[176:179], a[72:75], v[64:79]
ds_read_b64_tr_b16 a[168:169], v1 offset:59392
ds_read_b64_tr_b16 a[170:171], v1 offset:60416
buffer_load_dwordx4 v7, s[24:27], s52 offen offset:3072 lds
v_mul_f32 v18, v18, v54
v_mul_f32 v19, v19, v55
v_exp_f32 v16, v16
v_mfma_f32_32x32x16_bf16 v[80:95], a[180:183], a[72:75], v[80:95]
ds_read_b64_tr_b16 a[172:173], v2 offset:59392
ds_read_b64_tr_b16 a[174:175], v2 offset:60416
v_exp_f32 v17, v17
v_exp_f32 v18, v18
v_exp_f32 v19, v19
v_fma_f32 v16, v16, v12, v12
s_waitcnt lgkmcnt(8)
v_mfma_f32_32x32x16_bf16 v[64:79], a[184:187], a[76:79], v[64:79]
ds_read_b64_tr_b16 a[176:177], v1 offset:61440
ds_read_b64_tr_b16 a[178:179], v1 offset:62464
v_fma_f32 v17, v17, v12, v12
v_fma_f32 v18, v18, v12, v12
v_fma_f32 v19, v19, v12, v12
v_rcp_f32 v16, v16
v_rcp_f32 v17, v17
v_mfma_f32_32x32x16_bf16 v[80:95], a[188:191], a[76:79], v[80:95]
ds_read_b64_tr_b16 a[180:181], v2 offset:61440
ds_read_b64_tr_b16 a[182:183], v2 offset:62464
v_rcp_f32 v18, v18
v_rcp_f32 v19, v19
v_mul_f32 v52, v52, v16
v_mul_f32 v53, v53, v17
v_mul_f32 v54, v54, v18
s_waitcnt lgkmcnt(8)
v_mfma_f32_32x32x16_bf16 v[64:79], a[160:163], a[80:83], v[64:79]
ds_read_b64_tr_b16 a[184:185], v1 offset:63488
ds_read_b64_tr_b16 a[186:187], v1 offset:64512
s_getpc_b64 s[86:87]
L_pc52:
s_lshl_b32 s3, s42, 3
s_xor_b32 s3, s3, s43
s_lshl_b32 s3, s3, 2
v_mul_f32 v55, v55, v19
v_cvt_pk_bf16_f32 v48, v48, v49
v_cvt_pk_bf16_f32 v49, v50, v51
v_cvt_pk_bf16_f32 v50, v52, v53
v_mfma_f32_32x32x16_bf16 v[80:95], a[164:167], a[80:83], v[80:95]
ds_read_b64_tr_b16 a[188:189], v2 offset:63488
ds_read_b64_tr_b16 a[190:191], v2 offset:64512
s_add_u32 s3, s3, s40
s_mul_i32 s3, s3, 8
s_and_b32 s3, s3, 1023
v_cvt_pk_bf16_f32 v51, v54, v55
s_waitcnt lgkmcnt(8)
v_mfma_f32_32x32x16_bf16 v[64:79], a[168:171], a[84:87], v[64:79]
s_barrier
v_add_u32 v1, 65536, v1
v_add_u32 v2, 65536, v2
ds_read_b64_tr_b16 a[160:161], v1 offset:0
ds_read_b64_tr_b16 a[162:163], v1 offset:1024
buffer_store_dwordx4 v[48:51], v0, s[32:35], s64 offen offset:2048 sc1
v_mfma_f32_32x32x16_bf16 v[80:95], a[172:175], a[84:87], v[80:95]
ds_read_b64_tr_b16 a[164:165], v2 offset:0
ds_read_b64_tr_b16 a[166:167], v2 offset:1024
s_add_u32 m0, s41, 98304
s_add_u32 s52, s55, 327680
v_min_u32 v26, 7, v3
v_add_lshl_u32 v26, v26, s3, 7
v_min_u32 v26, L_codeend-L_pc52-4, v26
v_and_b32 v26, -4, v26
global_load_dword a223, v26, s[86:87]
s_waitcnt lgkmcnt(8)
v_mfma_f32_32x32x16_bf16 v[64:79], a[176:179], a[88:91], v[64:79]
ds_read_b64_tr_b16 a[168:169], v1 offset:2048
ds_read_b64_tr_b16 a[170:171], v1 offset:3072
buffer_load_dwordx4 v4, s[24:27], s52 offen lds
v_mul_f32 v16, v56, v56
v_mfma_f32_32x32x16_bf16 v[80:95], a[180:183], a[88:91], v[80:95]
ds_read_b64_tr_b16 a[172:173], v2 offset:2048
ds_read_b64_tr_b16 a[174:175], v2 offset:3072
v_mul_f32 v17, v57, v57
v_mul_f32 v18, v58, v58
v_mul_f32 v19, v59, v59
v_fma_f32 v16, v16, v11, v10
v_fma_f32 v17, v17, v11, v10
v_fma_f32 v18, v18, v11, v10
v_fma_f32 v19, v19, v11, v10
s_waitcnt lgkmcnt(8)
v_mfma_f32_32x32x16_bf16 v[64:79], a[184:187], a[92:95], v[64:79]
ds_read_b64_tr_b16 a[176:177], v1 offset:4096
ds_read_b64_tr_b16 a[178:179], v1 offset:5120
buffer_load_dwordx4 v5, s[24:27], s52 offen offset:1024 lds
v_mul_f32 v16, v16, v56
v_mul_f32 v17, v17, v57
v_mul_f32 v18, v18, v58
v_mul_f32 v19, v19, v59
v_mfma_f32_32x32x16_bf16 v[80:95], a[188:191], a[92:95], v[80:95]
ds_read_b64_tr_b16 a[180:181], v2 offset:4096
ds_read_b64_tr_b16 a[182:183], v2 offset:5120
v_exp_f32 v16, v16
v_exp_f32 v17, v17
v_exp_f32 v18, v18
v_exp_f32 v19, v19
s_waitcnt lgkmcnt(8)
v_mfma_f32_32x32x16_bf16 v[64:79], a[160:163], a[96:99], v[64:79]
ds_read_b64_tr_b16 a[184:185], v1 offset:6144
ds_read_b64_tr_b16 a[186:187], v1 offset:7168
v_fma_f32 v16, v16, v12, v12
v_fma_f32 v17, v17, v12, v12
v_fma_f32 v18, v18, v12, v12
v_fma_f32 v19, v19, v12, v12
v_rcp_f32 v16, v16
v_rcp_f32 v17, v17
v_mfma_f32_32x32x16_bf16 v[80:95], a[164:167], a[96:99], v[80:95]
ds_read_b64_tr_b16 a[188:189], v2 offset:6144
ds_read_b64_tr_b16 a[190:191], v2 offset:7168
v_rcp_f32 v18, v18
v_rcp_f32 v19, v19
v_mul_f32 v56, v56, v16
v_mul_f32 v57, v57, v17
s_waitcnt lgkmcnt(8)
v_mfma_f32_32x32x16_bf16 v[64:79], a[168:171], a[100:103], v[64:79]
ds_read_b64_tr_b16 a[160:161], v1 offset:8192
ds_read_b64_tr_b16 a[162:163], v1 offset:9216
buffer_load_dwordx4 v6, s[24:27], s52 offen offset:2048 lds
v_mul_f32 v58, v58, v18
v_mul_f32 v59, v59, v19
v_mul_f32 v16, v60, v60
v_mul_f32 v17, v61, v61
v_mul_f32 v18, v62, v62
v_mfma_f32_32x32x16_bf16 v[80:95], a[172:175], a[100:103], v[80:95]
ds_read_b64_tr_b16 a[164:165], v2 offset:8192
ds_read_b64_tr_b16 a[166:167], v2 offset:9216
v_mul_f32 v19, v63, v63
v_fma_f32 v16, v16, v11, v10
v_fma_f32 v17, v17, v11, v10
v_fma_f32 v18, v18, v11, v10
v_fma_f32 v19, v19, v11, v10
v_mul_f32 v16, v16, v60
s_waitcnt lgkmcnt(8)
v_mfma_f32_32x32x16_bf16 v[64:79], a[176:179], a[104:107], v[64:79]
ds_read_b64_tr_b16 a[168:169], v1 offset:10240
ds_read_b64_tr_b16 a[170:171], v1 offset:11264
buffer_load_dwordx4 v7, s[24:27], s52 offen offset:3072 lds
v_mul_f32 v17, v17, v61
v_mul_f32 v18, v18, v62
v_mul_f32 v19, v19, v63
v_exp_f32 v16, v16
v_mfma_f32_32x32x16_bf16 v[80:95], a[180:183], a[104:107], v[80:95]
ds_read_b64_tr_b16 a[172:173], v2 offset:10240
ds_read_b64_tr_b16 a[174:175], v2 offset:11264
v_exp_f32 v17, v17
v_exp_f32 v18, v18
v_exp_f32 v19, v19
v_fma_f32 v16, v16, v12, v12
s_waitcnt lgkmcnt(8)
v_mfma_f32_32x32x16_bf16 v[64:79], a[184:187], a[108:111], v[64:79]
ds_read_b64_tr_b16 a[176:177], v1 offset:12288
ds_read_b64_tr_b16 a[178:179], v1 offset:13312
v_fma_f32 v17, v17, v12, v12
v_fma_f32 v18, v18, v12, v12
v_fma_f32 v19, v19, v12, v12
v_rcp_f32 v16, v16
v_rcp_f32 v17, v17
v_mfma_f32_32x32x16_bf16 v[80:95], a[188:191], a[108:111], v[80:95]
ds_read_b64_tr_b16 a[180:181], v2 offset:12288
ds_read_b64_tr_b16 a[182:183], v2 offset:13312
v_rcp_f32 v18, v18
v_rcp_f32 v19, v19
v_mul_f32 v60, v60, v16
v_mul_f32 v61, v61, v17
v_mul_f32 v62, v62, v18
s_waitcnt lgkmcnt(8)
v_mfma_f32_32x32x16_bf16 v[64:79], a[160:163], a[112:115], v[64:79]
ds_read_b64_tr_b16 a[184:185], v1 offset:14336
ds_read_b64_tr_b16 a[186:187], v1 offset:15360
v_mul_f32 v63, v63, v19
v_cvt_pk_bf16_f32 v56, v56, v57
v_cvt_pk_bf16_f32 v57, v58, v59
v_cvt_pk_bf16_f32 v58, v60, v61
v_cvt_pk_bf16_f32 v59, v62, v63
v_mfma_f32_32x32x16_bf16 v[80:95], a[164:167], a[112:115], v[80:95]
ds_read_b64_tr_b16 a[188:189], v2 offset:14336
ds_read_b64_tr_b16 a[190:191], v2 offset:15360
buffer_store_dwordx4 v[56:59], v0, s[32:35], s64 offen offset:3072 sc1
s_waitcnt lgkmcnt(8)
v_mfma_f32_32x32x16_bf16 v[64:79], a[168:171], a[116:119], v[64:79]
s_barrier
v_subrev_u32 v1, 131072, v1
v_subrev_u32 v2, 131072, v2
ds_read_b64_tr_b16 a[160:161], v1 offset:0
ds_read_b64_tr_b16 a[162:163], v1 offset:1024
v_mfma_f32_32x32x16_bf16 v[80:95], a[172:175], a[116:119], v[80:95]
ds_read_b64_tr_b16 a[164:165], v2 offset:0
ds_read_b64_tr_b16 a[166:167], v2 offset:1024
s_add_u32 m0, s41, 114688
s_add_u32 s52, s55, 737280
s_waitcnt lgkmcnt(8)
v_mfma_f32_32x32x16_bf16 v[64:79], a[176:179], a[120:123], v[64:79]
ds_read_b64_tr_b16 a[168:169], v1 offset:2048
ds_read_b64_tr_b16 a[170:171], v1 offset:3072
buffer_load_dwordx4 v4, s[24:27], s52 offen lds
v_mfma_f32_32x32x16_bf16 v[80:95], a[180:183], a[120:123], v[80:95]
ds_read_b64_tr_b16 a[172:173], v2 offset:2048
ds_read_b64_tr_b16 a[174:175], v2 offset:3072
s_waitcnt lgkmcnt(8)
v_mfma_f32_32x32x16_bf16 v[64:79], a[184:187], a[124:127], v[64:79]
ds_read_b64_tr_b16 a[176:177], v1 offset:4096
ds_read_b64_tr_b16 a[178:179], v1 offset:5120
buffer_load_dwordx4 v5, s[24:27], s52 offen offset:1024 lds
v_mfma_f32_32x32x16_bf16 v[80:95], a[188:191], a[124:127], v[80:95]
ds_read_b64_tr_b16 a[180:181], v2 offset:4096
ds_read_b64_tr_b16 a[182:183], v2 offset:5120
s_waitcnt lgkmcnt(8)
v_mfma_f32_32x32x16_bf16 v[64:79], a[160:163], a[128:131], v[64:79]
ds_read_b64_tr_b16 a[184:185], v1 offset:6144
ds_read_b64_tr_b16 a[186:187], v1 offset:7168
s_waitcnt vmcnt(2)
buffer_atomic_add v14, v13, s[32:35], s79 offen sc1
v_mfma_f32_32x32x16_bf16 v[80:95], a[164:167], a[128:131], v[80:95]
ds_read_b64_tr_b16 a[188:189], v2 offset:6144
ds_read_b64_tr_b16 a[190:191], v2 offset:7168
s_waitcnt lgkmcnt(8)
v_mfma_f32_32x32x16_bf16 v[64:79], a[168:171], a[132:135], v[64:79]
ds_read_b64_tr_b16 a[160:161], v1 offset:8192
ds_read_b64_tr_b16 a[162:163], v1 offset:9216
buffer_load_dwordx4 v6, s[24:27], s52 offen offset:2048 lds
v_mfma_f32_32x32x16_bf16 v[80:95], a[172:175], a[132:135], v[80:95]
ds_read_b64_tr_b16 a[164:165], v2 offset:8192
ds_read_b64_tr_b16 a[166:167], v2 offset:9216
s_waitcnt lgkmcnt(8)
v_mfma_f32_32x32x16_bf16 v[64:79], a[176:179], a[136:139], v[64:79]
ds_read_b64_tr_b16 a[168:169], v1 offset:10240
ds_read_b64_tr_b16 a[170:171], v1 offset:11264
buffer_load_dwordx4 v7, s[24:27], s52 offen offset:3072 lds
v_mfma_f32_32x32x16_bf16 v[80:95], a[180:183], a[136:139], v[80:95]
ds_read_b64_tr_b16 a[172:173], v2 offset:10240
ds_read_b64_tr_b16 a[174:175], v2 offset:11264
s_waitcnt lgkmcnt(8)
v_mfma_f32_32x32x16_bf16 v[64:79], a[184:187], a[140:143], v[64:79]
ds_read_b64_tr_b16 a[176:177], v1 offset:12288
ds_read_b64_tr_b16 a[178:179], v1 offset:13312
v_mfma_f32_32x32x16_bf16 v[80:95], a[188:191], a[140:143], v[80:95]
ds_read_b64_tr_b16 a[180:181], v2 offset:12288
ds_read_b64_tr_b16 a[182:183], v2 offset:13312
s_waitcnt lgkmcnt(8)
v_mfma_f32_32x32x16_bf16 v[64:79], a[160:163], a[144:147], v[64:79]
ds_read_b64_tr_b16 a[184:185], v1 offset:14336
ds_read_b64_tr_b16 a[186:187], v1 offset:15360
s_lshl_b32 s6, s54, 9
s_add_u32 s6, s6, 32768
v_mfma_f32_32x32x16_bf16 v[80:95], a[164:167], a[144:147], v[80:95]
ds_read_b64_tr_b16 a[188:189], v2 offset:14336
ds_read_b64_tr_b16 a[190:191], v2 offset:15360
s_waitcnt lgkmcnt(8)
v_mfma_f32_32x32x16_bf16 v[64:79], a[168:171], a[148:151], v[64:79]
buffer_load_dword v29, off, s[32:35], s6 sc1
s_mul_i32 s98, s54, 110592
s_add_u32 s98, s98, 19005440
v_mfma_f32_32x32x16_bf16 v[80:95], a[172:175], a[148:151], v[80:95]
s_mul_i32 s3, s61, 12
s_cmp_eq_u32 s61, 0
s_cselect_b32 s98, 1073741824, s98
s_waitcnt lgkmcnt(4)
v_mfma_f32_32x32x16_bf16 v[64:79], a[176:179], a[152:155], v[64:79]
v_mfma_f32_32x32x16_bf16 v[80:95], a[180:183], a[152:155], v[80:95]
s_waitcnt lgkmcnt(0)
v_mfma_f32_32x32x16_bf16 v[64:79], a[184:187], a[156:159], v[64:79]
v_mfma_f32_32x32x16_bf16 v[80:95], a[188:191], a[156:159], v[80:95]
s_barrier
s_add_u32 m0, s41, 131072
s_add_u32 s52, s55, 1064960
buffer_load_dwordx4 v4, s[24:27], s52 offen lds
s_nop 6
v_pk_mul_f32 v[16:17], v[64:65], v[64:65]
v_pk_mul_f32 v[18:19], v[66:67], v[66:67]
v_pk_fma_f32 v[16:17], v[16:17], v[10:11], v[10:11] op_sel:[0,1,0] op_sel_hi:[1,1,0]
v_pk_fma_f32 v[18:19], v[18:19], v[10:11], v[10:11] op_sel:[0,1,0] op_sel_hi:[1,1,0]
v_pk_mul_f32 v[16:17], v[16:17], v[64:65]
v_pk_mul_f32 v[18:19], v[18:19], v[66:67]
v_exp_f32 v16, v16
v_exp_f32 v17, v17
v_exp_f32 v18, v18
v_exp_f32 v19, v19
v_pk_fma_f32 v[16:17], v[16:17], v[12:13], v[12:13] op_sel_hi:[1,0,0]
v_pk_fma_f32 v[18:19], v[18:19], v[12:13], v[12:13] op_sel_hi:[1,0,0]
v_rcp_f32 v16, v16
v_rcp_f32 v17, v17
v_rcp_f32 v18, v18
v_rcp_f32 v19, v19
v_pk_mul_f32 v[64:65], v[64:65], v[16:17]
v_pk_mul_f32 v[66:67], v[66:67], v[18:19]
v_pk_mul_f32 v[16:17], v[68:69], v[68:69]
v_pk_mul_f32 v[18:19], v[70:71], v[70:71]
buffer_load_dwordx4 v5, s[24:27], s52 offen offset:1024 lds
v_pk_fma_f32 v[16:17], v[16:17], v[10:11], v[10:11] op_sel:[0,1,0] op_sel_hi:[1,1,0]
v_pk_fma_f32 v[18:19], v[18:19], v[10:11], v[10:11] op_sel:[0,1,0] op_sel_hi:[1,1,0]
v_pk_mul_f32 v[16:17], v[16:17], v[68:69]
v_pk_mul_f32 v[18:19], v[18:19], v[70:71]
v_exp_f32 v16, v16
v_exp_f32 v17, v17
v_exp_f32 v18, v18
v_exp_f32 v19, v19
v_pk_fma_f32 v[16:17], v[16:17], v[12:13], v[12:13] op_sel_hi:[1,0,0]
v_pk_fma_f32 v[18:19], v[18:19], v[12:13], v[12:13] op_sel_hi:[1,0,0]
v_rcp_f32 v16, v16
v_rcp_f32 v17, v17
v_rcp_f32 v18, v18
v_rcp_f32 v19, v19
v_pk_mul_f32 v[68:69], v[68:69], v[16:17]
v_pk_mul_f32 v[70:71], v[70:71], v[18:19]
v_cvt_pk_bf16_f32 v64, v64, v65
v_cvt_pk_bf16_f32 v65, v66, v67
v_cvt_pk_bf16_f32 v66, v68, v69
v_cvt_pk_bf16_f32 v67, v70, v71
buffer_load_dwordx4 v6, s[24:27], s52 offen offset:2048 lds
buffer_store_dwordx4 v[64:67], v0, s[32:35], s65 offen sc1
v_pk_mul_f32 v[16:17], v[72:73], v[72:73]
v_pk_mul_f32 v[18:19], v[74:75], v[74:75]
v_pk_fma_f32 v[16:17], v[16:17], v[10:11], v[10:11] op_sel:[0,1,0] op_sel_hi:[1,1,0]
v_pk_fma_f32 v[18:19], v[18:19], v[10:11], v[10:11] op_sel:[0,1,0] op_sel_hi:[1,1,0]
v_pk_mul_f32 v[16:17], v[16:17], v[72:73]
v_pk_mul_f32 v[18:19], v[18:19], v[74:75]
v_exp_f32 v16, v16
v_exp_f32 v17, v17
v_exp_f32 v18, v18
v_exp_f32 v19, v19
v_pk_fma_f32 v[16:17], v[16:17], v[12:13], v[12:13] op_sel_hi:[1,0,0]
v_pk_fma_f32 v[18:19], v[18:19], v[12:13], v[12:13] op_sel_hi:[1,0,0]
v_rcp_f32 v16, v16
v_rcp_f32 v17, v17
v_rcp_f32 v18, v18
v_rcp_f32 v19, v19
v_pk_mul_f32 v[72:73], v[72:73], v[16:17]
v_pk_mul_f32 v[74:75], v[74:75], v[18:19]
v_pk_mul_f32 v[16:17], v[76:77], v[76:77]
v_pk_mul_f32 v[18:19], v[78:79], v[78:79]
buffer_load_dwordx4 v7, s[24:27], s52 offen offset:3072 lds
v_pk_fma_f32 v[16:17], v[16:17], v[10:11], v[10:11] op_sel:[0,1,0] op_sel_hi:[1,1,0]
v_pk_fma_f32 v[18:19], v[18:19], v[10:11], v[10:11] op_sel:[0,1,0] op_sel_hi:[1,1,0]
v_pk_mul_f32 v[16:17], v[16:17], v[76:77]
v_pk_mul_f32 v[18:19], v[18:19], v[78:79]
v_exp_f32 v16, v16
v_exp_f32 v17, v17
v_exp_f32 v18, v18
v_exp_f32 v19, v19
v_pk_fma_f32 v[16:17], v[16:17], v[12:13], v[12:13] op_sel_hi:[1,0,0]
v_pk_fma_f32 v[18:19], v[18:19], v[12:13], v[12:13] op_sel_hi:[1,0,0]
v_rcp_f32 v16, v16
v_rcp_f32 v17, v17
v_rcp_f32 v18, v18
v_rcp_f32 v19, v19
v_pk_mul_f32 v[76:77], v[76:77], v[16:17]
v_pk_mul_f32 v[78:79], v[78:79], v[18:19]
v_cvt_pk_bf16_f32 v72, v72, v73
v_cvt_pk_bf16_f32 v73, v74, v75
v_cvt_pk_bf16_f32 v74, v76, v77
v_cvt_pk_bf16_f32 v75, v78, v79
s_add_u32 m0, s41, 0
s_add_u32 s52, s55, 1474560
buffer_load_dwordx4 v4, s[24:27], s52 offen lds
buffer_store_dwordx4 v[72:75], v0, s[32:35], s65 offen offset:1024 sc1
v_pk_mul_f32 v[16:17], v[80:81], v[80:81]
v_pk_mul_f32 v[18:19], v[82:83], v[82:83]
v_pk_fma_f32 v[16:17], v[16:17], v[10:11], v[10:11] op_sel:[0,1,0] op_sel_hi:[1,1,0]
v_pk_fma_f32 v[18:19], v[18:19], v[10:11], v[10:11] op_sel:[0,1,0] op_sel_hi:[1,1,0]
v_pk_mul_f32 v[16:17], v[16:17], v[80:81]
v_pk_mul_f32 v[18:19], v[18:19], v[82:83]
v_exp_f32 v16, v16
v_exp_f32 v17, v17
v_exp_f32 v18, v18
v_exp_f32 v19, v19
v_pk_fma_f32 v[16:17], v[16:17], v[12:13], v[12:13] op_sel_hi:[1,0,0]
v_pk_fma_f32 v[18:19], v[18:19], v[12:13], v[12:13] op_sel_hi:[1,0,0]
v_rcp_f32 v16, v16
v_rcp_f32 v17, v17
v_rcp_f32 v18, v18
v_rcp_f32 v19, v19
v_pk_mul_f32 v[80:81], v[80:81], v[16:17]
v_pk_mul_f32 v[82:83], v[82:83], v[18:19]
v_pk_mul_f32 v[16:17], v[84:85], v[84:85]
buffer_load_dwordx4 v5, s[24:27], s52 offen offset:1024 lds
v_pk_mul_f32 v[18:19], v[86:87], v[86:87]
v_pk_fma_f32 v[16:17], v[16:17], v[10:11], v[10:11] op_sel:[0,1,0] op_sel_hi:[1,1,0]
v_pk_fma_f32 v[18:19], v[18:19], v[10:11], v[10:11] op_sel:[0,1,0] op_sel_hi:[1,1,0]
v_pk_mul_f32 v[16:17], v[16:17], v[84:85]
v_pk_mul_f32 v[18:19], v[18:19], v[86:87]
v_exp_f32 v16, v16
v_exp_f32 v17, v17
v_exp_f32 v18, v18
v_exp_f32 v19, v19
v_pk_fma_f32 v[16:17], v[16:17], v[12:13], v[12:13] op_sel_hi:[1,0,0]
v_pk_fma_f32 v[18:19], v[18:19], v[12:13], v[12:13] op_sel_hi:[1,0,0]
v_rcp_f32 v16, v16
v_rcp_f32 v17, v17
v_rcp_f32 v18, v18
v_rcp_f32 v19, v19
v_pk_mul_f32 v[84:85], v[84:85], v[16:17]
v_pk_mul_f32 v[86:87], v[86:87], v[18:19]
v_cvt_pk_bf16_f32 v80, v80, v81
v_cvt_pk_bf16_f32 v81, v82, v83
v_cvt_pk_bf16_f32 v82, v84, v85
v_cvt_pk_bf16_f32 v83, v86, v87
buffer_load_dwordx4 v6, s[24:27], s52 offen offset:2048 lds
buffer_store_dwordx4 v[80:83], v0, s[32:35], s65 offen offset:2048 sc1
v_pk_mul_f32 v[16:17], v[88:89], v[88:89]
v_pk_mul_f32 v[18:19], v[90:91], v[90:91]
v_pk_fma_f32 v[16:17], v[16:17], v[10:11], v[10:11] op_sel:[0,1,0] op_sel_hi:[1,1,0]
v_pk_fma_f32 v[18:19], v[18:19], v[10:11], v[10:11] op_sel:[0,1,0] op_sel_hi:[1,1,0]
v_pk_mul_f32 v[16:17], v[16:17], v[88:89]
v_pk_mul_f32 v[18:19], v[18:19], v[90:91]
v_exp_f32 v16, v16
v_exp_f32 v17, v17
v_exp_f32 v18, v18
v_exp_f32 v19, v19
v_pk_fma_f32 v[16:17], v[16:17], v[12:13], v[12:13] op_sel_hi:[1,0,0]
v_pk_fma_f32 v[18:19], v[18:19], v[12:13], v[12:13] op_sel_hi:[1,0,0]
v_rcp_f32 v16, v16
v_rcp_f32 v17, v17
v_rcp_f32 v18, v18
v_rcp_f32 v19, v19
v_pk_mul_f32 v[88:89], v[88:89], v[16:17]
v_pk_mul_f32 v[90:91], v[90:91], v[18:19]
v_pk_mul_f32 v[16:17], v[92:93], v[92:93]
buffer_load_dwordx4 v7, s[24:27], s52 offen offset:3072 lds
v_pk_mul_f32 v[18:19], v[94:95], v[94:95]
v_pk_fma_f32 v[16:17], v[16:17], v[10:11], v[10:11] op_sel:[0,1,0] op_sel_hi:[1,1,0]
v_pk_fma_f32 v[18:19], v[18:19], v[10:11], v[10:11] op_sel:[0,1,0] op_sel_hi:[1,1,0]
v_pk_mul_f32 v[16:17], v[16:17], v[92:93]
v_pk_mul_f32 v[18:19], v[18:19], v[94:95]
v_exp_f32 v16, v16
v_exp_f32 v17, v17
v_exp_f32 v18, v18
v_exp_f32 v19, v19
v_pk_fma_f32 v[16:17], v[16:17], v[12:13], v[12:13] op_sel_hi:[1,0,0]
v_pk_fma_f32 v[18:19], v[18:19], v[12:13], v[12:13] op_sel_hi:[1,0,0]
v_rcp_f32 v16, v16
v_rcp_f32 v17, v17
v_rcp_f32 v18, v18
v_rcp_f32 v19, v19
v_pk_mul_f32 v[92:93], v[92:93], v[16:17]
v_pk_mul_f32 v[94:95], v[94:95], v[18:19]
v_cvt_pk_bf16_f32 v88, v88, v89
v_cvt_pk_bf16_f32 v89, v90, v91
v_cvt_pk_bf16_f32 v90, v92, v93
v_cvt_pk_bf16_f32 v91, v94, v95
buffer_store_dwordx4 v[88:91], v0, s[32:35], s65 offen offset:3072 sc1
s_waitcnt vmcnt(12)
v_cmp_gt_u32 vcc, s3, v29
s_nop 1
s_cbranch_vccnz L_pw56
L_pr58:
s_add_u32 s99, s98, 0
buffer_load_dwordx4 a[0:3], v0, s[32:35], s99 offen sc1
buffer_load_dwordx4 a[4:7], v0, s[32:35], s99 offen offset:1024 sc1
buffer_load_dwordx4 a[8:11], v0, s[32:35], s99 offen offset:2048 sc1
buffer_load_dwordx4 a[12:15], v0, s[32:35], s99 offen offset:3072 sc1
s_add_u32 s99, s98, 8192
buffer_load_dwordx4 a[16:19], v0, s[32:35], s99 offen sc1
buffer_load_dwordx4 a[20:23], v0, s[32:35], s99 offen offset:1024 sc1
buffer_load_dwordx4 a[24:27], v0, s[32:35], s99 offen offset:2048 sc1
buffer_load_dwordx4 a[28:31], v0, s[32:35], s99 offen offset:3072 sc1
s_add_u32 s99, s98, 16384
buffer_load_dwordx4 a[32:35], v0, s[32:35], s99 offen sc1
buffer_load_dwordx4 a[36:39], v0, s[32:35], s99 offen offset:1024 sc1
buffer_load_dwordx4 a[40:43], v0, s[32:35], s99 offen offset:2048 sc1
buffer_load_dwordx4 a[44:47], v0, s[32:35], s99 offen offset:3072 sc1
s_branch L_s4
L_atte:
v_lshrrev_b32 v16, 5, v3
v_subrev_u32 v16, s40, v16
v_add_u32 v17, 0, v16
v_cmp_gt_u32 vcc, 5, v17
s_waitcnt vmcnt(15)
s_nop 0
v_cndmask_b32 v64, 0, v64, vcc
v_cndmask_b32 v65, 0, v65, vcc
s_waitcnt vmcnt(13)
v_cndmask_b32 v72, 0, v72, vcc
v_cndmask_b32 v73, 0, v73, vcc
v_add_u32 v17, 2, v16
v_cmp_gt_u32 vcc, 5, v17
s_nop 1
v_cndmask_b32 v66, 0, v66, vcc
v_cndmask_b32 v67, 0, v67, vcc
v_cndmask_b32 v74, 0, v74, vcc
v_cndmask_b32 v75, 0, v75, vcc
v_add_u32 v17, 4, v16
v_cmp_gt_u32 vcc, 5, v17
s_nop 1
v_cndmask_b32 v68, 0, v68, vcc
v_cndmask_b32 v69, 0, v69, vcc
s_waitcnt vmcnt(12)
v_cndmask_b32 v76, 0, v76, vcc
v_cndmask_b32 v77, 0, v77, vcc
v_add_u32 v17, 6, v16
v_cmp_gt_u32 vcc, 5, v17
s_nop 1
v_cndmask_b32 v70, 0, v70, vcc
v_cndmask_b32 v71, 0, v71, vcc
v_cndmask_b32 v78, 0, v78, vcc
v_cndmask_b32 v79, 0, v79, vcc
v_mov_b32 v253, 0
v_mov_b32 v254, 0
v_mov_b32 v255, 0
s_cmp_lt_i32 s0, -1
s_cselect_b32 s7, 0xf149f149, 0
v_mov_b32 v252, s7
s_waitcnt vmcnt(11)
v_mfma_f32_32x32x16_bf16 v[112:127], a[8:11], v[64:67], 0
v_accvgpr_read_b32 v240, a208
v_accvgpr_read_b32 v241, a209
v_accvgpr_read_b32 v242, a210
v_accvgpr_read_b32 v243, a211
v_accvgpr_read_b32 v244, a212
v_accvgpr_read_b32 v245, a213
v_accvgpr_read_b32 v246, a214
v_accvgpr_read_b32 v247, a215
s_waitcnt vmcnt(10)
v_mfma_f32_32x32x16_bf16 v[112:127], a[12:15], v[68:71], v[112:127]
v_accvgpr_read_b32 v21, a216
v_accvgpr_read_b32 v22, a217
v_accvgpr_read_b32 v23, a218
v_mov_b32 v249, 0
v_mov_b32 v250, 0
v_mov_b32 v251, 0
s_mov_b32 s64, 0xffffffff
s_mov_b32 s65, 0xfffffff0
v_mfma_f32_32x32x16_bf16 v[112:127], a[200:203], v[252:255], v[112:127]
s_mov_b32 s66, 0xfffffffe
s_mov_b32 s67, 0xffffffe0
s_mov_b32 s68, 0xfffffffc
s_mov_b32 s69, 0xffffffc0
s_mov_b32 s70, 0xfffffff8
s_mov_b32 s71, 0xffffff80
s_mov_b32 s72, 0xffffff00
s_add_u32 s99, s98, 4294926336
buffer_load_dwordx4 a[56:59], v0, s[8:11], s99 offen sc1
buffer_load_dwordx4 a[60:63], v0, s[8:11], s99 offen offset:1024 sc1
s_cmp_lt_i32 s0, -2
s_cselect_b32 s7, 0xf149f149, 0
v_mov_b32 v252, s7
s_waitcnt vmcnt(11)
v_mfma_f32_32x32x16_bf16 v[128:143], a[16:19], v[64:67], 0
s_mov_b32 s73, 0xfffff000
s_mov_b32 s74, 0xfffffe00
s_mov_b32 s75, 0xffffe000
s_mov_b32 s76, 0xfffffc00
s_mov_b32 s77, 0xffffc000
s_mov_b32 s78, 0xfffff800
s_mov_b32 s79, 0xffff8000
s_mov_b32 s80, 0xffff0000
s_waitcnt vmcnt(10)
v_mfma_f32_32x32x16_bf16 v[128:143], a[20:23], v[68:71], v[128:143]
s_mov_b32 s81, 0xfff00000
s_mov_b32 s82, 0xfffe0000
s_mov_b32 s83, 0xffe00000
s_mov_b32 s84, 0xfffc0000
s_mov_b32 s85, 0xffc00000
s_mov_b32 s86, 0xfff80000
s_mov_b32 s87, 0xff800000
s_mov_b32 s88, 0xff000000
v_mfma_f32_32x32x16_bf16 v[128:143], a[200:203], v[252:255], v[128:143]
s_mov_b32 s89, 0xf0000000
s_mov_b32 s90, 0xfe000000
s_mov_b32 s91, 0xe0000000
s_mov_b32 s92, 0xfc000000
s_mov_b32 s93, 0xc0000000
s_mov_b32 s94, 0xf8000000
s_mov_b32 s95, 0x80000000
s_add_u32 s99, s98, 4294639616
buffer_load_dwordx4 a[0:3], v0, s[8:11], s99 offen sc1
buffer_load_dwordx4 a[4:7], v0, s[8:11], s99 offen offset:1024 sc1
s_cmp_lt_i32 s0, -3
s_cselect_b32 s7, 0xf149f149, 0
v_mov_b32 v252, s7
s_waitcnt vmcnt(11)
v_mfma_f32_32x32x16_bf16 v[144:159], a[24:27], v[64:67], 0
v_max_f32 v24, v112, v113
v_max_f32 v25, v114, v115
v_max3_f32 v24, v116, v117, v24
s_waitcnt vmcnt(10)
v_mfma_f32_32x32x16_bf16 v[144:159], a[28:31], v[68:71], v[144:159]
v_max3_f32 v25, v118, v119, v25
v_max3_f32 v24, v120, v121, v24
v_max3_f32 v25, v122, v123, v25
v_mfma_f32_32x32x16_bf16 v[144:159], a[200:203], v[252:255], v[144:159]
v_max3_f32 v24, v124, v125, v24
v_max3_f32 v25, v126, v127, v25
s_add_u32 s99, s98, 0
buffer_load_dwordx4 a[64:67], v0, s[8:11], s99 offen sc1
buffer_load_dwordx4 a[68:71], v0, s[8:11], s99 offen offset:1024 sc1
s_cmp_lt_i32 s0, -4
s_cselect_b32 s7, 0xf149f149, 0
v_mov_b32 v252, s7
s_waitcnt vmcnt(11)
v_mfma_f32_32x32x16_bf16 v[160:175], a[32:35], v[64:67], 0
v_max3_f32 v24, v128, v129, v24
v_max3_f32 v25, v130, v131, v25
v_max3_f32 v24, v132, v133, v24
s_waitcnt vmcnt(10)
v_mfma_f32_32x32x16_bf16 v[160:175], a[36:39], v[68:71], v[160:175]
v_max3_f32 v25, v134, v135, v25
v_max3_f32 v24, v136, v137, v24
v_max3_f32 v25, v138, v139, v25
v_mfma_f32_32x32x16_bf16 v[160:175], a[200:203], v[252:255], v[160:175]
v_max3_f32 v24, v140, v141, v24
v_max3_f32 v25, v142, v143, v25
s_add_u32 s99, s98, 40960
buffer_load_dwordx4 a[72:75], v0, s[8:11], s99 offen sc1
buffer_load_dwordx4 a[76:79], v0, s[8:11], s99 offen offset:1024 sc1
s_cmp_lt_i32 s0, -5
s_cselect_b32 s7, 0xf149f149, 0
v_mov_b32 v252, s7
s_waitcnt vmcnt(11)
v_mfma_f32_32x32x16_bf16 v[176:191], a[40:43], v[64:67], 0
v_max3_f32 v24, v144, v145, v24
v_max3_f32 v25, v146, v147, v25
v_max3_f32 v24, v148, v149, v24
s_waitcnt vmcnt(10)
v_mfma_f32_32x32x16_bf16 v[176:191], a[44:47], v[68:71], v[176:191]
v_max3_f32 v25, v150, v151, v25
v_max3_f32 v24, v152, v153, v24
v_max3_f32 v25, v154, v155, v25
v_mfma_f32_32x32x16_bf16 v[176:191], a[200:203], v[252:255], v[176:191]
v_max3_f32 v24, v156, v157, v24
v_max3_f32 v25, v158, v159, v25
s_add_u32 s99, s49, 4294680576
s_mov_b64 exec, s[4:5]
buffer_load_dwordx4 a[88:91], v18, s[12:15], s99 offen sc1
buffer_load_dwordx4 a[92:95], v19, s[12:15], s99 offen sc1
s_mov_b64 exec, -1
s_cmp_lt_i32 s0, -6
s_cselect_b32 s7, 0xf149f149, 0
v_mov_b32 v252, s7
s_waitcnt vmcnt(11)
v_mfma_f32_32x32x16_bf16 v[192:207], a[48:51], v[64:67], 0
v_max3_f32 v24, v160, v161, v24
v_max3_f32 v25, v162, v163, v25
v_max3_f32 v24, v164, v165, v24
s_waitcnt vmcnt(10)
v_mfma_f32_32x32x16_bf16 v[192:207], a[52:55], v[68:71], v[192:207]
v_max3_f32 v25, v166, v167, v25
v_max3_f32 v24, v168, v169, v24
v_max3_f32 v25, v170, v171, v25
v_mfma_f32_32x32x16_bf16 v[192:207], a[200:203], v[252:255], v[192:207]
v_max3_f32 v24, v172, v173, v24
v_max3_f32 v25, v174, v175, v25
s_add_u32 s99, s49, 4294721536
s_mov_b64 exec, s[4:5]
buffer_load_dwordx4 a[96:99], v18, s[12:15], s99 offen sc1
buffer_load_dwordx4 a[100:103], v19, s[12:15], s99 offen sc1
s_mov_b64 exec, -1
s_cmp_lt_i32 s0, -7
s_cselect_b32 s7, 0xf149f149, 0
v_mov_b32 v252, s7
s_waitcnt vmcnt(11)
v_mfma_f32_32x32x16_bf16 v[208:223], a[56:59], v[64:67], 0
v_max3_f32 v24, v176, v177, v24
v_max3_f32 v25, v178, v179, v25
v_max3_f32 v24, v180, v181, v24
s_waitcnt vmcnt(10)
v_mfma_f32_32x32x16_bf16 v[208:223], a[60:63], v[68:71], v[208:223]
v_max3_f32 v25, v182, v183, v25
v_max3_f32 v24, v184, v185, v24
v_max3_f32 v25, v186, v187, v25
v_mfma_f32_32x32x16_bf16 v[208:223], a[200:203], v[252:255], v[208:223]
v_max3_f32 v24, v188, v189, v24
v_max3_f32 v25, v190, v191, v25
s_add_u32 s99, s49, 4294762496
s_mov_b64 exec, s[4:5]
buffer_load_dwordx4 a[104:107], v18, s[12:15], s99 offen sc1
buffer_load_dwordx4 a[108:111], v19, s[12:15], s99 offen sc1
s_mov_b64 exec, -1
s_cmp_lt_i32 s0, 0
s_cselect_b32 s7, 0xf149f149, 0
v_mov_b32 v252, s7
s_waitcnt vmcnt(11)
v_mfma_f32_32x32x16_bf16 v[96:111], a[0:3], v[64:67], 0
v_max3_f32 v24, v192, v193, v24
v_max3_f32 v25, v194, v195, v25
v_max3_f32 v24, v196, v197, v24
s_waitcnt vmcnt(10)
v_mfma_f32_32x32x16_bf16 v[96:111], a[4:7], v[68:71], v[96:111]
v_max3_f32 v25, v198, v199, v25
v_max3_f32 v24, v200, v201, v24
v_max3_f32 v25, v202, v203, v25
v_mfma_f32_32x32x16_bf16 v[96:111], a[200:203], v[252:255], v[96:111]
v_max3_f32 v24, v204, v205, v24
v_max3_f32 v25, v206, v207, v25
s_add_u32 s99, s49, 4294803456
s_mov_b64 exec, s[4:5]
buffer_load_dwordx4 a[112:115], v18, s[12:15], s99 offen sc1
buffer_load_dwordx4 a[116:119], v19, s[12:15], s99 offen sc1
s_mov_b64 exec, -1
s_waitcnt vmcnt(11)
s_nop 2
v_mfma_f32_32x32x16_bf16 v[224:239], a[64:67], v[64:67], 0
v_max3_f32 v24, v208, v209, v24
v_max3_f32 v25, v210, v211, v25
v_max3_f32 v24, v212, v213, v24
v_max3_f32 v25, v214, v215, v25
s_waitcnt vmcnt(10)
v_mfma_f32_32x32x16_bf16 v[224:239], a[68:71], v[68:71], v[224:239]
v_max3_f32 v24, v216, v217, v24
v_max3_f32 v25, v218, v219, v25
v_max3_f32 v24, v220, v221, v24
v_max3_f32 v25, v222, v223, v25
s_add_u32 s99, s49, 4294844416
s_mov_b64 exec, s[4:5]
buffer_load_dwordx4 a[120:123], v18, s[12:15], s99 offen sc1
buffer_load_dwordx4 a[124:127], v19, s[12:15], s99 offen sc1
s_mov_b64 exec, -1
s_nop 2
v_cndmask_b32 v224, v96, v224, s[64:65]
v_cndmask_b32 v225, v97, v225, s[66:67]
v_cndmask_b32 v226, v98, v226, s[68:69]
v_cndmask_b32 v227, v99, v227, s[70:71]
v_cndmask_b32 v228, v100, v228, s[72:73]
v_cndmask_b32 v229, v101, v229, s[74:75]
v_cndmask_b32 v230, v102, v230, s[76:77]
v_cndmask_b32 v231, v103, v231, s[78:79]
v_cndmask_b32 v232, v104, v232, s[80:81]
v_cndmask_b32 v233, v105, v233, s[82:83]
v_cndmask_b32 v234, v106, v234, s[84:85]
v_cndmask_b32 v235, v107, v235, s[86:87]
v_cndmask_b32 v236, v108, v236, s[88:89]
v_cndmask_b32 v237, v109, v237, s[90:91]
v_cndmask_b32 v238, v110, v238, s[92:93]
v_cndmask_b32 v239, v111, v239, s[94:95]
v_max3_f32 v24, v224, v225, v24
v_max3_f32 v25, v226, v227, v25
v_max3_f32 v24, v228, v229, v24
v_max3_f32 v25, v230, v231, v25
v_max3_f32 v24, v232, v233, v24
v_max3_f32 v25, v234, v235, v25
v_max3_f32 v24, v236, v237, v24
v_max3_f32 v25, v238, v239, v25
v_max_f32 v24, v24, v25
v_mov_b32 v25, v24
s_nop 1
v_permlane32_swap_b32 v24, v25
v_max_f32 v24, v24, v25
v_sub_f32 v24, 0, v24
v_and_b32 v25, 0xffff0000, v24
v_sub_f32 v24, v24, v25
v_and_b32 v16, 0xffff0000, v24
v_sub_f32 v24, v24, v16
v_lshrrev_b32 v25, 16, v25
v_or_b32 v25, v25, v16
v_lshrrev_b32 v24, 16, v24
v_cmp_gt_u32 vcc, 32, v3
s_nop 1
v_cndmask_b32 v248, v24, v25, vcc
s_nop 1
v_mfma_f32_32x32x16_bf16 v[112:127], a[200:203], v[248:251], v[112:127]
v_mfma_f32_32x32x16_bf16 v[128:143], a[200:203], v[248:251], v[128:143]
s_cmp_lt_i32 s0, -1
s_cselect_b32 s7, 0xf149f149, 0
v_mov_b32 v252, s7
v_mfma_f32_32x32x16_bf16 v[96:111], a[8:11], v[72:75], 0
v_mfma_f32_32x32x16_bf16 v[96:111], a[12:15], v[76:79], v[96:111]
v_mfma_f32_32x32x16_bf16 v[96:111], a[200:203], v[252:255], v[96:111]
s_add_u32 s99, s49, 4294885376
s_mov_b64 exec, s[4:5]
buffer_load_dwordx4 a[128:131], v18, s[12:15], s99 offen sc1
buffer_load_dwordx4 a[132:135], v19, s[12:15], s99 offen sc1
s_mov_b64 exec, -1
s_nop 3
v_mfma_f32_32x32x16_bf16 v[144:159], a[200:203], v[248:251], v[144:159]
v_exp_f32 v112, v112
v_exp_f32 v113, v113
v_exp_f32 v114, v114
v_exp_f32 v115, v115
v_exp_f32 v116, v116
v_exp_f32 v117, v117
v_exp_f32 v118, v118
v_exp_f32 v119, v119
v_cvt_pk_bf16_f32 v88, v112, v113
v_cvt_pk_bf16_f32 v89, v114, v115
v_cvt_pk_bf16_f32 v90, v116, v117
v_cvt_pk_bf16_f32 v91, v118, v119
v_exp_f32 v120, v120
v_exp_f32 v121, v121
v_exp_f32 v122, v122
v_exp_f32 v123, v123
v_exp_f32 v124, v124
v_exp_f32 v125, v125
v_exp_f32 v126, v126
v_exp_f32 v127, v127
v_cvt_pk_bf16_f32 v92, v120, v121
v_cvt_pk_bf16_f32 v93, v122, v123
v_cvt_pk_bf16_f32 v94, v124, v125
v_cvt_pk_bf16_f32 v95, v126, v127
s_add_u32 s99, s49, 4294926336
s_mov_b64 exec, s[4:5]
buffer_load_dwordx4 a[136:139], v18, s[12:15], s99 offen sc1
buffer_load_dwordx4 a[140:143], v19, s[12:15], s99 offen sc1
s_mov_b64 exec, -1
s_nop 3
v_mfma_f32_32x32x16_bf16 v[160:175], a[200:203], v[248:251], v[160:175]
v_exp_f32 v128, v128
v_exp_f32 v129, v129
v_exp_f32 v130, v130
v_exp_f32 v131, v131
s_waitcnt vmcnt(13)
v_mfma_f32_32x32x16_bf16 v[32:47], a[88:91], v[88:91], 0
v_exp_f32 v132, v132
v_exp_f32 v133, v133
v_exp_f32 v134, v134
s_waitcnt vmcnt(12)
v_mfma_f32_32x32x16_bf16 v[32:47], a[92:95], v[92:95], v[32:47]
v_exp_f32 v135, v135
v_cvt_pk_bf16_f32 v80, v128, v129
v_cvt_pk_bf16_f32 v81, v130, v131
v_cvt_pk_bf16_f32 v82, v132, v133
v_cvt_pk_bf16_f32 v83, v134, v135
s_cmp_lt_i32 s0, -2
s_cselect_b32 s7, 0xf149f149, 0
v_mov_b32 v252, s7
v_mfma_f32_32x32x16_bf16 v[112:127], a[16:19], v[72:75], 0
v_exp_f32 v136, v136
v_exp_f32 v137, v137
v_exp_f32 v138, v138
v_exp_f32 v139, v139
v_mfma_f32_32x32x16_bf16 v[112:127], a[20:23], v[76:79], v[112:127]
v_exp_f32 v140, v140
v_exp_f32 v141, v141
v_exp_f32 v142, v142
v_mfma_f32_32x32x16_bf16 v[112:127], a[200:203], v[252:255], v[112:127]
v_exp_f32 v143, v143
v_cvt_pk_bf16_f32 v84, v136, v137
v_cvt_pk_bf16_f32 v85, v138, v139
v_cvt_pk_bf16_f32 v86, v140, v141
v_cvt_pk_bf16_f32 v87, v142, v143
s_add_u32 s99, s49, 4294639616
s_mov_b64 exec, s[4:5]
buffer_load_dwordx4 a[80:83], v18, s[12:15], s99 offen sc1
buffer_load_dwordx4 a[84:87], v19, s[12:15], s99 offen sc1
s_mov_b64 exec, -1
s_nop 3
v_mfma_f32_32x32x16_bf16 v[176:191], a[200:203], v[248:251], v[176:191]
v_max_f32 v24, v112, v113
v_max_f32 v25, v114, v115
v_max3_f32 v24, v116, v117, v24
v_max3_f32 v25, v118, v119, v25
v_max3_f32 v24, v120, v121, v24
v_max3_f32 v25, v122, v123, v25
v_max3_f32 v24, v124, v125, v24
v_max3_f32 v25, v126, v127, v25
s_waitcnt vmcnt(13)
v_mfma_f32_32x32x16_bf16 v[32:47], a[96:99], v[80:83], v[32:47]
v_exp_f32 v144, v144
v_exp_f32 v145, v145
v_exp_f32 v146, v146
v_exp_f32 v147, v147
s_waitcnt vmcnt(12)
v_mfma_f32_32x32x16_bf16 v[32:47], a[100:103], v[84:87], v[32:47]
v_exp_f32 v148, v148
v_exp_f32 v149, v149
v_exp_f32 v150, v150
v_exp_f32 v151, v151
s_cmp_lt_i32 s0, -3
s_cselect_b32 s7, 0xf149f149, 0
v_mov_b32 v252, s7
v_mfma_f32_32x32x16_bf16 v[128:143], a[24:27], v[72:75], 0
v_cvt_pk_bf16_f32 v88, v144, v145
v_cvt_pk_bf16_f32 v89, v146, v147
v_cvt_pk_bf16_f32 v90, v148, v149
v_cvt_pk_bf16_f32 v91, v150, v151
v_exp_f32 v152, v152
v_exp_f32 v153, v153
v_mfma_f32_32x32x16_bf16 v[128:143], a[28:31], v[76:79], v[128:143]
v_exp_f32 v154, v154
v_exp_f32 v155, v155
v_exp_f32 v156, v156
v_exp_f32 v157, v157
v_mfma_f32_32x32x16_bf16 v[128:143], a[200:203], v[252:255], v[128:143]
v_exp_f32 v158, v158
v_exp_f32 v159, v159
v_cvt_pk_bf16_f32 v92, v152, v153
v_cvt_pk_bf16_f32 v93, v154, v155
v_cvt_pk_bf16_f32 v94, v156, v157
v_cvt_pk_bf16_f32 v95, v158, v159
s_add_u32 s99, s49, 0
s_mov_b64 exec, s[4:5]
buffer_load_dwordx4 a[144:147], v18, s[12:15], s99 offen sc1
buffer_load_dwordx4 a[148:151], v19, s[12:15], s99 offen sc1
s_mov_b64 exec, -1
buffer_atomic_add v14, v13, s[32:35], s47 offen sc1
s_nop 2
v_mfma_f32_32x32x16_bf16 v[192:207], a[200:203], v[248:251], v[192:207]
v_max3_f32 v24, v128, v129, v24
v_max3_f32 v25, v130, v131, v25
v_max3_f32 v24, v132, v133, v24
v_max3_f32 v25, v134, v135, v25
v_max3_f32 v24, v136, v137, v24
v_max3_f32 v25, v138, v139, v25
v_max3_f32 v24, v140, v141, v24
v_max3_f32 v25, v142, v143, v25
s_waitcnt vmcnt(14)
v_mfma_f32_32x32x16_bf16 v[32:47], a[104:107], v[88:91], v[32:47]
v_exp_f32 v160, v160
v_exp_f32 v161, v161
v_exp_f32 v162, v162
v_exp_f32 v163, v163
s_waitcnt vmcnt(13)
v_mfma_f32_32x32x16_bf16 v[32:47], a[108:111], v[92:95], v[32:47]
v_exp_f32 v164, v164
v_exp_f32 v165, v165
v_exp_f32 v166, v166
v_exp_f32 v167, v167
s_cmp_lt_i32 s0, -4
s_cselect_b32 s7, 0xf149f149, 0
v_mov_b32 v252, s7
v_mfma_f32_32x32x16_bf16 v[144:159], a[32:35], v[72:75], 0
v_cvt_pk_bf16_f32 v80, v160, v161
v_cvt_pk_bf16_f32 v81, v162, v163
v_cvt_pk_bf16_f32 v82, v164, v165
v_cvt_pk_bf16_f32 v83, v166, v167
v_exp_f32 v168, v168
v_exp_f32 v169, v169
v_mfma_f32_32x32x16_bf16 v[144:159], a[36:39], v[76:79], v[144:159]
v_exp_f32 v170, v170
v_exp_f32 v171, v171
v_exp_f32 v172, v172
v_exp_f32 v173, v173
v_mfma_f32_32x32x16_bf16 v[144:159], a[200:203], v[252:255], v[144:159]
v_exp_f32 v174, v174
v_exp_f32 v175, v175
v_cvt_pk_bf16_f32 v84, v168, v169
v_cvt_pk_bf16_f32 v85, v170, v171
v_cvt_pk_bf16_f32 v86, v172, v173
v_cvt_pk_bf16_f32 v87, v174, v175
s_add_u32 s99, s49, 40960
s_mov_b64 exec, s[4:5]
buffer_load_dwordx4 a[152:155], v18, s[12:15], s99 offen sc1
buffer_load_dwordx4 a[156:159], v19, s[12:15], s99 offen sc1
s_mov_b64 exec, -1
s_nop 3
v_mfma_f32_32x32x16_bf16 v[208:223], a[200:203], v[248:251], v[208:223]
v_max3_f32 v24, v144, v145, v24
v_max3_f32 v25, v146, v147, v25
v_max3_f32 v24, v148, v149, v24
v_max3_f32 v25, v150, v151, v25
v_max3_f32 v24, v152, v153, v24
v_max3_f32 v25, v154, v155, v25
v_max3_f32 v24, v156, v157, v24
v_max3_f32 v25, v158, v159, v25
s_waitcnt vmcnt(14)
v_mfma_f32_32x32x16_bf16 v[32:47], a[112:115], v[80:83], v[32:47]
v_exp_f32 v176, v176
v_exp_f32 v177, v177
v_exp_f32 v178, v178
v_exp_f32 v179, v179
s_waitcnt vmcnt(13)
v_mfma_f32_32x32x16_bf16 v[32:47], a[116:119], v[84:87], v[32:47]
v_exp_f32 v180, v180
v_exp_f32 v181, v181
v_exp_f32 v182, v182
v_exp_f32 v183, v183
s_cmp_lt_i32 s0, -5
s_cselect_b32 s7, 0xf149f149, 0
v_mov_b32 v252, s7
v_mfma_f32_32x32x16_bf16 v[160:175], a[40:43], v[72:75], 0
v_cvt_pk_bf16_f32 v88, v176, v177
v_cvt_pk_bf16_f32 v89, v178, v179
v_cvt_pk_bf16_f32 v90, v180, v181
v_cvt_pk_bf16_f32 v91, v182, v183
v_exp_f32 v184, v184
v_exp_f32 v185, v185
v_mfma_f32_32x32x16_bf16 v[160:175], a[44:47], v[76:79], v[160:175]
v_exp_f32 v186, v186
v_exp_f32 v187, v187
v_exp_f32 v188, v188
v_exp_f32 v189, v189
v_mfma_f32_32x32x16_bf16 v[160:175], a[200:203], v[252:255], v[160:175]
v_exp_f32 v190, v190
v_exp_f32 v191, v191
v_cvt_pk_bf16_f32 v92, v184, v185
v_cvt_pk_bf16_f32 v93, v186, v187
v_cvt_pk_bf16_f32 v94, v188, v189
v_cvt_pk_bf16_f32 v95, v190, v191
v_lshrrev_b32 v4, 3, v3
s_lshl_b32 s53, s40, 5
v_add_u32 v4, s53, v4
v_bfe_u32 v5, v3, 4, 1
v_lshlrev_b32 v5, 2, v5
v_and_b32 v6, 7, v3
v_xor_b32 v5, v5, v6
v_lshlrev_b32 v5, 4, v5
v_mad_u32_u24 v4, v4, s57, v5
s_lshl_b32 s53, s57, 3
s_sub_u32 s53, s53, 1024
v_add_u32 v5, s53, v4
v_add_u32 v6, s53, v5
v_add_u32 v7, s53, v6
s_lshl_b32 s53, s57, 6
s_mul_i32 s52, s63, s53
s_add_u32 s52, s52, s58
s_add_u32 m0, s41, 0
s_nop 0
buffer_load_dwordx4 v4, s[20:23], s52 offen lds
s_add_u32 m0, s41, 0
s_nop 0
buffer_load_dwordx4 v5, s[20:23], s52 offen offset:1024 lds
v_mfma_f32_32x32x16_bf16 v[224:239], a[200:203], v[248:251], v[224:239]
v_max3_f32 v24, v160, v161, v24
v_max3_f32 v25, v162, v163, v25
v_max3_f32 v24, v164, v165, v24
v_max3_f32 v25, v166, v167, v25
v_max3_f32 v24, v168, v169, v24
v_max3_f32 v25, v170, v171, v25
v_max3_f32 v24, v172, v173, v24
v_max3_f32 v25, v174, v175, v25
s_waitcnt vmcnt(14)
v_mfma_f32_32x32x16_bf16 v[32:47], a[120:123], v[88:91], v[32:47]
v_exp_f32 v192, v192
v_exp_f32 v193, v193
v_exp_f32 v194, v194
v_exp_f32 v195, v195
s_waitcnt vmcnt(13)
v_mfma_f32_32x32x16_bf16 v[32:47], a[124:127], v[92:95], v[32:47]
v_exp_f32 v196, v196
v_exp_f32 v197, v197
v_exp_f32 v198, v198
v_exp_f32 v199, v199
s_cmp_lt_i32 s0, -6
s_cselect_b32 s7, 0xf149f149, 0
s_add_u32 m0, s41, 0
s_nop 0
buffer_load_dwordx4 v6, s[20:23], s52 offen offset:2048 lds
s_add_u32 m0, s41, 0
s_nop 0
buffer_load_dwordx4 v7, s[20:23], s52 offen offset:3072 lds
s_mov_b32 s3, s62
s_lshl_b32 s3, s3, 2
s_add_u32 s3, s3, s60
s_lshl_b32 s3, s3, 4
s_lshr_b32 s4, s44, 2
s_add_u32 s3, s3, s4
s_lshl_b32 s3, s3, 2
s_add_u32 s3, s3, s40
s_mul_i32 s3, s3, 2176
v_min_u32 v28, 16, v3
v_add_lshl_u32 v28, v28, 0, 7
buffer_load_dword a223, v28, s[24:27], s3 offen
v_mov_b32 v252, s7
v_mfma_f32_32x32x16_bf16 v[176:191], a[48:51], v[72:75], 0
v_cvt_pk_bf16_f32 v80, v192, v193
v_cvt_pk_bf16_f32 v81, v194, v195
v_cvt_pk_bf16_f32 v82, v196, v197
v_cvt_pk_bf16_f32 v83, v198, v199
v_exp_f32 v200, v200
v_exp_f32 v201, v201
v_mfma_f32_32x32x16_bf16 v[176:191], a[52:55], v[76:79], v[176:191]
v_exp_f32 v202, v202
v_exp_f32 v203, v203
v_exp_f32 v204, v204
v_exp_f32 v205, v205
v_mfma_f32_32x32x16_bf16 v[176:191], a[200:203], v[252:255], v[176:191]
v_exp_f32 v206, v206
v_exp_f32 v207, v207
v_cvt_pk_bf16_f32 v84, v200, v201
v_cvt_pk_bf16_f32 v85, v202, v203
v_cvt_pk_bf16_f32 v86, v204, v205
v_cvt_pk_bf16_f32 v87, v206, v207
s_add_u32 m0, s41, 16384
s_add_u32 s51, s63, 2
s_sub_u32 s52, s51, 10
s_cselect_b32 s51, s51, s52
s_mul_i32 s52, s51, s53
s_add_u32 s52, s52, s58
buffer_load_dwordx4 v4, s[20:23], s52 offen lds
buffer_load_dwordx4 v5, s[20:23], s52 offen offset:1024 lds
s_waitcnt vmcnt(17)
v_mfma_f32_32x32x16_bf16 v[32:47], a[128:131], v[80:83], v[32:47]
v_max3_f32 v24, v176, v177, v24
v_max3_f32 v25, v178, v179, v25
v_max3_f32 v24, v180, v181, v24
v_max3_f32 v25, v182, v183, v25
v_max3_f32 v24, v184, v185, v24
v_max3_f32 v25, v186, v187, v25
v_max3_f32 v24, v188, v189, v24
v_max3_f32 v25, v190, v191, v25
v_exp_f32 v208, v208
s_waitcnt vmcnt(16)
v_mfma_f32_32x32x16_bf16 v[32:47], a[132:135], v[84:87], v[32:47]
v_exp_f32 v209, v209
v_exp_f32 v210, v210
v_exp_f32 v211, v211
v_exp_f32 v212, v212
v_exp_f32 v213, v213
s_cmp_lt_i32 s0, -7
s_cselect_b32 s7, 0xf149f149, 0
v_mov_b32 v252, s7
v_mfma_f32_32x32x16_bf16 v[192:207], a[56:59], v[72:75], 0
buffer_load_dwordx4 v6, s[20:23], s52 offen offset:2048 lds
buffer_load_dwordx4 v7, s[20:23], s52 offen offset:3072 lds
v_exp_f32 v214, v214
v_exp_f32 v215, v215
v_cvt_pk_bf16_f32 v88, v208, v209
v_cvt_pk_bf16_f32 v89, v210, v211
v_cvt_pk_bf16_f32 v90, v212, v213
v_cvt_pk_bf16_f32 v91, v214, v215
v_exp_f32 v216, v216
v_mfma_f32_32x32x16_bf16 v[192:207], a[60:63], v[76:79], v[192:207]
v_exp_f32 v217, v217
v_exp_f32 v218, v218
v_exp_f32 v219, v219
v_exp_f32 v220, v220
v_exp_f32 v221, v221
v_mfma_f32_32x32x16_bf16 v[192:207], a[200:203], v[252:255], v[192:207]
v_exp_f32 v222, v222
v_exp_f32 v223, v223
v_cvt_pk_bf16_f32 v92, v216, v217
v_cvt_pk_bf16_f32 v93, v218, v219
v_cvt_pk_bf16_f32 v94, v220, v221
v_cvt_pk_bf16_f32 v95, v222, v223
s_add_u32 m0, s41, 32768
s_add_u32 s51, s63, 4
s_sub_u32 s52, s51, 10
s_cselect_b32 s51, s51, s52
s_mul_i32 s52, s51, s53
s_add_u32 s52, s52, s58
buffer_load_dwordx4 v4, s[20:23], s52 offen lds
buffer_load_dwordx4 v5, s[20:23], s52 offen offset:1024 lds
s_waitcnt vmcnt(19)
v_mfma_f32_32x32x16_bf16 v[32:47], a[136:139], v[88:91], v[32:47]
v_max3_f32 v24, v192, v193, v24
v_max3_f32 v25, v194, v195, v25
v_max3_f32 v24, v196, v197, v24
v_max3_f32 v25, v198, v199, v25
v_max3_f32 v24, v200, v201, v24
v_max3_f32 v25, v202, v203, v25
v_max3_f32 v24, v204, v205, v24
v_max3_f32 v25, v206, v207, v25
v_exp_f32 v224, v224
s_waitcnt vmcnt(18)
v_mfma_f32_32x32x16_bf16 v[32:47], a[140:143], v[92:95], v[32:47]
v_exp_f32 v225, v225
v_exp_f32 v226, v226
v_exp_f32 v227, v227
v_exp_f32 v228, v228
v_exp_f32 v229, v229
s_cmp_lt_i32 s0, -8
s_cselect_b32 s7, 0xf149f149, 0
v_mov_b32 v252, s7
v_mfma_f32_32x32x16_bf16 v[208:223], a[64:67], v[72:75], 0
buffer_load_dwordx4 v6, s[20:23], s52 offen offset:2048 lds
buffer_load_dwordx4 v7, s[20:23], s52 offen offset:3072 lds
v_exp_f32 v230, v230
v_exp_f32 v231, v231
v_cvt_pk_bf16_f32 v80, v224, v225
v_cvt_pk_bf16_f32 v81, v226, v227
v_cvt_pk_bf16_f32 v82, v228, v229
v_cvt_pk_bf16_f32 v83, v230, v231
v_exp_f32 v232, v232
v_mfma_f32_32x32x16_bf16 v[208:223], a[68:71], v[76:79], v[208:223]
v_exp_f32 v233, v233
v_exp_f32 v234, v234
v_exp_f32 v235, v235
v_exp_f32 v236, v236
v_exp_f32 v237, v237
v_mfma_f32_32x32x16_bf16 v[208:223], a[200:203], v[252:255], v[208:223]
v_exp_f32 v238, v238
v_exp_f32 v239, v239
v_cvt_pk_bf16_f32 v84, v232, v233
v_cvt_pk_bf16_f32 v85, v234, v235
v_cvt_pk_bf16_f32 v86, v236, v237
v_cvt_pk_bf16_f32 v87, v238, v239
v_mfma_f32_32x32x16_bf16 v[224:239], a[72:75], v[72:75], 0
v_mfma_f32_32x32x16_bf16 v[224:239], a[76:79], v[76:79], v[224:239]
v_bfi_b32 v88, v240, 0, v80
v_bfi_b32 v89, v241, 0, v81
v_bfi_b32 v90, v242, 0, v82
v_bfi_b32 v91, v243, 0, v83
v_bfi_b32 v92, v244, 0, v84
v_bfi_b32 v93, v245, 0, v85
v_bfi_b32 v94, v246, 0, v86
v_bfi_b32 v95, v247, 0, v87
s_waitcnt vmcnt(19)
v_mfma_f32_32x32x16_bf16 v[32:47], a[80:83], v[88:91], v[32:47]
v_and_b32 v80, v240, v80
v_and_b32 v81, v241, v81
v_and_b32 v82, v242, v82
v_and_b32 v83, v243, v83
s_waitcnt vmcnt(18)
v_mfma_f32_32x32x16_bf16 v[32:47], a[84:87], v[92:95], v[32:47]
v_and_b32 v84, v244, v84
v_and_b32 v85, v245, v85
v_and_b32 v86, v246, v86
v_and_b32 v87, v247, v87
s_add_u32 m0, s41, 49152
s_add_u32 s51, s63, 6
s_sub_u32 s52, s51, 10
s_cselect_b32 s51, s51, s52
s_mul_i32 s52, s51, s53
s_add_u32 s52, s52, s58
buffer_load_dwordx4 v4, s[20:23], s52 offen lds
buffer_load_dwordx4 v5, s[20:23], s52 offen offset:1024 lds
buffer_load_dwordx4 v6, s[20:23], s52 offen offset:2048 lds
buffer_load_dwordx4 v7, s[20:23], s52 offen offset:3072 lds
s_waitcnt vmcnt(21)
v_mfma_f32_32x32x16_bf16 v[32:47], a[144:147], v[80:83], v[32:47]
v_max3_f32 v24, v208, v209, v24
v_max3_f32 v25, v210, v211, v25
v_max3_f32 v24, v212, v213, v24
v_max3_f32 v25, v214, v215, v25
v_max3_f32 v24, v216, v217, v24
v_max3_f32 v25, v218, v219, v25
v_max3_f32 v24, v220, v221, v24
v_max3_f32 v25, v222, v223, v25
v_cndmask_b32 v224, v96, v224, s[64:65]
v_cndmask_b32 v225, v97, v225, s[66:67]
v_cndmask_b32 v226, v98, v226, s[68:69]
v_cndmask_b32 v227, v99, v227, s[70:71]
v_cndmask_b32 v228, v100, v228, s[72:73]
v_cndmask_b32 v229, v101, v229, s[74:75]
v_cndmask_b32 v230, v102, v230, s[76:77]
v_cndmask_b32 v231, v103, v231, s[78:79]
v_cndmask_b32 v232, v104, v232, s[80:81]
v_cndmask_b32 v233, v105, v233, s[82:83]
v_cndmask_b32 v234, v106, v234, s[84:85]
v_cndmask_b32 v235, v107, v235, s[86:87]
v_cndmask_b32 v236, v108, v236, s[88:89]
v_cndmask_b32 v237, v109, v237, s[90:91]
v_cndmask_b32 v238, v110, v238, s[92:93]
v_cndmask_b32 v239, v111, v239, s[94:95]
s_waitcnt vmcnt(20)
v_mfma_f32_32x32x16_bf16 v[32:47], a[148:151], v[84:87], v[32:47]
v_max3_f32 v24, v224, v225, v24
v_max3_f32 v25, v226, v227, v25
v_max3_f32 v24, v228, v229, v24
v_max3_f32 v25, v230, v231, v25
v_max3_f32 v24, v232, v233, v24
v_max3_f32 v25, v234, v235, v25
v_max3_f32 v24, v236, v237, v24
v_max3_f32 v25, v238, v239, v25
v_max_f32 v24, v24, v25
v_mov_b32 v25, v24
s_nop 1
v_permlane32_swap_b32 v24, v25
v_max_f32 v24, v24, v25
v_sub_f32 v24, 0, v24
v_and_b32 v25, 0xffff0000, v24
v_sub_f32 v24, v24, v25
v_and_b32 v16, 0xffff0000, v24
v_sub_f32 v24, v24, v16
v_lshrrev_b32 v25, 16, v25
v_or_b32 v25, v25, v16
v_lshrrev_b32 v24, 16, v24
v_cmp_gt_u32 vcc, 32, v3
s_nop 1
v_cndmask_b32 v248, v24, v25, vcc
s_nop 1
v_mfma_f32_32x32x16_bf16 v[112:127], a[200:203], v[248:251], v[112:127]
v_mfma_f32_32x32x16_bf16 v[128:143], a[200:203], v[248:251], v[128:143]
s_add_u32 m0, s41, 65536
s_add_u32 s51, s63, 8
s_sub_u32 s52, s51, 10
s_cselect_b32 s51, s51, s52
s_mul_i32 s52, s51, s53
s_add_u32 s52, s52, s58
buffer_load_dwordx4 v4, s[20:23], s52 offen lds
buffer_load_dwordx4 v5, s[20:23], s52 offen offset:1024 lds
buffer_load_dwordx4 v6, s[20:23], s52 offen offset:2048 lds
v_mfma_f32_32x32x16_bf16 v[144:159], a[200:203], v[248:251], v[144:159]
s_nop 0
v_exp_f32 v112, v112
v_exp_f32 v113, v113
v_exp_f32 v114, v114
v_exp_f32 v115, v115
v_exp_f32 v116, v116
v_exp_f32 v117, v117
v_exp_f32 v118, v118
v_exp_f32 v119, v119
v_cvt_pk_bf16_f32 v88, v112, v113
v_cvt_pk_bf16_f32 v89, v114, v115
v_cvt_pk_bf16_f32 v90, v116, v117
buffer_load_dwordx4 v7, s[20:23], s52 offen offset:3072 lds
s_cmp_eq_u32 s57, 1280
s_cselect_b32 s5, 0, 10
s_lshl_b32 s6, s44, 9
buffer_load_dword v29, off, s[32:35], s6 offset:384 sc1
s_mul_i32 s4, s44, 2560
s_add_u32 s4, s4, 131072
s_mul_i32 s98, s44, 40960
s_add_u32 s98, s98, 11141120
s_cmp_eq_u32 s57, 1280
s_cselect_b32 s4, 1073741824, s4
s_cselect_b32 s98, 1073741824, s98
v_lshrrev_b32 v18, 5, v3
v_mul_u32_u24 v18, 1024, v18
v_lshl_add_u32 v18, v3, 3, v18
s_getpc_b64 s[86:87]
L_pc48:
s_lshl_b32 s3, s42, 3
s_xor_b32 s3, s3, s43
s_lshl_b32 s3, s3, 2
s_add_u32 s3, s3, s40
s_mul_i32 s3, s3, 8
s_and_b32 s3, s3, 1023
v_min_u32 v26, 7, v3
v_add_lshl_u32 v26, v26, s3, 7
v_min_u32 v26, L_codeend-L_pc48-4, v26
v_and_b32 v26, -4, v26
global_load_dword a223, v26, s[86:87]
v_cvt_pk_bf16_f32 v91, v118, v119
v_exp_f32 v120, v120
v_exp_f32 v121, v121
v_exp_f32 v122, v122
v_exp_f32 v123, v123
v_exp_f32 v124, v124
v_exp_f32 v125, v125
v_exp_f32 v126, v126
v_exp_f32 v127, v127
v_cvt_pk_bf16_f32 v92, v120, v121
v_cvt_pk_bf16_f32 v93, v122, v123
v_cvt_pk_bf16_f32 v94, v124, v125
v_cvt_pk_bf16_f32 v95, v126, v127
s_lshl_b32 s83, s43, 1
v_add_u32 v17, s83, v3
v_lshlrev_b32 v17, 7, v17
v_add_u32 v17, 90112, v17
s_cmp_eq_u32 s40, 0
s_cselect_b32 s84, 2, 0
v_cmp_gt_u32 vcc, s84, v3
v_mov_b32 v19, 1073741824
s_mul_i32 s83, s83, 40
v_cndmask_b32 v19, v19, v17, vcc
s_mul_i32 s84, s42, 5
s_add_u32 s83, s83, s84
v_add_u32 v17, 147456, v0
s_lshl_b32 s84, s40, 10
v_add_u32 v17, s84, v17
s_add_u32 m0, s41, 81920
s_mul_i32 s52, s63, s53
s_add_u32 s52, s52, s58
s_add_u32 s52, s52, 128
buffer_load_dwordx4 v4, s[20:23], s52 offen lds
buffer_load_dwordx4 v5, s[20:23], s52 offen offset:1024 lds
v_mfma_f32_32x32x16_bf16 v[160:175], a[200:203], v[248:251], v[160:175]
v_exp_f32 v128, v128
v_exp_f32 v129, v129
v_exp_f32 v130, v130
v_exp_f32 v131, v131
v_exp_f32 v132, v132
v_exp_f32 v133, v133
v_exp_f32 v134, v134
v_mfma_f32_32x32x16_bf16 v[48:63], a[96:99], v[88:91], 0
v_exp_f32 v135, v135
v_cvt_pk_bf16_f32 v80, v128, v129
v_cvt_pk_bf16_f32 v81, v130, v131
v_cvt_pk_bf16_f32 v82, v132, v133
buffer_load_dwordx4 v6, s[20:23], s52 offen offset:2048 lds
buffer_load_dwordx4 v7, s[20:23], s52 offen offset:3072 lds
v_cvt_pk_bf16_f32 v83, v134, v135
v_exp_f32 v136, v136
v_exp_f32 v137, v137
v_exp_f32 v138, v138
v_exp_f32 v139, v139
v_mfma_f32_32x32x16_bf16 v[48:63], a[100:103], v[92:95], v[48:63]
v_exp_f32 v140, v140
v_exp_f32 v141, v141
v_exp_f32 v142, v142
v_exp_f32 v143, v143
v_cvt_pk_bf16_f32 v84, v136, v137
v_cvt_pk_bf16_f32 v85, v138, v139
v_cvt_pk_bf16_f32 v86, v140, v141
v_cvt_pk_bf16_f32 v87, v142, v143
s_add_u32 s84, s40, 0
s_cmp_gt_u32 s84, 4
s_cselect_b32 s80, 35, 0
s_add_u32 s80, s80, s84
s_add_u32 s80, s80, s83
s_lshl_b32 s80, s80, 10
s_add_u32 s80, s80, 13762560
s_cmp_gt_u32 s84, 9
s_cselect_b32 s80, 1073741824, s80
s_add_u32 s84, s40, 4
s_cmp_gt_u32 s84, 4
s_cselect_b32 s81, 35, 0
s_add_u32 s81, s81, s84
s_add_u32 s81, s81, s83
s_lshl_b32 s81, s81, 10
s_add_u32 s81, s81, 13762560
s_cmp_gt_u32 s84, 9
s_cselect_b32 s81, 1073741824, s81
s_add_u32 s84, s40, 8
s_cmp_gt_u32 s84, 4
s_cselect_b32 s82, 35, 0
s_add_u32 s82, s82, s84
s_add_u32 s82, s82, s83
s_lshl_b32 s82, s82, 10
s_add_u32 s82, s82, 13762560
s_cmp_gt_u32 s84, 9
s_cselect_b32 s82, 1073741824, s82
s_add_u32 m0, s41, 98304
s_add_u32 s51, s63, 2
s_sub_u32 s52, s51, 10
s_cselect_b32 s51, s51, s52
s_mul_i32 s52, s51, s53
s_add_u32 s52, s52, s58
s_add_u32 s52, s52, 128
buffer_load_dwordx4 v4, s[20:23], s52 offen lds
buffer_load_dwordx4 v5, s[20:23], s52 offen offset:1024 lds
v_mfma_f32_32x32x16_bf16 v[176:191], a[200:203], v[248:251], v[176:191]
v_rcp_f32 v16, v44
s_nop 0
v_mul_f32 v32, v32, v16
v_mul_f32 v33, v33, v16
v_mul_f32 v34, v34, v16
v_mul_f32 v35, v35, v16
v_mul_f32 v36, v36, v16
v_mul_f32 v37, v37, v16
v_mul_f32 v38, v38, v16
v_mul_f32 v39, v39, v16
v_mul_f32 v40, v40, v16
v_mul_f32 v41, v41, v16
v_mul_f32 v42, v42, v16
v_mul_f32 v43, v43, v16
v_cvt_pk_bf16_f32 v32, v32, v33
v_cvt_pk_bf16_f32 v33, v34, v35
v_cvt_pk_bf16_f32 v34, v36, v37
v_cvt_pk_bf16_f32 v35, v38, v39
v_cvt_pk_bf16_f32 v36, v40, v41
v_cvt_pk_bf16_f32 v37, v42, v43
ds_write_b64 v21, v[32:33] offset:0
v_mfma_f32_32x32x16_bf16 v[48:63], a[104:107], v[80:83], v[48:63]
ds_write_b64 v22, v[34:35] offset:0
ds_write_b64 v23, v[36:37] offset:0
buffer_load_dwordx4 v6, s[20:23], s52 offen offset:2048 lds
buffer_load_dwordx4 v7, s[20:23], s52 offen offset:3072 lds
v_exp_f32 v144, v144
v_exp_f32 v145, v145
v_exp_f32 v146, v146
v_exp_f32 v147, v147
v_exp_f32 v148, v148
v_exp_f32 v149, v149
v_exp_f32 v150, v150
v_exp_f32 v151, v151
v_cvt_pk_bf16_f32 v88, v144, v145
v_cvt_pk_bf16_f32 v89, v146, v147
v_cvt_pk_bf16_f32 v90, v148, v149
v_mfma_f32_32x32x16_bf16 v[48:63], a[108:111], v[84:87], v[48:63]
v_cvt_pk_bf16_f32 v91, v150, v151
v_exp_f32 v152, v152
v_exp_f32 v153, v153
v_exp_f32 v154, v154
v_exp_f32 v155, v155
v_exp_f32 v156, v156
v_exp_f32 v157, v157
v_exp_f32 v158, v158
v_exp_f32 v159, v159
v_cvt_pk_bf16_f32 v92, v152, v153
v_cvt_pk_bf16_f32 v93, v154, v155
v_cvt_pk_bf16_f32 v94, v156, v157
v_cvt_pk_bf16_f32 v95, v158, v159
s_xor_b32 s76, s62, 0
s_lshl_b32 s76, s76, 7
s_add_u32 s76, s76, 98176
buffer_load_dword v20, off, s[32:35], s76 sc1
s_lshl_b32 s74, s58, 4
s_add_u32 s74, s74, 327680
s_mov_b32 s78, 0xffff0000
s_waitcnt vmcnt(10)
v_cmp_gt_u32 vcc, s5, v29
s_nop 1
s_cbranch_vccnz L_pw45
L_pr47:
buffer_load_dwordx2 v[64:65], v18, s[32:35], s4 offen offset:0 sc1
buffer_load_dwordx2 v[66:67], v18, s[32:35], s4 offen offset:256 sc1
v_mfma_f32_32x32x16_bf16 v[192:207], a[200:203], v[248:251], v[192:207]
v_exp_f32 v160, v160
v_exp_f32 v161, v161
v_exp_f32 v162, v162
v_exp_f32 v163, v163
v_exp_f32 v164, v164
v_exp_f32 v165, v165
v_exp_f32 v166, v166
v_mfma_f32_32x32x16_bf16 v[48:63], a[112:115], v[88:91], v[48:63]
v_exp_f32 v167, v167
v_cvt_pk_bf16_f32 v80, v160, v161
v_cvt_pk_bf16_f32 v81, v162, v163
v_cvt_pk_bf16_f32 v82, v164, v165
buffer_load_dwordx2 v[68:69], v18, s[32:35], s4 offen offset:512 sc1
buffer_load_dwordx2 v[70:71], v18, s[32:35], s4 offen offset:768 sc1
buffer_load_dwordx2 v[72:73], v18, s[32:35], s4 offen offset:1024 sc1
v_cvt_pk_bf16_f32 v83, v166, v167
v_exp_f32 v168, v168
v_exp_f32 v169, v169
v_exp_f32 v170, v170
v_exp_f32 v171, v171
v_mfma_f32_32x32x16_bf16 v[48:63], a[116:119], v[92:95], v[48:63]
v_exp_f32 v172, v172
v_exp_f32 v173, v173
v_exp_f32 v174, v174
v_exp_f32 v175, v175
v_cvt_pk_bf16_f32 v84, v168, v169
v_cvt_pk_bf16_f32 v85, v170, v171
v_cvt_pk_bf16_f32 v86, v172, v173
v_cvt_pk_bf16_f32 v87, v174, v175
s_add_u32 s99, s63, 0
s_sub_u32 s3, s99, 10
s_cselect_b32 s99, s99, s3
s_lshl_b32 s99, s99, 12
s_add_u32 s99, s99, s98
buffer_load_dwordx4 a[0:3], v0, s[32:35], s99 offen sc1
v_mfma_f32_32x32x16_bf16 v[208:223], a[200:203], v[248:251], v[208:223]
v_exp_f32 v176, v176
v_exp_f32 v177, v177
v_exp_f32 v178, v178
v_exp_f32 v179, v179
v_exp_f32 v180, v180
v_exp_f32 v181, v181
v_exp_f32 v182, v182
v_mfma_f32_32x32x16_bf16 v[48:63], a[120:123], v[80:83], v[48:63]
v_exp_f32 v183, v183
v_cvt_pk_bf16_f32 v88, v176, v177
v_cvt_pk_bf16_f32 v89, v178, v179
v_cvt_pk_bf16_f32 v90, v180, v181
buffer_load_dwordx4 a[4:7], v0, s[32:35], s99 offen offset:1024 sc1
buffer_load_dwordx4 a[8:11], v0, s[32:35], s99 offen offset:2048 sc1
v_cvt_pk_bf16_f32 v91, v182, v183
v_exp_f32 v184, v184
v_exp_f32 v185, v185
v_exp_f32 v186, v186
v_exp_f32 v187, v187
v_mfma_f32_32x32x16_bf16 v[48:63], a[124:127], v[84:87], v[48:63]
v_exp_f32 v188, v188
v_exp_f32 v189, v189
v_exp_f32 v190, v190
v_exp_f32 v191, v191
v_cvt_pk_bf16_f32 v92, v184, v185
v_cvt_pk_bf16_f32 v93, v186, v187
v_cvt_pk_bf16_f32 v94, v188, v189
v_cvt_pk_bf16_f32 v95, v190, v191
buffer_load_dwordx4 a[12:15], v0, s[32:35], s99 offen offset:3072 sc1
v_mfma_f32_32x32x16_bf16 v[224:239], a[200:203], v[248:251], v[224:239]
v_exp_f32 v192, v192
v_exp_f32 v193, v193
v_exp_f32 v194, v194
v_exp_f32 v195, v195
v_exp_f32 v196, v196
v_exp_f32 v197, v197
v_exp_f32 v198, v198
v_mfma_f32_32x32x16_bf16 v[48:63], a[128:131], v[88:91], v[48:63]
v_exp_f32 v199, v199
v_cvt_pk_bf16_f32 v80, v192, v193
v_cvt_pk_bf16_f32 v81, v194, v195
v_cvt_pk_bf16_f32 v82, v196, v197
s_add_u32 s99, s63, 1
s_sub_u32 s3, s99, 10
s_cselect_b32 s99, s99, s3
s_lshl_b32 s99, s99, 12
s_add_u32 s99, s99, s98
buffer_load_dwordx4 a[16:19], v0, s[32:35], s99 offen sc1
v_cvt_pk_bf16_f32 v83, v198, v199
v_exp_f32 v200, v200
v_exp_f32 v201, v201
v_exp_f32 v202, v202
v_exp_f32 v203, v203
v_mfma_f32_32x32x16_bf16 v[48:63], a[132:135], v[92:95], v[48:63]
v_exp_f32 v204, v204
v_exp_f32 v205, v205
v_exp_f32 v206, v206
v_exp_f32 v207, v207
v_cvt_pk_bf16_f32 v84, v200, v201
v_cvt_pk_bf16_f32 v85, v202, v203
v_cvt_pk_bf16_f32 v86, v204, v205
v_cvt_pk_bf16_f32 v87, v206, v207
buffer_load_dwordx4 a[20:23], v0, s[32:35], s99 offen offset:1024 sc1
v_mfma_f32_32x32x16_bf16 v[48:63], a[136:139], v[80:83], v[48:63]
v_exp_f32 v208, v208
v_exp_f32 v209, v209
v_exp_f32 v210, v210
v_exp_f32 v211, v211
v_exp_f32 v212, v212
v_exp_f32 v213, v213
v_exp_f32 v214, v214
v_exp_f32 v215, v215
v_cvt_pk_bf16_f32 v88, v208, v209
v_cvt_pk_bf16_f32 v89, v210, v211
v_cvt_pk_bf16_f32 v90, v212, v213
v_cvt_pk_bf16_f32 v91, v214, v215
buffer_load_dwordx4 a[24:27], v0, s[32:35], s99 offen offset:2048 sc1
buffer_load_dwordx4 a[28:31], v0, s[32:35], s99 offen offset:3072 sc1
v_mfma_f32_32x32x16_bf16 v[48:63], a[140:143], v[84:87], v[48:63]
v_exp_f32 v216, v216
v_exp_f32 v217, v217
v_exp_f32 v218, v218
v_exp_f32 v219, v219
v_exp_f32 v220, v220
v_exp_f32 v221, v221
v_exp_f32 v222, v222
v_exp_f32 v223, v223
v_cvt_pk_bf16_f32 v92, v216, v217
v_cvt_pk_bf16_f32 v93, v218, v219
v_cvt_pk_bf16_f32 v94, v220, v221
v_cvt_pk_bf16_f32 v95, v222, v223
s_add_u32 s99, s63, 2
s_sub_u32 s3, s99, 10
s_cselect_b32 s99, s99, s3
s_lshl_b32 s99, s99, 12
s_add_u32 s99, s99, s98
buffer_load_dwordx4 a[32:35], v0, s[32:35], s99 offen sc1
v_mfma_f32_32x32x16_bf16 v[48:63], a[144:147], v[88:91], v[48:63]
v_exp_f32 v224, v224
v_exp_f32 v225, v225
v_exp_f32 v226, v226
v_exp_f32 v227, v227
v_exp_f32 v228, v228
v_exp_f32 v229, v229
v_exp_f32 v230, v230
v_exp_f32 v231, v231
v_cvt_pk_bf16_f32 v80, v224, v225
v_cvt_pk_bf16_f32 v81, v226, v227
v_cvt_pk_bf16_f32 v82, v228, v229
v_cvt_pk_bf16_f32 v83, v230, v231
buffer_load_dwordx4 a[36:39], v0, s[32:35], s99 offen offset:1024 sc1
v_mfma_f32_32x32x16_bf16 v[48:63], a[148:151], v[92:95], v[48:63]
v_exp_f32 v232, v232
v_exp_f32 v233, v233
v_exp_f32 v234, v234
v_exp_f32 v235, v235
v_exp_f32 v236, v236
v_exp_f32 v237, v237
v_exp_f32 v238, v238
v_exp_f32 v239, v239
v_cvt_pk_bf16_f32 v84, v232, v233
v_cvt_pk_bf16_f32 v85, v234, v235
v_cvt_pk_bf16_f32 v86, v236, v237
v_cvt_pk_bf16_f32 v87, v238, v239
v_bfi_b32 v88, v240, 0, v80
v_bfi_b32 v89, v241, 0, v81
v_bfi_b32 v90, v242, 0, v82
v_bfi_b32 v91, v243, 0, v83
v_bfi_b32 v92, v244, 0, v84
v_bfi_b32 v93, v245, 0, v85
v_bfi_b32 v94, v246, 0, v86
v_bfi_b32 v95, v247, 0, v87
v_mfma_f32_32x32x16_bf16 v[48:63], a[88:91], v[88:91], v[48:63]
v_and_b32 v80, v240, v80
v_and_b32 v81, v241, v81
v_and_b32 v82, v242, v82
v_and_b32 v83, v243, v83
v_mfma_f32_32x32x16_bf16 v[48:63], a[92:95], v[92:95], v[48:63]
v_and_b32 v84, v244, v84
v_and_b32 v85, v245, v85
v_and_b32 v86, v246, v86
v_and_b32 v87, v247, v87
buffer_load_dwordx4 a[40:43], v0, s[32:35], s99 offen offset:2048 sc1
buffer_load_dwordx4 a[44:47], v0, s[32:35], s99 offen offset:3072 sc1
v_mfma_f32_32x32x16_bf16 v[48:63], a[152:155], v[80:83], v[48:63]
v_mfma_f32_32x32x16_bf16 v[48:63], a[156:159], v[84:87], v[48:63]
s_nop 11
v_rcp_f32 v16, v60
s_nop 0
v_mul_f32 v48, v48, v16
v_mul_f32 v49, v49, v16
v_mul_f32 v50, v50, v16
v_mul_f32 v51, v51, v16
v_mul_f32 v52, v52, v16
v_mul_f32 v53, v53, v16
v_mul_f32 v54, v54, v16
v_mul_f32 v55, v55, v16
v_mul_f32 v56, v56, v16
v_mul_f32 v57, v57, v16
v_mul_f32 v58, v58, v16
v_mul_f32 v59, v59, v16
v_cvt_pk_bf16_f32 v48, v48, v49
v_cvt_pk_bf16_f32 v49, v50, v51
v_cvt_pk_bf16_f32 v50, v52, v53
v_cvt_pk_bf16_f32 v51, v54, v55
v_cvt_pk_bf16_f32 v52, v56, v57
v_cvt_pk_bf16_f32 v53, v58, v59
ds_write_b64 v21, v[48:49] offset:5120
ds_write_b64 v22, v[50:51] offset:5120
ds_write_b64 v23, v[52:53] offset:5120
s_waitcnt lgkmcnt(0)
s_barrier
ds_read_b128 v[76:79], v17 offset:0
ds_read_b128 v[80:83], v17 offset:4096
ds_read_b128 v[84:87], v17 offset:8192
s_waitcnt lgkmcnt(2)
buffer_store_dwordx4 v[76:79], v0, s[32:35], s80 offen sc1
s_waitcnt lgkmcnt(1)
buffer_store_dwordx4 v[80:83], v0, s[32:35], s81 offen sc1
s_waitcnt lgkmcnt(0)
buffer_store_dwordx4 v[84:87], v0, s[32:35], s82 offen sc1
s_cmp_eq_u32 s57, 1280
s_cbranch_scc1 L_s3o
s_lshl_b32 s3, s62, 2
s_add_u32 s3, s3, s60
s_cmp_lt_u32 s3, 7
s_cbranch_scc1 L_s3w3
s_branch L_s3w2
L_s3w3:
v_bfe_u32 v30, v3, 2, 2
v_lshrrev_b32 v31, 5, v3
v_lshl_add_u32 v30, v31, 2, v30
v_lshlrev_b32 v1, 7, v30
v_bfe_u32 v30, v3, 4, 1
v_lshl_add_u32 v1, v30, 5, v1
v_and_b32 v30, 3, v3
v_lshl_add_u32 v1, v30, 3, v1
v_bfe_u32 v30, v3, 3, 1
v_lshl_add_u32 v1, v30, 6, v1
v_xor_b32 v2, 64, v1
ds_read_b64_tr_b16 a[160:161], v1 offset:0
ds_read_b64_tr_b16 a[162:163], v1 offset:1024
ds_read_b64_tr_b16 a[164:165], v2 offset:0
ds_read_b64_tr_b16 a[166:167], v2 offset:1024
ds_read_b64_tr_b16 a[168:169], v1 offset:2048
ds_read_b64_tr_b16 a[170:171], v1 offset:3072
ds_read_b64_tr_b16 a[172:173], v2 offset:2048
ds_read_b64_tr_b16 a[174:175], v2 offset:3072
ds_read_b64_tr_b16 a[176:177], v1 offset:4096
ds_read_b64_tr_b16 a[178:179], v1 offset:5120
ds_read_b64_tr_b16 a[180:181], v2 offset:4096
ds_read_b64_tr_b16 a[182:183], v2 offset:5120
s_waitcnt lgkmcnt(8)
s_waitcnt vmcnt(14)
v_mfma_f32_32x32x16_bf16 v[32:47], a[160:163], a[0:3], 0
ds_read_b64_tr_b16 a[184:185], v1 offset:6144
ds_read_b64_tr_b16 a[186:187], v1 offset:7168
s_add_u32 m0, s41, 114688
s_add_u32 s51, s63, 4
s_sub_u32 s52, s51, 10
s_cselect_b32 s51, s51, s52
v_mfma_f32_32x32x16_bf16 v[48:63], a[164:167], a[0:3], 0
ds_read_b64_tr_b16 a[188:189], v2 offset:6144
ds_read_b64_tr_b16 a[190:191], v2 offset:7168
s_mul_i32 s52, s51, s53
s_add_u32 s52, s52, s58
s_add_u32 s52, s52, 128
s_waitcnt lgkmcnt(8)
s_waitcnt vmcnt(13)
v_mfma_f32_32x32x16_bf16 v[32:47], a[168:171], a[4:7], v[32:47]
ds_read_b64_tr_b16 a[160:161], v1 offset:8192
ds_read_b64_tr_b16 a[162:163], v1 offset:9216
buffer_load_dwordx4 v4, s[20:23], s52 offen lds
v_mfma_f32_32x32x16_bf16 v[48:63], a[172:175], a[4:7], v[48:63]
ds_read_b64_tr_b16 a[164:165], v2 offset:8192
ds_read_b64_tr_b16 a[166:167], v2 offset:9216
s_add_u32 s99, s63, 3
s_sub_u32 s3, s99, 10
s_cselect_b32 s99, s99, s3
s_lshl_b32 s99, s99, 12
s_add_u32 s99, s99, s98
buffer_load_dwordx4 a[48:51], v0, s[32:35], s99 offen sc1
s_waitcnt lgkmcnt(8)
s_waitcnt vmcnt(14)
v_mfma_f32_32x32x16_bf16 v[32:47], a[176:179], a[8:11], v[32:47]
ds_read_b64_tr_b16 a[168:169], v1 offset:10240
ds_read_b64_tr_b16 a[170:171], v1 offset:11264
buffer_load_dwordx4 v5, s[20:23], s52 offen offset:1024 lds
v_mfma_f32_32x32x16_bf16 v[48:63], a[180:183], a[8:11], v[48:63]
ds_read_b64_tr_b16 a[172:173], v2 offset:10240
ds_read_b64_tr_b16 a[174:175], v2 offset:11264
buffer_load_dwordx4 a[52:55], v0, s[32:35], s99 offen offset:1024 sc1
s_mul_i32 s5, s44, 110592
s_add_u32 s5, s5, 19005440
s_lshl_b32 s4, s58, 5
s_add_u32 s64, s5, s4
s_add_u32 s65, s64, 4096
s_lshl_b32 s4, s59, 5
v_cmp_gt_u32 vcc, 45, v20
s_nop 1
s_cbranch_vccnz L_pw60
L_pr62:
v_and_b32 v21, 31, v3
v_lshlrev_b32 v21, 5, v21
v_lshrrev_b32 v22, 5, v3
v_lshl_add_u32 v21, v22, 4, v21
s_lshl_b32 s3, s59, 4
s_add_u32 s3, s3, 327680
buffer_load_dwordx4 v[100:103], v21, s[32:35], s74 offen offset:0 sc1
buffer_load_dwordx4 v[104:107], v21, s[32:35], s74 offen offset:1024 sc1
buffer_load_dwordx4 v[108:111], v21, s[32:35], s74 offen offset:2048 sc1
buffer_load_dwordx4 v[112:115], v21, s[32:35], s74 offen offset:3072 sc1
buffer_load_dwordx4 v[116:119], v21, s[32:35], s3 offen offset:0 sc1
buffer_load_dwordx4 v[120:123], v21, s[32:35], s3 offen offset:1024 sc1
s_waitcnt lgkmcnt(8)
s_waitcnt vmcnt(21)
v_mfma_f32_32x32x16_bf16 v[32:47], a[184:187], a[12:15], v[32:47]
ds_read_b64_tr_b16 a[176:177], v1 offset:12288
ds_read_b64_tr_b16 a[178:179], v1 offset:13312
buffer_load_dwordx4 a[56:59], v0, s[32:35], s99 offen offset:2048 sc1
v_mfma_f32_32x32x16_bf16 v[48:63], a[188:191], a[12:15], v[48:63]
ds_read_b64_tr_b16 a[180:181], v2 offset:12288
ds_read_b64_tr_b16 a[182:183], v2 offset:13312
s_add_u32 s66, s5, s4
s_lshl_b32 s79, s44, 9
s_add_u32 s79, s79, 32768
s_add_u32 s47, s79, 256
v_add_f32 v64, v64, v66
v_add_f32 v65, v65, v67
s_waitcnt lgkmcnt(8)
s_waitcnt vmcnt(21)
v_mfma_f32_32x32x16_bf16 v[32:47], a[160:163], a[16:19], v[32:47]
ds_read_b64_tr_b16 a[184:185], v1 offset:14336
ds_read_b64_tr_b16 a[186:187], v1 offset:15360
buffer_load_dwordx4 v6, s[20:23], s52 offen offset:2048 lds
v_mfma_f32_32x32x16_bf16 v[48:63], a[164:167], a[16:19], v[48:63]
ds_read_b64_tr_b16 a[188:189], v2 offset:14336
ds_read_b64_tr_b16 a[190:191], v2 offset:15360
buffer_load_dwordx4 a[60:63], v0, s[32:35], s99 offen offset:3072 sc1
s_add_u32 s99, s63, 4
s_sub_u32 s3, s99, 10
s_cselect_b32 s99, s99, s3
s_lshl_b32 s99, s99, 12
s_add_u32 s99, s99, s98
buffer_load_dwordx4 a[64:67], v0, s[32:35], s99 offen sc1
s_waitcnt vmcnt(14)
s_waitcnt lgkmcnt(8)
v_mfma_f32_32x32x16_bf16 v[32:47], a[168:171], a[20:23], v[32:47]
s_barrier
ds_read_b64_tr_b16 a[160:161], v1 offset:16384
ds_read_b64_tr_b16 a[162:163], v1 offset:17408
v_add_f32 v64, v64, v68
v_add_f32 v65, v65, v69
v_mfma_f32_32x32x16_bf16 v[48:63], a[172:175], a[20:23], v[48:63]
ds_read_b64_tr_b16 a[164:165], v2 offset:16384
ds_read_b64_tr_b16 a[166:167], v2 offset:17408
v_add_f32 v64, v64, v70
v_add_f32 v65, v65, v71
v_add_f32 v64, v64, v72
v_add_f32 v65, v65, v73
s_waitcnt lgkmcnt(8)
v_mfma_f32_32x32x16_bf16 v[32:47], a[176:179], a[24:27], v[32:47]
ds_read_b64_tr_b16 a[168:169], v1 offset:18432
ds_read_b64_tr_b16 a[170:171], v1 offset:19456
buffer_load_dwordx4 v7, s[20:23], s52 offen offset:3072 lds
v_mfma_f32_32x32x16_bf16 v[48:63], a[180:183], a[24:27], v[48:63]
ds_read_b64_tr_b16 a[172:173], v2 offset:18432
ds_read_b64_tr_b16 a[174:175], v2 offset:19456
s_add_u32 m0, s41, 131072
s_add_u32 s51, s63, 6
s_sub_u32 s52, s51, 10
s_cselect_b32 s51, s51, s52
s_mul_i32 s52, s51, s53
s_add_u32 s52, s52, s58
s_add_u32 s52, s52, 128
buffer_load_dwordx4 v4, s[20:23], s52 offen lds
buffer_load_dwordx4 a[68:71], v0, s[32:35], s99 offen offset:1024 sc1
buffer_atomic_add v14, v19, s[32:35], 0 offen sc1
v_mov_b32 v66, v64
s_nop 1
v_permlane32_swap_b32 v64, v66
v_add_f32 v64, v64, v66
v_mov_b32 v67, v65
s_nop 1
v_permlane32_swap_b32 v65, v67
v_add_f32 v65, v65, v67
s_waitcnt lgkmcnt(8)
v_mfma_f32_32x32x16_bf16 v[32:47], a[184:187], a[28:31], v[32:47]
ds_read_b64_tr_b16 a[176:177], v1 offset:20480
ds_read_b64_tr_b16 a[178:179], v1 offset:21504
buffer_load_dwordx4 v5, s[20:23], s52 offen offset:1024 lds
v_mfma_f32_32x32x16_bf16 v[48:63], a[188:191], a[28:31], v[48:63]
ds_read_b64_tr_b16 a[180:181], v2 offset:20480
ds_read_b64_tr_b16 a[182:183], v2 offset:21504
buffer_load_dwordx4 a[72:75], v0, s[32:35], s99 offen offset:2048 sc1
s_waitcnt lgkmcnt(8)
v_mfma_f32_32x32x16_bf16 v[32:47], a[160:163], a[32:35], v[32:47]
ds_read_b64_tr_b16 a[184:185], v1 offset:22528
ds_read_b64_tr_b16 a[186:187], v1 offset:23552
buffer_load_dwordx4 a[76:79], v0, s[32:35], s99 offen offset:3072 sc1
v_mfma_f32_32x32x16_bf16 v[48:63], a[164:167], a[32:35], v[48:63]
ds_read_b64_tr_b16 a[188:189], v2 offset:22528
ds_read_b64_tr_b16 a[190:191], v2 offset:23552
v_mul_f32 v64, 0xbacccccd, v64
v_mul_f32 v65, 0x3acccccd, v65
v_fma_f32 v65, -v64, v64, v65
v_max_f32 v65, 0, v65
v_add_f32 v66, 0x3727c5ac, v65
v_rsq_f32 v8, v66
s_waitcnt lgkmcnt(8)
v_mfma_f32_32x32x16_bf16 v[32:47], a[168:171], a[36:39], v[32:47]
ds_read_b64_tr_b16 a[160:161], v1 offset:24576
ds_read_b64_tr_b16 a[162:163], v1 offset:25600
buffer_load_dwordx4 v6, s[20:23], s52 offen offset:2048 lds
v_mfma_f32_32x32x16_bf16 v[48:63], a[172:175], a[36:39], v[48:63]
ds_read_b64_tr_b16 a[164:165], v2 offset:24576
ds_read_b64_tr_b16 a[166:167], v2 offset:25600
s_add_u32 s99, s63, 5
s_sub_u32 s3, s99, 10
s_cselect_b32 s99, s99, s3
s_lshl_b32 s99, s99, 12
s_add_u32 s99, s99, s98
buffer_load_dwordx4 a[80:83], v0, s[32:35], s99 offen sc1
v_cmp_gt_u32 vcc, 32, v3
v_mul_f32 v9, v64, v8
s_nop 0
v_cndmask_b32 v64, 0, v64, vcc
v_and_b32 v66, 0xffff0000, v64
v_sub_f32 v67, v64, v66
v_lshrrev_b32 v64, 16, v64
s_waitcnt lgkmcnt(8)
v_mfma_f32_32x32x16_bf16 v[32:47], a[176:179], a[40:43], v[32:47]
ds_read_b64_tr_b16 a[168:169], v1 offset:26624
ds_read_b64_tr_b16 a[170:171], v1 offset:27648
buffer_load_dwordx4 v7, s[20:23], s52 offen offset:3072 lds
v_mfma_f32_32x32x16_bf16 v[48:63], a[180:183], a[40:43], v[48:63]
ds_read_b64_tr_b16 a[172:173], v2 offset:26624
ds_read_b64_tr_b16 a[174:175], v2 offset:27648
buffer_load_dwordx4 a[84:87], v0, s[32:35], s99 offen offset:1024 sc1
s_waitcnt lgkmcnt(8)
v_mfma_f32_32x32x16_bf16 v[32:47], a[184:187], a[44:47], v[32:47]
ds_read_b64_tr_b16 a[176:177], v1 offset:28672
ds_read_b64_tr_b16 a[178:179], v1 offset:29696
buffer_load_dwordx4 a[88:91], v0, s[32:35], s99 offen offset:2048 sc1
v_mfma_f32_32x32x16_bf16 v[48:63], a[188:191], a[44:47], v[48:63]
ds_read_b64_tr_b16 a[180:181], v2 offset:28672
ds_read_b64_tr_b16 a[182:183], v2 offset:29696
v_or_b32 v66, v66, v64
v_lshrrev_b32 v67, 16, v67
v_accvgpr_write_b32 a196, v66
v_accvgpr_write_b32 a197, v67
v_rcp_f32 v12, v8
v_mul_f32 v10, 0xc0135761, v8
s_waitcnt lgkmcnt(8)
s_waitcnt vmcnt(24)
v_mfma_f32_32x32x16_bf16 v[32:47], a[160:163], a[48:51], v[32:47]
ds_read_b64_tr_b16 a[184:185], v1 offset:30720
ds_read_b64_tr_b16 a[186:187], v1 offset:31744
buffer_load_dwordx4 a[92:95], v0, s[32:35], s99 offen offset:3072 sc1
v_mfma_f32_32x32x16_bf16 v[48:63], a[164:167], a[48:51], v[48:63]
ds_read_b64_tr_b16 a[188:189], v2 offset:30720
ds_read_b64_tr_b16 a[190:191], v2 offset:31744
v_mul_f32 v66, v8, v8
v_mul_f32 v66, v66, v8
v_mul_f32 v11, 0xbdd2d3e8, v66
v_mov_b32 v156, 0
v_mov_b32 v157, 0
s_waitcnt lgkmcnt(8)
s_waitcnt vmcnt(23)
v_mfma_f32_32x32x16_bf16 v[32:47], a[168:171], a[52:55], v[32:47]
s_barrier
ds_read_b64_tr_b16 a[160:161], v1 offset:32768
ds_read_b64_tr_b16 a[162:163], v1 offset:33792
s_add_u32 m0, s41, 0
s_add_u32 s51, s63, 8
v_mfma_f32_32x32x16_bf16 v[48:63], a[172:175], a[52:55], v[48:63]
ds_read_b64_tr_b16 a[164:165], v2 offset:32768
ds_read_b64_tr_b16 a[166:167], v2 offset:33792
s_sub_u32 s52, s51, 10
s_cselect_b32 s51, s51, s52
s_mul_i32 s52, s51, s53
s_add_u32 s99, s63, 6
s_sub_u32 s3, s99, 10
s_cselect_b32 s99, s99, s3
s_lshl_b32 s99, s99, 12
s_add_u32 s99, s99, s98
buffer_load_dwordx4 a[96:99], v0, s[32:35], s99 offen sc1
s_waitcnt lgkmcnt(8)
s_waitcnt vmcnt(17)
v_mfma_f32_32x32x16_bf16 v[32:47], a[176:179], a[56:59], v[32:47]
ds_read_b64_tr_b16 a[168:169], v1 offset:34816
ds_read_b64_tr_b16 a[170:171], v1 offset:35840
s_add_u32 s52, s52, s58
s_add_u32 s52, s52, 128
v_mfma_f32_32x32x16_bf16 v[48:63], a[180:183], a[56:59], v[48:63]
ds_read_b64_tr_b16 a[172:173], v2 offset:34816
ds_read_b64_tr_b16 a[174:175], v2 offset:35840
buffer_load_dwordx4 v4, s[20:23], s52 offen lds
buffer_load_dwordx4 a[100:103], v0, s[32:35], s99 offen offset:1024 sc1
s_waitcnt lgkmcnt(8)
s_waitcnt vmcnt(17)
v_mfma_f32_32x32x16_bf16 v[32:47], a[184:187], a[60:63], v[32:47]
ds_read_b64_tr_b16 a[176:177], v1 offset:36864
ds_read_b64_tr_b16 a[178:179], v1 offset:37888
buffer_load_dwordx4 v5, s[20:23], s52 offen offset:1024 lds
v_mfma_f32_32x32x16_bf16 v[48:63], a[188:191], a[60:63], v[48:63]
ds_read_b64_tr_b16 a[180:181], v2 offset:36864
ds_read_b64_tr_b16 a[182:183], v2 offset:37888
buffer_load_dwordx4 a[104:107], v0, s[32:35], s99 offen offset:2048 sc1
v_add_f32 v101, v101, v102
v_add_f32 v103, v103, v100
v_cmp_gt_u32 vcc, 32, v3
v_add_f32 v101, v101, v103
s_nop 0
v_cndmask_b32 v100, v100, v101, vcc
v_mov_b32 v101, v100
s_nop 1
v_permlane32_swap_b32 v100, v101
v_add_f32 v100, v100, v101
v_and_b32 v22, 0xffff0000, v100
v_sub_f32 v22, v100, v22
v_lshrrev_b32 v23, 16, v100
v_and_or_b32 v22, v22, s78, v23
v_mov_b32 v144, v22
v_mov_b32 v145, v23
s_waitcnt lgkmcnt(8)
s_waitcnt vmcnt(18)
v_mfma_f32_32x32x16_bf16 v[32:47], a[160:163], a[64:67], v[32:47]
ds_read_b64_tr_b16 a[184:185], v1 offset:38912
ds_read_b64_tr_b16 a[186:187], v1 offset:39936
buffer_load_dwordx4 a[108:111], v0, s[32:35], s99 offen offset:3072 sc1
v_mfma_f32_32x32x16_bf16 v[48:63], a[164:167], a[64:67], v[48:63]
ds_read_b64_tr_b16 a[188:189], v2 offset:38912
ds_read_b64_tr_b16 a[190:191], v2 offset:39936
s_add_u32 s99, s63, 7
s_sub_u32 s3, s99, 10
s_cselect_b32 s99, s99, s3
s_waitcnt lgkmcnt(8)
s_waitcnt vmcnt(16)
v_mfma_f32_32x32x16_bf16 v[32:47], a[168:171], a[68:71], v[32:47]
ds_read_b64_tr_b16 a[160:161], v1 offset:40960
ds_read_b64_tr_b16 a[162:163], v1 offset:41984
buffer_load_dwordx4 v6, s[20:23], s52 offen offset:2048 lds
v_mfma_f32_32x32x16_bf16 v[48:63], a[172:175], a[68:71], v[48:63]
ds_read_b64_tr_b16 a[164:165], v2 offset:40960
ds_read_b64_tr_b16 a[166:167], v2 offset:41984
s_lshl_b32 s99, s99, 12
s_add_u32 s99, s99, s98
buffer_load_dwordx4 a[112:115], v0, s[32:35], s99 offen sc1
s_waitcnt lgkmcnt(8)
s_waitcnt vmcnt(15)
v_mfma_f32_32x32x16_bf16 v[32:47], a[176:179], a[72:75], v[32:47]
ds_read_b64_tr_b16 a[168:169], v1 offset:43008
ds_read_b64_tr_b16 a[170:171], v1 offset:44032
buffer_load_dwordx4 v7, s[20:23], s52 offen offset:3072 lds
v_mfma_f32_32x32x16_bf16 v[48:63], a[180:183], a[72:75], v[48:63]
ds_read_b64_tr_b16 a[172:173], v2 offset:43008
ds_read_b64_tr_b16 a[174:175], v2 offset:44032
buffer_load_dwordx4 a[116:119], v0, s[32:35], s99 offen offset:1024 sc1
v_add_f32 v105, v105, v106
v_add_f32 v107, v107, v104
v_cmp_gt_u32 vcc, 32, v3
v_add_f32 v105, v105, v107
s_nop 0
v_cndmask_b32 v104, v104, v105, vcc
v_mov_b32 v105, v104
s_nop 1
v_permlane32_swap_b32 v104, v105
v_add_f32 v104, v104, v105
v_and_b32 v22, 0xffff0000, v104
v_sub_f32 v22, v104, v22
v_lshrrev_b32 v23, 16, v104
v_and_or_b32 v22, v22, s78, v23
v_mov_b32 v146, v22
v_mov_b32 v147, v23
s_waitcnt lgkmcnt(8)
s_waitcnt vmcnt(16)
v_mfma_f32_32x32x16_bf16 v[32:47], a[184:187], a[76:79], v[32:47]
ds_read_b64_tr_b16 a[176:177], v1 offset:45056
ds_read_b64_tr_b16 a[178:179], v1 offset:46080
buffer_load_dwordx4 a[120:123], v0, s[32:35], s99 offen offset:2048 sc1
v_mfma_f32_32x32x16_bf16 v[48:63], a[188:191], a[76:79], v[48:63]
ds_read_b64_tr_b16 a[180:181], v2 offset:45056
ds_read_b64_tr_b16 a[182:183], v2 offset:46080
s_waitcnt lgkmcnt(8)
s_waitcnt vmcnt(15)
v_mfma_f32_32x32x16_bf16 v[32:47], a[160:163], a[80:83], v[32:47]
ds_read_b64_tr_b16 a[184:185], v1 offset:47104
ds_read_b64_tr_b16 a[186:187], v1 offset:48128
buffer_load_dwordx4 a[124:127], v0, s[32:35], s99 offen offset:3072 sc1
v_mfma_f32_32x32x16_bf16 v[48:63], a[164:167], a[80:83], v[48:63]
ds_read_b64_tr_b16 a[188:189], v2 offset:47104
ds_read_b64_tr_b16 a[190:191], v2 offset:48128
s_add_u32 s99, s63, 8
s_sub_u32 s3, s99, 10
s_cselect_b32 s99, s99, s3
s_waitcnt lgkmcnt(8)
s_waitcnt vmcnt(14)
v_mfma_f32_32x32x16_bf16 v[32:47], a[168:171], a[84:87], v[32:47]
s_barrier
ds_read_b64_tr_b16 a[160:161], v1 offset:49152
ds_read_b64_tr_b16 a[162:163], v1 offset:50176
s_add_u32 m0, s41, 16384
s_mul_i32 s52, s63, s53
v_mfma_f32_32x32x16_bf16 v[48:63], a[172:175], a[84:87], v[48:63]
ds_read_b64_tr_b16 a[164:165], v2 offset:49152
ds_read_b64_tr_b16 a[166:167], v2 offset:50176
s_add_u32 s52, s52, s59
s_lshl_b32 s99, s99, 12
s_add_u32 s99, s99, s98
buffer_load_dwordx4 a[128:131], v0, s[32:35], s99 offen sc1
v_add_f32 v109, v109, v110
v_add_f32 v111, v111, v108
v_cmp_gt_u32 vcc, 32, v3
v_add_f32 v109, v109, v111
s_nop 0
v_cndmask_b32 v108, v108, v109, vcc
v_mov_b32 v109, v108
s_nop 1
v_permlane32_swap_b32 v108, v109
v_add_f32 v108, v108, v109
v_and_b32 v22, 0xffff0000, v108
v_sub_f32 v22, v108, v22
v_lshrrev_b32 v23, 16, v108
v_and_or_b32 v22, v22, s78, v23
v_mov_b32 v148, v22
v_mov_b32 v149, v23
s_waitcnt lgkmcnt(8)
s_waitcnt vmcnt(14)
v_mfma_f32_32x32x16_bf16 v[32:47], a[176:179], a[88:91], v[32:47]
ds_read_b64_tr_b16 a[168:169], v1 offset:51200
ds_read_b64_tr_b16 a[170:171], v1 offset:52224
buffer_load_dwordx4 v4, s[20:23], s52 offen lds
v_mfma_f32_32x32x16_bf16 v[48:63], a[180:183], a[88:91], v[48:63]
ds_read_b64_tr_b16 a[172:173], v2 offset:51200
ds_read_b64_tr_b16 a[174:175], v2 offset:52224
buffer_load_dwordx4 a[132:135], v0, s[32:35], s99 offen offset:1024 sc1
s_waitcnt lgkmcnt(8)
s_waitcnt vmcnt(15)
v_mfma_f32_32x32x16_bf16 v[32:47], a[184:187], a[92:95], v[32:47]
ds_read_b64_tr_b16 a[176:177], v1 offset:53248
ds_read_b64_tr_b16 a[178:179], v1 offset:54272
buffer_load_dwordx4 v5, s[20:23], s52 offen offset:1024 lds
v_mfma_f32_32x32x16_bf16 v[48:63], a[188:191], a[92:95], v[48:63]
ds_read_b64_tr_b16 a[180:181], v2 offset:53248
ds_read_b64_tr_b16 a[182:183], v2 offset:54272
buffer_load_dwordx4 a[136:139], v0, s[32:35], s99 offen offset:2048 sc1
s_waitcnt lgkmcnt(8)
s_waitcnt vmcnt(16)
v_mfma_f32_32x32x16_bf16 v[32:47], a[160:163], a[96:99], v[32:47]
ds_read_b64_tr_b16 a[184:185], v1 offset:55296
ds_read_b64_tr_b16 a[186:187], v1 offset:56320
buffer_load_dwordx4 a[140:143], v0, s[32:35], s99 offen offset:3072 sc1
v_mfma_f32_32x32x16_bf16 v[48:63], a[164:167], a[96:99], v[48:63]
ds_read_b64_tr_b16 a[188:189], v2 offset:55296
ds_read_b64_tr_b16 a[190:191], v2 offset:56320
s_add_u32 s99, s63, 9
s_sub_u32 s3, s99, 10
s_cselect_b32 s99, s99, s3
s_waitcnt lgkmcnt(8)
s_waitcnt vmcnt(15)
v_mfma_f32_32x32x16_bf16 v[32:47], a[168:171], a[100:103], v[32:47]
ds_read_b64_tr_b16 a[160:161], v1 offset:57344
ds_read_b64_tr_b16 a[162:163], v1 offset:58368
buffer_load_dwordx4 v6, s[20:23], s52 offen offset:2048 lds
v_mfma_f32_32x32x16_bf16 v[48:63], a[172:175], a[100:103], v[48:63]
ds_read_b64_tr_b16 a[164:165], v2 offset:57344
ds_read_b64_tr_b16 a[166:167], v2 offset:58368
s_lshl_b32 s99, s99, 12
s_add_u32 s99, s99, s98
buffer_load_dwordx4 a[144:147], v0, s[32:35], s99 offen sc1
v_add_f32 v113, v113, v114
v_add_f32 v115, v115, v112
v_cmp_gt_u32 vcc, 32, v3
v_add_f32 v113, v113, v115
s_nop 0
v_cndmask_b32 v112, v112, v113, vcc
v_mov_b32 v113, v112
s_nop 1
v_permlane32_swap_b32 v112, v113
v_add_f32 v112, v112, v113
v_and_b32 v22, 0xffff0000, v112
v_sub_f32 v22, v112, v22
v_lshrrev_b32 v23, 16, v112
v_and_or_b32 v22, v22, s78, v23
v_mov_b32 v150, v22
v_mov_b32 v151, v23
s_waitcnt lgkmcnt(8)
s_waitcnt vmcnt(15)
v_mfma_f32_32x32x16_bf16 v[32:47], a[176:179], a[104:107], v[32:47]
ds_read_b64_tr_b16 a[168:169], v1 offset:59392
ds_read_b64_tr_b16 a[170:171], v1 offset:60416
buffer_load_dwordx4 v7, s[20:23], s52 offen offset:3072 lds
v_mfma_f32_32x32x16_bf16 v[48:63], a[180:183], a[104:107], v[48:63]
ds_read_b64_tr_b16 a[172:173], v2 offset:59392
ds_read_b64_tr_b16 a[174:175], v2 offset:60416
buffer_load_dwordx4 a[148:151], v0, s[32:35], s99 offen offset:1024 sc1
s_waitcnt lgkmcnt(8)
s_waitcnt vmcnt(16)
v_mfma_f32_32x32x16_bf16 v[32:47], a[184:187], a[108:111], v[32:47]
ds_read_b64_tr_b16 a[176:177], v1 offset:61440
ds_read_b64_tr_b16 a[178:179], v1 offset:62464
buffer_load_dwordx4 a[152:155], v0, s[32:35], s99 offen offset:2048 sc1
v_mfma_f32_32x32x16_bf16 v[48:63], a[188:191], a[108:111], v[48:63]
ds_read_b64_tr_b16 a[180:181], v2 offset:61440
ds_read_b64_tr_b16 a[182:183], v2 offset:62464
s_waitcnt lgkmcnt(8)
s_waitcnt vmcnt(15)
v_mfma_f32_32x32x16_bf16 v[32:47], a[160:163], a[112:115], v[32:47]
ds_read_b64_tr_b16 a[184:185], v1 offset:63488
ds_read_b64_tr_b16 a[186:187], v1 offset:64512
buffer_load_dwordx4 a[156:159], v0, s[32:35], s99 offen offset:3072 sc1
v_mfma_f32_32x32x16_bf16 v[48:63], a[164:167], a[112:115], v[48:63]
ds_read_b64_tr_b16 a[188:189], v2 offset:63488
ds_read_b64_tr_b16 a[190:191], v2 offset:64512
v_add_f32 v117, v117, v118
v_add_f32 v119, v119, v116
v_cmp_gt_u32 vcc, 32, v3
v_add_f32 v117, v117, v119
s_nop 0
v_cndmask_b32 v116, v116, v117, vcc
v_mov_b32 v117, v116
s_nop 1
v_permlane32_swap_b32 v116, v117
v_add_f32 v116, v116, v117
v_and_b32 v22, 0xffff0000, v116
v_sub_f32 v22, v116, v22
v_lshrrev_b32 v23, 16, v116
v_and_or_b32 v22, v22, s78, v23
v_mov_b32 v152, v22
v_mov_b32 v153, v23
s_waitcnt lgkmcnt(8)
s_waitcnt vmcnt(14)
v_mfma_f32_32x32x16_bf16 v[32:47], a[168:171], a[116:119], v[32:47]
s_barrier
v_add_u32 v1, 65536, v1
v_add_u32 v2, 65536, v2
ds_read_b64_tr_b16 a[160:161], v1 offset:0
ds_read_b64_tr_b16 a[162:163], v1 offset:1024
v_mfma_f32_32x32x16_bf16 v[48:63], a[172:175], a[116:119], v[48:63]
ds_read_b64_tr_b16 a[164:165], v2 offset:0
ds_read_b64_tr_b16 a[166:167], v2 offset:1024
s_add_u32 m0, s41, 32768
s_add_u32 s51, s63, 2
s_sub_u32 s52, s51, 10
s_cselect_b32 s51, s51, s52
s_waitcnt lgkmcnt(8)
s_waitcnt vmcnt(13)
v_mfma_f32_32x32x16_bf16 v[32:47], a[176:179], a[120:123], v[32:47]
ds_read_b64_tr_b16 a[168:169], v1 offset:2048
ds_read_b64_tr_b16 a[170:171], v1 offset:3072
s_mul_i32 s52, s51, s53
s_add_u32 s52, s52, s59
v_add_f32 v121, v121, v122
v_add_f32 v123, v123, v120
v_mfma_f32_32x32x16_bf16 v[48:63], a[180:183], a[120:123], v[48:63]
ds_read_b64_tr_b16 a[172:173], v2 offset:2048
ds_read_b64_tr_b16 a[174:175], v2 offset:3072
buffer_load_dwordx4 v4, s[20:23], s52 offen lds
s_waitcnt lgkmcnt(8)
s_waitcnt vmcnt(13)
v_mfma_f32_32x32x16_bf16 v[32:47], a[184:187], a[124:127], v[32:47]
ds_read_b64_tr_b16 a[176:177], v1 offset:4096
ds_read_b64_tr_b16 a[178:179], v1 offset:5120
buffer_load_dwordx4 v5, s[20:23], s52 offen offset:1024 lds
v_mfma_f32_32x32x16_bf16 v[48:63], a[188:191], a[124:127], v[48:63]
ds_read_b64_tr_b16 a[180:181], v2 offset:4096
ds_read_b64_tr_b16 a[182:183], v2 offset:5120
v_cmp_gt_u32 vcc, 32, v3
v_add_f32 v121, v121, v123
s_nop 0
v_cndmask_b32 v120, v120, v121, vcc
v_mov_b32 v121, v120
s_nop 1
v_permlane32_swap_b32 v120, v121
v_add_f32 v120, v120, v121
v_and_b32 v22, 0xffff0000, v120
v_sub_f32 v22, v120, v22
v_lshrrev_b32 v23, 16, v120
v_and_or_b32 v22, v22, s78, v23
v_mov_b32 v154, v22
v_mov_b32 v155, v23
s_waitcnt lgkmcnt(8)
s_waitcnt vmcnt(13)
v_mfma_f32_32x32x16_bf16 v[32:47], a[160:163], a[128:131], v[32:47]
ds_read_b64_tr_b16 a[184:185], v1 offset:6144
ds_read_b64_tr_b16 a[186:187], v1 offset:7168
v_mfma_f32_32x32x16_bf16 v[48:63], a[164:167], a[128:131], v[48:63]
ds_read_b64_tr_b16 a[188:189], v2 offset:6144
ds_read_b64_tr_b16 a[190:191], v2 offset:7168
s_waitcnt lgkmcnt(8)
s_waitcnt vmcnt(11)
v_mfma_f32_32x32x16_bf16 v[32:47], a[168:171], a[132:135], v[32:47]
ds_read_b64_tr_b16 a[160:161], v1 offset:8192
ds_read_b64_tr_b16 a[162:163], v1 offset:9216
buffer_load_dwordx4 v6, s[20:23], s52 offen offset:2048 lds
v_mfma_f32_32x32x16_bf16 v[48:63], a[172:175], a[132:135], v[48:63]
ds_read_b64_tr_b16 a[164:165], v2 offset:8192
ds_read_b64_tr_b16 a[166:167], v2 offset:9216
s_waitcnt lgkmcnt(8)
s_waitcnt vmcnt(10)
v_mfma_f32_32x32x16_bf16 v[32:47], a[176:179], a[136:139], v[32:47]
ds_read_b64_tr_b16 a[168:169], v1 offset:10240
ds_read_b64_tr_b16 a[170:171], v1 offset:11264
v_mfma_f32_32x32x16_bf16 v[48:63], a[180:183], a[136:139], v[48:63]
ds_read_b64_tr_b16 a[172:173], v2 offset:10240
ds_read_b64_tr_b16 a[174:175], v2 offset:11264
s_waitcnt lgkmcnt(8)
s_waitcnt vmcnt(9)
v_mfma_f32_32x32x16_bf16 v[32:47], a[184:187], a[140:143], v[32:47]
ds_read_b64_tr_b16 a[176:177], v1 offset:12288
ds_read_b64_tr_b16 a[178:179], v1 offset:13312
buffer_load_dwordx4 v7, s[20:23], s52 offen offset:3072 lds
v_mfma_f32_32x32x16_bf16 v[48:63], a[188:191], a[140:143], v[48:63]
ds_read_b64_tr_b16 a[180:181], v2 offset:12288
ds_read_b64_tr_b16 a[182:183], v2 offset:13312
v_mfma_f32_32x32x16_bf16 v[32:47], v[144:147], a[196:199], v[32:47]
s_waitcnt lgkmcnt(8)
s_waitcnt vmcnt(8)
v_mfma_f32_32x32x16_bf16 v[32:47], a[160:163], a[144:147], v[32:47]
ds_read_b64_tr_b16 a[184:185], v1 offset:14336
ds_read_b64_tr_b16 a[186:187], v1 offset:15360
v_mfma_f32_32x32x16_bf16 v[48:63], a[164:167], a[144:147], v[48:63]
ds_read_b64_tr_b16 a[188:189], v2 offset:14336
ds_read_b64_tr_b16 a[190:191], v2 offset:15360
v_mfma_f32_32x32x16_bf16 v[48:63], v[146:149], a[196:199], v[48:63]
s_waitcnt lgkmcnt(8)
s_waitcnt vmcnt(6)
v_mfma_f32_32x32x16_bf16 v[32:47], a[168:171], a[148:151], v[32:47]
s_barrier
ds_read_b64_tr_b16 a[160:161], v1 offset:16384
ds_read_b64_tr_b16 a[162:163], v1 offset:17408
s_add_u32 m0, s41, 49152
s_add_u32 s51, s63, 4
v_mfma_f32_32x32x16_bf16 v[48:63], a[172:175], a[148:151], v[48:63]
ds_read_b64_tr_b16 a[164:165], v2 offset:16384
ds_read_b64_tr_b16 a[166:167], v2 offset:17408
s_sub_u32 s52, s51, 10
s_cselect_b32 s51, s51, s52
s_mul_i32 s52, s51, s53
s_waitcnt lgkmcnt(8)
s_waitcnt vmcnt(5)
v_mfma_f32_32x32x16_bf16 v[32:47], a[176:179], a[152:155], v[32:47]
ds_read_b64_tr_b16 a[168:169], v1 offset:18432
ds_read_b64_tr_b16 a[170:171], v1 offset:19456
s_add_u32 s52, s52, s59
v_mfma_f32_32x32x16_bf16 v[48:63], a[180:183], a[152:155], v[48:63]
ds_read_b64_tr_b16 a[172:173], v2 offset:18432
ds_read_b64_tr_b16 a[174:175], v2 offset:19456
buffer_load_dwordx4 v4, s[20:23], s52 offen lds
v_mfma_f32_32x32x16_bf16 v[64:79], v[148:151], a[196:199], 0
buffer_load_dwordx4 v5, s[20:23], s52 offen offset:1024 lds
s_waitcnt lgkmcnt(8)
s_waitcnt vmcnt(6)
v_mfma_f32_32x32x16_bf16 v[32:47], a[184:187], a[156:159], v[32:47]
ds_read_b64_tr_b16 a[176:177], v1 offset:20480
ds_read_b64_tr_b16 a[178:179], v1 offset:21504
buffer_load_dwordx4 v6, s[20:23], s52 offen offset:2048 lds
v_mfma_f32_32x32x16_bf16 v[48:63], a[188:191], a[156:159], v[48:63]
ds_read_b64_tr_b16 a[180:181], v2 offset:20480
ds_read_b64_tr_b16 a[182:183], v2 offset:21504
buffer_load_dwordx4 v7, s[20:23], s52 offen offset:3072 lds
v_mfma_f32_32x32x16_bf16 v[80:95], v[150:153], a[196:199], 0
s_waitcnt lgkmcnt(8)
v_mfma_f32_32x32x16_bf16 v[64:79], a[160:163], a[0:3], v[64:79]
ds_read_b64_tr_b16 a[184:185], v1 offset:22528
ds_read_b64_tr_b16 a[186:187], v1 offset:23552
v_mfma_f32_32x32x16_bf16 v[80:95], a[164:167], a[0:3], v[80:95]
ds_read_b64_tr_b16 a[188:189], v2 offset:22528
ds_read_b64_tr_b16 a[190:191], v2 offset:23552
s_waitcnt lgkmcnt(8)
v_mfma_f32_32x32x16_bf16 v[64:79], a[168:171], a[4:7], v[64:79]
ds_read_b64_tr_b16 a[160:161], v1 offset:24576
ds_read_b64_tr_b16 a[162:163], v1 offset:25600
v_mul_f32 v16, v32, v32
v_mul_f32 v17, v33, v33
v_mul_f32 v18, v34, v34
v_mul_f32 v19, v35, v35
v_fma_f32 v16, v16, v11, v10
v_fma_f32 v17, v17, v11, v10
v_fma_f32 v18, v18, v11, v10
v_mfma_f32_32x32x16_bf16 v[80:95], a[172:175], a[4:7], v[80:95]
ds_read_b64_tr_b16 a[164:165], v2 offset:24576
ds_read_b64_tr_b16 a[166:167], v2 offset:25600
v_fma_f32 v19, v19, v11, v10
v_mul_f32 v16, v16, v32
v_mul_f32 v17, v17, v33
v_mul_f32 v18, v18, v34
v_mul_f32 v19, v19, v35
s_waitcnt lgkmcnt(8)
v_mfma_f32_32x32x16_bf16 v[64:79], a[176:179], a[8:11], v[64:79]
ds_read_b64_tr_b16 a[168:169], v1 offset:26624
ds_read_b64_tr_b16 a[170:171], v1 offset:27648
v_exp_f32 v16, v16
v_exp_f32 v17, v17
v_exp_f32 v18, v18
v_mfma_f32_32x32x16_bf16 v[80:95], a[180:183], a[8:11], v[80:95]
ds_read_b64_tr_b16 a[172:173], v2 offset:26624
ds_read_b64_tr_b16 a[174:175], v2 offset:27648
v_exp_f32 v19, v19
v_fma_f32 v16, v16, v12, v12
v_fma_f32 v17, v17, v12, v12
v_fma_f32 v18, v18, v12, v12
v_fma_f32 v19, v19, v12, v12
s_waitcnt lgkmcnt(8)
v_mfma_f32_32x32x16_bf16 v[64:79], a[184:187], a[12:15], v[64:79]
ds_read_b64_tr_b16 a[176:177], v1 offset:28672
ds_read_b64_tr_b16 a[178:179], v1 offset:29696
v_rcp_f32 v16, v16
v_rcp_f32 v17, v17
v_rcp_f32 v18, v18
v_rcp_f32 v19, v19
v_mfma_f32_32x32x16_bf16 v[80:95], a[188:191], a[12:15], v[80:95]
ds_read_b64_tr_b16 a[180:181], v2 offset:28672
ds_read_b64_tr_b16 a[182:183], v2 offset:29696
v_mul_f32 v32, v32, v16
v_mul_f32 v33, v33, v17
v_mul_f32 v34, v34, v18
v_mul_f32 v35, v35, v19
v_mul_f32 v16, v36, v36
s_waitcnt lgkmcnt(8)
v_mfma_f32_32x32x16_bf16 v[64:79], a[160:163], a[16:19], v[64:79]
ds_read_b64_tr_b16 a[184:185], v1 offset:30720
ds_read_b64_tr_b16 a[186:187], v1 offset:31744
v_mul_f32 v17, v37, v37
v_mul_f32 v18, v38, v38
v_mul_f32 v19, v39, v39
v_fma_f32 v16, v16, v11, v10
v_fma_f32 v17, v17, v11, v10
v_fma_f32 v18, v18, v11, v10
v_fma_f32 v19, v19, v11, v10
v_mfma_f32_32x32x16_bf16 v[80:95], a[164:167], a[16:19], v[80:95]
ds_read_b64_tr_b16 a[188:189], v2 offset:30720
ds_read_b64_tr_b16 a[190:191], v2 offset:31744
v_mul_f32 v16, v16, v36
v_mul_f32 v17, v17, v37
v_mul_f32 v18, v18, v38
v_mul_f32 v19, v19, v39
v_exp_f32 v16, v16
s_waitcnt lgkmcnt(8)
v_mfma_f32_32x32x16_bf16 v[64:79], a[168:171], a[20:23], v[64:79]
s_barrier
ds_read_b64_tr_b16 a[160:161], v1 offset:32768
ds_read_b64_tr_b16 a[162:163], v1 offset:33792
s_add_u32 m0, s41, 65536
s_add_u32 s51, s63, 6
v_exp_f32 v17, v17
v_mfma_f32_32x32x16_bf16 v[80:95], a[172:175], a[20:23], v[80:95]
ds_read_b64_tr_b16 a[164:165], v2 offset:32768
ds_read_b64_tr_b16 a[166:167], v2 offset:33792
s_sub_u32 s52, s51, 10
s_cselect_b32 s51, s51, s52
s_mul_i32 s52, s51, s53
v_exp_f32 v18, v18
s_waitcnt lgkmcnt(8)
v_mfma_f32_32x32x16_bf16 v[64:79], a[176:179], a[24:27], v[64:79]
ds_read_b64_tr_b16 a[168:169], v1 offset:34816
ds_read_b64_tr_b16 a[170:171], v1 offset:35840
s_add_u32 s52, s52, s59
v_exp_f32 v19, v19
v_fma_f32 v16, v16, v12, v12
v_fma_f32 v17, v17, v12, v12
v_fma_f32 v18, v18, v12, v12
v_fma_f32 v19, v19, v12, v12
v_mfma_f32_32x32x16_bf16 v[80:95], a[180:183], a[24:27], v[80:95]
ds_read_b64_tr_b16 a[172:173], v2 offset:34816
ds_read_b64_tr_b16 a[174:175], v2 offset:35840
buffer_load_dwordx4 v4, s[20:23], s52 offen lds
v_rcp_f32 v16, v16
s_waitcnt lgkmcnt(8)
v_mfma_f32_32x32x16_bf16 v[64:79], a[184:187], a[28:31], v[64:79]
ds_read_b64_tr_b16 a[176:177], v1 offset:36864
ds_read_b64_tr_b16 a[178:179], v1 offset:37888
buffer_load_dwordx4 v5, s[20:23], s52 offen offset:1024 lds
v_rcp_f32 v17, v17
v_rcp_f32 v18, v18
v_mfma_f32_32x32x16_bf16 v[80:95], a[188:191], a[28:31], v[80:95]
ds_read_b64_tr_b16 a[180:181], v2 offset:36864
ds_read_b64_tr_b16 a[182:183], v2 offset:37888
v_rcp_f32 v19, v19
v_mul_f32 v36, v36, v16
v_mul_f32 v37, v37, v17
v_mul_f32 v38, v38, v18
s_waitcnt lgkmcnt(8)
v_mfma_f32_32x32x16_bf16 v[64:79], a[160:163], a[32:35], v[64:79]
ds_read_b64_tr_b16 a[184:185], v1 offset:38912
ds_read_b64_tr_b16 a[186:187], v1 offset:39936
v_mul_f32 v39, v39, v19
v_cvt_pk_bf16_f32 v32, v32, v33
v_cvt_pk_bf16_f32 v33, v34, v35
v_cvt_pk_bf16_f32 v34, v36, v37
v_cvt_pk_bf16_f32 v35, v38, v39
v_mfma_f32_32x32x16_bf16 v[80:95], a[164:167], a[32:35], v[80:95]
ds_read_b64_tr_b16 a[188:189], v2 offset:38912
ds_read_b64_tr_b16 a[190:191], v2 offset:39936
buffer_store_dwordx4 v[32:35], v0, s[32:35], s64 offen sc1
s_waitcnt lgkmcnt(8)
v_mfma_f32_32x32x16_bf16 v[64:79], a[168:171], a[36:39], v[64:79]
ds_read_b64_tr_b16 a[160:161], v1 offset:40960
ds_read_b64_tr_b16 a[162:163], v1 offset:41984
buffer_load_dwordx4 v6, s[20:23], s52 offen offset:2048 lds
v_mul_f32 v16, v40, v40
v_mfma_f32_32x32x16_bf16 v[80:95], a[172:175], a[36:39], v[80:95]
ds_read_b64_tr_b16 a[164:165], v2 offset:40960
ds_read_b64_tr_b16 a[166:167], v2 offset:41984
v_mul_f32 v17, v41, v41
v_mul_f32 v18, v42, v42
v_mul_f32 v19, v43, v43
v_fma_f32 v16, v16, v11, v10
v_fma_f32 v17, v17, v11, v10
s_waitcnt lgkmcnt(8)
v_mfma_f32_32x32x16_bf16 v[64:79], a[176:179], a[40:43], v[64:79]
ds_read_b64_tr_b16 a[168:169], v1 offset:43008
ds_read_b64_tr_b16 a[170:171], v1 offset:44032
buffer_load_dwordx4 v7, s[20:23], s52 offen offset:3072 lds
v_fma_f32 v18, v18, v11, v10
v_fma_f32 v19, v19, v11, v10
v_mul_f32 v16, v16, v40
v_mul_f32 v17, v17, v41
v_mfma_f32_32x32x16_bf16 v[80:95], a[180:183], a[40:43], v[80:95]
ds_read_b64_tr_b16 a[172:173], v2 offset:43008
ds_read_b64_tr_b16 a[174:175], v2 offset:44032
v_mul_f32 v18, v18, v42
v_mul_f32 v19, v19, v43
v_exp_f32 v16, v16
v_exp_f32 v17, v17
s_waitcnt lgkmcnt(8)
v_mfma_f32_32x32x16_bf16 v[64:79], a[184:187], a[44:47], v[64:79]
ds_read_b64_tr_b16 a[176:177], v1 offset:45056
ds_read_b64_tr_b16 a[178:179], v1 offset:46080
v_exp_f32 v18, v18
v_exp_f32 v19, v19
v_fma_f32 v16, v16, v12, v12
v_fma_f32 v17, v17, v12, v12
v_mfma_f32_32x32x16_bf16 v[80:95], a[188:191], a[44:47], v[80:95]
ds_read_b64_tr_b16 a[180:181], v2 offset:45056
ds_read_b64_tr_b16 a[182:183], v2 offset:46080
v_fma_f32 v18, v18, v12, v12
v_fma_f32 v19, v19, v12, v12
v_rcp_f32 v16, v16
v_rcp_f32 v17, v17
s_waitcnt lgkmcnt(8)
v_mfma_f32_32x32x16_bf16 v[64:79], a[160:163], a[48:51], v[64:79]
ds_read_b64_tr_b16 a[184:185], v1 offset:47104
ds_read_b64_tr_b16 a[186:187], v1 offset:48128
v_rcp_f32 v18, v18
v_rcp_f32 v19, v19
v_mul_f32 v40, v40, v16
v_mul_f32 v41, v41, v17
v_mfma_f32_32x32x16_bf16 v[80:95], a[164:167], a[48:51], v[80:95]
ds_read_b64_tr_b16 a[188:189], v2 offset:47104
ds_read_b64_tr_b16 a[190:191], v2 offset:48128
v_mul_f32 v42, v42, v18
v_mul_f32 v43, v43, v19
v_mul_f32 v16, v44, v44
v_mul_f32 v17, v45, v45
v_mul_f32 v18, v46, v46
v_mul_f32 v19, v47, v47
s_waitcnt lgkmcnt(8)
v_mfma_f32_32x32x16_bf16 v[64:79], a[168:171], a[52:55], v[64:79]
s_barrier
ds_read_b64_tr_b16 a[160:161], v1 offset:49152
ds_read_b64_tr_b16 a[162:163], v1 offset:50176
s_add_u32 m0, s41, 81920
s_add_u32 s51, s63, 8
v_fma_f32 v16, v16, v11, v10
v_fma_f32 v17, v17, v11, v10
v_fma_f32 v18, v18, v11, v10
v_mfma_f32_32x32x16_bf16 v[80:95], a[172:175], a[52:55], v[80:95]
ds_read_b64_tr_b16 a[164:165], v2 offset:49152
ds_read_b64_tr_b16 a[166:167], v2 offset:50176
s_sub_u32 s52, s51, 10
s_cselect_b32 s51, s51, s52
s_mul_i32 s52, s51, s53
v_fma_f32 v19, v19, v11, v10
v_mul_f32 v16, v16, v44
s_waitcnt lgkmcnt(8)
v_mfma_f32_32x32x16_bf16 v[64:79], a[176:179], a[56:59], v[64:79]
ds_read_b64_tr_b16 a[168:169], v1 offset:51200
ds_read_b64_tr_b16 a[170:171], v1 offset:52224
s_add_u32 s52, s52, s59
v_mul_f32 v17, v17, v45
v_mul_f32 v18, v18, v46
v_mul_f32 v19, v19, v47
v_exp_f32 v16, v16
v_mfma_f32_32x32x16_bf16 v[80:95], a[180:183], a[56:59], v[80:95]
ds_read_b64_tr_b16 a[172:173], v2 offset:51200
ds_read_b64_tr_b16 a[174:175], v2 offset:52224
buffer_load_dwordx4 v4, s[20:23], s52 offen lds
v_exp_f32 v17, v17
v_exp_f32 v18, v18
s_waitcnt lgkmcnt(8)
v_mfma_f32_32x32x16_bf16 v[64:79], a[184:187], a[60:63], v[64:79]
ds_read_b64_tr_b16 a[176:177], v1 offset:53248
ds_read_b64_tr_b16 a[178:179], v1 offset:54272
buffer_load_dwordx4 v5, s[20:23], s52 offen offset:1024 lds
v_exp_f32 v19, v19
v_mfma_f32_32x32x16_bf16 v[80:95], a[188:191], a[60:63], v[80:95]
ds_read_b64_tr_b16 a[180:181], v2 offset:53248
ds_read_b64_tr_b16 a[182:183], v2 offset:54272
v_fma_f32 v16, v16, v12, v12
v_fma_f32 v17, v17, v12, v12
v_fma_f32 v18, v18, v12, v12
v_fma_f32 v19, v19, v12, v12
v_rcp_f32 v16, v16
s_waitcnt lgkmcnt(8)
v_mfma_f32_32x32x16_bf16 v[64:79], a[160:163], a[64:67], v[64:79]
ds_read_b64_tr_b16 a[184:185], v1 offset:55296
ds_read_b64_tr_b16 a[186:187], v1 offset:56320
v_rcp_f32 v17, v17
v_rcp_f32 v18, v18
v_rcp_f32 v19, v19
v_mul_f32 v44, v44, v16
v_mfma_f32_32x32x16_bf16 v[80:95], a[164:167], a[64:67], v[80:95]
ds_read_b64_tr_b16 a[188:189], v2 offset:55296
ds_read_b64_tr_b16 a[190:191], v2 offset:56320
v_mul_f32 v45, v45, v17
v_mul_f32 v46, v46, v18
v_mul_f32 v47, v47, v19
v_cvt_pk_bf16_f32 v40, v40, v41
v_cvt_pk_bf16_f32 v41, v42, v43
s_waitcnt lgkmcnt(8)
v_mfma_f32_32x32x16_bf16 v[64:79], a[168:171], a[68:71], v[64:79]
ds_read_b64_tr_b16 a[160:161], v1 offset:57344
ds_read_b64_tr_b16 a[162:163], v1 offset:58368
buffer_load_dwordx4 v6, s[20:23], s52 offen offset:2048 lds
v_cvt_pk_bf16_f32 v42, v44, v45
v_cvt_pk_bf16_f32 v43, v46, v47
v_mfma_f32_32x32x16_bf16 v[80:95], a[172:175], a[68:71], v[80:95]
ds_read_b64_tr_b16 a[164:165], v2 offset:57344
ds_read_b64_tr_b16 a[166:167], v2 offset:58368
buffer_store_dwordx4 v[40:43], v0, s[32:35], s64 offen offset:1024 sc1
s_waitcnt lgkmcnt(8)
v_mfma_f32_32x32x16_bf16 v[64:79], a[176:179], a[72:75], v[64:79]
ds_read_b64_tr_b16 a[168:169], v1 offset:59392
ds_read_b64_tr_b16 a[170:171], v1 offset:60416
buffer_load_dwordx4 v7, s[20:23], s52 offen offset:3072 lds
v_mfma_f32_32x32x16_bf16 v[80:95], a[180:183], a[72:75], v[80:95]
ds_read_b64_tr_b16 a[172:173], v2 offset:59392
ds_read_b64_tr_b16 a[174:175], v2 offset:60416
v_mul_f32 v16, v48, v48
v_mul_f32 v17, v49, v49
v_mul_f32 v18, v50, v50
v_mul_f32 v19, v51, v51
v_fma_f32 v16, v16, v11, v10
v_fma_f32 v17, v17, v11, v10
s_waitcnt lgkmcnt(8)
v_mfma_f32_32x32x16_bf16 v[64:79], a[184:187], a[76:79], v[64:79]
ds_read_b64_tr_b16 a[176:177], v1 offset:61440
ds_read_b64_tr_b16 a[178:179], v1 offset:62464
v_fma_f32 v18, v18, v11, v10
v_fma_f32 v19, v19, v11, v10
v_mul_f32 v16, v16, v48
v_mul_f32 v17, v17, v49
v_mul_f32 v18, v18, v50
v_mul_f32 v19, v19, v51
v_mfma_f32_32x32x16_bf16 v[80:95], a[188:191], a[76:79], v[80:95]
ds_read_b64_tr_b16 a[180:181], v2 offset:61440
ds_read_b64_tr_b16 a[182:183], v2 offset:62464
v_exp_f32 v16, v16
v_exp_f32 v17, v17
v_exp_f32 v18, v18
s_waitcnt lgkmcnt(8)
v_mfma_f32_32x32x16_bf16 v[64:79], a[160:163], a[80:83], v[64:79]
ds_read_b64_tr_b16 a[184:185], v1 offset:63488
ds_read_b64_tr_b16 a[186:187], v1 offset:64512
s_getpc_b64 s[86:87]
L_pc59:
s_lshl_b32 s3, s42, 3
s_xor_b32 s3, s3, s43
s_lshl_b32 s3, s3, 2
v_exp_f32 v19, v19
v_fma_f32 v16, v16, v12, v12
v_mfma_f32_32x32x16_bf16 v[80:95], a[164:167], a[80:83], v[80:95]
ds_read_b64_tr_b16 a[188:189], v2 offset:63488
ds_read_b64_tr_b16 a[190:191], v2 offset:64512
s_add_u32 s3, s3, s40
s_mul_i32 s3, s3, 8
s_and_b32 s3, s3, 1023
v_fma_f32 v17, v17, v12, v12
v_fma_f32 v18, v18, v12, v12
s_waitcnt lgkmcnt(8)
v_mfma_f32_32x32x16_bf16 v[64:79], a[168:171], a[84:87], v[64:79]
s_barrier
v_add_u32 v1, 65536, v1
v_add_u32 v2, 65536, v2
ds_read_b64_tr_b16 a[160:161], v1 offset:0
ds_read_b64_tr_b16 a[162:163], v1 offset:1024
v_fma_f32 v19, v19, v12, v12
v_rcp_f32 v16, v16
v_mfma_f32_32x32x16_bf16 v[80:95], a[172:175], a[84:87], v[80:95]
ds_read_b64_tr_b16 a[164:165], v2 offset:0
ds_read_b64_tr_b16 a[166:167], v2 offset:1024
s_movk_i32 s96, 1280
v_lshrrev_b32 v4, 3, v3
s_lshl_b32 s53, s40, 5
v_min_u32 v26, 7, v3
v_add_lshl_u32 v26, v26, s3, 7
v_min_u32 v26, L_codeend-L_pc59-4, v26
v_and_b32 v26, -4, v26
global_load_dword a223, v26, s[86:87]
s_waitcnt lgkmcnt(8)
v_mfma_f32_32x32x16_bf16 v[64:79], a[176:179], a[88:91], v[64:79]
ds_read_b64_tr_b16 a[168:169], v1 offset:2048
ds_read_b64_tr_b16 a[170:171], v1 offset:3072
s_lshr_b32 s52, s40, 1
s_mul_i32 s52, s52, 64
s_add_u32 s53, s53, s52
v_add_u32 v4, s53, v4
v_rcp_f32 v17, v17
v_mfma_f32_32x32x16_bf16 v[80:95], a[180:183], a[88:91], v[80:95]
ds_read_b64_tr_b16 a[172:173], v2 offset:2048
ds_read_b64_tr_b16 a[174:175], v2 offset:3072
v_bfe_u32 v5, v3, 4, 1
v_lshlrev_b32 v5, 2, v5
v_and_b32 v6, 7, v3
v_xor_b32 v5, v5, v6
v_lshlrev_b32 v5, 4, v5
v_mad_u32_u24 v4, v4, s96, v5
s_lshl_b32 s53, s96, 3
s_sub_u32 s53, s53, 1024
v_add_u32 v4, s56, v4
v_add_u32 v5, s53, v4
v_add_u32 v6, s53, v5
v_add_u32 v7, s53, v6
s_lshl_b32 s53, s96, 6
s_add_u32 m0, s41, 147456
s_add_u32 s52, s55, 0
buffer_load_dwordx4 v4, s[24:27], s52 offen lds
s_waitcnt lgkmcnt(8)
v_mfma_f32_32x32x16_bf16 v[64:79], a[184:187], a[92:95], v[64:79]
ds_read_b64_tr_b16 a[176:177], v1 offset:4096
ds_read_b64_tr_b16 a[178:179], v1 offset:5120
buffer_load_dwordx4 v5, s[24:27], s52 offen offset:1024 lds
v_rcp_f32 v18, v18
v_rcp_f32 v19, v19
v_mfma_f32_32x32x16_bf16 v[80:95], a[188:191], a[92:95], v[80:95]
ds_read_b64_tr_b16 a[180:181], v2 offset:4096
ds_read_b64_tr_b16 a[182:183], v2 offset:5120
v_mul_f32 v48, v48, v16
v_mul_f32 v49, v49, v17
v_mul_f32 v50, v50, v18
v_mul_f32 v51, v51, v19
v_mul_f32 v16, v52, v52
v_mul_f32 v17, v53, v53
s_waitcnt lgkmcnt(8)
v_mfma_f32_32x32x16_bf16 v[64:79], a[160:163], a[96:99], v[64:79]
ds_read_b64_tr_b16 a[184:185], v1 offset:6144
ds_read_b64_tr_b16 a[186:187], v1 offset:7168
buffer_load_dwordx4 v6, s[24:27], s52 offen offset:2048 lds
v_mul_f32 v18, v54, v54
v_mul_f32 v19, v55, v55
v_fma_f32 v16, v16, v11, v10
v_mfma_f32_32x32x16_bf16 v[80:95], a[164:167], a[96:99], v[80:95]
ds_read_b64_tr_b16 a[188:189], v2 offset:6144
ds_read_b64_tr_b16 a[190:191], v2 offset:7168
v_fma_f32 v17, v17, v11, v10
v_fma_f32 v18, v18, v11, v10
v_fma_f32 v19, v19, v11, v10
v_mul_f32 v16, v16, v52
v_mul_f32 v17, v17, v53
s_waitcnt lgkmcnt(8)
v_mfma_f32_32x32x16_bf16 v[64:79], a[168:171], a[100:103], v[64:79]
ds_read_b64_tr_b16 a[160:161], v1 offset:8192
ds_read_b64_tr_b16 a[162:163], v1 offset:9216
buffer_load_dwordx4 v7, s[24:27], s52 offen offset:3072 lds
v_mul_f32 v18, v18, v54
v_mul_f32 v19, v19, v55
v_exp_f32 v16, v16
v_mfma_f32_32x32x16_bf16 v[80:95], a[172:175], a[100:103], v[80:95]
ds_read_b64_tr_b16 a[164:165], v2 offset:8192
ds_read_b64_tr_b16 a[166:167], v2 offset:9216
s_add_u32 m0, s41, 98304
s_add_u32 s52, s55, 327680
v_exp_f32 v17, v17
v_exp_f32 v18, v18
s_waitcnt lgkmcnt(8)
v_mfma_f32_32x32x16_bf16 v[64:79], a[176:179], a[104:107], v[64:79]
ds_read_b64_tr_b16 a[168:169], v1 offset:10240
ds_read_b64_tr_b16 a[170:171], v1 offset:11264
buffer_load_dwordx4 v4, s[24:27], s52 offen lds
v_exp_f32 v19, v19
v_mfma_f32_32x32x16_bf16 v[80:95], a[180:183], a[104:107], v[80:95]
ds_read_b64_tr_b16 a[172:173], v2 offset:10240
ds_read_b64_tr_b16 a[174:175], v2 offset:11264
buffer_load_dwordx4 v5, s[24:27], s52 offen offset:1024 lds
v_fma_f32 v16, v16, v12, v12
v_fma_f32 v17, v17, v12, v12
v_fma_f32 v18, v18, v12, v12
s_waitcnt lgkmcnt(8)
v_mfma_f32_32x32x16_bf16 v[64:79], a[184:187], a[108:111], v[64:79]
ds_read_b64_tr_b16 a[176:177], v1 offset:12288
ds_read_b64_tr_b16 a[178:179], v1 offset:13312
buffer_load_dwordx4 v6, s[24:27], s52 offen offset:2048 lds
v_fma_f32 v19, v19, v12, v12
v_rcp_f32 v16, v16
v_mfma_f32_32x32x16_bf16 v[80:95], a[188:191], a[108:111], v[80:95]
ds_read_b64_tr_b16 a[180:181], v2 offset:12288
ds_read_b64_tr_b16 a[182:183], v2 offset:13312
v_rcp_f32 v17, v17
v_rcp_f32 v18, v18
v_rcp_f32 v19, v19
s_waitcnt lgkmcnt(8)
v_mfma_f32_32x32x16_bf16 v[64:79], a[160:163], a[112:115], v[64:79]
ds_read_b64_tr_b16 a[184:185], v1 offset:14336
ds_read_b64_tr_b16 a[186:187], v1 offset:15360
buffer_load_dwordx4 v7, s[24:27], s52 offen offset:3072 lds
v_mul_f32 v52, v52, v16
v_mul_f32 v53, v53, v17
v_mul_f32 v54, v54, v18
v_mfma_f32_32x32x16_bf16 v[80:95], a[164:167], a[112:115], v[80:95]
ds_read_b64_tr_b16 a[188:189], v2 offset:14336
ds_read_b64_tr_b16 a[190:191], v2 offset:15360
v_mul_f32 v55, v55, v19
v_cvt_pk_bf16_f32 v48, v48, v49
v_cvt_pk_bf16_f32 v49, v50, v51
v_cvt_pk_bf16_f32 v50, v52, v53
v_cvt_pk_bf16_f32 v51, v54, v55
s_waitcnt lgkmcnt(8)
v_mfma_f32_32x32x16_bf16 v[64:79], a[168:171], a[116:119], v[64:79]
s_barrier
v_subrev_u32 v1, 131072, v1
v_subrev_u32 v2, 131072, v2
ds_read_b64_tr_b16 a[160:161], v1 offset:0
ds_read_b64_tr_b16 a[162:163], v1 offset:1024
v_mfma_f32_32x32x16_bf16 v[80:95], a[172:175], a[116:119], v[80:95]
ds_read_b64_tr_b16 a[164:165], v2 offset:0
ds_read_b64_tr_b16 a[166:167], v2 offset:1024
s_add_u32 m0, s41, 114688
s_add_u32 s52, s55, 737280
buffer_store_dwordx4 v[48:51], v0, s[32:35], s64 offen offset:2048 sc1
s_waitcnt lgkmcnt(8)
v_mfma_f32_32x32x16_bf16 v[64:79], a[176:179], a[120:123], v[64:79]
ds_read_b64_tr_b16 a[168:169], v1 offset:2048
ds_read_b64_tr_b16 a[170:171], v1 offset:3072
buffer_load_dwordx4 v4, s[24:27], s52 offen lds
v_mfma_f32_32x32x16_bf16 v[80:95], a[180:183], a[120:123], v[80:95]
ds_read_b64_tr_b16 a[172:173], v2 offset:2048
ds_read_b64_tr_b16 a[174:175], v2 offset:3072
v_mul_f32 v16, v56, v56
v_mul_f32 v17, v57, v57
v_mul_f32 v18, v58, v58
v_mul_f32 v19, v59, v59
v_fma_f32 v16, v16, v11, v10
s_waitcnt lgkmcnt(8)
v_mfma_f32_32x32x16_bf16 v[64:79], a[184:187], a[124:127], v[64:79]
ds_read_b64_tr_b16 a[176:177], v1 offset:4096
ds_read_b64_tr_b16 a[178:179], v1 offset:5120
buffer_load_dwordx4 v5, s[24:27], s52 offen offset:1024 lds
v_fma_f32 v17, v17, v11, v10
v_fma_f32 v18, v18, v11, v10
v_fma_f32 v19, v19, v11, v10
v_mul_f32 v16, v16, v56
v_mfma_f32_32x32x16_bf16 v[80:95], a[188:191], a[124:127], v[80:95]
ds_read_b64_tr_b16 a[180:181], v2 offset:4096
ds_read_b64_tr_b16 a[182:183], v2 offset:5120
v_mul_f32 v17, v17, v57
v_mul_f32 v18, v18, v58
v_mul_f32 v19, v19, v59
v_exp_f32 v16, v16
s_waitcnt lgkmcnt(8)
v_mfma_f32_32x32x16_bf16 v[64:79], a[160:163], a[128:131], v[64:79]
ds_read_b64_tr_b16 a[184:185], v1 offset:6144
ds_read_b64_tr_b16 a[186:187], v1 offset:7168
v_exp_f32 v17, v17
v_exp_f32 v18, v18
v_exp_f32 v19, v19
v_fma_f32 v16, v16, v12, v12
v_mfma_f32_32x32x16_bf16 v[80:95], a[164:167], a[128:131], v[80:95]
ds_read_b64_tr_b16 a[188:189], v2 offset:6144
ds_read_b64_tr_b16 a[190:191], v2 offset:7168
v_fma_f32 v17, v17, v12, v12
v_fma_f32 v18, v18, v12, v12
v_fma_f32 v19, v19, v12, v12
v_rcp_f32 v16, v16
s_waitcnt lgkmcnt(8)
v_mfma_f32_32x32x16_bf16 v[64:79], a[168:171], a[132:135], v[64:79]
ds_read_b64_tr_b16 a[160:161], v1 offset:8192
ds_read_b64_tr_b16 a[162:163], v1 offset:9216
buffer_load_dwordx4 v6, s[24:27], s52 offen offset:2048 lds
v_rcp_f32 v17, v17
v_rcp_f32 v18, v18
v_mfma_f32_32x32x16_bf16 v[80:95], a[172:175], a[132:135], v[80:95]
ds_read_b64_tr_b16 a[164:165], v2 offset:8192
ds_read_b64_tr_b16 a[166:167], v2 offset:9216
v_rcp_f32 v19, v19
v_mul_f32 v56, v56, v16
v_mul_f32 v57, v57, v17
v_mul_f32 v58, v58, v18
s_waitcnt lgkmcnt(8)
v_mfma_f32_32x32x16_bf16 v[64:79], a[176:179], a[136:139], v[64:79]
ds_read_b64_tr_b16 a[168:169], v1 offset:10240
ds_read_b64_tr_b16 a[170:171], v1 offset:11264
buffer_load_dwordx4 v7, s[24:27], s52 offen offset:3072 lds
v_mul_f32 v59, v59, v19
v_mul_f32 v16, v60, v60
v_mul_f32 v17, v61, v61
v_mul_f32 v18, v62, v62
v_mfma_f32_32x32x16_bf16 v[80:95], a[180:183], a[136:139], v[80:95]
ds_read_b64_tr_b16 a[172:173], v2 offset:10240
ds_read_b64_tr_b16 a[174:175], v2 offset:11264
v_mul_f32 v19, v63, v63
v_fma_f32 v16, v16, v11, v10
v_fma_f32 v17, v17, v11, v10
v_fma_f32 v18, v18, v11, v10
v_fma_f32 v19, v19, v11, v10
s_waitcnt lgkmcnt(8)
v_mfma_f32_32x32x16_bf16 v[64:79], a[184:187], a[140:143], v[64:79]
ds_read_b64_tr_b16 a[176:177], v1 offset:12288
ds_read_b64_tr_b16 a[178:179], v1 offset:13312
v_mul_f32 v16, v16, v60
v_mul_f32 v17, v17, v61
v_mul_f32 v18, v18, v62
v_mul_f32 v19, v19, v63
v_exp_f32 v16, v16
v_mfma_f32_32x32x16_bf16 v[80:95], a[188:191], a[140:143], v[80:95]
ds_read_b64_tr_b16 a[180:181], v2 offset:12288
ds_read_b64_tr_b16 a[182:183], v2 offset:13312
v_exp_f32 v17, v17
v_exp_f32 v18, v18
v_exp_f32 v19, v19
v_fma_f32 v16, v16, v12, v12
s_waitcnt lgkmcnt(8)
v_mfma_f32_32x32x16_bf16 v[64:79], a[160:163], a[144:147], v[64:79]
ds_read_b64_tr_b16 a[184:185], v1 offset:14336
ds_read_b64_tr_b16 a[186:187], v1 offset:15360
v_fma_f32 v17, v17, v12, v12
v_fma_f32 v18, v18, v12, v12
v_fma_f32 v19, v19, v12, v12
v_rcp_f32 v16, v16
v_rcp_f32 v17, v17
v_mfma_f32_32x32x16_bf16 v[80:95], a[164:167], a[144:147], v[80:95]
ds_read_b64_tr_b16 a[188:189], v2 offset:14336
ds_read_b64_tr_b16 a[190:191], v2 offset:15360
v_rcp_f32 v18, v18
v_rcp_f32 v19, v19
v_mul_f32 v60, v60, v16
s_waitcnt lgkmcnt(8)
v_mfma_f32_32x32x16_bf16 v[64:79], a[168:171], a[148:151], v[64:79]
s_barrier
ds_read_b64_tr_b16 a[160:161], v1 offset:16384
ds_read_b64_tr_b16 a[162:163], v1 offset:17408
s_add_u32 m0, s41, 131072
s_add_u32 s52, s55, 1064960
v_mul_f32 v61, v61, v17
v_mul_f32 v62, v62, v18
v_mul_f32 v63, v63, v19
v_mfma_f32_32x32x16_bf16 v[80:95], a[172:175], a[148:151], v[80:95]
ds_read_b64_tr_b16 a[164:165], v2 offset:16384
ds_read_b64_tr_b16 a[166:167], v2 offset:17408
v_cvt_pk_bf16_f32 v56, v56, v57
v_cvt_pk_bf16_f32 v57, v58, v59
v_cvt_pk_bf16_f32 v58, v60, v61
v_cvt_pk_bf16_f32 v59, v62, v63
s_waitcnt lgkmcnt(8)
v_mfma_f32_32x32x16_bf16 v[64:79], a[176:179], a[152:155], v[64:79]
ds_read_b64_tr_b16 a[168:169], v1 offset:18432
ds_read_b64_tr_b16 a[170:171], v1 offset:19456
buffer_load_dwordx4 v4, s[24:27], s52 offen lds
v_mfma_f32_32x32x16_bf16 v[80:95], a[180:183], a[152:155], v[80:95]
ds_read_b64_tr_b16 a[172:173], v2 offset:18432
ds_read_b64_tr_b16 a[174:175], v2 offset:19456
buffer_store_dwordx4 v[56:59], v0, s[32:35], s64 offen offset:3072 sc1
s_waitcnt lgkmcnt(8)
v_mfma_f32_32x32x16_bf16 v[64:79], a[184:187], a[156:159], v[64:79]
ds_read_b64_tr_b16 a[176:177], v1 offset:20480
ds_read_b64_tr_b16 a[178:179], v1 offset:21504
buffer_load_dwordx4 v5, s[24:27], s52 offen offset:1024 lds
v_mfma_f32_32x32x16_bf16 v[80:95], a[188:191], a[156:159], v[80:95]
ds_read_b64_tr_b16 a[180:181], v2 offset:20480
ds_read_b64_tr_b16 a[182:183], v2 offset:21504
buffer_load_dwordx4 v6, s[24:27], s52 offen offset:2048 lds
v_mfma_f32_32x32x16_bf16 v[32:47], v[152:155], a[196:199], 0
buffer_load_dwordx4 v7, s[24:27], s52 offen offset:3072 lds
v_mfma_f32_32x32x16_bf16 v[48:63], v[154:157], a[196:199], 0
s_waitcnt lgkmcnt(8)
v_mfma_f32_32x32x16_bf16 v[32:47], a[160:163], a[0:3], v[32:47]
ds_read_b64_tr_b16 a[184:185], v1 offset:22528
ds_read_b64_tr_b16 a[186:187], v1 offset:23552
v_mfma_f32_32x32x16_bf16 v[48:63], a[164:167], a[0:3], v[48:63]
ds_read_b64_tr_b16 a[188:189], v2 offset:22528
ds_read_b64_tr_b16 a[190:191], v2 offset:23552
s_waitcnt lgkmcnt(8)
v_mfma_f32_32x32x16_bf16 v[32:47], a[168:171], a[4:7], v[32:47]
ds_read_b64_tr_b16 a[160:161], v1 offset:24576
ds_read_b64_tr_b16 a[162:163], v1 offset:25600
v_mul_f32 v16, v64, v64
v_mul_f32 v17, v65, v65
v_mul_f32 v18, v66, v66
v_mul_f32 v19, v67, v67
v_fma_f32 v16, v16, v11, v10
v_fma_f32 v17, v17, v11, v10
v_fma_f32 v18, v18, v11, v10
v_mfma_f32_32x32x16_bf16 v[48:63], a[172:175], a[4:7], v[48:63]
ds_read_b64_tr_b16 a[164:165], v2 offset:24576
ds_read_b64_tr_b16 a[166:167], v2 offset:25600
v_fma_f32 v19, v19, v11, v10
v_mul_f32 v16, v16, v64
v_mul_f32 v17, v17, v65
v_mul_f32 v18, v18, v66
v_mul_f32 v19, v19, v67
v_exp_f32 v16, v16
s_waitcnt lgkmcnt(8)
v_mfma_f32_32x32x16_bf16 v[32:47], a[176:179], a[8:11], v[32:47]
ds_read_b64_tr_b16 a[168:169], v1 offset:26624
ds_read_b64_tr_b16 a[170:171], v1 offset:27648
v_exp_f32 v17, v17
v_exp_f32 v18, v18
v_exp_f32 v19, v19
v_fma_f32 v16, v16, v12, v12
v_mfma_f32_32x32x16_bf16 v[48:63], a[180:183], a[8:11], v[48:63]
ds_read_b64_tr_b16 a[172:173], v2 offset:26624
ds_read_b64_tr_b16 a[174:175], v2 offset:27648
v_fma_f32 v17, v17, v12, v12
v_fma_f32 v18, v18, v12, v12
v_fma_f32 v19, v19, v12, v12
v_rcp_f32 v16, v16
v_rcp_f32 v17, v17
s_waitcnt lgkmcnt(8)
v_mfma_f32_32x32x16_bf16 v[32:47], a[184:187], a[12:15], v[32:47]
ds_read_b64_tr_b16 a[176:177], v1 offset:28672
ds_read_b64_tr_b16 a[178:179], v1 offset:29696
v_rcp_f32 v18, v18
v_rcp_f32 v19, v19
v_mul_f32 v64, v64, v16
v_mul_f32 v65, v65, v17
v_mul_f32 v66, v66, v18
v_mfma_f32_32x32x16_bf16 v[48:63], a[188:191], a[12:15], v[48:63]
ds_read_b64_tr_b16 a[180:181], v2 offset:28672
ds_read_b64_tr_b16 a[182:183], v2 offset:29696
v_mul_f32 v67, v67, v19
v_mul_f32 v16, v68, v68
v_mul_f32 v17, v69, v69
v_mul_f32 v18, v70, v70
v_mul_f32 v19, v71, v71
v_fma_f32 v16, v16, v11, v10
s_waitcnt lgkmcnt(8)
v_mfma_f32_32x32x16_bf16 v[32:47], a[160:163], a[16:19], v[32:47]
ds_read_b64_tr_b16 a[184:185], v1 offset:30720
ds_read_b64_tr_b16 a[186:187], v1 offset:31744
v_fma_f32 v17, v17, v11, v10
v_fma_f32 v18, v18, v11, v10
v_fma_f32 v19, v19, v11, v10
v_mul_f32 v16, v16, v68
v_mul_f32 v17, v17, v69
v_mul_f32 v18, v18, v70
v_mul_f32 v19, v19, v71
v_mfma_f32_32x32x16_bf16 v[48:63], a[164:167], a[16:19], v[48:63]
ds_read_b64_tr_b16 a[188:189], v2 offset:30720
ds_read_b64_tr_b16 a[190:191], v2 offset:31744
v_exp_f32 v16, v16
v_exp_f32 v17, v17
v_exp_f32 v18, v18
s_waitcnt lgkmcnt(8)
v_mfma_f32_32x32x16_bf16 v[32:47], a[168:171], a[20:23], v[32:47]
s_waitcnt vmcnt(33)
s_barrier
ds_read_b64_tr_b16 a[160:161], v1 offset:32768
ds_read_b64_tr_b16 a[162:163], v1 offset:33792
s_add_u32 m0, s41, 0
s_add_u32 s52, s55, 1474560
v_exp_f32 v19, v19
v_fma_f32 v16, v16, v12, v12
v_fma_f32 v17, v17, v12, v12
v_mfma_f32_32x32x16_bf16 v[48:63], a[172:175], a[20:23], v[48:63]
ds_read_b64_tr_b16 a[164:165], v2 offset:32768
ds_read_b64_tr_b16 a[166:167], v2 offset:33792
v_fma_f32 v18, v18, v12, v12
v_fma_f32 v19, v19, v12, v12
v_rcp_f32 v16, v16
v_rcp_f32 v17, v17
s_waitcnt lgkmcnt(8)
v_mfma_f32_32x32x16_bf16 v[32:47], a[176:179], a[24:27], v[32:47]
ds_read_b64_tr_b16 a[168:169], v1 offset:34816
ds_read_b64_tr_b16 a[170:171], v1 offset:35840
buffer_load_dwordx4 v4, s[24:27], s52 offen lds
v_rcp_f32 v18, v18
v_rcp_f32 v19, v19
v_mfma_f32_32x32x16_bf16 v[48:63], a[180:183], a[24:27], v[48:63]
ds_read_b64_tr_b16 a[172:173], v2 offset:34816
ds_read_b64_tr_b16 a[174:175], v2 offset:35840
v_mul_f32 v68, v68, v16
v_mul_f32 v69, v69, v17
v_mul_f32 v70, v70, v18
v_mul_f32 v71, v71, v19
v_cvt_pk_bf16_f32 v64, v64, v65
v_cvt_pk_bf16_f32 v65, v66, v67
v_cvt_pk_bf16_f32 v66, v68, v69
s_waitcnt lgkmcnt(8)
v_mfma_f32_32x32x16_bf16 v[32:47], a[184:187], a[28:31], v[32:47]
ds_read_b64_tr_b16 a[176:177], v1 offset:36864
ds_read_b64_tr_b16 a[178:179], v1 offset:37888
buffer_load_dwordx4 v5, s[24:27], s52 offen offset:1024 lds
v_cvt_pk_bf16_f32 v67, v70, v71
v_mfma_f32_32x32x16_bf16 v[48:63], a[188:191], a[28:31], v[48:63]
ds_read_b64_tr_b16 a[180:181], v2 offset:36864
ds_read_b64_tr_b16 a[182:183], v2 offset:37888
buffer_store_dwordx4 v[64:67], v0, s[32:35], s65 offen sc1
s_waitcnt lgkmcnt(8)
v_mfma_f32_32x32x16_bf16 v[32:47], a[160:163], a[32:35], v[32:47]
ds_read_b64_tr_b16 a[184:185], v1 offset:38912
ds_read_b64_tr_b16 a[186:187], v1 offset:39936
s_waitcnt vmcnt(6)
buffer_atomic_add v14, v13, s[32:35], s79 offen sc1
v_mul_f32 v16, v72, v72
v_mul_f32 v17, v73, v73
v_mul_f32 v18, v74, v74
v_mfma_f32_32x32x16_bf16 v[48:63], a[164:167], a[32:35], v[48:63]
ds_read_b64_tr_b16 a[188:189], v2 offset:38912
ds_read_b64_tr_b16 a[190:191], v2 offset:39936
v_mul_f32 v19, v75, v75
v_fma_f32 v16, v16, v11, v10
v_fma_f32 v17, v17, v11, v10
v_fma_f32 v18, v18, v11, v10
v_fma_f32 v19, v19, v11, v10
v_mul_f32 v16, v16, v72
s_waitcnt lgkmcnt(8)
v_mfma_f32_32x32x16_bf16 v[32:47], a[168:171], a[36:39], v[32:47]
ds_read_b64_tr_b16 a[160:161], v1 offset:40960
ds_read_b64_tr_b16 a[162:163], v1 offset:41984
buffer_load_dwordx4 v6, s[24:27], s52 offen offset:2048 lds
v_mul_f32 v17, v17, v73
v_mul_f32 v18, v18, v74
v_mul_f32 v19, v19, v75
v_mfma_f32_32x32x16_bf16 v[48:63], a[172:175], a[36:39], v[48:63]
ds_read_b64_tr_b16 a[164:165], v2 offset:40960
ds_read_b64_tr_b16 a[166:167], v2 offset:41984
v_exp_f32 v16, v16
v_exp_f32 v17, v17
v_exp_f32 v18, v18
v_exp_f32 v19, v19
s_waitcnt lgkmcnt(8)
v_mfma_f32_32x32x16_bf16 v[32:47], a[176:179], a[40:43], v[32:47]
ds_read_b64_tr_b16 a[168:169], v1 offset:43008
ds_read_b64_tr_b16 a[170:171], v1 offset:44032
buffer_load_dwordx4 v7, s[24:27], s52 offen offset:3072 lds
v_fma_f32 v16, v16, v12, v12
v_fma_f32 v17, v17, v12, v12
v_fma_f32 v18, v18, v12, v12
v_mfma_f32_32x32x16_bf16 v[48:63], a[180:183], a[40:43], v[48:63]
ds_read_b64_tr_b16 a[172:173], v2 offset:43008
ds_read_b64_tr_b16 a[174:175], v2 offset:44032
v_fma_f32 v19, v19, v12, v12
v_rcp_f32 v16, v16
v_rcp_f32 v17, v17
v_rcp_f32 v18, v18
s_waitcnt lgkmcnt(8)
v_mfma_f32_32x32x16_bf16 v[32:47], a[184:187], a[44:47], v[32:47]
ds_read_b64_tr_b16 a[176:177], v1 offset:45056
ds_read_b64_tr_b16 a[178:179], v1 offset:46080
v_rcp_f32 v19, v19
v_mul_f32 v72, v72, v16
v_mul_f32 v73, v73, v17
v_mul_f32 v74, v74, v18
v_mul_f32 v75, v75, v19
v_mul_f32 v16, v76, v76
v_mfma_f32_32x32x16_bf16 v[48:63], a[188:191], a[44:47], v[48:63]
ds_read_b64_tr_b16 a[180:181], v2 offset:45056
ds_read_b64_tr_b16 a[182:183], v2 offset:46080
v_mul_f32 v17, v77, v77
v_mul_f32 v18, v78, v78
v_mul_f32 v19, v79, v79
v_fma_f32 v16, v16, v11, v10
v_fma_f32 v17, v17, v11, v10
v_fma_f32 v18, v18, v11, v10
s_waitcnt lgkmcnt(8)
v_mfma_f32_32x32x16_bf16 v[32:47], a[160:163], a[48:51], v[32:47]
ds_read_b64_tr_b16 a[184:185], v1 offset:47104
ds_read_b64_tr_b16 a[186:187], v1 offset:48128
v_fma_f32 v19, v19, v11, v10
v_mul_f32 v16, v16, v76
v_mul_f32 v17, v17, v77
v_mul_f32 v18, v18, v78
v_mul_f32 v19, v19, v79
v_exp_f32 v16, v16
v_mfma_f32_32x32x16_bf16 v[48:63], a[164:167], a[48:51], v[48:63]
ds_read_b64_tr_b16 a[188:189], v2 offset:47104
ds_read_b64_tr_b16 a[190:191], v2 offset:48128
v_exp_f32 v17, v17
v_exp_f32 v18, v18
v_exp_f32 v19, v19
v_fma_f32 v16, v16, v12, v12
s_waitcnt lgkmcnt(8)
v_mfma_f32_32x32x16_bf16 v[32:47], a[168:171], a[52:55], v[32:47]
s_barrier
ds_read_b64_tr_b16 a[160:161], v1 offset:49152
ds_read_b64_tr_b16 a[162:163], v1 offset:50176
s_add_u32 m0, s41, 16384
s_add_u32 s52, s55, 1802240
v_fma_f32 v17, v17, v12, v12
v_fma_f32 v18, v18, v12, v12
v_fma_f32 v19, v19, v12, v12
v_mfma_f32_32x32x16_bf16 v[48:63], a[172:175], a[52:55], v[48:63]
ds_read_b64_tr_b16 a[164:165], v2 offset:49152
ds_read_b64_tr_b16 a[166:167], v2 offset:50176
v_rcp_f32 v16, v16
v_rcp_f32 v17, v17
v_rcp_f32 v18, v18
s_waitcnt lgkmcnt(8)
v_mfma_f32_32x32x16_bf16 v[32:47], a[176:179], a[56:59], v[32:47]
ds_read_b64_tr_b16 a[168:169], v1 offset:51200
ds_read_b64_tr_b16 a[170:171], v1 offset:52224
buffer_load_dwordx4 v4, s[24:27], s52 offen lds
v_rcp_f32 v19, v19
v_mul_f32 v76, v76, v16
v_mul_f32 v77, v77, v17
v_mfma_f32_32x32x16_bf16 v[48:63], a[180:183], a[56:59], v[48:63]
ds_read_b64_tr_b16 a[172:173], v2 offset:51200
ds_read_b64_tr_b16 a[174:175], v2 offset:52224
v_mul_f32 v78, v78, v18
v_mul_f32 v79, v79, v19
v_cvt_pk_bf16_f32 v72, v72, v73
v_cvt_pk_bf16_f32 v73, v74, v75
v_cvt_pk_bf16_f32 v74, v76, v77
v_cvt_pk_bf16_f32 v75, v78, v79
s_waitcnt lgkmcnt(8)
v_mfma_f32_32x32x16_bf16 v[32:47], a[184:187], a[60:63], v[32:47]
ds_read_b64_tr_b16 a[176:177], v1 offset:53248
ds_read_b64_tr_b16 a[178:179], v1 offset:54272
buffer_load_dwordx4 v5, s[24:27], s52 offen offset:1024 lds
v_mfma_f32_32x32x16_bf16 v[48:63], a[188:191], a[60:63], v[48:63]
ds_read_b64_tr_b16 a[180:181], v2 offset:53248
ds_read_b64_tr_b16 a[182:183], v2 offset:54272
buffer_store_dwordx4 v[72:75], v0, s[32:35], s65 offen offset:1024 sc1
v_mul_f32 v16, v80, v80
s_waitcnt lgkmcnt(8)
v_mfma_f32_32x32x16_bf16 v[32:47], a[160:163], a[64:67], v[32:47]
ds_read_b64_tr_b16 a[184:185], v1 offset:55296
ds_read_b64_tr_b16 a[186:187], v1 offset:56320
v_mul_f32 v17, v81, v81
v_mul_f32 v18, v82, v82
v_mul_f32 v19, v83, v83
v_fma_f32 v16, v16, v11, v10
v_fma_f32 v17, v17, v11, v10
v_fma_f32 v18, v18, v11, v10
v_fma_f32 v19, v19, v11, v10
v_mfma_f32_32x32x16_bf16 v[48:63], a[164:167], a[64:67], v[48:63]
ds_read_b64_tr_b16 a[188:189], v2 offset:55296
ds_read_b64_tr_b16 a[190:191], v2 offset:56320
v_mul_f32 v16, v16, v80
v_mul_f32 v17, v17, v81
v_mul_f32 v18, v18, v82
v_mul_f32 v19, v19, v83
v_exp_f32 v16, v16
s_waitcnt lgkmcnt(8)
v_mfma_f32_32x32x16_bf16 v[32:47], a[168:171], a[68:71], v[32:47]
ds_read_b64_tr_b16 a[160:161], v1 offset:57344
ds_read_b64_tr_b16 a[162:163], v1 offset:58368
buffer_load_dwordx4 v6, s[24:27], s52 offen offset:2048 lds
v_exp_f32 v17, v17
v_exp_f32 v18, v18
v_mfma_f32_32x32x16_bf16 v[48:63], a[172:175], a[68:71], v[48:63]
ds_read_b64_tr_b16 a[164:165], v2 offset:57344
ds_read_b64_tr_b16 a[166:167], v2 offset:58368
v_exp_f32 v19, v19
v_fma_f32 v16, v16, v12, v12
v_fma_f32 v17, v17, v12, v12
v_fma_f32 v18, v18, v12, v12
v_fma_f32 v19, v19, v12, v12
s_waitcnt lgkmcnt(8)
v_mfma_f32_32x32x16_bf16 v[32:47], a[176:179], a[72:75], v[32:47]
ds_read_b64_tr_b16 a[168:169], v1 offset:59392
ds_read_b64_tr_b16 a[170:171], v1 offset:60416
buffer_load_dwordx4 v7, s[24:27], s52 offen offset:3072 lds
v_rcp_f32 v16, v16
v_rcp_f32 v17, v17
v_mfma_f32_32x32x16_bf16 v[48:63], a[180:183], a[72:75], v[48:63]
ds_read_b64_tr_b16 a[172:173], v2 offset:59392
ds_read_b64_tr_b16 a[174:175], v2 offset:60416
v_rcp_f32 v18, v18
v_rcp_f32 v19, v19
v_mul_f32 v80, v80, v16
v_mul_f32 v81, v81, v17
v_mul_f32 v82, v82, v18
s_waitcnt lgkmcnt(8)
v_mfma_f32_32x32x16_bf16 v[32:47], a[184:187], a[76:79], v[32:47]
ds_read_b64_tr_b16 a[176:177], v1 offset:61440
ds_read_b64_tr_b16 a[178:179], v1 offset:62464
v_mul_f32 v83, v83, v19
v_mul_f32 v16, v84, v84
v_mul_f32 v17, v85, v85
v_mul_f32 v18, v86, v86
v_mul_f32 v19, v87, v87
v_fma_f32 v16, v16, v11, v10
v_fma_f32 v17, v17, v11, v10
v_mfma_f32_32x32x16_bf16 v[48:63], a[188:191], a[76:79], v[48:63]
ds_read_b64_tr_b16 a[180:181], v2 offset:61440
ds_read_b64_tr_b16 a[182:183], v2 offset:62464
v_fma_f32 v18, v18, v11, v10
v_fma_f32 v19, v19, v11, v10
v_mul_f32 v16, v16, v84
v_mul_f32 v17, v17, v85
v_mul_f32 v18, v18, v86
v_mul_f32 v19, v19, v87
s_waitcnt lgkmcnt(8)
v_mfma_f32_32x32x16_bf16 v[32:47], a[160:163], a[80:83], v[32:47]
ds_read_b64_tr_b16 a[184:185], v1 offset:63488
ds_read_b64_tr_b16 a[186:187], v1 offset:64512
v_exp_f32 v16, v16
v_exp_f32 v17, v17
v_exp_f32 v18, v18
v_exp_f32 v19, v19
v_mfma_f32_32x32x16_bf16 v[48:63], a[164:167], a[80:83], v[48:63]
ds_read_b64_tr_b16 a[188:189], v2 offset:63488
ds_read_b64_tr_b16 a[190:191], v2 offset:64512
v_fma_f32 v16, v16, v12, v12
v_fma_f32 v17, v17, v12, v12
v_fma_f32 v18, v18, v12, v12
v_fma_f32 v19, v19, v12, v12
v_rcp_f32 v16, v16
s_waitcnt lgkmcnt(8)
v_mfma_f32_32x32x16_bf16 v[32:47], a[168:171], a[84:87], v[32:47]
s_barrier
v_add_u32 v1, 65536, v1
v_add_u32 v2, 65536, v2
ds_read_b64_tr_b16 a[160:161], v1 offset:0
ds_read_b64_tr_b16 a[162:163], v1 offset:1024
v_rcp_f32 v17, v17
v_rcp_f32 v18, v18
v_mfma_f32_32x32x16_bf16 v[48:63], a[172:175], a[84:87], v[48:63]
ds_read_b64_tr_b16 a[164:165], v2 offset:0
ds_read_b64_tr_b16 a[166:167], v2 offset:1024
s_add_u32 m0, s41, 32768
s_add_u32 s52, s55, 81920
v_rcp_f32 v19, v19
v_mul_f32 v84, v84, v16
v_mul_f32 v85, v85, v17
s_waitcnt lgkmcnt(8)
v_mfma_f32_32x32x16_bf16 v[32:47], a[176:179], a[88:91], v[32:47]
ds_read_b64_tr_b16 a[168:169], v1 offset:2048
ds_read_b64_tr_b16 a[170:171], v1 offset:3072
buffer_load_dwordx4 v4, s[24:27], s52 offen lds
v_mul_f32 v86, v86, v18
v_mul_f32 v87, v87, v19
v_cvt_pk_bf16_f32 v80, v80, v81
v_cvt_pk_bf16_f32 v81, v82, v83
v_mfma_f32_32x32x16_bf16 v[48:63], a[180:183], a[88:91], v[48:63]
ds_read_b64_tr_b16 a[172:173], v2 offset:2048
ds_read_b64_tr_b16 a[174:175], v2 offset:3072
v_cvt_pk_bf16_f32 v82, v84, v85
v_cvt_pk_bf16_f32 v83, v86, v87
s_waitcnt lgkmcnt(8)
v_mfma_f32_32x32x16_bf16 v[32:47], a[184:187], a[92:95], v[32:47]
ds_read_b64_tr_b16 a[176:177], v1 offset:4096
ds_read_b64_tr_b16 a[178:179], v1 offset:5120
buffer_load_dwordx4 v5, s[24:27], s52 offen offset:1024 lds
buffer_store_dwordx4 v[80:83], v0, s[32:35], s65 offen offset:2048 sc1
v_mfma_f32_32x32x16_bf16 v[48:63], a[188:191], a[92:95], v[48:63]
ds_read_b64_tr_b16 a[180:181], v2 offset:4096
ds_read_b64_tr_b16 a[182:183], v2 offset:5120
v_mul_f32 v16, v88, v88
v_mul_f32 v17, v89, v89
v_mul_f32 v18, v90, v90
v_mul_f32 v19, v91, v91
v_fma_f32 v16, v16, v11, v10
s_waitcnt lgkmcnt(8)
v_mfma_f32_32x32x16_bf16 v[32:47], a[160:163], a[96:99], v[32:47]
ds_read_b64_tr_b16 a[184:185], v1 offset:6144
ds_read_b64_tr_b16 a[186:187], v1 offset:7168
v_fma_f32 v17, v17, v11, v10
v_fma_f32 v18, v18, v11, v10
v_fma_f32 v19, v19, v11, v10
v_mul_f32 v16, v16, v88
v_mul_f32 v17, v17, v89
v_mul_f32 v18, v18, v90
v_mul_f32 v19, v19, v91
v_mfma_f32_32x32x16_bf16 v[48:63], a[164:167], a[96:99], v[48:63]
ds_read_b64_tr_b16 a[188:189], v2 offset:6144
ds_read_b64_tr_b16 a[190:191], v2 offset:7168
v_exp_f32 v16, v16
v_exp_f32 v17, v17
v_exp_f32 v18, v18
s_waitcnt lgkmcnt(8)
v_mfma_f32_32x32x16_bf16 v[32:47], a[168:171], a[100:103], v[32:47]
ds_read_b64_tr_b16 a[160:161], v1 offset:8192
ds_read_b64_tr_b16 a[162:163], v1 offset:9216
buffer_load_dwordx4 v6, s[24:27], s52 offen offset:2048 lds
v_exp_f32 v19, v19
v_fma_f32 v16, v16, v12, v12
v_fma_f32 v17, v17, v12, v12
v_mfma_f32_32x32x16_bf16 v[48:63], a[172:175], a[100:103], v[48:63]
ds_read_b64_tr_b16 a[164:165], v2 offset:8192
ds_read_b64_tr_b16 a[166:167], v2 offset:9216
v_fma_f32 v18, v18, v12, v12
v_fma_f32 v19, v19, v12, v12
v_rcp_f32 v16, v16
v_rcp_f32 v17, v17
s_waitcnt lgkmcnt(8)
v_mfma_f32_32x32x16_bf16 v[32:47], a[176:179], a[104:107], v[32:47]
ds_read_b64_tr_b16 a[168:169], v1 offset:10240
ds_read_b64_tr_b16 a[170:171], v1 offset:11264
buffer_load_dwordx4 v7, s[24:27], s52 offen offset:3072 lds
v_rcp_f32 v18, v18
v_rcp_f32 v19, v19
v_mfma_f32_32x32x16_bf16 v[48:63], a[180:183], a[104:107], v[48:63]
ds_read_b64_tr_b16 a[172:173], v2 offset:10240
ds_read_b64_tr_b16 a[174:175], v2 offset:11264
v_mul_f32 v88, v88, v16
v_mul_f32 v89, v89, v17
v_mul_f32 v90, v90, v18
v_mul_f32 v91, v91, v19
v_mul_f32 v16, v92, v92
v_mul_f32 v17, v93, v93
v_mul_f32 v18, v94, v94
s_waitcnt lgkmcnt(8)
v_mfma_f32_32x32x16_bf16 v[32:47], a[184:187], a[108:111], v[32:47]
ds_read_b64_tr_b16 a[176:177], v1 offset:12288
ds_read_b64_tr_b16 a[178:179], v1 offset:13312
v_mul_f32 v19, v95, v95
v_fma_f32 v16, v16, v11, v10
v_fma_f32 v17, v17, v11, v10
v_fma_f32 v18, v18, v11, v10
v_fma_f32 v19, v19, v11, v10
v_mul_f32 v16, v16, v92
v_mul_f32 v17, v17, v93
v_mfma_f32_32x32x16_bf16 v[48:63], a[188:191], a[108:111], v[48:63]
ds_read_b64_tr_b16 a[180:181], v2 offset:12288
ds_read_b64_tr_b16 a[182:183], v2 offset:13312
v_mul_f32 v18, v18, v94
v_mul_f32 v19, v19, v95
v_exp_f32 v16, v16
v_exp_f32 v17, v17
s_waitcnt lgkmcnt(8)
v_mfma_f32_32x32x16_bf16 v[32:47], a[160:163], a[112:115], v[32:47]
ds_read_b64_tr_b16 a[184:185], v1 offset:14336
ds_read_b64_tr_b16 a[186:187], v1 offset:15360
v_exp_f32 v18, v18
v_exp_f32 v19, v19
v_fma_f32 v16, v16, v12, v12
v_fma_f32 v17, v17, v12, v12
v_fma_f32 v18, v18, v12, v12
v_fma_f32 v19, v19, v12, v12
v_mfma_f32_32x32x16_bf16 v[48:63], a[164:167], a[112:115], v[48:63]
ds_read_b64_tr_b16 a[188:189], v2 offset:14336
ds_read_b64_tr_b16 a[190:191], v2 offset:15360
v_rcp_f32 v16, v16
v_rcp_f32 v17, v17
v_rcp_f32 v18, v18
s_waitcnt lgkmcnt(8)
v_mfma_f32_32x32x16_bf16 v[32:47], a[168:171], a[116:119], v[32:47]
s_barrier
ds_read_b64_tr_b16 a[160:161], v1 offset:16384
ds_read_b64_tr_b16 a[162:163], v1 offset:17408
s_add_u32 m0, s41, 49152
s_add_u32 s52, s55, 409600
v_rcp_f32 v19, v19
v_mul_f32 v92, v92, v16
v_mfma_f32_32x32x16_bf16 v[48:63], a[172:175], a[116:119], v[48:63]
ds_read_b64_tr_b16 a[164:165], v2 offset:16384
ds_read_b64_tr_b16 a[166:167], v2 offset:17408
v_mul_f32 v93, v93, v17
v_mul_f32 v94, v94, v18
v_mul_f32 v95, v95, v19
v_cvt_pk_bf16_f32 v88, v88, v89
v_cvt_pk_bf16_f32 v89, v90, v91
v_cvt_pk_bf16_f32 v90, v92, v93
v_cvt_pk_bf16_f32 v91, v94, v95
s_waitcnt lgkmcnt(8)
v_mfma_f32_32x32x16_bf16 v[32:47], a[176:179], a[120:123], v[32:47]
ds_read_b64_tr_b16 a[168:169], v1 offset:18432
ds_read_b64_tr_b16 a[170:171], v1 offset:19456
buffer_load_dwordx4 v4, s[24:27], s52 offen lds
v_mfma_f32_32x32x16_bf16 v[48:63], a[180:183], a[120:123], v[48:63]
ds_read_b64_tr_b16 a[172:173], v2 offset:18432
ds_read_b64_tr_b16 a[174:175], v2 offset:19456
buffer_store_dwordx4 v[88:91], v0, s[32:35], s65 offen offset:3072 sc1
s_waitcnt lgkmcnt(8)
v_mfma_f32_32x32x16_bf16 v[32:47], a[184:187], a[124:127], v[32:47]
ds_read_b64_tr_b16 a[176:177], v1 offset:20480
ds_read_b64_tr_b16 a[178:179], v1 offset:21504
buffer_load_dwordx4 v5, s[24:27], s52 offen offset:1024 lds
v_mfma_f32_32x32x16_bf16 v[48:63], a[188:191], a[124:127], v[48:63]
ds_read_b64_tr_b16 a[180:181], v2 offset:20480
ds_read_b64_tr_b16 a[182:183], v2 offset:21504
s_waitcnt lgkmcnt(8)
v_mfma_f32_32x32x16_bf16 v[32:47], a[160:163], a[128:131], v[32:47]
ds_read_b64_tr_b16 a[184:185], v1 offset:22528
ds_read_b64_tr_b16 a[186:187], v1 offset:23552
v_mfma_f32_32x32x16_bf16 v[48:63], a[164:167], a[128:131], v[48:63]
ds_read_b64_tr_b16 a[188:189], v2 offset:22528
ds_read_b64_tr_b16 a[190:191], v2 offset:23552
s_waitcnt lgkmcnt(8)
v_mfma_f32_32x32x16_bf16 v[32:47], a[168:171], a[132:135], v[32:47]
ds_read_b64_tr_b16 a[160:161], v1 offset:24576
ds_read_b64_tr_b16 a[162:163], v1 offset:25600
buffer_load_dwordx4 v6, s[24:27], s52 offen offset:2048 lds
v_mfma_f32_32x32x16_bf16 v[48:63], a[172:175], a[132:135], v[48:63]
ds_read_b64_tr_b16 a[164:165], v2 offset:24576
ds_read_b64_tr_b16 a[166:167], v2 offset:25600
s_waitcnt lgkmcnt(8)
v_mfma_f32_32x32x16_bf16 v[32:47], a[176:179], a[136:139], v[32:47]
ds_read_b64_tr_b16 a[168:169], v1 offset:26624
ds_read_b64_tr_b16 a[170:171], v1 offset:27648
buffer_load_dwordx4 v7, s[24:27], s52 offen offset:3072 lds
v_mfma_f32_32x32x16_bf16 v[48:63], a[180:183], a[136:139], v[48:63]
ds_read_b64_tr_b16 a[172:173], v2 offset:26624
ds_read_b64_tr_b16 a[174:175], v2 offset:27648
s_waitcnt lgkmcnt(8)
v_mfma_f32_32x32x16_bf16 v[32:47], a[184:187], a[140:143], v[32:47]
ds_read_b64_tr_b16 a[176:177], v1 offset:28672
ds_read_b64_tr_b16 a[178:179], v1 offset:29696
s_lshl_b32 s6, s54, 9
s_add_u32 s6, s6, 32768
v_mfma_f32_32x32x16_bf16 v[48:63], a[188:191], a[140:143], v[48:63]
ds_read_b64_tr_b16 a[180:181], v2 offset:28672
ds_read_b64_tr_b16 a[182:183], v2 offset:29696
s_waitcnt lgkmcnt(8)
v_mfma_f32_32x32x16_bf16 v[32:47], a[160:163], a[144:147], v[32:47]
ds_read_b64_tr_b16 a[184:185], v1 offset:30720
ds_read_b64_tr_b16 a[186:187], v1 offset:31744
buffer_load_dword v29, off, s[32:35], s6 sc1
v_mfma_f32_32x32x16_bf16 v[48:63], a[164:167], a[144:147], v[48:63]
ds_read_b64_tr_b16 a[188:189], v2 offset:30720
ds_read_b64_tr_b16 a[190:191], v2 offset:31744
s_mul_i32 s98, s54, 110592
s_add_u32 s98, s98, 19005440
s_mul_i32 s3, s61, 12
s_cmp_eq_u32 s61, 0
s_cselect_b32 s98, 1073741824, s98
s_waitcnt lgkmcnt(8)
v_mfma_f32_32x32x16_bf16 v[32:47], a[168:171], a[148:151], v[32:47]
v_mfma_f32_32x32x16_bf16 v[48:63], a[172:175], a[148:151], v[48:63]
s_waitcnt lgkmcnt(4)
v_mfma_f32_32x32x16_bf16 v[32:47], a[176:179], a[152:155], v[32:47]
v_mfma_f32_32x32x16_bf16 v[48:63], a[180:183], a[152:155], v[48:63]
s_waitcnt lgkmcnt(0)
v_mfma_f32_32x32x16_bf16 v[32:47], a[184:187], a[156:159], v[32:47]
s_waitcnt vmcnt(4)
buffer_atomic_add v14, v13, s[32:35], s79 offen offset:128 sc1
v_mfma_f32_32x32x16_bf16 v[48:63], a[188:191], a[156:159], v[48:63]
s_barrier
s_add_u32 m0, s41, 65536
s_add_u32 s52, s55, 819200
buffer_load_dwordx4 v4, s[24:27], s52 offen lds
s_nop 4
v_pk_mul_f32 v[16:17], v[32:33], v[32:33]
v_pk_mul_f32 v[18:19], v[34:35], v[34:35]
v_pk_fma_f32 v[16:17], v[16:17], v[10:11], v[10:11] op_sel:[0,1,0] op_sel_hi:[1,1,0]
v_pk_fma_f32 v[18:19], v[18:19], v[10:11], v[10:11] op_sel:[0,1,0] op_sel_hi:[1,1,0]
v_pk_mul_f32 v[16:17], v[16:17], v[32:33]
v_pk_mul_f32 v[18:19], v[18:19], v[34:35]
v_exp_f32 v16, v16
v_exp_f32 v17, v17
v_exp_f32 v18, v18
v_exp_f32 v19, v19
v_pk_fma_f32 v[16:17], v[16:17], v[12:13], v[12:13] op_sel_hi:[1,0,0]
v_pk_fma_f32 v[18:19], v[18:19], v[12:13], v[12:13] op_sel_hi:[1,0,0]
v_rcp_f32 v16, v16
v_rcp_f32 v17, v17
v_rcp_f32 v18, v18
v_rcp_f32 v19, v19
v_pk_mul_f32 v[32:33], v[32:33], v[16:17]
v_pk_mul_f32 v[34:35], v[34:35], v[18:19]
v_pk_mul_f32 v[16:17], v[36:37], v[36:37]
v_pk_mul_f32 v[18:19], v[38:39], v[38:39]
buffer_load_dwordx4 v5, s[24:27], s52 offen offset:1024 lds
v_pk_fma_f32 v[16:17], v[16:17], v[10:11], v[10:11] op_sel:[0,1,0] op_sel_hi:[1,1,0]
v_pk_fma_f32 v[18:19], v[18:19], v[10:11], v[10:11] op_sel:[0,1,0] op_sel_hi:[1,1,0]
v_pk_mul_f32 v[16:17], v[16:17], v[36:37]
v_pk_mul_f32 v[18:19], v[18:19], v[38:39]
v_exp_f32 v16, v16
v_exp_f32 v17, v17
v_exp_f32 v18, v18
v_exp_f32 v19, v19
v_pk_fma_f32 v[16:17], v[16:17], v[12:13], v[12:13] op_sel_hi:[1,0,0]
v_pk_fma_f32 v[18:19], v[18:19], v[12:13], v[12:13] op_sel_hi:[1,0,0]
v_rcp_f32 v16, v16
v_rcp_f32 v17, v17
v_rcp_f32 v18, v18
v_rcp_f32 v19, v19
v_pk_mul_f32 v[36:37], v[36:37], v[16:17]
v_pk_mul_f32 v[38:39], v[38:39], v[18:19]
v_cvt_pk_bf16_f32 v32, v32, v33
v_cvt_pk_bf16_f32 v33, v34, v35
v_cvt_pk_bf16_f32 v34, v36, v37
v_cvt_pk_bf16_f32 v35, v38, v39
buffer_load_dwordx4 v6, s[24:27], s52 offen offset:2048 lds
buffer_store_dwordx4 v[32:35], v0, s[32:35], s66 offen sc1
v_pk_mul_f32 v[16:17], v[40:41], v[40:41]
v_pk_mul_f32 v[18:19], v[42:43], v[42:43]
v_pk_fma_f32 v[16:17], v[16:17], v[10:11], v[10:11] op_sel:[0,1,0] op_sel_hi:[1,1,0]
v_pk_fma_f32 v[18:19], v[18:19], v[10:11], v[10:11] op_sel:[0,1,0] op_sel_hi:[1,1,0]
v_pk_mul_f32 v[16:17], v[16:17], v[40:41]
v_pk_mul_f32 v[18:19], v[18:19], v[42:43]
v_exp_f32 v16, v16
v_exp_f32 v17, v17
v_exp_f32 v18, v18
v_exp_f32 v19, v19
v_pk_fma_f32 v[16:17], v[16:17], v[12:13], v[12:13] op_sel_hi:[1,0,0]
v_pk_fma_f32 v[18:19], v[18:19], v[12:13], v[12:13] op_sel_hi:[1,0,0]
v_rcp_f32 v16, v16
v_rcp_f32 v17, v17
v_rcp_f32 v18, v18
v_rcp_f32 v19, v19
v_pk_mul_f32 v[40:41], v[40:41], v[16:17]
v_pk_mul_f32 v[42:43], v[42:43], v[18:19]
v_pk_mul_f32 v[16:17], v[44:45], v[44:45]
v_pk_mul_f32 v[18:19], v[46:47], v[46:47]
buffer_load_dwordx4 v7, s[24:27], s52 offen offset:3072 lds
v_pk_fma_f32 v[16:17], v[16:17], v[10:11], v[10:11] op_sel:[0,1,0] op_sel_hi:[1,1,0]
v_pk_fma_f32 v[18:19], v[18:19], v[10:11], v[10:11] op_sel:[0,1,0] op_sel_hi:[1,1,0]
v_pk_mul_f32 v[16:17], v[16:17], v[44:45]
v_pk_mul_f32 v[18:19], v[18:19], v[46:47]
v_exp_f32 v16, v16
v_exp_f32 v17, v17
v_exp_f32 v18, v18
v_exp_f32 v19, v19
v_pk_fma_f32 v[16:17], v[16:17], v[12:13], v[12:13] op_sel_hi:[1,0,0]
v_pk_fma_f32 v[18:19], v[18:19], v[12:13], v[12:13] op_sel_hi:[1,0,0]
v_rcp_f32 v16, v16
v_rcp_f32 v17, v17
v_rcp_f32 v18, v18
v_rcp_f32 v19, v19
v_pk_mul_f32 v[44:45], v[44:45], v[16:17]
v_pk_mul_f32 v[46:47], v[46:47], v[18:19]
v_cvt_pk_bf16_f32 v40, v40, v41
v_cvt_pk_bf16_f32 v41, v42, v43
v_cvt_pk_bf16_f32 v42, v44, v45
v_cvt_pk_bf16_f32 v43, v46, v47
s_add_u32 m0, s41, 81920
s_add_u32 s52, s55, 1146880
buffer_load_dwordx4 v4, s[24:27], s52 offen lds
buffer_store_dwordx4 v[40:43], v0, s[32:35], s66 offen offset:1024 sc1
v_pk_mul_f32 v[16:17], v[48:49], v[48:49]
v_pk_mul_f32 v[18:19], v[50:51], v[50:51]
v_pk_fma_f32 v[16:17], v[16:17], v[10:11], v[10:11] op_sel:[0,1,0] op_sel_hi:[1,1,0]
v_pk_fma_f32 v[18:19], v[18:19], v[10:11], v[10:11] op_sel:[0,1,0] op_sel_hi:[1,1,0]
v_pk_mul_f32 v[16:17], v[16:17], v[48:49]
v_pk_mul_f32 v[18:19], v[18:19], v[50:51]
v_exp_f32 v16, v16
v_exp_f32 v17, v17
v_exp_f32 v18, v18
v_exp_f32 v19, v19
v_pk_fma_f32 v[16:17], v[16:17], v[12:13], v[12:13] op_sel_hi:[1,0,0]
v_pk_fma_f32 v[18:19], v[18:19], v[12:13], v[12:13] op_sel_hi:[1,0,0]
v_rcp_f32 v16, v16
v_rcp_f32 v17, v17
v_rcp_f32 v18, v18
v_rcp_f32 v19, v19
v_pk_mul_f32 v[48:49], v[48:49], v[16:17]
v_pk_mul_f32 v[50:51], v[50:51], v[18:19]
v_pk_mul_f32 v[16:17], v[52:53], v[52:53]
buffer_load_dwordx4 v5, s[24:27], s52 offen offset:1024 lds
v_pk_mul_f32 v[18:19], v[54:55], v[54:55]
v_pk_fma_f32 v[16:17], v[16:17], v[10:11], v[10:11] op_sel:[0,1,0] op_sel_hi:[1,1,0]
v_pk_fma_f32 v[18:19], v[18:19], v[10:11], v[10:11] op_sel:[0,1,0] op_sel_hi:[1,1,0]
v_pk_mul_f32 v[16:17], v[16:17], v[52:53]
v_pk_mul_f32 v[18:19], v[18:19], v[54:55]
v_exp_f32 v16, v16
v_exp_f32 v17, v17
v_exp_f32 v18, v18
v_exp_f32 v19, v19
v_pk_fma_f32 v[16:17], v[16:17], v[12:13], v[12:13] op_sel_hi:[1,0,0]
v_pk_fma_f32 v[18:19], v[18:19], v[12:13], v[12:13] op_sel_hi:[1,0,0]
v_rcp_f32 v16, v16
v_rcp_f32 v17, v17
v_rcp_f32 v18, v18
v_rcp_f32 v19, v19
v_pk_mul_f32 v[52:53], v[52:53], v[16:17]
v_pk_mul_f32 v[54:55], v[54:55], v[18:19]
v_cvt_pk_bf16_f32 v48, v48, v49
v_cvt_pk_bf16_f32 v49, v50, v51
v_cvt_pk_bf16_f32 v50, v52, v53
v_cvt_pk_bf16_f32 v51, v54, v55
buffer_load_dwordx4 v6, s[24:27], s52 offen offset:2048 lds
buffer_store_dwordx4 v[48:51], v0, s[32:35], s66 offen offset:2048 sc1
v_pk_mul_f32 v[16:17], v[56:57], v[56:57]
v_pk_mul_f32 v[18:19], v[58:59], v[58:59]
v_pk_fma_f32 v[16:17], v[16:17], v[10:11], v[10:11] op_sel:[0,1,0] op_sel_hi:[1,1,0]
v_pk_fma_f32 v[18:19], v[18:19], v[10:11], v[10:11] op_sel:[0,1,0] op_sel_hi:[1,1,0]
v_pk_mul_f32 v[16:17], v[16:17], v[56:57]
v_pk_mul_f32 v[18:19], v[18:19], v[58:59]
v_exp_f32 v16, v16
v_exp_f32 v17, v17
v_exp_f32 v18, v18
v_exp_f32 v19, v19
v_pk_fma_f32 v[16:17], v[16:17], v[12:13], v[12:13] op_sel_hi:[1,0,0]
v_pk_fma_f32 v[18:19], v[18:19], v[12:13], v[12:13] op_sel_hi:[1,0,0]
v_rcp_f32 v16, v16
v_rcp_f32 v17, v17
v_rcp_f32 v18, v18
v_rcp_f32 v19, v19
v_pk_mul_f32 v[56:57], v[56:57], v[16:17]
v_pk_mul_f32 v[58:59], v[58:59], v[18:19]
v_pk_mul_f32 v[16:17], v[60:61], v[60:61]
buffer_load_dwordx4 v7, s[24:27], s52 offen offset:3072 lds
v_pk_mul_f32 v[18:19], v[62:63], v[62:63]
v_pk_fma_f32 v[16:17], v[16:17], v[10:11], v[10:11] op_sel:[0,1,0] op_sel_hi:[1,1,0]
v_pk_fma_f32 v[18:19], v[18:19], v[10:11], v[10:11] op_sel:[0,1,0] op_sel_hi:[1,1,0]
v_pk_mul_f32 v[16:17], v[16:17], v[60:61]
v_pk_mul_f32 v[18:19], v[18:19], v[62:63]
v_exp_f32 v16, v16
v_exp_f32 v17, v17
v_exp_f32 v18, v18
v_exp_f32 v19, v19
v_pk_fma_f32 v[16:17], v[16:17], v[12:13], v[12:13] op_sel_hi:[1,0,0]
v_pk_fma_f32 v[18:19], v[18:19], v[12:13], v[12:13] op_sel_hi:[1,0,0]
v_rcp_f32 v16, v16
v_rcp_f32 v17, v17
v_rcp_f32 v18, v18
v_rcp_f32 v19, v19
v_pk_mul_f32 v[60:61], v[60:61], v[16:17]
v_pk_mul_f32 v[62:63], v[62:63], v[18:19]
v_cvt_pk_bf16_f32 v56, v56, v57
v_cvt_pk_bf16_f32 v57, v58, v59
v_cvt_pk_bf16_f32 v58, v60, v61
v_cvt_pk_bf16_f32 v59, v62, v63
buffer_store_dwordx4 v[56:59], v0, s[32:35], s66 offen offset:3072 sc1
s_waitcnt vmcnt(13)
v_cmp_gt_u32 vcc, s3, v29
s_nop 1
s_cbranch_vccnz L_pw63
L_pr65:
s_add_u32 s99, s98, 0
buffer_load_dwordx4 a[0:3], v0, s[32:35], s99 offen sc1
buffer_load_dwordx4 a[4:7], v0, s[32:35], s99 offen offset:1024 sc1
buffer_load_dwordx4 a[8:11], v0, s[32:35], s99 offen offset:2048 sc1
buffer_load_dwordx4 a[12:15], v0, s[32:35], s99 offen offset:3072 sc1
s_add_u32 s99, s98, 8192
buffer_load_dwordx4 a[16:19], v0, s[32:35], s99 offen sc1
buffer_load_dwordx4 a[20:23], v0, s[32:35], s99 offen offset:1024 sc1
buffer_load_dwordx4 a[24:27], v0, s[32:35], s99 offen offset:2048 sc1
buffer_load_dwordx4 a[28:31], v0, s[32:35], s99 offen offset:3072 sc1
s_add_u32 s99, s98, 16384
buffer_load_dwordx4 a[32:35], v0, s[32:35], s99 offen sc1
buffer_load_dwordx4 a[36:39], v0, s[32:35], s99 offen offset:1024 sc1
buffer_load_dwordx4 a[40:43], v0, s[32:35], s99 offen offset:2048 sc1
buffer_load_dwordx4 a[44:47], v0, s[32:35], s99 offen offset:3072 sc1
s_branch L_s4
L_s3o:
s_waitcnt vmcnt(0)
s_barrier
buffer_atomic_add v14, v19, s[32:35], 0 offen sc1
s_lshl_b32 s6, s44, 7
s_add_u32 s6, s6, 90112
buffer_load_dword v29, off, s[32:35], s6 sc1
s_mul_i32 s98, s44, 40960
s_add_u32 s98, s98, 13762560
s_mul_i32 s5, s44, 40960
s_add_u32 s5, s5, 16384000
s_lshl_b32 s4, s58, 5
s_add_u32 s64, s5, s4
s_add_u32 s65, s64, 4096
s_lshl_b32 s4, s59, 5
s_add_u32 s66, s5, s4
s_lshl_b32 s79, s44, 9
s_add_u32 s79, s79, 32768
s_add_u32 s47, s79, 384
s_waitcnt vmcnt(0)
v_cmp_gt_u32 vcc, 8, v29
s_nop 1
s_cbranch_vccnz L_pw66
L_pr68:
s_add_u32 s99, s63, 0
s_sub_u32 s3, s99, 10
s_cselect_b32 s99, s99, s3
s_lshl_b32 s99, s99, 12
s_add_u32 s99, s99, s98
buffer_load_dwordx4 a[0:3], v0, s[32:35], s99 offen sc1
buffer_load_dwordx4 a[4:7], v0, s[32:35], s99 offen offset:1024 sc1
buffer_load_dwordx4 a[8:11], v0, s[32:35], s99 offen offset:2048 sc1
buffer_load_dwordx4 a[12:15], v0, s[32:35], s99 offen offset:3072 sc1
s_add_u32 s99, s63, 1
s_sub_u32 s3, s99, 10
s_cselect_b32 s99, s99, s3
s_lshl_b32 s99, s99, 12
s_add_u32 s99, s99, s98
buffer_load_dwordx4 a[16:19], v0, s[32:35], s99 offen sc1
buffer_load_dwordx4 a[20:23], v0, s[32:35], s99 offen offset:1024 sc1
buffer_load_dwordx4 a[24:27], v0, s[32:35], s99 offen offset:2048 sc1
buffer_load_dwordx4 a[28:31], v0, s[32:35], s99 offen offset:3072 sc1
s_add_u32 s99, s63, 2
s_sub_u32 s3, s99, 10
s_cselect_b32 s99, s99, s3
s_lshl_b32 s99, s99, 12
s_add_u32 s99, s99, s98
buffer_load_dwordx4 a[32:35], v0, s[32:35], s99 offen sc1
buffer_load_dwordx4 a[36:39], v0, s[32:35], s99 offen offset:1024 sc1
buffer_load_dwordx4 a[40:43], v0, s[32:35], s99 offen offset:2048 sc1
buffer_load_dwordx4 a[44:47], v0, s[32:35], s99 offen offset:3072 sc1
v_bfe_u32 v30, v3, 2, 2
v_lshrrev_b32 v31, 5, v3
v_lshl_add_u32 v30, v31, 2, v30
v_lshlrev_b32 v1, 7, v30
v_bfe_u32 v30, v3, 4, 1
v_lshl_add_u32 v1, v30, 5, v1
v_and_b32 v30, 3, v3
v_lshl_add_u32 v1, v30, 3, v1
v_bfe_u32 v30, v3, 3, 1
v_lshl_add_u32 v1, v30, 6, v1
v_xor_b32 v2, 64, v1
ds_read_b64_tr_b16 a[160:161], v1 offset:0
ds_read_b64_tr_b16 a[162:163], v1 offset:1024
ds_read_b64_tr_b16 a[164:165], v2 offset:0
ds_read_b64_tr_b16 a[166:167], v2 offset:1024
ds_read_b64_tr_b16 a[168:169], v1 offset:2048
ds_read_b64_tr_b16 a[170:171], v1 offset:3072
ds_read_b64_tr_b16 a[172:173], v2 offset:2048
ds_read_b64_tr_b16 a[174:175], v2 offset:3072
ds_read_b64_tr_b16 a[176:177], v1 offset:4096
ds_read_b64_tr_b16 a[178:179], v1 offset:5120
ds_read_b64_tr_b16 a[180:181], v2 offset:4096
ds_read_b64_tr_b16 a[182:183], v2 offset:5120
s_waitcnt lgkmcnt(8)
s_waitcnt vmcnt(11)
v_mfma_f32_32x32x16_bf16 v[32:47], a[160:163], a[0:3], 0
ds_read_b64_tr_b16 a[184:185], v1 offset:6144
ds_read_b64_tr_b16 a[186:187], v1 offset:7168
s_add_u32 m0, s41, 114688
s_add_u32 s51, s63, 4
s_sub_u32 s52, s51, 10
s_cselect_b32 s51, s51, s52
v_mfma_f32_32x32x16_bf16 v[48:63], a[164:167], a[0:3], 0
ds_read_b64_tr_b16 a[188:189], v2 offset:6144
ds_read_b64_tr_b16 a[190:191], v2 offset:7168
s_mul_i32 s52, s51, s53
s_add_u32 s52, s52, s58
s_add_u32 s52, s52, 128
s_waitcnt lgkmcnt(8)
s_waitcnt vmcnt(10)
v_mfma_f32_32x32x16_bf16 v[32:47], a[168:171], a[4:7], v[32:47]
ds_read_b64_tr_b16 a[160:161], v1 offset:8192
ds_read_b64_tr_b16 a[162:163], v1 offset:9216
buffer_load_dwordx4 v4, s[20:23], s52 offen lds
v_mfma_f32_32x32x16_bf16 v[48:63], a[172:175], a[4:7], v[48:63]
ds_read_b64_tr_b16 a[164:165], v2 offset:8192
ds_read_b64_tr_b16 a[166:167], v2 offset:9216
s_add_u32 s99, s63, 3
s_sub_u32 s3, s99, 10
s_cselect_b32 s99, s99, s3
s_lshl_b32 s99, s99, 12
s_add_u32 s99, s99, s98
buffer_load_dwordx4 a[48:51], v0, s[32:35], s99 offen sc1
s_waitcnt lgkmcnt(8)
s_waitcnt vmcnt(11)
v_mfma_f32_32x32x16_bf16 v[32:47], a[176:179], a[8:11], v[32:47]
ds_read_b64_tr_b16 a[168:169], v1 offset:10240
ds_read_b64_tr_b16 a[170:171], v1 offset:11264
buffer_load_dwordx4 v5, s[20:23], s52 offen offset:1024 lds
v_mfma_f32_32x32x16_bf16 v[48:63], a[180:183], a[8:11], v[48:63]
ds_read_b64_tr_b16 a[172:173], v2 offset:10240
ds_read_b64_tr_b16 a[174:175], v2 offset:11264
buffer_load_dwordx4 a[52:55], v0, s[32:35], s99 offen offset:1024 sc1
s_waitcnt lgkmcnt(8)
s_waitcnt vmcnt(12)
v_mfma_f32_32x32x16_bf16 v[32:47], a[184:187], a[12:15], v[32:47]
ds_read_b64_tr_b16 a[176:177], v1 offset:12288
ds_read_b64_tr_b16 a[178:179], v1 offset:13312
buffer_load_dwordx4 a[56:59], v0, s[32:35], s99 offen offset:2048 sc1
v_mfma_f32_32x32x16_bf16 v[48:63], a[188:191], a[12:15], v[48:63]
ds_read_b64_tr_b16 a[180:181], v2 offset:12288
ds_read_b64_tr_b16 a[182:183], v2 offset:13312
s_waitcnt lgkmcnt(8)
s_waitcnt vmcnt(12)
v_mfma_f32_32x32x16_bf16 v[32:47], a[160:163], a[16:19], v[32:47]
ds_read_b64_tr_b16 a[184:185], v1 offset:14336
ds_read_b64_tr_b16 a[186:187], v1 offset:15360
buffer_load_dwordx4 v6, s[20:23], s52 offen offset:2048 lds
v_mfma_f32_32x32x16_bf16 v[48:63], a[164:167], a[16:19], v[48:63]
ds_read_b64_tr_b16 a[188:189], v2 offset:14336
ds_read_b64_tr_b16 a[190:191], v2 offset:15360
buffer_load_dwordx4 a[60:63], v0, s[32:35], s99 offen offset:3072 sc1
s_waitcnt lgkmcnt(8)
s_waitcnt vmcnt(13)
v_mfma_f32_32x32x16_bf16 v[32:47], a[168:171], a[20:23], v[32:47]
s_barrier
ds_read_b64_tr_b16 a[160:161], v1 offset:16384
ds_read_b64_tr_b16 a[162:163], v1 offset:17408
s_add_u32 s99, s63, 4
s_sub_u32 s3, s99, 10
s_cselect_b32 s99, s99, s3
v_mfma_f32_32x32x16_bf16 v[48:63], a[172:175], a[20:23], v[48:63]
ds_read_b64_tr_b16 a[164:165], v2 offset:16384
ds_read_b64_tr_b16 a[166:167], v2 offset:17408
s_lshl_b32 s99, s99, 12
s_add_u32 s99, s99, s98
buffer_load_dwordx4 a[64:67], v0, s[32:35], s99 offen sc1
s_waitcnt lgkmcnt(8)
s_waitcnt vmcnt(13)
v_mfma_f32_32x32x16_bf16 v[32:47], a[176:179], a[24:27], v[32:47]
ds_read_b64_tr_b16 a[168:169], v1 offset:18432
ds_read_b64_tr_b16 a[170:171], v1 offset:19456
buffer_load_dwordx4 v7, s[20:23], s52 offen offset:3072 lds
v_mfma_f32_32x32x16_bf16 v[48:63], a[180:183], a[24:27], v[48:63]
ds_read_b64_tr_b16 a[172:173], v2 offset:18432
ds_read_b64_tr_b16 a[174:175], v2 offset:19456
s_add_u32 m0, s41, 131072
s_add_u32 s51, s63, 6
s_sub_u32 s52, s51, 10
s_cselect_b32 s51, s51, s52
s_mul_i32 s52, s51, s53
s_add_u32 s52, s52, s58
s_add_u32 s52, s52, 128
buffer_load_dwordx4 v4, s[20:23], s52 offen lds
buffer_load_dwordx4 a[68:71], v0, s[32:35], s99 offen offset:1024 sc1
s_waitcnt lgkmcnt(8)
s_waitcnt vmcnt(15)
v_mfma_f32_32x32x16_bf16 v[32:47], a[184:187], a[28:31], v[32:47]
ds_read_b64_tr_b16 a[176:177], v1 offset:20480
ds_read_b64_tr_b16 a[178:179], v1 offset:21504
buffer_load_dwordx4 v5, s[20:23], s52 offen offset:1024 lds
v_mfma_f32_32x32x16_bf16 v[48:63], a[188:191], a[28:31], v[48:63]
ds_read_b64_tr_b16 a[180:181], v2 offset:20480
ds_read_b64_tr_b16 a[182:183], v2 offset:21504
buffer_load_dwordx4 a[72:75], v0, s[32:35], s99 offen offset:2048 sc1
s_waitcnt lgkmcnt(8)
s_waitcnt vmcnt(16)
v_mfma_f32_32x32x16_bf16 v[32:47], a[160:163], a[32:35], v[32:47]
ds_read_b64_tr_b16 a[184:185], v1 offset:22528
ds_read_b64_tr_b16 a[186:187], v1 offset:23552
buffer_load_dwordx4 a[76:79], v0, s[32:35], s99 offen offset:3072 sc1
v_mfma_f32_32x32x16_bf16 v[48:63], a[164:167], a[32:35], v[48:63]
ds_read_b64_tr_b16 a[188:189], v2 offset:22528
ds_read_b64_tr_b16 a[190:191], v2 offset:23552
s_add_u32 s99, s63, 5
s_sub_u32 s3, s99, 10
s_cselect_b32 s99, s99, s3
s_waitcnt lgkmcnt(8)
s_waitcnt vmcnt(16)
v_mfma_f32_32x32x16_bf16 v[32:47], a[168:171], a[36:39], v[32:47]
ds_read_b64_tr_b16 a[160:161], v1 offset:24576
ds_read_b64_tr_b16 a[162:163], v1 offset:25600
buffer_load_dwordx4 v6, s[20:23], s52 offen offset:2048 lds
v_mfma_f32_32x32x16_bf16 v[48:63], a[172:175], a[36:39], v[48:63]
ds_read_b64_tr_b16 a[164:165], v2 offset:24576
ds_read_b64_tr_b16 a[166:167], v2 offset:25600
s_lshl_b32 s99, s99, 12
s_add_u32 s99, s99, s98
buffer_load_dwordx4 a[80:83], v0, s[32:35], s99 offen sc1
s_waitcnt lgkmcnt(8)
s_waitcnt vmcnt(17)
v_mfma_f32_32x32x16_bf16 v[32:47], a[176:179], a[40:43], v[32:47]
ds_read_b64_tr_b16 a[168:169], v1 offset:26624
ds_read_b64_tr_b16 a[170:171], v1 offset:27648
buffer_load_dwordx4 v7, s[20:23], s52 offen offset:3072 lds
v_mfma_f32_32x32x16_bf16 v[48:63], a[180:183], a[40:43], v[48:63]
ds_read_b64_tr_b16 a[172:173], v2 offset:26624
ds_read_b64_tr_b16 a[174:175], v2 offset:27648
buffer_load_dwordx4 a[84:87], v0, s[32:35], s99 offen offset:1024 sc1
s_waitcnt lgkmcnt(8)
s_waitcnt vmcnt(18)
v_mfma_f32_32x32x16_bf16 v[32:47], a[184:187], a[44:47], v[32:47]
ds_read_b64_tr_b16 a[176:177], v1 offset:28672
ds_read_b64_tr_b16 a[178:179], v1 offset:29696
buffer_load_dwordx4 a[88:91], v0, s[32:35], s99 offen offset:2048 sc1
v_mfma_f32_32x32x16_bf16 v[48:63], a[188:191], a[44:47], v[48:63]
ds_read_b64_tr_b16 a[180:181], v2 offset:28672
ds_read_b64_tr_b16 a[182:183], v2 offset:29696
s_waitcnt lgkmcnt(8)
s_waitcnt vmcnt(17)
v_mfma_f32_32x32x16_bf16 v[32:47], a[160:163], a[48:51], v[32:47]
ds_read_b64_tr_b16 a[184:185], v1 offset:30720
ds_read_b64_tr_b16 a[186:187], v1 offset:31744
buffer_load_dwordx4 a[92:95], v0, s[32:35], s99 offen offset:3072 sc1
v_mfma_f32_32x32x16_bf16 v[48:63], a[164:167], a[48:51], v[48:63]
ds_read_b64_tr_b16 a[188:189], v2 offset:30720
ds_read_b64_tr_b16 a[190:191], v2 offset:31744
s_add_u32 s99, s63, 6
s_sub_u32 s3, s99, 10
s_cselect_b32 s99, s99, s3
s_waitcnt lgkmcnt(8)
s_waitcnt vmcnt(16)
v_mfma_f32_32x32x16_bf16 v[32:47], a[168:171], a[52:55], v[32:47]
s_barrier
ds_read_b64_tr_b16 a[160:161], v1 offset:32768
ds_read_b64_tr_b16 a[162:163], v1 offset:33792
s_add_u32 m0, s41, 0
s_add_u32 s51, s63, 8
v_mfma_f32_32x32x16_bf16 v[48:63], a[172:175], a[52:55], v[48:63]
ds_read_b64_tr_b16 a[164:165], v2 offset:32768
ds_read_b64_tr_b16 a[166:167], v2 offset:33792
s_sub_u32 s52, s51, 10
s_cselect_b32 s51, s51, s52
s_mul_i32 s52, s51, s53
s_lshl_b32 s99, s99, 12
s_add_u32 s99, s99, s98
buffer_load_dwordx4 a[96:99], v0, s[32:35], s99 offen sc1
s_waitcnt lgkmcnt(8)
s_waitcnt vmcnt(16)
v_mfma_f32_32x32x16_bf16 v[32:47], a[176:179], a[56:59], v[32:47]
ds_read_b64_tr_b16 a[168:169], v1 offset:34816
ds_read_b64_tr_b16 a[170:171], v1 offset:35840
s_add_u32 s52, s52, s58
s_add_u32 s52, s52, 128
v_mfma_f32_32x32x16_bf16 v[48:63], a[180:183], a[56:59], v[48:63]
ds_read_b64_tr_b16 a[172:173], v2 offset:34816
ds_read_b64_tr_b16 a[174:175], v2 offset:35840
buffer_load_dwordx4 v4, s[20:23], s52 offen lds
buffer_load_dwordx4 a[100:103], v0, s[32:35], s99 offen offset:1024 sc1
s_waitcnt lgkmcnt(8)
s_waitcnt vmcnt(16)
v_mfma_f32_32x32x16_bf16 v[32:47], a[184:187], a[60:63], v[32:47]
ds_read_b64_tr_b16 a[176:177], v1 offset:36864
ds_read_b64_tr_b16 a[178:179], v1 offset:37888
buffer_load_dwordx4 v5, s[20:23], s52 offen offset:1024 lds
v_mfma_f32_32x32x16_bf16 v[48:63], a[188:191], a[60:63], v[48:63]
ds_read_b64_tr_b16 a[180:181], v2 offset:36864
ds_read_b64_tr_b16 a[182:183], v2 offset:37888
buffer_load_dwordx4 a[104:107], v0, s[32:35], s99 offen offset:2048 sc1
s_waitcnt lgkmcnt(8)
s_waitcnt vmcnt(17)
v_mfma_f32_32x32x16_bf16 v[32:47], a[160:163], a[64:67], v[32:47]
ds_read_b64_tr_b16 a[184:185], v1 offset:38912
ds_read_b64_tr_b16 a[186:187], v1 offset:39936
buffer_load_dwordx4 a[108:111], v0, s[32:35], s99 offen offset:3072 sc1
v_mfma_f32_32x32x16_bf16 v[48:63], a[164:167], a[64:67], v[48:63]
ds_read_b64_tr_b16 a[188:189], v2 offset:38912
ds_read_b64_tr_b16 a[190:191], v2 offset:39936
s_add_u32 s99, s63, 7
s_sub_u32 s3, s99, 10
s_cselect_b32 s99, s99, s3
s_waitcnt lgkmcnt(8)
s_waitcnt vmcnt(15)
v_mfma_f32_32x32x16_bf16 v[32:47], a[168:171], a[68:71], v[32:47]
ds_read_b64_tr_b16 a[160:161], v1 offset:40960
ds_read_b64_tr_b16 a[162:163], v1 offset:41984
buffer_load_dwordx4 v6, s[20:23], s52 offen offset:2048 lds
v_mfma_f32_32x32x16_bf16 v[48:63], a[172:175], a[68:71], v[48:63]
ds_read_b64_tr_b16 a[164:165], v2 offset:40960
ds_read_b64_tr_b16 a[166:167], v2 offset:41984
s_lshl_b32 s99, s99, 12
s_add_u32 s99, s99, s98
buffer_load_dwordx4 a[112:115], v0, s[32:35], s99 offen sc1
s_waitcnt lgkmcnt(8)
s_waitcnt vmcnt(15)
v_mfma_f32_32x32x16_bf16 v[32:47], a[176:179], a[72:75], v[32:47]
ds_read_b64_tr_b16 a[168:169], v1 offset:43008
ds_read_b64_tr_b16 a[170:171], v1 offset:44032
buffer_load_dwordx4 v7, s[20:23], s52 offen offset:3072 lds
v_mfma_f32_32x32x16_bf16 v[48:63], a[180:183], a[72:75], v[48:63]
ds_read_b64_tr_b16 a[172:173], v2 offset:43008
ds_read_b64_tr_b16 a[174:175], v2 offset:44032
buffer_load_dwordx4 a[116:119], v0, s[32:35], s99 offen offset:1024 sc1
s_waitcnt lgkmcnt(8)
s_waitcnt vmcnt(16)
v_mfma_f32_32x32x16_bf16 v[32:47], a[184:187], a[76:79], v[32:47]
ds_read_b64_tr_b16 a[176:177], v1 offset:45056
ds_read_b64_tr_b16 a[178:179], v1 offset:46080
buffer_load_dwordx4 a[120:123], v0, s[32:35], s99 offen offset:2048 sc1
v_mfma_f32_32x32x16_bf16 v[48:63], a[188:191], a[76:79], v[48:63]
ds_read_b64_tr_b16 a[180:181], v2 offset:45056
ds_read_b64_tr_b16 a[182:183], v2 offset:46080
s_waitcnt lgkmcnt(8)
s_waitcnt vmcnt(15)
v_mfma_f32_32x32x16_bf16 v[32:47], a[160:163], a[80:83], v[32:47]
ds_read_b64_tr_b16 a[184:185], v1 offset:47104
ds_read_b64_tr_b16 a[186:187], v1 offset:48128
buffer_load_dwordx4 a[124:127], v0, s[32:35], s99 offen offset:3072 sc1
v_mfma_f32_32x32x16_bf16 v[48:63], a[164:167], a[80:83], v[48:63]
ds_read_b64_tr_b16 a[188:189], v2 offset:47104
ds_read_b64_tr_b16 a[190:191], v2 offset:48128
s_add_u32 s99, s63, 8
s_sub_u32 s3, s99, 10
s_cselect_b32 s99, s99, s3
s_waitcnt lgkmcnt(8)
s_waitcnt vmcnt(14)
v_mfma_f32_32x32x16_bf16 v[32:47], a[168:171], a[84:87], v[32:47]
s_barrier
ds_read_b64_tr_b16 a[160:161], v1 offset:49152
ds_read_b64_tr_b16 a[162:163], v1 offset:50176
v_lshrrev_b32 v4, 2, v3
v_and_b32 v5, 3, v3
v_mfma_f32_32x32x16_bf16 v[48:63], a[172:175], a[84:87], v[48:63]
ds_read_b64_tr_b16 a[164:165], v2 offset:49152
ds_read_b64_tr_b16 a[166:167], v2 offset:50176
v_lshlrev_b32 v5, 4, v5
v_mad_u32_u24 v4, v4, s57, v5
s_lshl_b32 s53, s57, 4
s_lshl_b32 s99, s99, 12
s_add_u32 s99, s99, s98
buffer_load_dwordx4 a[128:131], v0, s[32:35], s99 offen sc1
s_waitcnt lgkmcnt(8)
s_waitcnt vmcnt(14)
v_mfma_f32_32x32x16_bf16 v[32:47], a[176:179], a[88:91], v[32:47]
ds_read_b64_tr_b16 a[168:169], v1 offset:51200
ds_read_b64_tr_b16 a[170:171], v1 offset:52224
s_sub_u32 s53, s53, 1024
v_add_u32 v5, s53, v4
v_add_u32 v6, s53, v5
v_add_u32 v7, s53, v6
v_mfma_f32_32x32x16_bf16 v[48:63], a[180:183], a[88:91], v[48:63]
ds_read_b64_tr_b16 a[172:173], v2 offset:51200
ds_read_b64_tr_b16 a[174:175], v2 offset:52224
s_lshl_b32 s53, s57, 6
s_add_u32 m0, s41, 16384
s_add_u32 s51, s63, s40
s_add_u32 s51, s51, 0
s_sub_u32 s52, s51, 10
s_cselect_b32 s51, s51, s52
s_mul_i32 s52, s51, s53
s_add_u32 s52, s52, s59
buffer_load_dwordx4 v4, s[20:23], s52 offen lds
buffer_load_dwordx4 a[132:135], v0, s[32:35], s99 offen offset:1024 sc1
s_waitcnt lgkmcnt(8)
s_waitcnt vmcnt(15)
v_mfma_f32_32x32x16_bf16 v[32:47], a[184:187], a[92:95], v[32:47]
ds_read_b64_tr_b16 a[176:177], v1 offset:53248
ds_read_b64_tr_b16 a[178:179], v1 offset:54272
buffer_load_dwordx4 v5, s[20:23], s52 offen offset:1024 lds
v_mfma_f32_32x32x16_bf16 v[48:63], a[188:191], a[92:95], v[48:63]
ds_read_b64_tr_b16 a[180:181], v2 offset:53248
ds_read_b64_tr_b16 a[182:183], v2 offset:54272
buffer_load_dwordx4 a[136:139], v0, s[32:35], s99 offen offset:2048 sc1
s_waitcnt lgkmcnt(8)
s_waitcnt vmcnt(16)
v_mfma_f32_32x32x16_bf16 v[32:47], a[160:163], a[96:99], v[32:47]
ds_read_b64_tr_b16 a[184:185], v1 offset:55296
ds_read_b64_tr_b16 a[186:187], v1 offset:56320
buffer_load_dwordx4 a[140:143], v0, s[32:35], s99 offen offset:3072 sc1
v_mfma_f32_32x32x16_bf16 v[48:63], a[164:167], a[96:99], v[48:63]
ds_read_b64_tr_b16 a[188:189], v2 offset:55296
ds_read_b64_tr_b16 a[190:191], v2 offset:56320
s_add_u32 s99, s63, 9
s_sub_u32 s3, s99, 10
s_cselect_b32 s99, s99, s3
s_waitcnt lgkmcnt(8)
s_waitcnt vmcnt(15)
v_mfma_f32_32x32x16_bf16 v[32:47], a[168:171], a[100:103], v[32:47]
ds_read_b64_tr_b16 a[160:161], v1 offset:57344
ds_read_b64_tr_b16 a[162:163], v1 offset:58368
buffer_load_dwordx4 v6, s[20:23], s52 offen offset:2048 lds
v_mfma_f32_32x32x16_bf16 v[48:63], a[172:175], a[100:103], v[48:63]
ds_read_b64_tr_b16 a[164:165], v2 offset:57344
ds_read_b64_tr_b16 a[166:167], v2 offset:58368
s_lshl_b32 s99, s99, 12
s_add_u32 s99, s99, s98
buffer_load_dwordx4 a[144:147], v0, s[32:35], s99 offen sc1
s_waitcnt lgkmcnt(8)
s_waitcnt vmcnt(15)
v_mfma_f32_32x32x16_bf16 v[32:47], a[176:179], a[104:107], v[32:47]
ds_read_b64_tr_b16 a[168:169], v1 offset:59392
ds_read_b64_tr_b16 a[170:171], v1 offset:60416
buffer_load_dwordx4 v7, s[20:23], s52 offen offset:3072 lds
v_mfma_f32_32x32x16_bf16 v[48:63], a[180:183], a[104:107], v[48:63]
ds_read_b64_tr_b16 a[172:173], v2 offset:59392
ds_read_b64_tr_b16 a[174:175], v2 offset:60416
buffer_load_dwordx4 a[148:151], v0, s[32:35], s99 offen offset:1024 sc1
s_waitcnt lgkmcnt(8)
s_waitcnt vmcnt(16)
v_mfma_f32_32x32x16_bf16 v[32:47], a[184:187], a[108:111], v[32:47]
ds_read_b64_tr_b16 a[176:177], v1 offset:61440
ds_read_b64_tr_b16 a[178:179], v1 offset:62464
buffer_load_dwordx4 a[152:155], v0, s[32:35], s99 offen offset:2048 sc1
v_mfma_f32_32x32x16_bf16 v[48:63], a[188:191], a[108:111], v[48:63]
ds_read_b64_tr_b16 a[180:181], v2 offset:61440
ds_read_b64_tr_b16 a[182:183], v2 offset:62464
s_waitcnt lgkmcnt(8)
s_waitcnt vmcnt(15)
v_mfma_f32_32x32x16_bf16 v[32:47], a[160:163], a[112:115], v[32:47]
ds_read_b64_tr_b16 a[184:185], v1 offset:63488
ds_read_b64_tr_b16 a[186:187], v1 offset:64512
buffer_load_dwordx4 a[156:159], v0, s[32:35], s99 offen offset:3072 sc1
v_mfma_f32_32x32x16_bf16 v[48:63], a[164:167], a[112:115], v[48:63]
ds_read_b64_tr_b16 a[188:189], v2 offset:63488
ds_read_b64_tr_b16 a[190:191], v2 offset:64512
s_waitcnt lgkmcnt(8)
s_waitcnt vmcnt(14)
v_mfma_f32_32x32x16_bf16 v[32:47], a[168:171], a[116:119], v[32:47]
s_barrier
v_add_u32 v1, 65536, v1
v_add_u32 v2, 65536, v2
ds_read_b64_tr_b16 a[160:161], v1 offset:0
ds_read_b64_tr_b16 a[162:163], v1 offset:1024
v_mfma_f32_32x32x16_bf16 v[48:63], a[172:175], a[116:119], v[48:63]
ds_read_b64_tr_b16 a[164:165], v2 offset:0
ds_read_b64_tr_b16 a[166:167], v2 offset:1024
s_add_u32 m0, s41, 32768
s_add_u32 s51, s63, s40
s_add_u32 s51, s51, 4
s_waitcnt lgkmcnt(8)
s_waitcnt vmcnt(13)
v_mfma_f32_32x32x16_bf16 v[32:47], a[176:179], a[120:123], v[32:47]
ds_read_b64_tr_b16 a[168:169], v1 offset:2048
ds_read_b64_tr_b16 a[170:171], v1 offset:3072
s_sub_u32 s52, s51, 10
s_cselect_b32 s51, s51, s52
s_mul_i32 s52, s51, s53
s_add_u32 s52, s52, s59
v_mfma_f32_32x32x16_bf16 v[48:63], a[180:183], a[120:123], v[48:63]
ds_read_b64_tr_b16 a[172:173], v2 offset:2048
ds_read_b64_tr_b16 a[174:175], v2 offset:3072
buffer_load_dwordx4 v4, s[20:23], s52 offen lds
s_waitcnt lgkmcnt(8)
s_waitcnt vmcnt(13)
v_mfma_f32_32x32x16_bf16 v[32:47], a[184:187], a[124:127], v[32:47]
ds_read_b64_tr_b16 a[176:177], v1 offset:4096
ds_read_b64_tr_b16 a[178:179], v1 offset:5120
buffer_load_dwordx4 v5, s[20:23], s52 offen offset:1024 lds
v_mfma_f32_32x32x16_bf16 v[48:63], a[188:191], a[124:127], v[48:63]
ds_read_b64_tr_b16 a[180:181], v2 offset:4096
ds_read_b64_tr_b16 a[182:183], v2 offset:5120
s_waitcnt lgkmcnt(8)
s_waitcnt vmcnt(13)
v_mfma_f32_32x32x16_bf16 v[32:47], a[160:163], a[128:131], v[32:47]
ds_read_b64_tr_b16 a[184:185], v1 offset:6144
ds_read_b64_tr_b16 a[186:187], v1 offset:7168
v_mfma_f32_32x32x16_bf16 v[48:63], a[164:167], a[128:131], v[48:63]
ds_read_b64_tr_b16 a[188:189], v2 offset:6144
ds_read_b64_tr_b16 a[190:191], v2 offset:7168
s_waitcnt lgkmcnt(8)
s_waitcnt vmcnt(11)
v_mfma_f32_32x32x16_bf16 v[32:47], a[168:171], a[132:135], v[32:47]
ds_read_b64_tr_b16 a[160:161], v1 offset:8192
ds_read_b64_tr_b16 a[162:163], v1 offset:9216
buffer_load_dwordx4 v6, s[20:23], s52 offen offset:2048 lds
v_mfma_f32_32x32x16_bf16 v[48:63], a[172:175], a[132:135], v[48:63]
ds_read_b64_tr_b16 a[164:165], v2 offset:8192
ds_read_b64_tr_b16 a[166:167], v2 offset:9216
s_waitcnt lgkmcnt(8)
s_waitcnt vmcnt(10)
v_mfma_f32_32x32x16_bf16 v[32:47], a[176:179], a[136:139], v[32:47]
ds_read_b64_tr_b16 a[168:169], v1 offset:10240
ds_read_b64_tr_b16 a[170:171], v1 offset:11264
buffer_load_dwordx4 v7, s[20:23], s52 offen offset:3072 lds
v_mfma_f32_32x32x16_bf16 v[48:63], a[180:183], a[136:139], v[48:63]
ds_read_b64_tr_b16 a[172:173], v2 offset:10240
ds_read_b64_tr_b16 a[174:175], v2 offset:11264
s_waitcnt lgkmcnt(8)
s_waitcnt vmcnt(10)
v_mfma_f32_32x32x16_bf16 v[32:47], a[184:187], a[140:143], v[32:47]
ds_read_b64_tr_b16 a[176:177], v1 offset:12288
ds_read_b64_tr_b16 a[178:179], v1 offset:13312
v_mfma_f32_32x32x16_bf16 v[48:63], a[188:191], a[140:143], v[48:63]
ds_read_b64_tr_b16 a[180:181], v2 offset:12288
ds_read_b64_tr_b16 a[182:183], v2 offset:13312
s_waitcnt lgkmcnt(8)
s_waitcnt vmcnt(8)
v_mfma_f32_32x32x16_bf16 v[32:47], a[160:163], a[144:147], v[32:47]
ds_read_b64_tr_b16 a[184:185], v1 offset:14336
ds_read_b64_tr_b16 a[186:187], v1 offset:15360
v_mfma_f32_32x32x16_bf16 v[48:63], a[164:167], a[144:147], v[48:63]
ds_read_b64_tr_b16 a[188:189], v2 offset:14336
ds_read_b64_tr_b16 a[190:191], v2 offset:15360
s_waitcnt lgkmcnt(8)
s_waitcnt vmcnt(6)
v_mfma_f32_32x32x16_bf16 v[32:47], a[168:171], a[148:151], v[32:47]
s_barrier
ds_read_b64_tr_b16 a[160:161], v1 offset:16384
ds_read_b64_tr_b16 a[162:163], v1 offset:17408
s_add_u32 m0, s41, 49152
s_add_u32 s51, s63, s40
v_mfma_f32_32x32x16_bf16 v[48:63], a[172:175], a[148:151], v[48:63]
ds_read_b64_tr_b16 a[164:165], v2 offset:16384
ds_read_b64_tr_b16 a[166:167], v2 offset:17408
s_add_u32 s51, s51, 8
s_sub_u32 s52, s51, 10
s_cselect_b32 s51, s51, s52
s_waitcnt lgkmcnt(8)
s_waitcnt vmcnt(5)
v_mfma_f32_32x32x16_bf16 v[32:47], a[176:179], a[152:155], v[32:47]
ds_read_b64_tr_b16 a[168:169], v1 offset:18432
ds_read_b64_tr_b16 a[170:171], v1 offset:19456
s_mul_i32 s52, s51, s53
s_add_u32 s52, s52, s59
s_cmp_lt_u32 s40, 2
s_cselect_b32 s52, s52, 1073741824
v_mfma_f32_32x32x16_bf16 v[48:63], a[180:183], a[152:155], v[48:63]
ds_read_b64_tr_b16 a[172:173], v2 offset:18432
ds_read_b64_tr_b16 a[174:175], v2 offset:19456
buffer_load_dwordx4 v4, s[20:23], s52 offen lds
s_waitcnt lgkmcnt(8)
s_waitcnt vmcnt(5)
v_mfma_f32_32x32x16_bf16 v[32:47], a[184:187], a[156:159], v[32:47]
ds_read_b64_tr_b16 a[176:177], v1 offset:20480
ds_read_b64_tr_b16 a[178:179], v1 offset:21504
buffer_load_dwordx4 v5, s[20:23], s52 offen offset:1024 lds
v_mfma_f32_32x32x16_bf16 v[48:63], a[188:191], a[156:159], v[48:63]
ds_read_b64_tr_b16 a[180:181], v2 offset:20480
ds_read_b64_tr_b16 a[182:183], v2 offset:21504
buffer_load_dwordx4 v6, s[20:23], s52 offen offset:2048 lds
buffer_load_dwordx4 v7, s[20:23], s52 offen offset:3072 lds
s_waitcnt lgkmcnt(8)
v_mfma_f32_32x32x16_bf16 v[64:79], a[160:163], a[0:3], 0
ds_read_b64_tr_b16 a[184:185], v1 offset:22528
ds_read_b64_tr_b16 a[186:187], v1 offset:23552
v_mfma_f32_32x32x16_bf16 v[80:95], a[164:167], a[0:3], 0
ds_read_b64_tr_b16 a[188:189], v2 offset:22528
ds_read_b64_tr_b16 a[190:191], v2 offset:23552
s_waitcnt lgkmcnt(8)
v_mfma_f32_32x32x16_bf16 v[64:79], a[168:171], a[4:7], v[64:79]
ds_read_b64_tr_b16 a[160:161], v1 offset:24576
ds_read_b64_tr_b16 a[162:163], v1 offset:25600
v_cvt_pk_bf16_f32 v32, v32, v33
v_cvt_pk_bf16_f32 v33, v34, v35
v_cvt_pk_bf16_f32 v34, v36, v37
v_mfma_f32_32x32x16_bf16 v[80:95], a[172:175], a[4:7], v[80:95]
ds_read_b64_tr_b16 a[164:165], v2 offset:24576
ds_read_b64_tr_b16 a[166:167], v2 offset:25600
v_cvt_pk_bf16_f32 v35, v38, v39
s_waitcnt lgkmcnt(8)
v_mfma_f32_32x32x16_bf16 v[64:79], a[176:179], a[8:11], v[64:79]
ds_read_b64_tr_b16 a[168:169], v1 offset:26624
ds_read_b64_tr_b16 a[170:171], v1 offset:27648
v_mfma_f32_32x32x16_bf16 v[80:95], a[180:183], a[8:11], v[80:95]
ds_read_b64_tr_b16 a[172:173], v2 offset:26624
ds_read_b64_tr_b16 a[174:175], v2 offset:27648
s_waitcnt lgkmcnt(8)
v_mfma_f32_32x32x16_bf16 v[64:79], a[184:187], a[12:15], v[64:79]
ds_read_b64_tr_b16 a[176:177], v1 offset:28672
ds_read_b64_tr_b16 a[178:179], v1 offset:29696
buffer_store_dwordx4 v[32:35], v0, s[32:35], s64 offen sc1
v_mfma_f32_32x32x16_bf16 v[80:95], a[188:191], a[12:15], v[80:95]
ds_read_b64_tr_b16 a[180:181], v2 offset:28672
ds_read_b64_tr_b16 a[182:183], v2 offset:29696
s_waitcnt lgkmcnt(8)
v_mfma_f32_32x32x16_bf16 v[64:79], a[160:163], a[16:19], v[64:79]
ds_read_b64_tr_b16 a[184:185], v1 offset:30720
ds_read_b64_tr_b16 a[186:187], v1 offset:31744
v_cvt_pk_bf16_f32 v40, v40, v41
v_cvt_pk_bf16_f32 v41, v42, v43
v_mfma_f32_32x32x16_bf16 v[80:95], a[164:167], a[16:19], v[80:95]
ds_read_b64_tr_b16 a[188:189], v2 offset:30720
ds_read_b64_tr_b16 a[190:191], v2 offset:31744
v_cvt_pk_bf16_f32 v42, v44, v45
v_cvt_pk_bf16_f32 v43, v46, v47
s_waitcnt lgkmcnt(8)
v_mfma_f32_32x32x16_bf16 v[64:79], a[168:171], a[20:23], v[64:79]
s_barrier
ds_read_b64_tr_b16 a[160:161], v1 offset:32768
ds_read_b64_tr_b16 a[162:163], v1 offset:33792
s_movk_i32 s96, 1280
v_lshrrev_b32 v4, 3, v3
v_mfma_f32_32x32x16_bf16 v[80:95], a[172:175], a[20:23], v[80:95]
ds_read_b64_tr_b16 a[164:165], v2 offset:32768
ds_read_b64_tr_b16 a[166:167], v2 offset:33792
s_lshl_b32 s53, s40, 5
s_lshr_b32 s52, s40, 1
s_mul_i32 s52, s52, 64
s_waitcnt lgkmcnt(8)
v_mfma_f32_32x32x16_bf16 v[64:79], a[176:179], a[24:27], v[64:79]
ds_read_b64_tr_b16 a[168:169], v1 offset:34816
ds_read_b64_tr_b16 a[170:171], v1 offset:35840
s_add_u32 s53, s53, s52
v_add_u32 v4, s53, v4
v_bfe_u32 v5, v3, 4, 1
v_lshlrev_b32 v5, 2, v5
v_mfma_f32_32x32x16_bf16 v[80:95], a[180:183], a[24:27], v[80:95]
ds_read_b64_tr_b16 a[172:173], v2 offset:34816
ds_read_b64_tr_b16 a[174:175], v2 offset:35840
v_and_b32 v6, 7, v3
v_xor_b32 v5, v5, v6
v_lshlrev_b32 v5, 4, v5
v_mad_u32_u24 v4, v4, s96, v5
s_lshl_b32 s53, s96, 3
s_sub_u32 s53, s53, 1024
v_add_u32 v4, s56, v4
v_add_u32 v5, s53, v4
v_add_u32 v6, s53, v5
v_add_u32 v7, s53, v6
s_lshl_b32 s53, s96, 6
s_add_u32 m0, s41, 147456
s_add_u32 s52, s55, 0
buffer_load_dwordx4 v4, s[24:27], s52 offen lds
s_waitcnt lgkmcnt(8)
v_mfma_f32_32x32x16_bf16 v[64:79], a[184:187], a[28:31], v[64:79]
ds_read_b64_tr_b16 a[176:177], v1 offset:36864
ds_read_b64_tr_b16 a[178:179], v1 offset:37888
buffer_load_dwordx4 v5, s[24:27], s52 offen offset:1024 lds
v_mfma_f32_32x32x16_bf16 v[80:95], a[188:191], a[28:31], v[80:95]
ds_read_b64_tr_b16 a[180:181], v2 offset:36864
ds_read_b64_tr_b16 a[182:183], v2 offset:37888
s_waitcnt lgkmcnt(8)
v_mfma_f32_32x32x16_bf16 v[64:79], a[160:163], a[32:35], v[64:79]
ds_read_b64_tr_b16 a[184:185], v1 offset:38912
ds_read_b64_tr_b16 a[186:187], v1 offset:39936
buffer_load_dwordx4 v6, s[24:27], s52 offen offset:2048 lds
v_mfma_f32_32x32x16_bf16 v[80:95], a[164:167], a[32:35], v[80:95]
ds_read_b64_tr_b16 a[188:189], v2 offset:38912
ds_read_b64_tr_b16 a[190:191], v2 offset:39936
s_waitcnt lgkmcnt(8)
v_mfma_f32_32x32x16_bf16 v[64:79], a[168:171], a[36:39], v[64:79]
ds_read_b64_tr_b16 a[160:161], v1 offset:40960
ds_read_b64_tr_b16 a[162:163], v1 offset:41984
buffer_load_dwordx4 v7, s[24:27], s52 offen offset:3072 lds
v_mfma_f32_32x32x16_bf16 v[80:95], a[172:175], a[36:39], v[80:95]
ds_read_b64_tr_b16 a[164:165], v2 offset:40960
ds_read_b64_tr_b16 a[166:167], v2 offset:41984
s_add_u32 m0, s41, 65536
s_add_u32 s52, s55, 819200
s_waitcnt lgkmcnt(8)
v_mfma_f32_32x32x16_bf16 v[64:79], a[176:179], a[40:43], v[64:79]
ds_read_b64_tr_b16 a[168:169], v1 offset:43008
ds_read_b64_tr_b16 a[170:171], v1 offset:44032
buffer_load_dwordx4 v4, s[24:27], s52 offen lds
v_mfma_f32_32x32x16_bf16 v[80:95], a[180:183], a[40:43], v[80:95]
ds_read_b64_tr_b16 a[172:173], v2 offset:43008
ds_read_b64_tr_b16 a[174:175], v2 offset:44032
buffer_load_dwordx4 v5, s[24:27], s52 offen offset:1024 lds
s_waitcnt lgkmcnt(8)
v_mfma_f32_32x32x16_bf16 v[64:79], a[184:187], a[44:47], v[64:79]
ds_read_b64_tr_b16 a[176:177], v1 offset:45056
ds_read_b64_tr_b16 a[178:179], v1 offset:46080
buffer_load_dwordx4 v6, s[24:27], s52 offen offset:2048 lds
v_mfma_f32_32x32x16_bf16 v[80:95], a[188:191], a[44:47], v[80:95]
ds_read_b64_tr_b16 a[180:181], v2 offset:45056
ds_read_b64_tr_b16 a[182:183], v2 offset:46080
s_waitcnt lgkmcnt(8)
v_mfma_f32_32x32x16_bf16 v[64:79], a[160:163], a[48:51], v[64:79]
ds_read_b64_tr_b16 a[184:185], v1 offset:47104
ds_read_b64_tr_b16 a[186:187], v1 offset:48128
buffer_load_dwordx4 v7, s[24:27], s52 offen offset:3072 lds
v_mfma_f32_32x32x16_bf16 v[80:95], a[164:167], a[48:51], v[80:95]
ds_read_b64_tr_b16 a[188:189], v2 offset:47104
ds_read_b64_tr_b16 a[190:191], v2 offset:48128
buffer_store_dwordx4 v[40:43], v0, s[32:35], s64 offen offset:1024 sc1
s_waitcnt lgkmcnt(8)
v_mfma_f32_32x32x16_bf16 v[64:79], a[168:171], a[52:55], v[64:79]
s_barrier
ds_read_b64_tr_b16 a[160:161], v1 offset:49152
ds_read_b64_tr_b16 a[162:163], v1 offset:50176
s_add_u32 m0, s41, 81920
s_add_u32 s52, s55, 1146880
v_mfma_f32_32x32x16_bf16 v[80:95], a[172:175], a[52:55], v[80:95]
ds_read_b64_tr_b16 a[164:165], v2 offset:49152
ds_read_b64_tr_b16 a[166:167], v2 offset:50176
s_waitcnt lgkmcnt(8)
v_mfma_f32_32x32x16_bf16 v[64:79], a[176:179], a[56:59], v[64:79]
ds_read_b64_tr_b16 a[168:169], v1 offset:51200
ds_read_b64_tr_b16 a[170:171], v1 offset:52224
buffer_load_dwordx4 v4, s[24:27], s52 offen lds
v_mfma_f32_32x32x16_bf16 v[80:95], a[180:183], a[56:59], v[80:95]
ds_read_b64_tr_b16 a[172:173], v2 offset:51200
ds_read_b64_tr_b16 a[174:175], v2 offset:52224
s_waitcnt lgkmcnt(8)
v_mfma_f32_32x32x16_bf16 v[64:79], a[184:187], a[60:63], v[64:79]
ds_read_b64_tr_b16 a[176:177], v1 offset:53248
ds_read_b64_tr_b16 a[178:179], v1 offset:54272
buffer_load_dwordx4 v5, s[24:27], s52 offen offset:1024 lds
v_mfma_f32_32x32x16_bf16 v[80:95], a[188:191], a[60:63], v[80:95]
ds_read_b64_tr_b16 a[180:181], v2 offset:53248
ds_read_b64_tr_b16 a[182:183], v2 offset:54272
v_cvt_pk_bf16_f32 v48, v48, v49
s_waitcnt lgkmcnt(8)
v_mfma_f32_32x32x16_bf16 v[64:79], a[160:163], a[64:67], v[64:79]
ds_read_b64_tr_b16 a[184:185], v1 offset:55296
ds_read_b64_tr_b16 a[186:187], v1 offset:56320
v_cvt_pk_bf16_f32 v49, v50, v51
v_cvt_pk_bf16_f32 v50, v52, v53
v_cvt_pk_bf16_f32 v51, v54, v55
v_mfma_f32_32x32x16_bf16 v[80:95], a[164:167], a[64:67], v[80:95]
ds_read_b64_tr_b16 a[188:189], v2 offset:55296
ds_read_b64_tr_b16 a[190:191], v2 offset:56320
s_waitcnt lgkmcnt(8)
v_mfma_f32_32x32x16_bf16 v[64:79], a[168:171], a[68:71], v[64:79]
ds_read_b64_tr_b16 a[160:161], v1 offset:57344
ds_read_b64_tr_b16 a[162:163], v1 offset:58368
buffer_load_dwordx4 v6, s[24:27], s52 offen offset:2048 lds
v_mfma_f32_32x32x16_bf16 v[80:95], a[172:175], a[68:71], v[80:95]
ds_read_b64_tr_b16 a[164:165], v2 offset:57344
ds_read_b64_tr_b16 a[166:167], v2 offset:58368
s_waitcnt lgkmcnt(8)
v_mfma_f32_32x32x16_bf16 v[64:79], a[176:179], a[72:75], v[64:79]
ds_read_b64_tr_b16 a[168:169], v1 offset:59392
ds_read_b64_tr_b16 a[170:171], v1 offset:60416
buffer_load_dwordx4 v7, s[24:27], s52 offen offset:3072 lds
v_mfma_f32_32x32x16_bf16 v[80:95], a[180:183], a[72:75], v[80:95]
ds_read_b64_tr_b16 a[172:173], v2 offset:59392
ds_read_b64_tr_b16 a[174:175], v2 offset:60416
buffer_store_dwordx4 v[48:51], v0, s[32:35], s64 offen offset:2048 sc1
s_waitcnt lgkmcnt(8)
v_mfma_f32_32x32x16_bf16 v[64:79], a[184:187], a[76:79], v[64:79]
ds_read_b64_tr_b16 a[176:177], v1 offset:61440
ds_read_b64_tr_b16 a[178:179], v1 offset:62464
v_mfma_f32_32x32x16_bf16 v[80:95], a[188:191], a[76:79], v[80:95]
ds_read_b64_tr_b16 a[180:181], v2 offset:61440
ds_read_b64_tr_b16 a[182:183], v2 offset:62464
s_waitcnt lgkmcnt(8)
v_mfma_f32_32x32x16_bf16 v[64:79], a[160:163], a[80:83], v[64:79]
ds_read_b64_tr_b16 a[184:185], v1 offset:63488
ds_read_b64_tr_b16 a[186:187], v1 offset:64512
s_getpc_b64 s[86:87]
L_pc69:
s_lshl_b32 s3, s42, 3
s_xor_b32 s3, s3, s43
s_lshl_b32 s3, s3, 2
v_mfma_f32_32x32x16_bf16 v[80:95], a[164:167], a[80:83], v[80:95]
ds_read_b64_tr_b16 a[188:189], v2 offset:63488
ds_read_b64_tr_b16 a[190:191], v2 offset:64512
s_add_u32 s3, s3, s40
s_mul_i32 s3, s3, 8
s_and_b32 s3, s3, 1023
s_waitcnt lgkmcnt(8)
v_mfma_f32_32x32x16_bf16 v[64:79], a[168:171], a[84:87], v[64:79]
s_barrier
v_add_u32 v1, 65536, v1
v_add_u32 v2, 65536, v2
ds_read_b64_tr_b16 a[160:161], v1 offset:0
ds_read_b64_tr_b16 a[162:163], v1 offset:1024
v_mfma_f32_32x32x16_bf16 v[80:95], a[172:175], a[84:87], v[80:95]
ds_read_b64_tr_b16 a[164:165], v2 offset:0
ds_read_b64_tr_b16 a[166:167], v2 offset:1024
s_add_u32 m0, s41, 98304
s_add_u32 s52, s55, 327680
v_min_u32 v26, 7, v3
v_add_lshl_u32 v26, v26, s3, 7
v_min_u32 v26, L_codeend-L_pc69-4, v26
v_and_b32 v26, -4, v26
global_load_dword a223, v26, s[86:87]
s_waitcnt lgkmcnt(8)
v_mfma_f32_32x32x16_bf16 v[64:79], a[176:179], a[88:91], v[64:79]
ds_read_b64_tr_b16 a[168:169], v1 offset:2048
ds_read_b64_tr_b16 a[170:171], v1 offset:3072
buffer_load_dwordx4 v4, s[24:27], s52 offen lds
v_mfma_f32_32x32x16_bf16 v[80:95], a[180:183], a[88:91], v[80:95]
ds_read_b64_tr_b16 a[172:173], v2 offset:2048
ds_read_b64_tr_b16 a[174:175], v2 offset:3072
v_cvt_pk_bf16_f32 v56, v56, v57
s_waitcnt lgkmcnt(8)
v_mfma_f32_32x32x16_bf16 v[64:79], a[184:187], a[92:95], v[64:79]
ds_read_b64_tr_b16 a[176:177], v1 offset:4096
ds_read_b64_tr_b16 a[178:179], v1 offset:5120
buffer_load_dwordx4 v5, s[24:27], s52 offen offset:1024 lds
v_mfma_f32_32x32x16_bf16 v[80:95], a[188:191], a[92:95], v[80:95]
ds_read_b64_tr_b16 a[180:181], v2 offset:4096
ds_read_b64_tr_b16 a[182:183], v2 offset:5120
v_cvt_pk_bf16_f32 v57, v58, v59
v_cvt_pk_bf16_f32 v58, v60, v61
s_waitcnt lgkmcnt(8)
v_mfma_f32_32x32x16_bf16 v[64:79], a[160:163], a[96:99], v[64:79]
ds_read_b64_tr_b16 a[184:185], v1 offset:6144
ds_read_b64_tr_b16 a[186:187], v1 offset:7168
v_cvt_pk_bf16_f32 v59, v62, v63
v_mfma_f32_32x32x16_bf16 v[80:95], a[164:167], a[96:99], v[80:95]
ds_read_b64_tr_b16 a[188:189], v2 offset:6144
ds_read_b64_tr_b16 a[190:191], v2 offset:7168
s_waitcnt lgkmcnt(8)
v_mfma_f32_32x32x16_bf16 v[64:79], a[168:171], a[100:103], v[64:79]
ds_read_b64_tr_b16 a[160:161], v1 offset:8192
ds_read_b64_tr_b16 a[162:163], v1 offset:9216
buffer_load_dwordx4 v6, s[24:27], s52 offen offset:2048 lds
v_mfma_f32_32x32x16_bf16 v[80:95], a[172:175], a[100:103], v[80:95]
ds_read_b64_tr_b16 a[164:165], v2 offset:8192
ds_read_b64_tr_b16 a[166:167], v2 offset:9216
s_waitcnt lgkmcnt(8)
v_mfma_f32_32x32x16_bf16 v[64:79], a[176:179], a[104:107], v[64:79]
ds_read_b64_tr_b16 a[168:169], v1 offset:10240
ds_read_b64_tr_b16 a[170:171], v1 offset:11264
buffer_load_dwordx4 v7, s[24:27], s52 offen offset:3072 lds
v_mfma_f32_32x32x16_bf16 v[80:95], a[180:183], a[104:107], v[80:95]
ds_read_b64_tr_b16 a[172:173], v2 offset:10240
ds_read_b64_tr_b16 a[174:175], v2 offset:11264
v_bfe_u32 v30, v3, 2, 2
v_lshrrev_b32 v31, 5, v3
v_lshl_add_u32 v30, v31, 2, v30
s_waitcnt lgkmcnt(8)
v_mfma_f32_32x32x16_bf16 v[64:79], a[184:187], a[108:111], v[64:79]
ds_read_b64_tr_b16 a[176:177], v1 offset:12288
ds_read_b64_tr_b16 a[178:179], v1 offset:13312
v_lshlrev_b32 v31, 6, v30
v_bfe_u32 v30, v3, 4, 1
v_lshl_add_u32 v31, v30, 5, v31
v_and_b32 v30, 3, v3
v_mfma_f32_32x32x16_bf16 v[80:95], a[188:191], a[108:111], v[80:95]
ds_read_b64_tr_b16 a[180:181], v2 offset:12288
ds_read_b64_tr_b16 a[182:183], v2 offset:13312
v_lshl_add_u32 v31, v30, 3, v31
buffer_store_dwordx4 v[56:59], v0, s[32:35], s64 offen offset:3072 sc1
s_waitcnt lgkmcnt(8)
v_mfma_f32_32x32x16_bf16 v[64:79], a[160:163], a[112:115], v[64:79]
ds_read_b64_tr_b16 a[184:185], v1 offset:14336
ds_read_b64_tr_b16 a[186:187], v1 offset:15360
v_mfma_f32_32x32x16_bf16 v[80:95], a[164:167], a[112:115], v[80:95]
ds_read_b64_tr_b16 a[188:189], v2 offset:14336
ds_read_b64_tr_b16 a[190:191], v2 offset:15360
s_waitcnt lgkmcnt(8)
v_mfma_f32_32x32x16_bf16 v[64:79], a[168:171], a[116:119], v[64:79]
s_barrier
v_subrev_u32 v1, 131072, v1
v_subrev_u32 v2, 131072, v2
ds_read_b64_tr_b16 a[160:161], v1 offset:0
ds_read_b64_tr_b16 a[162:163], v1 offset:1024
v_mfma_f32_32x32x16_bf16 v[80:95], a[172:175], a[116:119], v[80:95]
ds_read_b64_tr_b16 a[164:165], v2 offset:0
ds_read_b64_tr_b16 a[166:167], v2 offset:1024
s_add_u32 m0, s41, 114688
s_add_u32 s52, s55, 737280
s_waitcnt lgkmcnt(8)
v_mfma_f32_32x32x16_bf16 v[64:79], a[176:179], a[120:123], v[64:79]
ds_read_b64_tr_b16 a[168:169], v1 offset:2048
ds_read_b64_tr_b16 a[170:171], v1 offset:3072
buffer_load_dwordx4 v4, s[24:27], s52 offen lds
v_mfma_f32_32x32x16_bf16 v[80:95], a[180:183], a[120:123], v[80:95]
ds_read_b64_tr_b16 a[172:173], v2 offset:2048
ds_read_b64_tr_b16 a[174:175], v2 offset:3072
s_waitcnt lgkmcnt(8)
v_mfma_f32_32x32x16_bf16 v[64:79], a[184:187], a[124:127], v[64:79]
ds_read_b64_tr_b16 a[176:177], v1 offset:4096
ds_read_b64_tr_b16 a[178:179], v1 offset:5120
buffer_load_dwordx4 v5, s[24:27], s52 offen offset:1024 lds
v_mfma_f32_32x32x16_bf16 v[80:95], a[188:191], a[124:127], v[80:95]
ds_read_b64_tr_b16 a[180:181], v2 offset:4096
ds_read_b64_tr_b16 a[182:183], v2 offset:5120
s_waitcnt lgkmcnt(8)
v_mfma_f32_32x32x16_bf16 v[64:79], a[160:163], a[128:131], v[64:79]
ds_read_b64_tr_b16 a[184:185], v1 offset:6144
ds_read_b64_tr_b16 a[186:187], v1 offset:7168
v_mfma_f32_32x32x16_bf16 v[80:95], a[164:167], a[128:131], v[80:95]
ds_read_b64_tr_b16 a[188:189], v2 offset:6144
ds_read_b64_tr_b16 a[190:191], v2 offset:7168
s_waitcnt lgkmcnt(8)
v_mfma_f32_32x32x16_bf16 v[64:79], a[168:171], a[132:135], v[64:79]
ds_read_b64_tr_b16 a[160:161], v1 offset:8192
ds_read_b64_tr_b16 a[162:163], v1 offset:9216
buffer_load_dwordx4 v6, s[24:27], s52 offen offset:2048 lds
v_mfma_f32_32x32x16_bf16 v[80:95], a[172:175], a[132:135], v[80:95]
ds_read_b64_tr_b16 a[164:165], v2 offset:8192
ds_read_b64_tr_b16 a[166:167], v2 offset:9216
s_waitcnt lgkmcnt(8)
v_mfma_f32_32x32x16_bf16 v[64:79], a[176:179], a[136:139], v[64:79]
ds_read_b64_tr_b16 a[168:169], v1 offset:10240
ds_read_b64_tr_b16 a[170:171], v1 offset:11264
buffer_load_dwordx4 v7, s[24:27], s52 offen offset:3072 lds
v_mfma_f32_32x32x16_bf16 v[80:95], a[180:183], a[136:139], v[80:95]
ds_read_b64_tr_b16 a[172:173], v2 offset:10240
ds_read_b64_tr_b16 a[174:175], v2 offset:11264
s_waitcnt lgkmcnt(8)
v_mfma_f32_32x32x16_bf16 v[64:79], a[184:187], a[140:143], v[64:79]
ds_read_b64_tr_b16 a[176:177], v1 offset:12288
ds_read_b64_tr_b16 a[178:179], v1 offset:13312
v_mfma_f32_32x32x16_bf16 v[80:95], a[188:191], a[140:143], v[80:95]
ds_read_b64_tr_b16 a[180:181], v2 offset:12288
ds_read_b64_tr_b16 a[182:183], v2 offset:13312
s_waitcnt lgkmcnt(8)
v_mfma_f32_32x32x16_bf16 v[64:79], a[160:163], a[144:147], v[64:79]
ds_read_b64_tr_b16 a[184:185], v1 offset:14336
ds_read_b64_tr_b16 a[186:187], v1 offset:15360
v_mfma_f32_32x32x16_bf16 v[80:95], a[164:167], a[144:147], v[80:95]
ds_read_b64_tr_b16 a[188:189], v2 offset:14336
ds_read_b64_tr_b16 a[190:191], v2 offset:15360
s_waitcnt lgkmcnt(8)
v_mfma_f32_32x32x16_bf16 v[64:79], a[168:171], a[148:151], v[64:79]
s_barrier
v_add_u32 v1, 0, v31
ds_read_b64_tr_b16 a[160:161], v1 offset:16384
ds_read_b64_tr_b16 a[162:163], v1 offset:16896
s_add_u32 m0, s41, 131072
v_mfma_f32_32x32x16_bf16 v[80:95], a[172:175], a[148:151], v[80:95]
s_add_u32 s52, s55, 1064960
buffer_load_dwordx4 v4, s[24:27], s52 offen lds
s_waitcnt lgkmcnt(6)
v_mfma_f32_32x32x16_bf16 v[64:79], a[176:179], a[152:155], v[64:79]
ds_read_b64_tr_b16 a[168:169], v1 offset:17408
ds_read_b64_tr_b16 a[170:171], v1 offset:17920
buffer_load_dwordx4 v5, s[24:27], s52 offen offset:1024 lds
v_mfma_f32_32x32x16_bf16 v[80:95], a[180:183], a[152:155], v[80:95]
buffer_load_dwordx4 v6, s[24:27], s52 offen offset:2048 lds
s_waitcnt lgkmcnt(4)
v_mfma_f32_32x32x16_bf16 v[64:79], a[184:187], a[156:159], v[64:79]
ds_read_b64_tr_b16 a[176:177], v1 offset:18432
ds_read_b64_tr_b16 a[178:179], v1 offset:18944
buffer_load_dwordx4 v7, s[24:27], s52 offen offset:3072 lds
v_mfma_f32_32x32x16_bf16 v[80:95], a[188:191], a[156:159], v[80:95]
s_waitcnt lgkmcnt(4)
v_mfma_f32_32x32x16_bf16 v[32:47], a[160:163], a[0:3], 0
ds_read_b64_tr_b16 a[184:185], v1 offset:19456
ds_read_b64_tr_b16 a[186:187], v1 offset:19968
s_waitcnt lgkmcnt(4)
v_mfma_f32_32x32x16_bf16 v[32:47], a[168:171], a[4:7], v[32:47]
ds_read_b64_tr_b16 a[160:161], v1 offset:20480
ds_read_b64_tr_b16 a[162:163], v1 offset:20992
s_waitcnt lgkmcnt(4)
v_mfma_f32_32x32x16_bf16 v[32:47], a[176:179], a[8:11], v[32:47]
ds_read_b64_tr_b16 a[168:169], v1 offset:21504
ds_read_b64_tr_b16 a[170:171], v1 offset:22016
v_cvt_pk_bf16_f32 v64, v64, v65
v_cvt_pk_bf16_f32 v65, v66, v67
v_cvt_pk_bf16_f32 v66, v68, v69
s_waitcnt lgkmcnt(4)
v_mfma_f32_32x32x16_bf16 v[32:47], a[184:187], a[12:15], v[32:47]
ds_read_b64_tr_b16 a[176:177], v1 offset:22528
ds_read_b64_tr_b16 a[178:179], v1 offset:23040
v_cvt_pk_bf16_f32 v67, v70, v71
s_waitcnt lgkmcnt(4)
v_mfma_f32_32x32x16_bf16 v[32:47], a[160:163], a[16:19], v[32:47]
ds_read_b64_tr_b16 a[184:185], v1 offset:23552
ds_read_b64_tr_b16 a[186:187], v1 offset:24064
s_waitcnt lgkmcnt(4)
v_mfma_f32_32x32x16_bf16 v[32:47], a[168:171], a[20:23], v[32:47]
ds_read_b64_tr_b16 a[160:161], v1 offset:24576
ds_read_b64_tr_b16 a[162:163], v1 offset:25088
buffer_store_dwordx4 v[64:67], v0, s[32:35], s65 offen sc1
s_waitcnt lgkmcnt(4)
v_mfma_f32_32x32x16_bf16 v[32:47], a[176:179], a[24:27], v[32:47]
ds_read_b64_tr_b16 a[168:169], v1 offset:25600
ds_read_b64_tr_b16 a[170:171], v1 offset:26112
s_waitcnt lgkmcnt(4)
v_mfma_f32_32x32x16_bf16 v[32:47], a[184:187], a[28:31], v[32:47]
ds_read_b64_tr_b16 a[176:177], v1 offset:26624
ds_read_b64_tr_b16 a[178:179], v1 offset:27136
v_cvt_pk_bf16_f32 v72, v72, v73
v_cvt_pk_bf16_f32 v73, v74, v75
s_waitcnt lgkmcnt(4)
v_mfma_f32_32x32x16_bf16 v[32:47], a[160:163], a[32:35], v[32:47]
ds_read_b64_tr_b16 a[184:185], v1 offset:27648
ds_read_b64_tr_b16 a[186:187], v1 offset:28160
v_cvt_pk_bf16_f32 v74, v76, v77
v_cvt_pk_bf16_f32 v75, v78, v79
s_waitcnt lgkmcnt(4)
v_mfma_f32_32x32x16_bf16 v[32:47], a[168:171], a[36:39], v[32:47]
ds_read_b64_tr_b16 a[160:161], v1 offset:28672
ds_read_b64_tr_b16 a[162:163], v1 offset:29184
s_waitcnt lgkmcnt(4)
v_mfma_f32_32x32x16_bf16 v[32:47], a[176:179], a[40:43], v[32:47]
ds_read_b64_tr_b16 a[168:169], v1 offset:29696
ds_read_b64_tr_b16 a[170:171], v1 offset:30208
buffer_store_dwordx4 v[72:75], v0, s[32:35], s65 offen offset:1024 sc1
s_waitcnt lgkmcnt(4)
v_mfma_f32_32x32x16_bf16 v[32:47], a[184:187], a[44:47], v[32:47]
ds_read_b64_tr_b16 a[176:177], v1 offset:30720
ds_read_b64_tr_b16 a[178:179], v1 offset:31232
s_waitcnt lgkmcnt(4)
v_mfma_f32_32x32x16_bf16 v[32:47], a[160:163], a[48:51], v[32:47]
ds_read_b64_tr_b16 a[184:185], v1 offset:31744
ds_read_b64_tr_b16 a[186:187], v1 offset:32256
v_cvt_pk_bf16_f32 v80, v80, v81
s_waitcnt lgkmcnt(4)
v_mfma_f32_32x32x16_bf16 v[32:47], a[168:171], a[52:55], v[32:47]
s_waitcnt vmcnt(35)
s_barrier
ds_read_b64_tr_b16 a[160:161], v1 offset:32768
ds_read_b64_tr_b16 a[162:163], v1 offset:33280
s_add_u32 m0, s41, 0
s_waitcnt lgkmcnt(4)
v_mfma_f32_32x32x16_bf16 v[32:47], a[176:179], a[56:59], v[32:47]
ds_read_b64_tr_b16 a[168:169], v1 offset:33792
ds_read_b64_tr_b16 a[170:171], v1 offset:34304
s_add_u32 s52, s55, 1474560
v_cvt_pk_bf16_f32 v81, v82, v83
s_waitcnt lgkmcnt(4)
v_mfma_f32_32x32x16_bf16 v[32:47], a[184:187], a[60:63], v[32:47]
ds_read_b64_tr_b16 a[176:177], v1 offset:34816
ds_read_b64_tr_b16 a[178:179], v1 offset:35328
v_cvt_pk_bf16_f32 v82, v84, v85
v_cvt_pk_bf16_f32 v83, v86, v87
s_waitcnt lgkmcnt(4)
v_mfma_f32_32x32x16_bf16 v[32:47], a[160:163], a[64:67], v[32:47]
ds_read_b64_tr_b16 a[184:185], v1 offset:35840
ds_read_b64_tr_b16 a[186:187], v1 offset:36352
buffer_load_dwordx4 v4, s[24:27], s52 offen lds
s_waitcnt lgkmcnt(4)
v_mfma_f32_32x32x16_bf16 v[32:47], a[168:171], a[68:71], v[32:47]
ds_read_b64_tr_b16 a[160:161], v1 offset:36864
ds_read_b64_tr_b16 a[162:163], v1 offset:37376
s_waitcnt lgkmcnt(4)
v_mfma_f32_32x32x16_bf16 v[32:47], a[176:179], a[72:75], v[32:47]
ds_read_b64_tr_b16 a[168:169], v1 offset:37888
ds_read_b64_tr_b16 a[170:171], v1 offset:38400
buffer_store_dwordx4 v[80:83], v0, s[32:35], s65 offen offset:2048 sc1
s_waitcnt lgkmcnt(4)
v_mfma_f32_32x32x16_bf16 v[32:47], a[184:187], a[76:79], v[32:47]
ds_read_b64_tr_b16 a[176:177], v1 offset:38912
ds_read_b64_tr_b16 a[178:179], v1 offset:39424
buffer_load_dwordx4 v5, s[24:27], s52 offen offset:1024 lds
s_waitcnt lgkmcnt(4)
v_mfma_f32_32x32x16_bf16 v[32:47], a[160:163], a[80:83], v[32:47]
ds_read_b64_tr_b16 a[184:185], v1 offset:39936
ds_read_b64_tr_b16 a[186:187], v1 offset:40448
s_waitcnt lgkmcnt(4)
v_mfma_f32_32x32x16_bf16 v[32:47], a[168:171], a[84:87], v[32:47]
ds_read_b64_tr_b16 a[160:161], v1 offset:40960
ds_read_b64_tr_b16 a[162:163], v1 offset:41472
v_cvt_pk_bf16_f32 v88, v88, v89
s_waitcnt lgkmcnt(4)
v_mfma_f32_32x32x16_bf16 v[32:47], a[176:179], a[88:91], v[32:47]
ds_read_b64_tr_b16 a[168:169], v1 offset:41984
ds_read_b64_tr_b16 a[170:171], v1 offset:42496
v_cvt_pk_bf16_f32 v89, v90, v91
v_cvt_pk_bf16_f32 v90, v92, v93
v_cvt_pk_bf16_f32 v91, v94, v95
s_waitcnt lgkmcnt(4)
v_mfma_f32_32x32x16_bf16 v[32:47], a[184:187], a[92:95], v[32:47]
ds_read_b64_tr_b16 a[176:177], v1 offset:43008
ds_read_b64_tr_b16 a[178:179], v1 offset:43520
buffer_load_dwordx4 v6, s[24:27], s52 offen offset:2048 lds
s_waitcnt lgkmcnt(4)
v_mfma_f32_32x32x16_bf16 v[32:47], a[160:163], a[96:99], v[32:47]
ds_read_b64_tr_b16 a[184:185], v1 offset:44032
ds_read_b64_tr_b16 a[186:187], v1 offset:44544
s_waitcnt lgkmcnt(4)
v_mfma_f32_32x32x16_bf16 v[32:47], a[168:171], a[100:103], v[32:47]
ds_read_b64_tr_b16 a[160:161], v1 offset:45056
ds_read_b64_tr_b16 a[162:163], v1 offset:45568
s_waitcnt lgkmcnt(4)
v_mfma_f32_32x32x16_bf16 v[32:47], a[176:179], a[104:107], v[32:47]
ds_read_b64_tr_b16 a[168:169], v1 offset:46080
ds_read_b64_tr_b16 a[170:171], v1 offset:46592
buffer_store_dwordx4 v[88:91], v0, s[32:35], s65 offen offset:3072 sc1
s_waitcnt lgkmcnt(4)
v_mfma_f32_32x32x16_bf16 v[32:47], a[184:187], a[108:111], v[32:47]
ds_read_b64_tr_b16 a[176:177], v1 offset:47104
ds_read_b64_tr_b16 a[178:179], v1 offset:47616
buffer_load_dwordx4 v7, s[24:27], s52 offen offset:3072 lds
s_waitcnt lgkmcnt(4)
v_mfma_f32_32x32x16_bf16 v[32:47], a[160:163], a[112:115], v[32:47]
ds_read_b64_tr_b16 a[184:185], v1 offset:48128
ds_read_b64_tr_b16 a[186:187], v1 offset:48640
s_waitcnt lgkmcnt(4)
v_mfma_f32_32x32x16_bf16 v[32:47], a[168:171], a[116:119], v[32:47]
s_waitcnt vmcnt(37)
s_barrier
ds_read_b64_tr_b16 a[160:161], v1 offset:49152
ds_read_b64_tr_b16 a[162:163], v1 offset:49664
s_add_u32 m0, s41, 16384
s_waitcnt lgkmcnt(4)
v_mfma_f32_32x32x16_bf16 v[32:47], a[176:179], a[120:123], v[32:47]
ds_read_b64_tr_b16 a[168:169], v1 offset:50176
ds_read_b64_tr_b16 a[170:171], v1 offset:50688
s_add_u32 s52, s55, 1802240
s_lshl_b32 s6, s54, 9
s_add_u32 s6, s6, 32768
s_waitcnt lgkmcnt(4)
v_mfma_f32_32x32x16_bf16 v[32:47], a[184:187], a[124:127], v[32:47]
ds_read_b64_tr_b16 a[176:177], v1 offset:51200
ds_read_b64_tr_b16 a[178:179], v1 offset:51712
buffer_load_dword v29, off, s[32:35], s6 sc1
s_mul_i32 s98, s54, 110592
s_add_u32 s98, s98, 19005440
s_mul_i32 s3, s61, 12
s_cmp_eq_u32 s61, 0
s_cselect_b32 s98, 1073741824, s98
s_waitcnt lgkmcnt(4)
v_mfma_f32_32x32x16_bf16 v[32:47], a[160:163], a[128:131], v[32:47]
ds_read_b64_tr_b16 a[184:185], v1 offset:52224
ds_read_b64_tr_b16 a[186:187], v1 offset:52736
buffer_load_dwordx4 v4, s[24:27], s52 offen lds
s_waitcnt lgkmcnt(4)
v_mfma_f32_32x32x16_bf16 v[32:47], a[168:171], a[132:135], v[32:47]
ds_read_b64_tr_b16 a[160:161], v1 offset:53248
ds_read_b64_tr_b16 a[162:163], v1 offset:53760
s_waitcnt lgkmcnt(4)
v_mfma_f32_32x32x16_bf16 v[32:47], a[176:179], a[136:139], v[32:47]
ds_read_b64_tr_b16 a[168:169], v1 offset:54272
ds_read_b64_tr_b16 a[170:171], v1 offset:54784
buffer_load_dwordx4 v5, s[24:27], s52 offen offset:1024 lds
s_waitcnt lgkmcnt(4)
v_mfma_f32_32x32x16_bf16 v[32:47], a[184:187], a[140:143], v[32:47]
ds_read_b64_tr_b16 a[176:177], v1 offset:55296
ds_read_b64_tr_b16 a[178:179], v1 offset:55808
s_waitcnt lgkmcnt(4)
v_mfma_f32_32x32x16_bf16 v[32:47], a[160:163], a[144:147], v[32:47]
ds_read_b64_tr_b16 a[184:185], v1 offset:56320
ds_read_b64_tr_b16 a[186:187], v1 offset:56832
s_waitcnt lgkmcnt(4)
v_mfma_f32_32x32x16_bf16 v[32:47], a[168:171], a[148:151], v[32:47]
buffer_load_dwordx4 v6, s[24:27], s52 offen offset:2048 lds
s_waitcnt lgkmcnt(2)
v_mfma_f32_32x32x16_bf16 v[32:47], a[176:179], a[152:155], v[32:47]
buffer_load_dwordx4 v7, s[24:27], s52 offen offset:3072 lds
s_waitcnt lgkmcnt(0)
v_mfma_f32_32x32x16_bf16 v[32:47], a[184:187], a[156:159], v[32:47]
s_barrier
s_add_u32 m0, s41, 32768
s_add_u32 s52, s55, 81920
buffer_load_dwordx4 v4, s[24:27], s52 offen lds
s_nop 7
v_cvt_pk_bf16_f32 v32, v32, v33
buffer_load_dwordx4 v5, s[24:27], s52 offen offset:1024 lds
v_cvt_pk_bf16_f32 v33, v34, v35
buffer_load_dwordx4 v6, s[24:27], s52 offen offset:2048 lds
v_cvt_pk_bf16_f32 v34, v36, v37
buffer_load_dwordx4 v7, s[24:27], s52 offen offset:3072 lds
v_cvt_pk_bf16_f32 v35, v38, v39
s_add_u32 m0, s41, 49152
s_add_u32 s52, s55, 409600
buffer_load_dwordx4 v4, s[24:27], s52 offen lds
buffer_store_dwordx4 v[32:35], v0, s[32:35], s66 offen sc1
buffer_load_dwordx4 v5, s[24:27], s52 offen offset:1024 lds
v_cvt_pk_bf16_f32 v40, v40, v41
buffer_load_dwordx4 v6, s[24:27], s52 offen offset:2048 lds
v_cvt_pk_bf16_f32 v41, v42, v43
buffer_load_dwordx4 v7, s[24:27], s52 offen offset:3072 lds
v_cvt_pk_bf16_f32 v42, v44, v45
v_cvt_pk_bf16_f32 v43, v46, v47
buffer_store_dwordx4 v[40:43], v0, s[32:35], s66 offen offset:1024 sc1
s_waitcnt vmcnt(14)
v_cmp_gt_u32 vcc, s3, v29
s_nop 1
s_cbranch_vccnz L_pw70
L_pr72:
s_add_u32 s99, s98, 0
buffer_load_dwordx4 a[0:3], v0, s[32:35], s99 offen sc1
buffer_load_dwordx4 a[4:7], v0, s[32:35], s99 offen offset:1024 sc1
buffer_load_dwordx4 a[8:11], v0, s[32:35], s99 offen offset:2048 sc1
buffer_load_dwordx4 a[12:15], v0, s[32:35], s99 offen offset:3072 sc1
s_add_u32 s99, s98, 8192
buffer_load_dwordx4 a[16:19], v0, s[32:35], s99 offen sc1
buffer_load_dwordx4 a[20:23], v0, s[32:35], s99 offen offset:1024 sc1
buffer_load_dwordx4 a[24:27], v0, s[32:35], s99 offen offset:2048 sc1
buffer_load_dwordx4 a[28:31], v0, s[32:35], s99 offen offset:3072 sc1
s_add_u32 s99, s98, 16384
buffer_load_dwordx4 a[32:35], v0, s[32:35], s99 offen sc1
buffer_load_dwordx4 a[36:39], v0, s[32:35], s99 offen offset:1024 sc1
buffer_load_dwordx4 a[40:43], v0, s[32:35], s99 offen offset:2048 sc1
buffer_load_dwordx4 a[44:47], v0, s[32:35], s99 offen offset:3072 sc1
L_s4:
s_cmp_eq_u32 s61, 0
s_cbranch_scc1 L_s4id
s_mul_i32 s4, s54, 40960
s_lshl_b32 s5, s55, 5
s_add_u32 s4, s4, s5
s_add_u32 s4, s4, 16384000
s_barrier
v_bfe_u32 v30, v3, 2, 2
v_lshrrev_b32 v31, 5, v3
v_lshl_add_u32 v30, v31, 2, v30
v_lshlrev_b32 v1, 7, v30
v_bfe_u32 v30, v3, 4, 1
v_lshl_add_u32 v1, v30, 5, v1
v_and_b32 v30, 3, v3
v_lshl_add_u32 v1, v30, 3, v1
v_bfe_u32 v30, v3, 3, 1
v_lshl_add_u32 v1, v30, 6, v1
v_add_u32 v1, 131072, v1
v_xor_b32 v2, 64, v1
ds_read_b64_tr_b16 a[160:161], v1 offset:16384
ds_read_b64_tr_b16 a[162:163], v1 offset:17408
ds_read_b64_tr_b16 a[164:165], v2 offset:16384
ds_read_b64_tr_b16 a[166:167], v2 offset:17408
ds_read_b64_tr_b16 a[168:169], v1 offset:18432
ds_read_b64_tr_b16 a[170:171], v1 offset:19456
ds_read_b64_tr_b16 a[172:173], v2 offset:18432
ds_read_b64_tr_b16 a[174:175], v2 offset:19456
ds_read_b64_tr_b16 a[176:177], v1 offset:20480
ds_read_b64_tr_b16 a[178:179], v1 offset:21504
ds_read_b64_tr_b16 a[180:181], v2 offset:20480
ds_read_b64_tr_b16 a[182:183], v2 offset:21504
s_waitcnt lgkmcnt(8)
s_waitcnt vmcnt(11)
v_mfma_f32_32x32x16_bf16 v[32:47], a[160:163], a[0:3], 0
ds_read_b64_tr_b16 a[184:185], v1 offset:22528
ds_read_b64_tr_b16 a[186:187], v1 offset:23552
buffer_atomic_add v14, v13, s[32:35], s47 offen sc1
v_mfma_f32_32x32x16_bf16 v[48:63], a[164:167], a[0:3], 0
ds_read_b64_tr_b16 a[188:189], v2 offset:22528
ds_read_b64_tr_b16 a[190:191], v2 offset:23552
s_add_u32 s99, s98, 24576
s_waitcnt lgkmcnt(8)
s_waitcnt vmcnt(11)
v_mfma_f32_32x32x16_bf16 v[32:47], a[168:171], a[4:7], v[32:47]
ds_read_b64_tr_b16 a[160:161], v1 offset:24576
ds_read_b64_tr_b16 a[162:163], v1 offset:25600
buffer_load_dwordx4 a[48:51], v0, s[32:35], s99 offen sc1
v_mfma_f32_32x32x16_bf16 v[48:63], a[172:175], a[4:7], v[48:63]
ds_read_b64_tr_b16 a[164:165], v2 offset:24576
ds_read_b64_tr_b16 a[166:167], v2 offset:25600
buffer_load_dwordx4 a[52:55], v0, s[32:35], s99 offen offset:1024 sc1
s_waitcnt lgkmcnt(8)
s_waitcnt vmcnt(12)
v_mfma_f32_32x32x16_bf16 v[32:47], a[176:179], a[8:11], v[32:47]
ds_read_b64_tr_b16 a[168:169], v1 offset:26624
ds_read_b64_tr_b16 a[170:171], v1 offset:27648
buffer_load_dwordx4 a[56:59], v0, s[32:35], s99 offen offset:2048 sc1
v_mfma_f32_32x32x16_bf16 v[48:63], a[180:183], a[8:11], v[48:63]
ds_read_b64_tr_b16 a[172:173], v2 offset:26624
ds_read_b64_tr_b16 a[174:175], v2 offset:27648
buffer_load_dwordx4 a[60:63], v0, s[32:35], s99 offen offset:3072 sc1
s_waitcnt lgkmcnt(8)
s_waitcnt vmcnt(13)
v_mfma_f32_32x32x16_bf16 v[32:47], a[184:187], a[12:15], v[32:47]
ds_read_b64_tr_b16 a[176:177], v1 offset:28672
ds_read_b64_tr_b16 a[178:179], v1 offset:29696
s_add_u32 s99, s98, 36864
v_mfma_f32_32x32x16_bf16 v[48:63], a[188:191], a[12:15], v[48:63]
ds_read_b64_tr_b16 a[180:181], v2 offset:28672
ds_read_b64_tr_b16 a[182:183], v2 offset:29696
buffer_load_dwordx4 a[64:67], v0, s[32:35], s99 offen sc1
buffer_load_dwordx4 a[68:71], v0, s[32:35], s99 offen offset:1024 sc1
s_waitcnt lgkmcnt(8)
s_waitcnt vmcnt(14)
v_mfma_f32_32x32x16_bf16 v[32:47], a[160:163], a[16:19], v[32:47]
ds_read_b64_tr_b16 a[184:185], v1 offset:30720
ds_read_b64_tr_b16 a[186:187], v1 offset:31744
buffer_load_dwordx4 a[72:75], v0, s[32:35], s99 offen offset:2048 sc1
v_mfma_f32_32x32x16_bf16 v[48:63], a[164:167], a[16:19], v[48:63]
ds_read_b64_tr_b16 a[188:189], v2 offset:30720
ds_read_b64_tr_b16 a[190:191], v2 offset:31744
buffer_load_dwordx4 a[76:79], v0, s[32:35], s99 offen offset:3072 sc1
s_waitcnt lgkmcnt(8)
s_waitcnt vmcnt(15)
v_mfma_f32_32x32x16_bf16 v[32:47], a[168:171], a[20:23], v[32:47]
s_barrier
v_subrev_u32 v1, 65536, v1
v_subrev_u32 v2, 65536, v2
ds_read_b64_tr_b16 a[160:161], v1 offset:32768
ds_read_b64_tr_b16 a[162:163], v1 offset:33792
v_mfma_f32_32x32x16_bf16 v[48:63], a[172:175], a[20:23], v[48:63]
ds_read_b64_tr_b16 a[164:165], v2 offset:32768
ds_read_b64_tr_b16 a[166:167], v2 offset:33792
s_add_u32 s99, s98, 45056
buffer_load_dwordx4 a[80:83], v0, s[32:35], s99 offen sc1
s_waitcnt lgkmcnt(8)
s_waitcnt vmcnt(15)
v_mfma_f32_32x32x16_bf16 v[32:47], a[176:179], a[24:27], v[32:47]
ds_read_b64_tr_b16 a[168:169], v1 offset:34816
ds_read_b64_tr_b16 a[170:171], v1 offset:35840
buffer_load_dwordx4 a[84:87], v0, s[32:35], s99 offen offset:1024 sc1
v_mfma_f32_32x32x16_bf16 v[48:63], a[180:183], a[24:27], v[48:63]
ds_read_b64_tr_b16 a[172:173], v2 offset:34816
ds_read_b64_tr_b16 a[174:175], v2 offset:35840
s_waitcnt lgkmcnt(8)
s_waitcnt vmcnt(15)
v_mfma_f32_32x32x16_bf16 v[32:47], a[184:187], a[28:31], v[32:47]
ds_read_b64_tr_b16 a[176:177], v1 offset:36864
ds_read_b64_tr_b16 a[178:179], v1 offset:37888
buffer_load_dwordx4 a[88:91], v0, s[32:35], s99 offen offset:2048 sc1
v_mfma_f32_32x32x16_bf16 v[48:63], a[188:191], a[28:31], v[48:63]
ds_read_b64_tr_b16 a[180:181], v2 offset:36864
ds_read_b64_tr_b16 a[182:183], v2 offset:37888
s_waitcnt lgkmcnt(8)
s_waitcnt vmcnt(15)
v_mfma_f32_32x32x16_bf16 v[32:47], a[160:163], a[32:35], v[32:47]
ds_read_b64_tr_b16 a[184:185], v1 offset:38912
ds_read_b64_tr_b16 a[186:187], v1 offset:39936
buffer_load_dwordx4 a[92:95], v0, s[32:35], s99 offen offset:3072 sc1
v_mfma_f32_32x32x16_bf16 v[48:63], a[164:167], a[32:35], v[48:63]
ds_read_b64_tr_b16 a[188:189], v2 offset:38912
ds_read_b64_tr_b16 a[190:191], v2 offset:39936
s_add_u32 s99, s98, 53248
s_waitcnt lgkmcnt(8)
s_waitcnt vmcnt(15)
v_mfma_f32_32x32x16_bf16 v[32:47], a[168:171], a[36:39], v[32:47]
ds_read_b64_tr_b16 a[160:161], v1 offset:40960
ds_read_b64_tr_b16 a[162:163], v1 offset:41984
buffer_load_dwordx4 a[96:99], v0, s[32:35], s99 offen sc1
v_mfma_f32_32x32x16_bf16 v[48:63], a[172:175], a[36:39], v[48:63]
ds_read_b64_tr_b16 a[164:165], v2 offset:40960
ds_read_b64_tr_b16 a[166:167], v2 offset:41984
s_waitcnt lgkmcnt(8)
s_waitcnt vmcnt(15)
v_mfma_f32_32x32x16_bf16 v[32:47], a[176:179], a[40:43], v[32:47]
ds_read_b64_tr_b16 a[168:169], v1 offset:43008
ds_read_b64_tr_b16 a[170:171], v1 offset:44032
buffer_load_dwordx4 a[100:103], v0, s[32:35], s99 offen offset:1024 sc1
v_mfma_f32_32x32x16_bf16 v[48:63], a[180:183], a[40:43], v[48:63]
ds_read_b64_tr_b16 a[172:173], v2 offset:43008
ds_read_b64_tr_b16 a[174:175], v2 offset:44032
s_waitcnt lgkmcnt(8)
s_waitcnt vmcnt(15)
v_mfma_f32_32x32x16_bf16 v[32:47], a[184:187], a[44:47], v[32:47]
ds_read_b64_tr_b16 a[176:177], v1 offset:45056
ds_read_b64_tr_b16 a[178:179], v1 offset:46080
buffer_load_dwordx4 a[104:107], v0, s[32:35], s99 offen offset:2048 sc1
v_mfma_f32_32x32x16_bf16 v[48:63], a[188:191], a[44:47], v[48:63]
ds_read_b64_tr_b16 a[180:181], v2 offset:45056
ds_read_b64_tr_b16 a[182:183], v2 offset:46080
s_waitcnt lgkmcnt(8)
s_waitcnt vmcnt(14)
v_mfma_f32_32x32x16_bf16 v[32:47], a[160:163], a[48:51], v[32:47]
ds_read_b64_tr_b16 a[184:185], v1 offset:47104
ds_read_b64_tr_b16 a[186:187], v1 offset:48128
buffer_load_dwordx4 a[108:111], v0, s[32:35], s99 offen offset:3072 sc1
v_mfma_f32_32x32x16_bf16 v[48:63], a[164:167], a[48:51], v[48:63]
ds_read_b64_tr_b16 a[188:189], v2 offset:47104
ds_read_b64_tr_b16 a[190:191], v2 offset:48128
s_add_u32 s99, s98, 61440
s_waitcnt lgkmcnt(8)
s_waitcnt vmcnt(14)
v_mfma_f32_32x32x16_bf16 v[32:47], a[168:171], a[52:55], v[32:47]
s_barrier
ds_read_b64_tr_b16 a[160:161], v1 offset:49152
ds_read_b64_tr_b16 a[162:163], v1 offset:50176
s_add_u32 m0, s41, 147456
s_add_u32 s52, s55, 1556480
v_mfma_f32_32x32x16_bf16 v[48:63], a[172:175], a[52:55], v[48:63]
ds_read_b64_tr_b16 a[164:165], v2 offset:49152
ds_read_b64_tr_b16 a[166:167], v2 offset:50176
buffer_load_dwordx4 a[112:115], v0, s[32:35], s99 offen sc1
s_waitcnt lgkmcnt(8)
s_waitcnt vmcnt(14)
v_mfma_f32_32x32x16_bf16 v[32:47], a[176:179], a[56:59], v[32:47]
ds_read_b64_tr_b16 a[168:169], v1 offset:51200
ds_read_b64_tr_b16 a[170:171], v1 offset:52224
buffer_load_dwordx4 v4, s[24:27], s52 offen lds
v_mfma_f32_32x32x16_bf16 v[48:63], a[180:183], a[56:59], v[48:63]
ds_read_b64_tr_b16 a[172:173], v2 offset:51200
ds_read_b64_tr_b16 a[174:175], v2 offset:52224
buffer_load_dwordx4 a[116:119], v0, s[32:35], s99 offen offset:1024 sc1
s_waitcnt lgkmcnt(8)
s_waitcnt vmcnt(15)
v_mfma_f32_32x32x16_bf16 v[32:47], a[184:187], a[60:63], v[32:47]
ds_read_b64_tr_b16 a[176:177], v1 offset:53248
ds_read_b64_tr_b16 a[178:179], v1 offset:54272
buffer_load_dwordx4 a[120:123], v0, s[32:35], s99 offen offset:2048 sc1
v_mfma_f32_32x32x16_bf16 v[48:63], a[188:191], a[60:63], v[48:63]
ds_read_b64_tr_b16 a[180:181], v2 offset:53248
ds_read_b64_tr_b16 a[182:183], v2 offset:54272
s_waitcnt lgkmcnt(8)
s_waitcnt vmcnt(15)
v_mfma_f32_32x32x16_bf16 v[32:47], a[160:163], a[64:67], v[32:47]
ds_read_b64_tr_b16 a[184:185], v1 offset:55296
ds_read_b64_tr_b16 a[186:187], v1 offset:56320
buffer_load_dwordx4 a[124:127], v0, s[32:35], s99 offen offset:3072 sc1
v_mfma_f32_32x32x16_bf16 v[48:63], a[164:167], a[64:67], v[48:63]
ds_read_b64_tr_b16 a[188:189], v2 offset:55296
ds_read_b64_tr_b16 a[190:191], v2 offset:56320
s_add_u32 s99, s98, 73728
s_waitcnt lgkmcnt(8)
s_waitcnt vmcnt(15)
v_mfma_f32_32x32x16_bf16 v[32:47], a[168:171], a[68:71], v[32:47]
ds_read_b64_tr_b16 a[160:161], v1 offset:57344
ds_read_b64_tr_b16 a[162:163], v1 offset:58368
buffer_load_dwordx4 v5, s[24:27], s52 offen offset:1024 lds
v_mfma_f32_32x32x16_bf16 v[48:63], a[172:175], a[68:71], v[48:63]
ds_read_b64_tr_b16 a[164:165], v2 offset:57344
ds_read_b64_tr_b16 a[166:167], v2 offset:58368
buffer_load_dwordx4 a[128:131], v0, s[32:35], s99 offen sc1
s_waitcnt lgkmcnt(8)
s_waitcnt vmcnt(16)
v_mfma_f32_32x32x16_bf16 v[32:47], a[176:179], a[72:75], v[32:47]
ds_read_b64_tr_b16 a[168:169], v1 offset:59392
ds_read_b64_tr_b16 a[170:171], v1 offset:60416
buffer_load_dwordx4 a[132:135], v0, s[32:35], s99 offen offset:1024 sc1
v_mfma_f32_32x32x16_bf16 v[48:63], a[180:183], a[72:75], v[48:63]
ds_read_b64_tr_b16 a[172:173], v2 offset:59392
ds_read_b64_tr_b16 a[174:175], v2 offset:60416
s_waitcnt lgkmcnt(8)
s_waitcnt vmcnt(16)
v_mfma_f32_32x32x16_bf16 v[32:47], a[184:187], a[76:79], v[32:47]
ds_read_b64_tr_b16 a[176:177], v1 offset:61440
ds_read_b64_tr_b16 a[178:179], v1 offset:62464
buffer_load_dwordx4 a[136:139], v0, s[32:35], s99 offen offset:2048 sc1
v_mfma_f32_32x32x16_bf16 v[48:63], a[188:191], a[76:79], v[48:63]
ds_read_b64_tr_b16 a[180:181], v2 offset:61440
ds_read_b64_tr_b16 a[182:183], v2 offset:62464
s_waitcnt lgkmcnt(8)
s_waitcnt vmcnt(16)
v_mfma_f32_32x32x16_bf16 v[32:47], a[160:163], a[80:83], v[32:47]
ds_read_b64_tr_b16 a[184:185], v1 offset:63488
ds_read_b64_tr_b16 a[186:187], v1 offset:64512
buffer_load_dwordx4 a[140:143], v0, s[32:35], s99 offen offset:3072 sc1
v_and_b32 v117, 31, v3
v_mfma_f32_32x32x16_bf16 v[48:63], a[164:167], a[80:83], v[48:63]
ds_read_b64_tr_b16 a[188:189], v2 offset:63488
ds_read_b64_tr_b16 a[190:191], v2 offset:64512
s_add_u32 s99, s98, 81920
v_lshlrev_b32 v116, 7, v117
v_bfe_u32 v117, v3, 1, 3
s_waitcnt lgkmcnt(8)
s_waitcnt vmcnt(16)
v_mfma_f32_32x32x16_bf16 v[32:47], a[168:171], a[84:87], v[32:47]
s_barrier
v_add_u32 v1, 65536, v1
v_add_u32 v2, 65536, v2
ds_read_b64_tr_b16 a[160:161], v1 offset:0
ds_read_b64_tr_b16 a[162:163], v1 offset:1024
v_mfma_f32_32x32x16_bf16 v[48:63], a[172:175], a[84:87], v[48:63]
ds_read_b64_tr_b16 a[164:165], v2 offset:0
ds_read_b64_tr_b16 a[166:167], v2 offset:1024
buffer_load_dwordx4 a[144:147], v0, s[32:35], s99 offen sc1
s_waitcnt lgkmcnt(8)
s_waitcnt vmcnt(16)
v_mfma_f32_32x32x16_bf16 v[32:47], a[176:179], a[88:91], v[32:47]
ds_read_b64_tr_b16 a[168:169], v1 offset:2048
ds_read_b64_tr_b16 a[170:171], v1 offset:3072
buffer_load_dwordx4 v6, s[24:27], s52 offen offset:2048 lds
v_lshl_add_u32 v116, v117, 4, v116
v_mfma_f32_32x32x16_bf16 v[48:63], a[180:183], a[88:91], v[48:63]
ds_read_b64_tr_b16 a[172:173], v2 offset:2048
ds_read_b64_tr_b16 a[174:175], v2 offset:3072
buffer_load_dwordx4 a[148:151], v0, s[32:35], s99 offen offset:1024 sc1
s_waitcnt lgkmcnt(8)
s_waitcnt vmcnt(17)
v_mfma_f32_32x32x16_bf16 v[32:47], a[184:187], a[92:95], v[32:47]
ds_read_b64_tr_b16 a[176:177], v1 offset:4096
ds_read_b64_tr_b16 a[178:179], v1 offset:5120
buffer_load_dwordx4 a[152:155], v0, s[32:35], s99 offen offset:2048 sc1
v_mfma_f32_32x32x16_bf16 v[48:63], a[188:191], a[92:95], v[48:63]
ds_read_b64_tr_b16 a[180:181], v2 offset:4096
ds_read_b64_tr_b16 a[182:183], v2 offset:5120
v_lshrrev_b32 v117, 5, v3
v_lshl_add_u32 v116, v117, 3, v116
v_add_u32 v116, s41, v116
v_add_u32 v116, 147456, v116
s_waitcnt lgkmcnt(8)
s_waitcnt vmcnt(17)
v_mfma_f32_32x32x16_bf16 v[32:47], a[160:163], a[96:99], v[32:47]
ds_read_b64_tr_b16 a[184:185], v1 offset:6144
ds_read_b64_tr_b16 a[186:187], v1 offset:7168
buffer_load_dwordx4 v7, s[24:27], s52 offen offset:3072 lds
v_mfma_f32_32x32x16_bf16 v[48:63], a[164:167], a[96:99], v[48:63]
ds_read_b64_tr_b16 a[188:189], v2 offset:6144
ds_read_b64_tr_b16 a[190:191], v2 offset:7168
buffer_load_dwordx4 a[156:159], v0, s[32:35], s99 offen offset:3072 sc1
s_waitcnt lgkmcnt(8)
s_waitcnt vmcnt(18)
v_mfma_f32_32x32x16_bf16 v[32:47], a[168:171], a[100:103], v[32:47]
ds_read_b64_tr_b16 a[160:161], v1 offset:8192
ds_read_b64_tr_b16 a[162:163], v1 offset:9216
s_add_u32 s99, s98, 90112
v_accvgpr_read_b32 v121, a240
v_accvgpr_read_b32 v185, a224
v_lshlrev_b32 v120, 16, v121
v_mfma_f32_32x32x16_bf16 v[48:63], a[172:175], a[100:103], v[48:63]
ds_read_b64_tr_b16 a[164:165], v2 offset:8192
ds_read_b64_tr_b16 a[166:167], v2 offset:9216
buffer_load_dwordx4 a[0:3], v0, s[32:35], s99 offen sc1
s_waitcnt lgkmcnt(8)
s_waitcnt vmcnt(18)
v_mfma_f32_32x32x16_bf16 v[32:47], a[176:179], a[104:107], v[32:47]
ds_read_b64_tr_b16 a[168:169], v1 offset:10240
ds_read_b64_tr_b16 a[170:171], v1 offset:11264
buffer_load_dwordx4 a[4:7], v0, s[32:35], s99 offen offset:1024 sc1
v_and_b32 v121, 0xffff0000, v121
v_mfma_f32_32x32x16_bf16 v[48:63], a[180:183], a[104:107], v[48:63]
ds_read_b64_tr_b16 a[172:173], v2 offset:10240
ds_read_b64_tr_b16 a[174:175], v2 offset:11264
v_lshlrev_b32 v184, 16, v185
v_and_b32 v185, 0xffff0000, v185
v_accvgpr_read_b32 v123, a241
s_waitcnt lgkmcnt(8)
s_waitcnt vmcnt(18)
v_mfma_f32_32x32x16_bf16 v[32:47], a[184:187], a[108:111], v[32:47]
ds_read_b64_tr_b16 a[176:177], v1 offset:12288
ds_read_b64_tr_b16 a[178:179], v1 offset:13312
buffer_load_dword v29, off, s[32:35], s6 offset:128 sc1
v_accvgpr_read_b32 v187, a225
v_mfma_f32_32x32x16_bf16 v[48:63], a[188:191], a[108:111], v[48:63]
ds_read_b64_tr_b16 a[180:181], v2 offset:12288
ds_read_b64_tr_b16 a[182:183], v2 offset:13312
buffer_load_dwordx4 a[8:11], v0, s[32:35], s99 offen offset:2048 sc1
s_waitcnt lgkmcnt(8)
s_waitcnt vmcnt(19)
v_mfma_f32_32x32x16_bf16 v[32:47], a[160:163], a[112:115], v[32:47]
ds_read_b64_tr_b16 a[184:185], v1 offset:14336
ds_read_b64_tr_b16 a[186:187], v1 offset:15360
buffer_load_dwordx4 a[12:15], v0, s[32:35], s99 offen offset:3072 sc1
v_lshlrev_b32 v122, 16, v123
v_mfma_f32_32x32x16_bf16 v[48:63], a[164:167], a[112:115], v[48:63]
ds_read_b64_tr_b16 a[188:189], v2 offset:14336
ds_read_b64_tr_b16 a[190:191], v2 offset:15360
s_add_u32 s99, s98, 98304
v_and_b32 v123, 0xffff0000, v123
v_lshlrev_b32 v186, 16, v187
s_waitcnt lgkmcnt(8)
s_waitcnt vmcnt(18)
v_mfma_f32_32x32x16_bf16 v[32:47], a[168:171], a[116:119], v[32:47]
s_barrier
v_subrev_u32 v1, 131072, v1
v_subrev_u32 v2, 131072, v2
ds_read_b64_tr_b16 a[160:161], v1 offset:0
ds_read_b64_tr_b16 a[162:163], v1 offset:1024
v_mfma_f32_32x32x16_bf16 v[48:63], a[172:175], a[116:119], v[48:63]
ds_read_b64_tr_b16 a[164:165], v2 offset:0
ds_read_b64_tr_b16 a[166:167], v2 offset:1024
s_add_u32 m0, s41, 98304
s_add_u32 s52, s55, 1884160
buffer_load_dwordx4 a[16:19], v0, s[32:35], s99 offen sc1
s_waitcnt lgkmcnt(8)
s_waitcnt vmcnt(18)
v_mfma_f32_32x32x16_bf16 v[32:47], a[176:179], a[120:123], v[32:47]
ds_read_b64_tr_b16 a[168:169], v1 offset:2048
ds_read_b64_tr_b16 a[170:171], v1 offset:3072
buffer_load_dwordx4 v4, s[24:27], s52 offen lds
v_and_b32 v187, 0xffff0000, v187
v_mfma_f32_32x32x16_bf16 v[48:63], a[180:183], a[120:123], v[48:63]
ds_read_b64_tr_b16 a[172:173], v2 offset:2048
ds_read_b64_tr_b16 a[174:175], v2 offset:3072
buffer_load_dwordx4 a[20:23], v0, s[32:35], s99 offen offset:1024 sc1
s_waitcnt lgkmcnt(8)
s_waitcnt vmcnt(19)
v_mfma_f32_32x32x16_bf16 v[32:47], a[184:187], a[124:127], v[32:47]
ds_read_b64_tr_b16 a[176:177], v1 offset:4096
ds_read_b64_tr_b16 a[178:179], v1 offset:5120
buffer_load_dwordx4 a[24:27], v0, s[32:35], s99 offen offset:2048 sc1
v_mfma_f32_32x32x16_bf16 v[48:63], a[188:191], a[124:127], v[48:63]
ds_read_b64_tr_b16 a[180:181], v2 offset:4096
ds_read_b64_tr_b16 a[182:183], v2 offset:5120
v_accvgpr_read_b32 v125, a242
v_accvgpr_read_b32 v189, a226
v_lshlrev_b32 v124, 16, v125
s_waitcnt lgkmcnt(8)
s_waitcnt vmcnt(18)
v_mfma_f32_32x32x16_bf16 v[32:47], a[160:163], a[128:131], v[32:47]
ds_read_b64_tr_b16 a[184:185], v1 offset:6144
ds_read_b64_tr_b16 a[186:187], v1 offset:7168
buffer_load_dwordx4 a[28:31], v0, s[32:35], s99 offen offset:3072 sc1
v_and_b32 v125, 0xffff0000, v125
v_mfma_f32_32x32x16_bf16 v[48:63], a[164:167], a[128:131], v[48:63]
ds_read_b64_tr_b16 a[188:189], v2 offset:6144
ds_read_b64_tr_b16 a[190:191], v2 offset:7168
s_waitcnt vmcnt(7)
v_cmp_gt_u32 vcc, 12, v29
s_nop 1
s_cbranch_vccnz L_pw73
L_pr75:
s_add_u32 s99, s98, 4096
s_waitcnt lgkmcnt(8)
v_mfma_f32_32x32x16_bf16 v[32:47], a[168:171], a[132:135], v[32:47]
ds_read_b64_tr_b16 a[160:161], v1 offset:8192
ds_read_b64_tr_b16 a[162:163], v1 offset:9216
buffer_load_dwordx4 v5, s[24:27], s52 offen offset:1024 lds
v_lshlrev_b32 v188, 16, v189
v_mfma_f32_32x32x16_bf16 v[48:63], a[172:175], a[132:135], v[48:63]
ds_read_b64_tr_b16 a[164:165], v2 offset:8192
ds_read_b64_tr_b16 a[166:167], v2 offset:9216
buffer_load_dwordx4 a[32:35], v0, s[32:35], s99 offen sc1
s_waitcnt lgkmcnt(8)
v_mfma_f32_32x32x16_bf16 v[32:47], a[176:179], a[136:139], v[32:47]
ds_read_b64_tr_b16 a[168:169], v1 offset:10240
ds_read_b64_tr_b16 a[170:171], v1 offset:11264
buffer_load_dwordx4 a[36:39], v0, s[32:35], s99 offen offset:1024 sc1
v_and_b32 v189, 0xffff0000, v189
v_mfma_f32_32x32x16_bf16 v[48:63], a[180:183], a[136:139], v[48:63]
ds_read_b64_tr_b16 a[172:173], v2 offset:10240
ds_read_b64_tr_b16 a[174:175], v2 offset:11264
v_accvgpr_read_b32 v127, a243
v_accvgpr_read_b32 v191, a227
v_lshlrev_b32 v126, 16, v127
s_waitcnt lgkmcnt(8)
v_mfma_f32_32x32x16_bf16 v[32:47], a[184:187], a[140:143], v[32:47]
ds_read_b64_tr_b16 a[176:177], v1 offset:12288
ds_read_b64_tr_b16 a[178:179], v1 offset:13312
buffer_load_dwordx4 a[40:43], v0, s[32:35], s99 offen offset:2048 sc1
v_and_b32 v127, 0xffff0000, v127
v_mfma_f32_32x32x16_bf16 v[48:63], a[188:191], a[140:143], v[48:63]
ds_read_b64_tr_b16 a[180:181], v2 offset:12288
ds_read_b64_tr_b16 a[182:183], v2 offset:13312
v_lshlrev_b32 v190, 16, v191
v_and_b32 v191, 0xffff0000, v191
v_accvgpr_read_b32 v129, a244
s_waitcnt lgkmcnt(8)
v_mfma_f32_32x32x16_bf16 v[32:47], a[160:163], a[144:147], v[32:47]
ds_read_b64_tr_b16 a[184:185], v1 offset:14336
ds_read_b64_tr_b16 a[186:187], v1 offset:15360
buffer_load_dwordx4 a[44:47], v0, s[32:35], s99 offen offset:3072 sc1
v_mfma_f32_32x32x16_bf16 v[48:63], a[164:167], a[144:147], v[48:63]
ds_read_b64_tr_b16 a[188:189], v2 offset:14336
ds_read_b64_tr_b16 a[190:191], v2 offset:15360
s_add_u32 s99, s98, 12288
v_accvgpr_read_b32 v193, a228
v_lshlrev_b32 v128, 16, v129
v_and_b32 v129, 0xffff0000, v129
s_waitcnt lgkmcnt(8)
v_mfma_f32_32x32x16_bf16 v[32:47], a[168:171], a[148:151], v[32:47]
s_barrier
ds_read_b64_tr_b16 a[160:161], v1 offset:16384
ds_read_b64_tr_b16 a[162:163], v1 offset:17408
v_lshlrev_b32 v192, 16, v193
v_and_b32 v193, 0xffff0000, v193
v_mfma_f32_32x32x16_bf16 v[48:63], a[172:175], a[148:151], v[48:63]
ds_read_b64_tr_b16 a[164:165], v2 offset:16384
ds_read_b64_tr_b16 a[166:167], v2 offset:17408
buffer_load_dwordx4 a[48:51], v0, s[32:35], s99 offen sc1
s_waitcnt lgkmcnt(8)
v_mfma_f32_32x32x16_bf16 v[32:47], a[176:179], a[152:155], v[32:47]
ds_read_b64_tr_b16 a[168:169], v1 offset:18432
ds_read_b64_tr_b16 a[170:171], v1 offset:19456
buffer_load_dwordx4 v6, s[24:27], s52 offen offset:2048 lds
v_mfma_f32_32x32x16_bf16 v[48:63], a[180:183], a[152:155], v[48:63]
ds_read_b64_tr_b16 a[172:173], v2 offset:18432
ds_read_b64_tr_b16 a[174:175], v2 offset:19456
buffer_load_dwordx4 a[52:55], v0, s[32:35], s99 offen offset:1024 sc1
s_waitcnt lgkmcnt(8)
v_mfma_f32_32x32x16_bf16 v[32:47], a[184:187], a[156:159], v[32:47]
ds_read_b64_tr_b16 a[176:177], v1 offset:20480
ds_read_b64_tr_b16 a[178:179], v1 offset:21504
buffer_load_dwordx4 a[56:59], v0, s[32:35], s99 offen offset:2048 sc1
v_accvgpr_read_b32 v131, a245
v_mfma_f32_32x32x16_bf16 v[48:63], a[188:191], a[156:159], v[48:63]
ds_read_b64_tr_b16 a[180:181], v2 offset:20480
ds_read_b64_tr_b16 a[182:183], v2 offset:21504
v_accvgpr_read_b32 v195, a229
v_lshlrev_b32 v130, 16, v131
v_and_b32 v131, 0xffff0000, v131
s_waitcnt lgkmcnt(8)
v_mfma_f32_32x32x16_bf16 v[32:47], a[160:163], a[0:3], v[32:47]
ds_read_b64_tr_b16 a[184:185], v1 offset:22528
ds_read_b64_tr_b16 a[186:187], v1 offset:23552
buffer_load_dwordx4 v7, s[24:27], s52 offen offset:3072 lds
v_lshlrev_b32 v194, 16, v195
v_mfma_f32_32x32x16_bf16 v[48:63], a[164:167], a[0:3], v[48:63]
ds_read_b64_tr_b16 a[188:189], v2 offset:22528
ds_read_b64_tr_b16 a[190:191], v2 offset:23552
buffer_load_dwordx4 a[60:63], v0, s[32:35], s99 offen offset:3072 sc1
s_waitcnt lgkmcnt(8)
v_mfma_f32_32x32x16_bf16 v[32:47], a[168:171], a[4:7], v[32:47]
ds_read_b64_tr_b16 a[160:161], v1 offset:24576
ds_read_b64_tr_b16 a[162:163], v1 offset:25600
s_add_u32 s99, s98, 20480
v_and_b32 v195, 0xffff0000, v195
v_accvgpr_read_b32 v133, a246
v_accvgpr_read_b32 v197, a230
v_mfma_f32_32x32x16_bf16 v[48:63], a[172:175], a[4:7], v[48:63]
ds_read_b64_tr_b16 a[164:165], v2 offset:24576
ds_read_b64_tr_b16 a[166:167], v2 offset:25600
buffer_load_dwordx4 a[64:67], v0, s[32:35], s99 offen sc1
s_waitcnt lgkmcnt(8)
s_waitcnt vmcnt(18)
v_mfma_f32_32x32x16_bf16 v[32:47], a[176:179], a[8:11], v[32:47]
ds_read_b64_tr_b16 a[168:169], v1 offset:26624
ds_read_b64_tr_b16 a[170:171], v1 offset:27648
buffer_load_dwordx4 a[68:71], v0, s[32:35], s99 offen offset:1024 sc1
v_lshlrev_b32 v132, 16, v133
v_mfma_f32_32x32x16_bf16 v[48:63], a[180:183], a[8:11], v[48:63]
ds_read_b64_tr_b16 a[172:173], v2 offset:26624
ds_read_b64_tr_b16 a[174:175], v2 offset:27648
v_and_b32 v133, 0xffff0000, v133
v_lshlrev_b32 v196, 16, v197
v_and_b32 v197, 0xffff0000, v197
s_waitcnt lgkmcnt(8)
s_waitcnt vmcnt(18)
v_mfma_f32_32x32x16_bf16 v[32:47], a[184:187], a[12:15], v[32:47]
ds_read_b64_tr_b16 a[176:177], v1 offset:28672
ds_read_b64_tr_b16 a[178:179], v1 offset:29696
buffer_load_dwordx4 a[72:75], v0, s[32:35], s99 offen offset:2048 sc1
v_accvgpr_read_b32 v135, a247
v_mfma_f32_32x32x16_bf16 v[48:63], a[188:191], a[12:15], v[48:63]
ds_read_b64_tr_b16 a[180:181], v2 offset:28672
ds_read_b64_tr_b16 a[182:183], v2 offset:29696
v_accvgpr_read_b32 v199, a231
v_lshlrev_b32 v134, 16, v135
v_and_b32 v135, 0xffff0000, v135
s_waitcnt lgkmcnt(8)
s_waitcnt vmcnt(18)
v_mfma_f32_32x32x16_bf16 v[32:47], a[160:163], a[16:19], v[32:47]
ds_read_b64_tr_b16 a[184:185], v1 offset:30720
ds_read_b64_tr_b16 a[186:187], v1 offset:31744
buffer_load_dwordx4 a[76:79], v0, s[32:35], s99 offen offset:3072 sc1
v_lshlrev_b32 v198, 16, v199
v_mfma_f32_32x32x16_bf16 v[48:63], a[164:167], a[16:19], v[48:63]
ds_read_b64_tr_b16 a[188:189], v2 offset:30720
ds_read_b64_tr_b16 a[190:191], v2 offset:31744
s_add_u32 s99, s98, 28672
v_and_b32 v199, 0xffff0000, v199
v_accvgpr_read_b32 v137, a248
s_waitcnt lgkmcnt(8)
s_waitcnt vmcnt(17)
v_mfma_f32_32x32x16_bf16 v[32:47], a[168:171], a[20:23], v[32:47]
s_barrier
ds_read_b64_tr_b16 a[160:161], v1 offset:32768
ds_read_b64_tr_b16 a[162:163], v1 offset:33792
s_movk_i32 s96, 1280
v_lshrrev_b32 v4, 3, v3
v_mfma_f32_32x32x16_bf16 v[48:63], a[172:175], a[20:23], v[48:63]
ds_read_b64_tr_b16 a[164:165], v2 offset:32768
ds_read_b64_tr_b16 a[166:167], v2 offset:33792
s_lshl_b32 s53, s40, 5
s_lshr_b32 s52, s40, 1
s_mul_i32 s52, s52, 512
buffer_load_dwordx4 a[80:83], v0, s[32:35], s99 offen sc1
s_waitcnt lgkmcnt(8)
s_waitcnt vmcnt(17)
v_mfma_f32_32x32x16_bf16 v[32:47], a[176:179], a[24:27], v[32:47]
ds_read_b64_tr_b16 a[168:169], v1 offset:34816
ds_read_b64_tr_b16 a[170:171], v1 offset:35840
s_add_u32 s53, s53, s52
v_add_u32 v4, s53, v4
v_bfe_u32 v5, v3, 4, 1
v_lshlrev_b32 v5, 2, v5
v_mfma_f32_32x32x16_bf16 v[48:63], a[180:183], a[24:27], v[48:63]
ds_read_b64_tr_b16 a[172:173], v2 offset:34816
ds_read_b64_tr_b16 a[174:175], v2 offset:35840
v_and_b32 v6, 7, v3
v_xor_b32 v5, v5, v6
v_lshlrev_b32 v5, 4, v5
v_mad_u32_u24 v4, v4, s96, v5
s_lshl_b32 s53, s96, 3
s_sub_u32 s53, s53, 1024
v_add_u32 v4, s56, v4
v_add_u32 v5, s53, v4
v_add_u32 v6, s53, v5
v_add_u32 v7, s53, v6
s_lshl_b32 s53, s96, 6
s_add_u32 m0, s41, 114688
s_add_u32 s52, s55, 655360
buffer_load_dwordx4 v4, s[24:27], s52 offen lds
buffer_load_dwordx4 a[84:87], v0, s[32:35], s99 offen offset:1024 sc1
s_waitcnt lgkmcnt(8)
s_waitcnt vmcnt(18)
v_mfma_f32_32x32x16_bf16 v[32:47], a[184:187], a[28:31], v[32:47]
ds_read_b64_tr_b16 a[176:177], v1 offset:36864
ds_read_b64_tr_b16 a[178:179], v1 offset:37888
buffer_load_dwordx4 a[88:91], v0, s[32:35], s99 offen offset:2048 sc1
v_accvgpr_read_b32 v201, a232
v_mfma_f32_32x32x16_bf16 v[48:63], a[188:191], a[28:31], v[48:63]
ds_read_b64_tr_b16 a[180:181], v2 offset:36864
ds_read_b64_tr_b16 a[182:183], v2 offset:37888
v_lshlrev_b32 v136, 16, v137
v_and_b32 v137, 0xffff0000, v137
v_lshlrev_b32 v200, 16, v201
s_waitcnt lgkmcnt(8)
s_waitcnt vmcnt(17)
v_mfma_f32_32x32x16_bf16 v[32:47], a[160:163], a[32:35], v[32:47]
ds_read_b64_tr_b16 a[184:185], v1 offset:38912
ds_read_b64_tr_b16 a[186:187], v1 offset:39936
buffer_load_dwordx4 a[92:95], v0, s[32:35], s99 offen offset:3072 sc1
v_and_b32 v201, 0xffff0000, v201
v_mfma_f32_32x32x16_bf16 v[48:63], a[164:167], a[32:35], v[48:63]
ds_read_b64_tr_b16 a[188:189], v2 offset:38912
ds_read_b64_tr_b16 a[190:191], v2 offset:39936
s_add_u32 s99, s98, 40960
v_accvgpr_read_b32 v139, a249
v_accvgpr_read_b32 v203, a233
s_waitcnt lgkmcnt(8)
s_waitcnt vmcnt(17)
v_mfma_f32_32x32x16_bf16 v[32:47], a[168:171], a[36:39], v[32:47]
ds_read_b64_tr_b16 a[160:161], v1 offset:40960
ds_read_b64_tr_b16 a[162:163], v1 offset:41984
buffer_load_dwordx4 v5, s[24:27], s52 offen offset:1024 lds
v_mfma_f32_32x32x16_bf16 v[48:63], a[172:175], a[36:39], v[48:63]
ds_read_b64_tr_b16 a[164:165], v2 offset:40960
ds_read_b64_tr_b16 a[166:167], v2 offset:41984
buffer_load_dwordx4 a[96:99], v0, s[32:35], s99 offen sc1
s_waitcnt lgkmcnt(8)
s_waitcnt vmcnt(18)
v_mfma_f32_32x32x16_bf16 v[32:47], a[176:179], a[40:43], v[32:47]
ds_read_b64_tr_b16 a[168:169], v1 offset:43008
ds_read_b64_tr_b16 a[170:171], v1 offset:44032
buffer_load_dwordx4 a[100:103], v0, s[32:35], s99 offen offset:1024 sc1
v_lshlrev_b32 v138, 16, v139
v_mfma_f32_32x32x16_bf16 v[48:63], a[180:183], a[40:43], v[48:63]
ds_read_b64_tr_b16 a[172:173], v2 offset:43008
ds_read_b64_tr_b16 a[174:175], v2 offset:44032
v_and_b32 v139, 0xffff0000, v139
v_lshlrev_b32 v202, 16, v203
v_and_b32 v203, 0xffff0000, v203
s_waitcnt lgkmcnt(8)
s_waitcnt vmcnt(18)
v_mfma_f32_32x32x16_bf16 v[32:47], a[184:187], a[44:47], v[32:47]
ds_read_b64_tr_b16 a[176:177], v1 offset:45056
ds_read_b64_tr_b16 a[178:179], v1 offset:46080
buffer_load_dwordx4 a[104:107], v0, s[32:35], s99 offen offset:2048 sc1
v_accvgpr_read_b32 v141, a250
v_mfma_f32_32x32x16_bf16 v[48:63], a[188:191], a[44:47], v[48:63]
ds_read_b64_tr_b16 a[180:181], v2 offset:45056
ds_read_b64_tr_b16 a[182:183], v2 offset:46080
v_accvgpr_read_b32 v205, a234
v_lshlrev_b32 v140, 16, v141
v_and_b32 v141, 0xffff0000, v141
s_waitcnt lgkmcnt(8)
s_waitcnt vmcnt(18)
v_mfma_f32_32x32x16_bf16 v[32:47], a[160:163], a[48:51], v[32:47]
ds_read_b64_tr_b16 a[184:185], v1 offset:47104
ds_read_b64_tr_b16 a[186:187], v1 offset:48128
buffer_load_dwordx4 a[108:111], v0, s[32:35], s99 offen offset:3072 sc1
v_lshlrev_b32 v204, 16, v205
v_mfma_f32_32x32x16_bf16 v[48:63], a[164:167], a[48:51], v[48:63]
ds_read_b64_tr_b16 a[188:189], v2 offset:47104
ds_read_b64_tr_b16 a[190:191], v2 offset:48128
s_add_u32 s99, s98, 49152
v_and_b32 v205, 0xffff0000, v205
v_accvgpr_read_b32 v143, a251
s_waitcnt lgkmcnt(8)
s_waitcnt vmcnt(17)
v_mfma_f32_32x32x16_bf16 v[32:47], a[168:171], a[52:55], v[32:47]
s_barrier
ds_read_b64_tr_b16 a[160:161], v1 offset:49152
ds_read_b64_tr_b16 a[162:163], v1 offset:50176
v_accvgpr_read_b32 v207, a235
v_lshlrev_b32 v142, 16, v143
v_mfma_f32_32x32x16_bf16 v[48:63], a[172:175], a[52:55], v[48:63]
ds_read_b64_tr_b16 a[164:165], v2 offset:49152
ds_read_b64_tr_b16 a[166:167], v2 offset:50176
buffer_load_dwordx4 a[112:115], v0, s[32:35], s99 offen sc1
s_waitcnt lgkmcnt(8)
s_waitcnt vmcnt(17)
v_mfma_f32_32x32x16_bf16 v[32:47], a[176:179], a[56:59], v[32:47]
ds_read_b64_tr_b16 a[168:169], v1 offset:51200
ds_read_b64_tr_b16 a[170:171], v1 offset:52224
buffer_load_dwordx4 v6, s[24:27], s52 offen offset:2048 lds
v_and_b32 v143, 0xffff0000, v143
v_mfma_f32_32x32x16_bf16 v[48:63], a[180:183], a[56:59], v[48:63]
ds_read_b64_tr_b16 a[172:173], v2 offset:51200
ds_read_b64_tr_b16 a[174:175], v2 offset:52224
buffer_load_dwordx4 a[116:119], v0, s[32:35], s99 offen offset:1024 sc1
s_waitcnt lgkmcnt(8)
s_waitcnt vmcnt(17)
v_mfma_f32_32x32x16_bf16 v[32:47], a[184:187], a[60:63], v[32:47]
ds_read_b64_tr_b16 a[176:177], v1 offset:53248
ds_read_b64_tr_b16 a[178:179], v1 offset:54272
buffer_load_dwordx4 a[120:123], v0, s[32:35], s99 offen offset:2048 sc1
v_lshlrev_b32 v206, 16, v207
v_mfma_f32_32x32x16_bf16 v[48:63], a[188:191], a[60:63], v[48:63]
ds_read_b64_tr_b16 a[180:181], v2 offset:53248
ds_read_b64_tr_b16 a[182:183], v2 offset:54272
v_and_b32 v207, 0xffff0000, v207
v_accvgpr_read_b32 v145, a252
v_accvgpr_read_b32 v209, a236
s_waitcnt lgkmcnt(8)
s_waitcnt vmcnt(17)
v_mfma_f32_32x32x16_bf16 v[32:47], a[160:163], a[64:67], v[32:47]
ds_read_b64_tr_b16 a[184:185], v1 offset:55296
ds_read_b64_tr_b16 a[186:187], v1 offset:56320
buffer_load_dwordx4 v7, s[24:27], s52 offen offset:3072 lds
v_mfma_f32_32x32x16_bf16 v[48:63], a[164:167], a[64:67], v[48:63]
ds_read_b64_tr_b16 a[188:189], v2 offset:55296
ds_read_b64_tr_b16 a[190:191], v2 offset:56320
buffer_load_dwordx4 a[124:127], v0, s[32:35], s99 offen offset:3072 sc1
s_waitcnt lgkmcnt(8)
s_waitcnt vmcnt(18)
v_mfma_f32_32x32x16_bf16 v[32:47], a[168:171], a[68:71], v[32:47]
ds_read_b64_tr_b16 a[160:161], v1 offset:57344
ds_read_b64_tr_b16 a[162:163], v1 offset:58368
s_add_u32 s99, s98, 57344
v_lshlrev_b32 v144, 16, v145
v_and_b32 v145, 0xffff0000, v145
v_lshlrev_b32 v208, 16, v209
v_and_b32 v209, 0xffff0000, v209
v_mfma_f32_32x32x16_bf16 v[48:63], a[172:175], a[68:71], v[48:63]
ds_read_b64_tr_b16 a[164:165], v2 offset:57344
ds_read_b64_tr_b16 a[166:167], v2 offset:58368
buffer_load_dwordx4 a[128:131], v0, s[32:35], s99 offen sc1
s_waitcnt lgkmcnt(8)
s_waitcnt vmcnt(18)
v_mfma_f32_32x32x16_bf16 v[32:47], a[176:179], a[72:75], v[32:47]
ds_read_b64_tr_b16 a[168:169], v1 offset:59392
ds_read_b64_tr_b16 a[170:171], v1 offset:60416
buffer_load_dwordx4 a[132:135], v0, s[32:35], s99 offen offset:1024 sc1
v_mfma_f32_32x32x16_bf16 v[48:63], a[180:183], a[72:75], v[48:63]
ds_read_b64_tr_b16 a[172:173], v2 offset:59392
ds_read_b64_tr_b16 a[174:175], v2 offset:60416
v_accvgpr_read_b32 v147, a253
v_accvgpr_read_b32 v211, a237
v_lshlrev_b32 v146, 16, v147
s_waitcnt lgkmcnt(8)
s_waitcnt vmcnt(18)
v_mfma_f32_32x32x16_bf16 v[32:47], a[184:187], a[76:79], v[32:47]
ds_read_b64_tr_b16 a[176:177], v1 offset:61440
ds_read_b64_tr_b16 a[178:179], v1 offset:62464
buffer_load_dwordx4 a[136:139], v0, s[32:35], s99 offen offset:2048 sc1
v_and_b32 v147, 0xffff0000, v147
v_mfma_f32_32x32x16_bf16 v[48:63], a[188:191], a[76:79], v[48:63]
ds_read_b64_tr_b16 a[180:181], v2 offset:61440
ds_read_b64_tr_b16 a[182:183], v2 offset:62464
v_lshlrev_b32 v210, 16, v211
v_and_b32 v211, 0xffff0000, v211
v_accvgpr_read_b32 v149, a254
s_waitcnt lgkmcnt(8)
s_waitcnt vmcnt(18)
v_mfma_f32_32x32x16_bf16 v[32:47], a[160:163], a[80:83], v[32:47]
ds_read_b64_tr_b16 a[184:185], v1 offset:63488
ds_read_b64_tr_b16 a[186:187], v1 offset:64512
buffer_load_dwordx4 a[140:143], v0, s[32:35], s99 offen offset:3072 sc1
v_accvgpr_read_b32 v213, a238
v_mfma_f32_32x32x16_bf16 v[48:63], a[164:167], a[80:83], v[48:63]
ds_read_b64_tr_b16 a[188:189], v2 offset:63488
ds_read_b64_tr_b16 a[190:191], v2 offset:64512
s_add_u32 s99, s98, 65536
v_lshlrev_b32 v148, 16, v149
v_and_b32 v149, 0xffff0000, v149
s_waitcnt lgkmcnt(8)
s_waitcnt vmcnt(17)
v_mfma_f32_32x32x16_bf16 v[32:47], a[168:171], a[84:87], v[32:47]
s_barrier
v_add_u32 v1, 65536, v1
v_add_u32 v2, 65536, v2
ds_read_b64_tr_b16 a[160:161], v1 offset:0
ds_read_b64_tr_b16 a[162:163], v1 offset:1024
v_mfma_f32_32x32x16_bf16 v[48:63], a[172:175], a[84:87], v[48:63]
ds_read_b64_tr_b16 a[164:165], v2 offset:0
ds_read_b64_tr_b16 a[166:167], v2 offset:1024
s_add_u32 m0, s41, 131072
s_add_u32 s52, s55, 2129920
buffer_load_dwordx4 a[144:147], v0, s[32:35], s99 offen sc1
s_waitcnt lgkmcnt(8)
s_waitcnt vmcnt(17)
v_mfma_f32_32x32x16_bf16 v[32:47], a[176:179], a[88:91], v[32:47]
ds_read_b64_tr_b16 a[168:169], v1 offset:2048
ds_read_b64_tr_b16 a[170:171], v1 offset:3072
buffer_load_dwordx4 v4, s[24:27], s52 offen lds
v_lshlrev_b32 v212, 16, v213
v_mfma_f32_32x32x16_bf16 v[48:63], a[180:183], a[88:91], v[48:63]
ds_read_b64_tr_b16 a[172:173], v2 offset:2048
ds_read_b64_tr_b16 a[174:175], v2 offset:3072
buffer_load_dwordx4 a[148:151], v0, s[32:35], s99 offen offset:1024 sc1
s_waitcnt lgkmcnt(8)
s_waitcnt vmcnt(18)
v_mfma_f32_32x32x16_bf16 v[32:47], a[184:187], a[92:95], v[32:47]
ds_read_b64_tr_b16 a[176:177], v1 offset:4096
ds_read_b64_tr_b16 a[178:179], v1 offset:5120
buffer_load_dwordx4 a[152:155], v0, s[32:35], s99 offen offset:2048 sc1
v_and_b32 v213, 0xffff0000, v213
v_mfma_f32_32x32x16_bf16 v[48:63], a[188:191], a[92:95], v[48:63]
ds_read_b64_tr_b16 a[180:181], v2 offset:4096
ds_read_b64_tr_b16 a[182:183], v2 offset:5120
v_accvgpr_read_b32 v151, a255
v_accvgpr_read_b32 v215, a239
v_lshlrev_b32 v150, 16, v151
s_waitcnt lgkmcnt(8)
s_waitcnt vmcnt(17)
v_mfma_f32_32x32x16_bf16 v[32:47], a[160:163], a[96:99], v[32:47]
ds_read_b64_tr_b16 a[184:185], v1 offset:6144
ds_read_b64_tr_b16 a[186:187], v1 offset:7168
buffer_load_dwordx4 a[156:159], v0, s[32:35], s99 offen offset:3072 sc1
v_mfma_f32_32x32x16_bf16 v[48:63], a[164:167], a[96:99], v[48:63]
ds_read_b64_tr_b16 a[188:189], v2 offset:6144
ds_read_b64_tr_b16 a[190:191], v2 offset:7168
s_add_u32 s99, s98, 77824
v_and_b32 v151, 0xffff0000, v151
v_lshlrev_b32 v214, 16, v215
v_and_b32 v215, 0xffff0000, v215
s_waitcnt lgkmcnt(8)
s_waitcnt vmcnt(17)
v_mfma_f32_32x32x16_bf16 v[32:47], a[168:171], a[100:103], v[32:47]
ds_read_b64_tr_b16 a[160:161], v1 offset:8192
ds_read_b64_tr_b16 a[162:163], v1 offset:9216
buffer_load_dwordx4 v5, s[24:27], s52 offen offset:1024 lds
v_mfma_f32_32x32x16_bf16 v[48:63], a[172:175], a[100:103], v[48:63]
ds_read_b64_tr_b16 a[164:165], v2 offset:8192
ds_read_b64_tr_b16 a[166:167], v2 offset:9216
buffer_load_dwordx4 a[0:3], v0, s[32:35], s99 offen sc1
s_waitcnt lgkmcnt(8)
s_waitcnt vmcnt(18)
v_mfma_f32_32x32x16_bf16 v[32:47], a[176:179], a[104:107], v[32:47]
ds_read_b64_tr_b16 a[168:169], v1 offset:10240
ds_read_b64_tr_b16 a[170:171], v1 offset:11264
buffer_load_dwordx4 a[4:7], v0, s[32:35], s99 offen offset:1024 sc1
v_lshrrev_b32 v112, 3, v3
v_mfma_f32_32x32x16_bf16 v[48:63], a[180:183], a[104:107], v[48:63]
ds_read_b64_tr_b16 a[172:173], v2 offset:10240
ds_read_b64_tr_b16 a[174:175], v2 offset:11264
s_lshl_b32 s5, s54, 5
v_add_u32 v112, s5, v112
v_mul_u32_u24 v112, 1280, v112
s_waitcnt lgkmcnt(8)
s_waitcnt vmcnt(18)
v_mfma_f32_32x32x16_bf16 v[32:47], a[184:187], a[108:111], v[32:47]
ds_read_b64_tr_b16 a[176:177], v1 offset:12288
ds_read_b64_tr_b16 a[178:179], v1 offset:13312
buffer_load_dwordx4 a[8:11], v0, s[32:35], s99 offen offset:2048 sc1
v_and_b32 v113, 7, v3
v_mfma_f32_32x32x16_bf16 v[48:63], a[188:191], a[108:111], v[48:63]
ds_read_b64_tr_b16 a[180:181], v2 offset:12288
ds_read_b64_tr_b16 a[182:183], v2 offset:13312
v_lshl_add_u32 v112, v113, 4, v112
v_add_u32 v113, 10240, v112
v_add_u32 v114, 10240, v113
s_waitcnt lgkmcnt(8)
s_waitcnt vmcnt(18)
v_mfma_f32_32x32x16_bf16 v[32:47], a[160:163], a[112:115], v[32:47]
ds_read_b64_tr_b16 a[184:185], v1 offset:14336
ds_read_b64_tr_b16 a[186:187], v1 offset:15360
buffer_load_dwordx4 a[12:15], v0, s[32:35], s99 offen offset:3072 sc1
v_add_u32 v115, 10240, v114
v_mfma_f32_32x32x16_bf16 v[48:63], a[164:167], a[112:115], v[48:63]
ds_read_b64_tr_b16 a[188:189], v2 offset:14336
ds_read_b64_tr_b16 a[190:191], v2 offset:15360
s_add_u32 s99, s98, 86016
v_lshrrev_b32 v117, 4, v3
v_xor_b32 v118, v117, v3
s_waitcnt lgkmcnt(8)
s_waitcnt vmcnt(17)
v_mfma_f32_32x32x16_bf16 v[32:47], a[168:171], a[116:119], v[32:47]
s_barrier
ds_read_b64_tr_b16 a[160:161], v1 offset:16384
ds_read_b64_tr_b16 a[162:163], v1 offset:17408
v_and_b32 v118, 7, v118
v_xor_b32 v119, 4, v118
v_mfma_f32_32x32x16_bf16 v[48:63], a[172:175], a[116:119], v[48:63]
ds_read_b64_tr_b16 a[164:165], v2 offset:16384
ds_read_b64_tr_b16 a[166:167], v2 offset:17408
buffer_load_dwordx4 a[16:19], v0, s[32:35], s99 offen sc1
s_waitcnt lgkmcnt(8)
s_waitcnt vmcnt(17)
v_mfma_f32_32x32x16_bf16 v[32:47], a[176:179], a[120:123], v[32:47]
ds_read_b64_tr_b16 a[168:169], v1 offset:18432
ds_read_b64_tr_b16 a[170:171], v1 offset:19456
buffer_load_dwordx4 v6, s[24:27], s52 offen offset:2048 lds
v_and_b32 v117, 0x38, v3
v_mfma_f32_32x32x16_bf16 v[48:63], a[180:183], a[120:123], v[48:63]
ds_read_b64_tr_b16 a[172:173], v2 offset:18432
ds_read_b64_tr_b16 a[174:175], v2 offset:19456
buffer_load_dwordx4 a[20:23], v0, s[32:35], s99 offen offset:1024 sc1
s_waitcnt lgkmcnt(8)
s_waitcnt vmcnt(17)
v_mfma_f32_32x32x16_bf16 v[32:47], a[184:187], a[124:127], v[32:47]
ds_read_b64_tr_b16 a[176:177], v1 offset:20480
ds_read_b64_tr_b16 a[178:179], v1 offset:21504
buffer_load_dwordx4 a[24:27], v0, s[32:35], s99 offen offset:2048 sc1
v_mfma_f32_32x32x16_bf16 v[48:63], a[188:191], a[124:127], v[48:63]
ds_read_b64_tr_b16 a[180:181], v2 offset:20480
ds_read_b64_tr_b16 a[182:183], v2 offset:21504
v_or_b32 v118, v118, v117
v_or_b32 v119, v119, v117
s_add_u32 s5, s41, 147456
v_lshl_add_u32 v118, v118, 4, s5
s_waitcnt lgkmcnt(8)
s_waitcnt vmcnt(17)
v_mfma_f32_32x32x16_bf16 v[32:47], a[160:163], a[128:131], v[32:47]
ds_read_b64_tr_b16 a[184:185], v1 offset:22528
ds_read_b64_tr_b16 a[186:187], v1 offset:23552
buffer_load_dwordx4 v7, s[24:27], s52 offen offset:3072 lds
v_mfma_f32_32x32x16_bf16 v[48:63], a[164:167], a[128:131], v[48:63]
ds_read_b64_tr_b16 a[188:189], v2 offset:22528
ds_read_b64_tr_b16 a[190:191], v2 offset:23552
buffer_load_dwordx4 a[28:31], v0, s[32:35], s99 offen offset:3072 sc1
s_waitcnt lgkmcnt(8)
s_waitcnt vmcnt(18)
v_mfma_f32_32x32x16_bf16 v[32:47], a[168:171], a[132:135], v[32:47]
ds_read_b64_tr_b16 a[160:161], v1 offset:24576
ds_read_b64_tr_b16 a[162:163], v1 offset:25600
s_add_u32 s99, s98, 94208
v_lshl_add_u32 v119, v119, 4, s5
v_mov_b32 v216, 0xbfb8aa3b
v_mov_b32 v217, 0xbfb8aa3b
v_mfma_f32_32x32x16_bf16 v[48:63], a[172:175], a[132:135], v[48:63]
ds_read_b64_tr_b16 a[164:165], v2 offset:24576
ds_read_b64_tr_b16 a[166:167], v2 offset:25600
buffer_load_dwordx4 a[32:35], v0, s[32:35], s99 offen sc1
s_waitcnt lgkmcnt(8)
s_waitcnt vmcnt(18)
v_mfma_f32_32x32x16_bf16 v[32:47], a[176:179], a[136:139], v[32:47]
ds_read_b64_tr_b16 a[168:169], v1 offset:26624
ds_read_b64_tr_b16 a[170:171], v1 offset:27648
buffer_load_dwordx4 a[36:39], v0, s[32:35], s99 offen offset:1024 sc1
v_xor_b32 v220, 0, v116
v_mfma_f32_32x32x16_bf16 v[48:63], a[180:183], a[136:139], v[48:63]
ds_read_b64_tr_b16 a[172:173], v2 offset:26624
ds_read_b64_tr_b16 a[174:175], v2 offset:27648
v_xor_b32 v221, 16, v116
v_xor_b32 v222, 32, v116
v_xor_b32 v223, 48, v116
s_waitcnt lgkmcnt(8)
s_waitcnt vmcnt(18)
v_mfma_f32_32x32x16_bf16 v[32:47], a[184:187], a[140:143], v[32:47]
ds_read_b64_tr_b16 a[176:177], v1 offset:28672
ds_read_b64_tr_b16 a[178:179], v1 offset:29696
buffer_load_dword v29, off, s[32:35], s6 offset:256 sc1
v_xor_b32 v224, 64, v116
v_mfma_f32_32x32x16_bf16 v[48:63], a[188:191], a[140:143], v[48:63]
ds_read_b64_tr_b16 a[180:181], v2 offset:28672
ds_read_b64_tr_b16 a[182:183], v2 offset:29696
buffer_load_dwordx4 a[40:43], v0, s[32:35], s99 offen offset:2048 sc1
s_waitcnt lgkmcnt(8)
s_waitcnt vmcnt(19)
v_mfma_f32_32x32x16_bf16 v[32:47], a[160:163], a[144:147], v[32:47]
ds_read_b64_tr_b16 a[184:185], v1 offset:30720
ds_read_b64_tr_b16 a[186:187], v1 offset:31744
buffer_load_dwordx4 a[44:47], v0, s[32:35], s99 offen offset:3072 sc1
v_xor_b32 v225, 80, v116
v_mfma_f32_32x32x16_bf16 v[48:63], a[164:167], a[144:147], v[48:63]
ds_read_b64_tr_b16 a[188:189], v2 offset:30720
ds_read_b64_tr_b16 a[190:191], v2 offset:31744
s_add_u32 s99, s98, 102400
v_xor_b32 v226, 96, v116
v_xor_b32 v227, 112, v116
s_waitcnt lgkmcnt(8)
s_waitcnt vmcnt(18)
v_mfma_f32_32x32x16_bf16 v[32:47], a[168:171], a[148:151], v[32:47]
s_barrier
v_add_u32 v1, 65536, v1
v_add_u32 v2, 65536, v2
ds_read_b64_tr_b16 a[160:161], v1 offset:16384
ds_read_b64_tr_b16 a[162:163], v1 offset:17408
v_mfma_f32_32x32x16_bf16 v[48:63], a[172:175], a[148:151], v[48:63]
ds_read_b64_tr_b16 a[164:165], v2 offset:16384
ds_read_b64_tr_b16 a[166:167], v2 offset:17408
buffer_load_dwordx4 a[48:51], v0, s[32:35], s99 offen sc1
s_waitcnt lgkmcnt(8)
s_waitcnt vmcnt(18)
v_mfma_f32_32x32x16_bf16 v[32:47], a[176:179], a[152:155], v[32:47]
ds_read_b64_tr_b16 a[168:169], v1 offset:18432
ds_read_b64_tr_b16 a[170:171], v1 offset:19456
buffer_load_dwordx4 a[52:55], v0, s[32:35], s99 offen offset:1024 sc1
v_mfma_f32_32x32x16_bf16 v[48:63], a[180:183], a[152:155], v[48:63]
ds_read_b64_tr_b16 a[172:173], v2 offset:18432
ds_read_b64_tr_b16 a[174:175], v2 offset:19456
s_waitcnt lgkmcnt(8)
s_waitcnt vmcnt(18)
v_mfma_f32_32x32x16_bf16 v[32:47], a[184:187], a[156:159], v[32:47]
ds_read_b64_tr_b16 a[176:177], v1 offset:20480
ds_read_b64_tr_b16 a[178:179], v1 offset:21504
buffer_load_dwordx4 a[56:59], v0, s[32:35], s99 offen offset:2048 sc1
v_mfma_f32_32x32x16_bf16 v[48:63], a[188:191], a[156:159], v[48:63]
ds_read_b64_tr_b16 a[180:181], v2 offset:20480
ds_read_b64_tr_b16 a[182:183], v2 offset:21504
s_waitcnt lgkmcnt(8)
s_waitcnt vmcnt(17)
v_mfma_f32_32x32x16_bf16 v[32:47], a[160:163], a[0:3], v[32:47]
ds_read_b64_tr_b16 a[184:185], v1 offset:22528
ds_read_b64_tr_b16 a[186:187], v1 offset:23552
buffer_load_dwordx4 a[60:63], v0, s[32:35], s99 offen offset:3072 sc1
v_mfma_f32_32x32x16_bf16 v[48:63], a[164:167], a[0:3], v[48:63]
ds_read_b64_tr_b16 a[188:189], v2 offset:22528
ds_read_b64_tr_b16 a[190:191], v2 offset:23552
s_waitcnt vmcnt(6)
v_cmp_gt_u32 vcc, 3, v29
s_nop 1
s_cbranch_vccnz L_pw76
L_pr78:
s_add_u32 s99, s98, 32768
s_waitcnt lgkmcnt(8)
v_mfma_f32_32x32x16_bf16 v[32:47], a[168:171], a[4:7], v[32:47]
ds_read_b64_tr_b16 a[160:161], v1 offset:24576
ds_read_b64_tr_b16 a[162:163], v1 offset:25600
buffer_load_dwordx4 a[64:67], v0, s[32:35], s99 offen sc1
v_mfma_f32_32x32x16_bf16 v[48:63], a[172:175], a[4:7], v[48:63]
ds_read_b64_tr_b16 a[164:165], v2 offset:24576
ds_read_b64_tr_b16 a[166:167], v2 offset:25600
s_waitcnt lgkmcnt(8)
v_mfma_f32_32x32x16_bf16 v[32:47], a[176:179], a[8:11], v[32:47]
ds_read_b64_tr_b16 a[168:169], v1 offset:26624
ds_read_b64_tr_b16 a[170:171], v1 offset:27648
buffer_load_dwordx4 a[68:71], v0, s[32:35], s99 offen offset:1024 sc1
v_mfma_f32_32x32x16_bf16 v[48:63], a[180:183], a[8:11], v[48:63]
ds_read_b64_tr_b16 a[172:173], v2 offset:26624
ds_read_b64_tr_b16 a[174:175], v2 offset:27648
buffer_load_dword v29, off, s[32:35], s6 offset:384 sc1
s_waitcnt lgkmcnt(8)
v_mfma_f32_32x32x16_bf16 v[32:47], a[184:187], a[12:15], v[32:47]
ds_read_b64_tr_b16 a[176:177], v1 offset:28672
ds_read_b64_tr_b16 a[178:179], v1 offset:29696
buffer_load_dwordx4 a[72:75], v0, s[32:35], s99 offen offset:2048 sc1
v_mfma_f32_32x32x16_bf16 v[48:63], a[188:191], a[12:15], v[48:63]
ds_read_b64_tr_b16 a[180:181], v2 offset:28672
ds_read_b64_tr_b16 a[182:183], v2 offset:29696
s_waitcnt lgkmcnt(8)
v_mfma_f32_32x32x16_bf16 v[32:47], a[160:163], a[16:19], v[32:47]
ds_read_b64_tr_b16 a[184:185], v1 offset:30720
ds_read_b64_tr_b16 a[186:187], v1 offset:31744
buffer_load_dwordx4 a[76:79], v0, s[32:35], s99 offen offset:3072 sc1
v_mfma_f32_32x32x16_bf16 v[48:63], a[164:167], a[16:19], v[48:63]
ds_read_b64_tr_b16 a[188:189], v2 offset:30720
ds_read_b64_tr_b16 a[190:191], v2 offset:31744
s_add_u32 s99, s98, 69632
s_waitcnt lgkmcnt(8)
v_mfma_f32_32x32x16_bf16 v[32:47], a[168:171], a[20:23], v[32:47]
s_barrier
v_subrev_u32 v1, 65536, v1
v_subrev_u32 v2, 65536, v2
ds_read_b64_tr_b16 a[160:161], v1 offset:32768
ds_read_b64_tr_b16 a[162:163], v1 offset:33792
v_mfma_f32_32x32x16_bf16 v[48:63], a[172:175], a[20:23], v[48:63]
ds_read_b64_tr_b16 a[164:165], v2 offset:32768
ds_read_b64_tr_b16 a[166:167], v2 offset:33792
buffer_load_dwordx4 a[80:83], v0, s[32:35], s99 offen sc1
s_waitcnt lgkmcnt(8)
v_mfma_f32_32x32x16_bf16 v[32:47], a[176:179], a[24:27], v[32:47]
ds_read_b64_tr_b16 a[168:169], v1 offset:34816
ds_read_b64_tr_b16 a[170:171], v1 offset:35840
buffer_load_dwordx4 a[84:87], v0, s[32:35], s99 offen offset:1024 sc1
v_mfma_f32_32x32x16_bf16 v[48:63], a[180:183], a[24:27], v[48:63]
ds_read_b64_tr_b16 a[172:173], v2 offset:34816
ds_read_b64_tr_b16 a[174:175], v2 offset:35840
s_waitcnt lgkmcnt(8)
v_mfma_f32_32x32x16_bf16 v[32:47], a[184:187], a[28:31], v[32:47]
ds_read_b64_tr_b16 a[176:177], v1 offset:36864
ds_read_b64_tr_b16 a[178:179], v1 offset:37888
buffer_load_dwordx4 a[88:91], v0, s[32:35], s99 offen offset:2048 sc1
v_mfma_f32_32x32x16_bf16 v[48:63], a[188:191], a[28:31], v[48:63]
ds_read_b64_tr_b16 a[180:181], v2 offset:36864
ds_read_b64_tr_b16 a[182:183], v2 offset:37888
s_waitcnt lgkmcnt(8)
v_mfma_f32_32x32x16_bf16 v[32:47], a[160:163], a[32:35], v[32:47]
ds_read_b64_tr_b16 a[184:185], v1 offset:38912
ds_read_b64_tr_b16 a[186:187], v1 offset:39936
buffer_load_dwordx4 a[92:95], v0, s[32:35], s99 offen offset:3072 sc1
v_mfma_f32_32x32x16_bf16 v[48:63], a[164:167], a[32:35], v[48:63]
ds_read_b64_tr_b16 a[188:189], v2 offset:38912
ds_read_b64_tr_b16 a[190:191], v2 offset:39936
s_add_u32 s99, s98, 106496
s_waitcnt lgkmcnt(8)
v_mfma_f32_32x32x16_bf16 v[32:47], a[168:171], a[36:39], v[32:47]
ds_read_b64_tr_b16 a[160:161], v1 offset:40960
ds_read_b64_tr_b16 a[162:163], v1 offset:41984
buffer_load_dwordx4 a[96:99], v0, s[32:35], s99 offen sc1
v_mfma_f32_32x32x16_bf16 v[48:63], a[172:175], a[36:39], v[48:63]
ds_read_b64_tr_b16 a[164:165], v2 offset:40960
ds_read_b64_tr_b16 a[166:167], v2 offset:41984
s_waitcnt vmcnt(7)
v_cmp_gt_u32 vcc, 4, v29
s_nop 1
s_cbranch_vccnz L_pw79
L_pr81:
buffer_load_dwordx4 v[96:99], v0, s[32:35], s4 offen sc1
buffer_load_dwordx4 v[100:103], v0, s[32:35], s4 offen offset:1024 sc1
buffer_load_dwordx4 v[104:107], v0, s[32:35], s4 offen offset:2048 sc1
buffer_load_dwordx4 v[108:111], v0, s[32:35], s4 offen offset:3072 sc1
s_waitcnt lgkmcnt(8)
v_mfma_f32_32x32x16_bf16 v[32:47], a[176:179], a[40:43], v[32:47]
ds_read_b64_tr_b16 a[168:169], v1 offset:43008
ds_read_b64_tr_b16 a[170:171], v1 offset:44032
buffer_load_dwordx4 a[100:103], v0, s[32:35], s99 offen offset:1024 sc1
v_mfma_f32_32x32x16_bf16 v[48:63], a[180:183], a[40:43], v[48:63]
ds_read_b64_tr_b16 a[172:173], v2 offset:43008
ds_read_b64_tr_b16 a[174:175], v2 offset:44032
s_waitcnt lgkmcnt(8)
v_mfma_f32_32x32x16_bf16 v[32:47], a[184:187], a[44:47], v[32:47]
ds_read_b64_tr_b16 a[176:177], v1 offset:45056
ds_read_b64_tr_b16 a[178:179], v1 offset:46080
buffer_load_dwordx4 a[104:107], v0, s[32:35], s99 offen offset:2048 sc1
v_mfma_f32_32x32x16_bf16 v[48:63], a[188:191], a[44:47], v[48:63]
ds_read_b64_tr_b16 a[180:181], v2 offset:45056
ds_read_b64_tr_b16 a[182:183], v2 offset:46080
s_waitcnt lgkmcnt(8)
v_mfma_f32_32x32x16_bf16 v[32:47], a[160:163], a[48:51], v[32:47]
ds_read_b64_tr_b16 a[184:185], v1 offset:47104
ds_read_b64_tr_b16 a[186:187], v1 offset:48128
buffer_load_dwordx4 a[108:111], v0, s[32:35], s99 offen offset:3072 sc1
v_mfma_f32_32x32x16_bf16 v[48:63], a[164:167], a[48:51], v[48:63]
ds_read_b64_tr_b16 a[188:189], v2 offset:47104
ds_read_b64_tr_b16 a[190:191], v2 offset:48128
s_waitcnt lgkmcnt(8)
v_mfma_f32_32x32x16_bf16 v[32:47], a[168:171], a[52:55], v[32:47]
s_barrier
ds_read_b64_tr_b16 a[160:161], v1 offset:49152
ds_read_b64_tr_b16 a[162:163], v1 offset:50176
v_mfma_f32_32x32x16_bf16 v[48:63], a[172:175], a[52:55], v[48:63]
s_waitcnt lgkmcnt(6)
v_mfma_f32_32x32x16_bf16 v[32:47], a[176:179], a[56:59], v[32:47]
ds_read_b64_tr_b16 a[168:169], v1 offset:51200
ds_read_b64_tr_b16 a[170:171], v1 offset:52224
s_waitcnt vmcnt(6)
v_lshlrev_b32 v152, 16, v96
v_and_b32 v153, 0xffff0000, v96
v_lshlrev_b32 v154, 16, v97
v_mfma_f32_32x32x16_bf16 v[48:63], a[180:183], a[56:59], v[48:63]
v_and_b32 v155, 0xffff0000, v97
v_lshlrev_b32 v156, 16, v98
v_and_b32 v157, 0xffff0000, v98
v_lshlrev_b32 v158, 16, v99
s_waitcnt lgkmcnt(4)
v_mfma_f32_32x32x16_bf16 v[32:47], a[184:187], a[60:63], v[32:47]
ds_read_b64_tr_b16 a[176:177], v1 offset:53248
ds_read_b64_tr_b16 a[178:179], v1 offset:54272
v_and_b32 v159, 0xffff0000, v99
s_waitcnt vmcnt(5)
v_lshlrev_b32 v160, 16, v100
v_and_b32 v161, 0xffff0000, v100
v_mfma_f32_32x32x16_bf16 v[48:63], a[188:191], a[60:63], v[48:63]
v_lshlrev_b32 v162, 16, v101
v_and_b32 v163, 0xffff0000, v101
v_lshlrev_b32 v164, 16, v102
v_and_b32 v165, 0xffff0000, v102
s_waitcnt lgkmcnt(4)
v_mfma_f32_32x32x16_bf16 v[32:47], a[160:163], a[64:67], v[32:47]
ds_read_b64_tr_b16 a[184:185], v1 offset:55296
ds_read_b64_tr_b16 a[186:187], v1 offset:56320
v_lshlrev_b32 v166, 16, v103
v_and_b32 v167, 0xffff0000, v103
s_waitcnt lgkmcnt(4)
v_mfma_f32_32x32x16_bf16 v[32:47], a[168:171], a[68:71], v[32:47]
ds_read_b64_tr_b16 a[160:161], v1 offset:57344
ds_read_b64_tr_b16 a[162:163], v1 offset:58368
s_waitcnt vmcnt(4)
v_lshlrev_b32 v168, 16, v104
v_and_b32 v169, 0xffff0000, v104
s_waitcnt lgkmcnt(4)
v_mfma_f32_32x32x16_bf16 v[32:47], a[176:179], a[72:75], v[32:47]
ds_read_b64_tr_b16 a[168:169], v1 offset:59392
ds_read_b64_tr_b16 a[170:171], v1 offset:60416
v_lshlrev_b32 v170, 16, v105
v_and_b32 v171, 0xffff0000, v105
s_waitcnt lgkmcnt(4)
v_mfma_f32_32x32x16_bf16 v[32:47], a[184:187], a[76:79], v[32:47]
ds_read_b64_tr_b16 a[176:177], v1 offset:61440
ds_read_b64_tr_b16 a[178:179], v1 offset:62464
v_lshlrev_b32 v172, 16, v106
v_and_b32 v173, 0xffff0000, v106
s_waitcnt lgkmcnt(4)
v_mfma_f32_32x32x16_bf16 v[32:47], a[160:163], a[80:83], v[32:47]
ds_read_b64_tr_b16 a[184:185], v1 offset:63488
ds_read_b64_tr_b16 a[186:187], v1 offset:64512
v_lshlrev_b32 v174, 16, v107
v_and_b32 v175, 0xffff0000, v107
s_waitcnt lgkmcnt(4)
v_mfma_f32_32x32x16_bf16 v[32:47], a[168:171], a[84:87], v[32:47]
s_barrier
v_add_u32 v1, 65536, v1
v_add_u32 v2, 65536, v2
ds_read_b64_tr_b16 a[160:161], v1 offset:0
ds_read_b64_tr_b16 a[162:163], v1 offset:1024
s_waitcnt lgkmcnt(4)
v_mfma_f32_32x32x16_bf16 v[32:47], a[176:179], a[88:91], v[32:47]
ds_read_b64_tr_b16 a[168:169], v1 offset:2048
ds_read_b64_tr_b16 a[170:171], v1 offset:3072
s_waitcnt vmcnt(3)
v_lshlrev_b32 v176, 16, v108
v_and_b32 v177, 0xffff0000, v108
s_waitcnt lgkmcnt(4)
v_mfma_f32_32x32x16_bf16 v[32:47], a[184:187], a[92:95], v[32:47]
ds_read_b64_tr_b16 a[176:177], v1 offset:4096
ds_read_b64_tr_b16 a[178:179], v1 offset:5120
v_lshlrev_b32 v178, 16, v109
v_and_b32 v179, 0xffff0000, v109
s_waitcnt lgkmcnt(4)
v_mfma_f32_32x32x16_bf16 v[32:47], a[160:163], a[96:99], v[32:47]
ds_read_b64_tr_b16 a[184:185], v1 offset:6144
ds_read_b64_tr_b16 a[186:187], v1 offset:7168
v_lshlrev_b32 v180, 16, v110
v_and_b32 v181, 0xffff0000, v110
s_waitcnt lgkmcnt(4)
s_waitcnt vmcnt(2)
v_mfma_f32_32x32x16_bf16 v[32:47], a[168:171], a[100:103], v[32:47]
v_subrev_u32 v1, 65536, v1
v_subrev_u32 v2, 65536, v2
ds_read_b64_tr_b16 a[160:161], v2 offset:49152
ds_read_b64_tr_b16 a[162:163], v2 offset:50176
s_waitcnt lgkmcnt(4)
s_waitcnt vmcnt(1)
v_mfma_f32_32x32x16_bf16 v[32:47], a[176:179], a[104:107], v[32:47]
ds_read_b64_tr_b16 a[168:169], v2 offset:51200
ds_read_b64_tr_b16 a[170:171], v2 offset:52224
v_lshlrev_b32 v182, 16, v111
v_and_b32 v183, 0xffff0000, v111
s_waitcnt lgkmcnt(4)
s_waitcnt vmcnt(0)
v_mfma_f32_32x32x16_bf16 v[32:47], a[184:187], a[108:111], v[32:47]
ds_read_b64_tr_b16 a[176:177], v2 offset:53248
ds_read_b64_tr_b16 a[178:179], v2 offset:54272
s_waitcnt lgkmcnt(4)
v_mfma_f32_32x32x16_bf16 v[48:63], a[160:163], a[64:67], v[48:63]
ds_read_b64_tr_b16 a[184:185], v2 offset:55296
ds_read_b64_tr_b16 a[186:187], v2 offset:56320
s_waitcnt lgkmcnt(4)
v_mfma_f32_32x32x16_bf16 v[48:63], a[168:171], a[68:71], v[48:63]
ds_read_b64_tr_b16 a[160:161], v2 offset:57344
ds_read_b64_tr_b16 a[162:163], v2 offset:58368
s_nop 1
v_add_f32 v32, v120, v32
v_add_f32 v33, v121, v33
v_add_f32 v34, v122, v34
v_add_f32 v35, v123, v35
v_add_f32 v36, v124, v36
v_add_f32 v37, v125, v37
v_add_f32 v38, v126, v38
v_add_f32 v39, v127, v39
v_mul_f32 v232, v216, v32
v_mul_f32 v233, v216, v33
v_mul_f32 v234, v216, v34
v_mul_f32 v235, v216, v35
v_mul_f32 v236, v216, v36
v_mul_f32 v237, v216, v37
s_waitcnt lgkmcnt(4)
v_mfma_f32_32x32x16_bf16 v[48:63], a[176:179], a[72:75], v[48:63]
ds_read_b64_tr_b16 a[168:169], v2 offset:59392
ds_read_b64_tr_b16 a[170:171], v2 offset:60416
v_mul_f32 v238, v216, v38
v_mul_f32 v239, v216, v39
v_exp_f32 v232, v232
v_exp_f32 v233, v233
v_exp_f32 v234, v234
v_exp_f32 v235, v235
v_exp_f32 v236, v236
v_exp_f32 v237, v237
s_waitcnt lgkmcnt(4)
v_mfma_f32_32x32x16_bf16 v[48:63], a[184:187], a[76:79], v[48:63]
ds_read_b64_tr_b16 a[176:177], v2 offset:61440
ds_read_b64_tr_b16 a[178:179], v2 offset:62464
v_exp_f32 v238, v238
v_exp_f32 v239, v239
v_mul_f32 v32, v152, v32
v_mul_f32 v33, v153, v33
v_mul_f32 v34, v154, v34
v_mul_f32 v35, v155, v35
v_mul_f32 v36, v156, v36
v_mul_f32 v37, v157, v37
v_mul_f32 v38, v158, v38
v_mul_f32 v39, v159, v39
v_add_f32 v232, 1.0, v232
s_waitcnt lgkmcnt(4)
v_mfma_f32_32x32x16_bf16 v[48:63], a[160:163], a[80:83], v[48:63]
ds_read_b64_tr_b16 a[184:185], v2 offset:63488
ds_read_b64_tr_b16 a[186:187], v2 offset:64512
v_add_f32 v233, 1.0, v233
v_add_f32 v234, 1.0, v234
v_add_f32 v235, 1.0, v235
v_add_f32 v236, 1.0, v236
v_add_f32 v237, 1.0, v237
v_add_f32 v238, 1.0, v238
v_add_f32 v239, 1.0, v239
v_rcp_f32 v232, v232
v_rcp_f32 v233, v233
v_rcp_f32 v234, v234
s_waitcnt lgkmcnt(4)
v_mfma_f32_32x32x16_bf16 v[48:63], a[168:171], a[84:87], v[48:63]
v_add_u32 v1, 65536, v1
v_add_u32 v2, 65536, v2
ds_read_b64_tr_b16 a[160:161], v2 offset:0
ds_read_b64_tr_b16 a[162:163], v2 offset:1024
v_rcp_f32 v235, v235
v_rcp_f32 v236, v236
v_rcp_f32 v237, v237
v_rcp_f32 v238, v238
v_rcp_f32 v239, v239
v_fma_f32 v32, v232, v32, v184
v_fma_f32 v33, v233, v33, v185
v_fma_f32 v34, v234, v34, v186
s_waitcnt lgkmcnt(4)
v_mfma_f32_32x32x16_bf16 v[48:63], a[176:179], a[88:91], v[48:63]
ds_read_b64_tr_b16 a[168:169], v2 offset:2048
ds_read_b64_tr_b16 a[170:171], v2 offset:3072
v_fma_f32 v35, v235, v35, v187
v_fma_f32 v36, v236, v36, v188
v_fma_f32 v37, v237, v37, v189
v_fma_f32 v38, v238, v38, v190
v_fma_f32 v39, v239, v39, v191
v_cvt_pk_bf16_f32 v32, v32, v33
v_cvt_pk_bf16_f32 v33, v34, v35
v_cvt_pk_bf16_f32 v34, v36, v37
v_cvt_pk_bf16_f32 v35, v38, v39
ds_write_b64 v220, v[32:33]
ds_write_b64 v221, v[34:35]
v_add_f32 v40, v128, v40
v_add_f32 v41, v129, v41
s_waitcnt lgkmcnt(6)
v_mfma_f32_32x32x16_bf16 v[48:63], a[184:187], a[92:95], v[48:63]
ds_read_b64_tr_b16 a[176:177], v2 offset:4096
ds_read_b64_tr_b16 a[178:179], v2 offset:5120
v_add_f32 v42, v130, v42
v_add_f32 v43, v131, v43
v_add_f32 v44, v132, v44
v_add_f32 v45, v133, v45
v_add_f32 v46, v134, v46
v_add_f32 v47, v135, v47
v_mul_f32 v232, v216, v40
v_mul_f32 v233, v216, v41
v_mul_f32 v234, v216, v42
v_mul_f32 v235, v216, v43
v_mul_f32 v236, v216, v44
v_mul_f32 v237, v216, v45
v_mul_f32 v238, v216, v46
v_mul_f32 v239, v216, v47
s_waitcnt lgkmcnt(6)
v_mfma_f32_32x32x16_bf16 v[48:63], a[160:163], a[96:99], v[48:63]
ds_read_b64_tr_b16 a[184:185], v2 offset:6144
ds_read_b64_tr_b16 a[186:187], v2 offset:7168
v_exp_f32 v232, v232
v_exp_f32 v233, v233
v_exp_f32 v234, v234
v_exp_f32 v235, v235
v_exp_f32 v236, v236
v_exp_f32 v237, v237
v_exp_f32 v238, v238
s_waitcnt lgkmcnt(6)
v_mfma_f32_32x32x16_bf16 v[48:63], a[168:171], a[100:103], v[48:63]
v_exp_f32 v239, v239
v_mul_f32 v40, v160, v40
v_mul_f32 v41, v161, v41
v_mul_f32 v42, v162, v42
v_mul_f32 v43, v163, v43
v_mul_f32 v44, v164, v44
v_mul_f32 v45, v165, v45
v_mul_f32 v46, v166, v46
v_mul_f32 v47, v167, v47
v_add_f32 v232, 1.0, v232
v_add_f32 v233, 1.0, v233
v_add_f32 v234, 1.0, v234
v_add_f32 v235, 1.0, v235
v_add_f32 v236, 1.0, v236
v_add_f32 v237, 1.0, v237
s_waitcnt lgkmcnt(2)
v_mfma_f32_32x32x16_bf16 v[48:63], a[176:179], a[104:107], v[48:63]
v_add_f32 v238, 1.0, v238
v_add_f32 v239, 1.0, v239
v_rcp_f32 v232, v232
v_rcp_f32 v233, v233
v_rcp_f32 v234, v234
v_rcp_f32 v235, v235
v_rcp_f32 v236, v236
v_rcp_f32 v237, v237
v_rcp_f32 v238, v238
s_waitcnt lgkmcnt(0)
v_mfma_f32_32x32x16_bf16 v[48:63], a[184:187], a[108:111], v[48:63]
v_rcp_f32 v239, v239
v_fma_f32 v40, v232, v40, v192
v_fma_f32 v41, v233, v41, v193
v_fma_f32 v42, v234, v42, v194
v_fma_f32 v43, v235, v43, v195
v_fma_f32 v44, v236, v44, v196
v_fma_f32 v45, v237, v45, v197
v_fma_f32 v46, v238, v46, v198
v_fma_f32 v47, v239, v47, v199
v_cvt_pk_bf16_f32 v40, v40, v41
v_cvt_pk_bf16_f32 v41, v42, v43
v_cvt_pk_bf16_f32 v42, v44, v45
v_cvt_pk_bf16_f32 v43, v46, v47
ds_write_b64 v222, v[40:41]
ds_write_b64 v223, v[42:43]
v_pk_add_f32 v[48:49], v[48:49], v[136:137]
v_pk_add_f32 v[50:51], v[50:51], v[138:139]
v_pk_add_f32 v[52:53], v[52:53], v[140:141]
v_pk_add_f32 v[54:55], v[54:55], v[142:143]
v_pk_mul_f32 v[232:233], v[48:49], v[216:217]
v_pk_mul_f32 v[234:235], v[50:51], v[216:217]
v_pk_mul_f32 v[236:237], v[52:53], v[216:217]
v_pk_mul_f32 v[238:239], v[54:55], v[216:217]
v_exp_f32 v232, v232
v_exp_f32 v233, v233
v_exp_f32 v234, v234
v_exp_f32 v235, v235
v_exp_f32 v236, v236
v_exp_f32 v237, v237
v_exp_f32 v238, v238
v_exp_f32 v239, v239
v_pk_mul_f32 v[48:49], v[48:49], v[168:169]
v_pk_mul_f32 v[50:51], v[50:51], v[170:171]
v_pk_mul_f32 v[52:53], v[52:53], v[172:173]
v_pk_mul_f32 v[54:55], v[54:55], v[174:175]
v_pk_add_f32 v[232:233], v[232:233], 1.0 op_sel_hi:[1,0]
v_pk_add_f32 v[234:235], v[234:235], 1.0 op_sel_hi:[1,0]
v_pk_add_f32 v[236:237], v[236:237], 1.0 op_sel_hi:[1,0]
v_pk_add_f32 v[238:239], v[238:239], 1.0 op_sel_hi:[1,0]
v_rcp_f32 v232, v232
v_rcp_f32 v233, v233
v_rcp_f32 v234, v234
v_rcp_f32 v235, v235
v_rcp_f32 v236, v236
v_rcp_f32 v237, v237
v_rcp_f32 v238, v238
v_rcp_f32 v239, v239
v_pk_fma_f32 v[48:49], v[48:49], v[232:233], v[200:201]
v_pk_fma_f32 v[50:51], v[50:51], v[234:235], v[202:203]
v_pk_fma_f32 v[52:53], v[52:53], v[236:237], v[204:205]
v_pk_fma_f32 v[54:55], v[54:55], v[238:239], v[206:207]
v_cvt_pk_bf16_f32 v48, v48, v49
v_cvt_pk_bf16_f32 v49, v50, v51
v_cvt_pk_bf16_f32 v50, v52, v53
v_cvt_pk_bf16_f32 v51, v54, v55
ds_write_b64 v224, v[48:49]
ds_write_b64 v225, v[50:51]
v_pk_add_f32 v[56:57], v[56:57], v[144:145]
v_pk_add_f32 v[58:59], v[58:59], v[146:147]
v_pk_add_f32 v[60:61], v[60:61], v[148:149]
v_pk_add_f32 v[62:63], v[62:63], v[150:151]
v_pk_mul_f32 v[232:233], v[56:57], v[216:217]
v_pk_mul_f32 v[234:235], v[58:59], v[216:217]
v_pk_mul_f32 v[236:237], v[60:61], v[216:217]
v_pk_mul_f32 v[238:239], v[62:63], v[216:217]
v_exp_f32 v232, v232
v_exp_f32 v233, v233
v_exp_f32 v234, v234
v_exp_f32 v235, v235
v_exp_f32 v236, v236
v_exp_f32 v237, v237
v_exp_f32 v238, v238
v_exp_f32 v239, v239
v_pk_mul_f32 v[56:57], v[56:57], v[176:177]
v_pk_mul_f32 v[58:59], v[58:59], v[178:179]
v_pk_mul_f32 v[60:61], v[60:61], v[180:181]
v_pk_mul_f32 v[62:63], v[62:63], v[182:183]
v_pk_add_f32 v[232:233], v[232:233], 1.0 op_sel_hi:[1,0]
v_pk_add_f32 v[234:235], v[234:235], 1.0 op_sel_hi:[1,0]
v_pk_add_f32 v[236:237], v[236:237], 1.0 op_sel_hi:[1,0]
v_pk_add_f32 v[238:239], v[238:239], 1.0 op_sel_hi:[1,0]
v_rcp_f32 v232, v232
v_rcp_f32 v233, v233
v_rcp_f32 v234, v234
v_rcp_f32 v235, v235
v_rcp_f32 v236, v236
v_rcp_f32 v237, v237
v_rcp_f32 v238, v238
v_rcp_f32 v239, v239
v_pk_fma_f32 v[56:57], v[56:57], v[232:233], v[208:209]
v_pk_fma_f32 v[58:59], v[58:59], v[234:235], v[210:211]
v_pk_fma_f32 v[60:61], v[60:61], v[236:237], v[212:213]
v_pk_fma_f32 v[62:63], v[62:63], v[238:239], v[214:215]
v_cvt_pk_bf16_f32 v56, v56, v57
v_cvt_pk_bf16_f32 v57, v58, v59
v_cvt_pk_bf16_f32 v58, v60, v61
v_cvt_pk_bf16_f32 v59, v62, v63
ds_write_b64 v226, v[56:57]
ds_write_b64 v227, v[58:59]
s_waitcnt lgkmcnt(0)
ds_read_b128 v[96:99], v118 offset:0
ds_read_b128 v[100:103], v119 offset:1024
ds_read_b128 v[104:107], v118 offset:2048
ds_read_b128 v[108:111], v119 offset:3072
s_waitcnt lgkmcnt(3)
buffer_store_dwordx4 v[96:99], v112, s[28:31], s55 offen
s_waitcnt lgkmcnt(2)
buffer_store_dwordx4 v[100:103], v113, s[28:31], s55 offen
s_waitcnt lgkmcnt(1)
buffer_store_dwordx4 v[104:107], v114, s[28:31], s55 offen
s_waitcnt lgkmcnt(0)
buffer_store_dwordx4 v[108:111], v115, s[28:31], s55 offen
s_endpgm
L_s4id:
s_cmp_eq_u32 s56, 0
s_cbranch_scc0 L_s4done
s_barrier
s_waitcnt vmcnt(12)
buffer_atomic_add v14, v13, s[32:35], s47 offen sc1
s_mov_b32 s47, 1073741824
s_barrier
s_barrier
s_add_u32 m0, s41, 147456
s_add_u32 s52, s55, 1556480
buffer_load_dwordx4 v4, s[24:27], s52 offen lds
buffer_load_dwordx4 v5, s[24:27], s52 offen offset:1024 lds
buffer_load_dwordx4 v6, s[24:27], s52 offen offset:2048 lds
buffer_load_dwordx4 v7, s[24:27], s52 offen offset:3072 lds
s_barrier
s_barrier
s_add_u32 m0, s41, 98304
s_add_u32 s52, s55, 1884160
buffer_load_dwordx4 v4, s[24:27], s52 offen lds
buffer_load_dwordx4 v5, s[24:27], s52 offen offset:1024 lds
buffer_load_dwordx4 v6, s[24:27], s52 offen offset:2048 lds
buffer_load_dwordx4 v7, s[24:27], s52 offen offset:3072 lds
s_barrier
s_barrier
s_movk_i32 s96, 1280
v_lshrrev_b32 v4, 3, v3
s_lshl_b32 s53, s40, 5
s_lshr_b32 s52, s40, 1
s_mul_i32 s52, s52, 512
s_add_u32 s53, s53, s52
v_add_u32 v4, s53, v4
v_bfe_u32 v5, v3, 4, 1
v_lshlrev_b32 v5, 2, v5
v_and_b32 v6, 7, v3
v_xor_b32 v5, v5, v6
v_lshlrev_b32 v5, 4, v5
v_mad_u32_u24 v4, v4, s96, v5
s_lshl_b32 s53, s96, 3
s_sub_u32 s53, s53, 1024
v_add_u32 v4, s56, v4
v_add_u32 v5, s53, v4
v_add_u32 v6, s53, v5
v_add_u32 v7, s53, v6
s_lshl_b32 s53, s96, 6
s_add_u32 m0, s41, 114688
s_add_u32 s52, s55, 655360
buffer_load_dwordx4 v4, s[24:27], s52 offen lds
buffer_load_dwordx4 v5, s[24:27], s52 offen offset:1024 lds
buffer_load_dwordx4 v6, s[24:27], s52 offen offset:2048 lds
buffer_load_dwordx4 v7, s[24:27], s52 offen offset:3072 lds
s_barrier
s_barrier
s_add_u32 m0, s41, 131072
s_add_u32 s52, s55, 2129920
buffer_load_dwordx4 v4, s[24:27], s52 offen lds
buffer_load_dwordx4 v5, s[24:27], s52 offen offset:1024 lds
buffer_load_dwordx4 v6, s[24:27], s52 offen offset:2048 lds
buffer_load_dwordx4 v7, s[24:27], s52 offen offset:3072 lds
s_barrier
s_waitcnt vmcnt(12)
s_barrier
s_waitcnt vmcnt(8)
s_barrier
s_waitcnt vmcnt(4)
s_barrier
s_waitcnt vmcnt(0)
s_barrier
L_s4done:
s_waitcnt vmcnt(0)
buffer_atomic_add v14, v13, s[32:35], s47 offen sc1
s_endpgm
L_pw2:
s_waitcnt vmcnt(0)
s_mov_b32 s97, 0
L_pl3:
buffer_load_dword v29, off, s[36:39], 0 offset:128 sc1
s_add_u32 s97, s97, 1
s_waitcnt vmcnt(0)
v_cmp_gt_u32 vcc, 1, v29
s_cmp_gt_u32 s97, 0x40000
s_cbranch_scc1 L_pr4
s_nop 1
s_cbranch_vccz L_pr4
s_sleep 2
s_branch L_pl3
L_pw6:
s_waitcnt vmcnt(0)
buffer_atomic_add v14, v13, s[32:35], s47 offen sc1
s_mov_b32 s47, 1073741824
s_mov_b32 s97, 0
L_pl7:
buffer_load_dword v29, off, s[32:35], s6 sc1
s_add_u32 s97, s97, 1
s_waitcnt vmcnt(0)
v_cmp_gt_u32 vcc, s3, v29
s_cmp_gt_u32 s97, 0x40000
s_cbranch_scc1 L_pr8
s_nop 1
s_cbranch_vccz L_pr8
s_sleep 2
s_branch L_pl7
L_pw9:
s_waitcnt vmcnt(0)
s_mov_b32 s97, 0
L_pl10:
buffer_load_dword v29, off, s[36:39], 0 offset:128 sc1
s_add_u32 s97, s97, 1
s_waitcnt vmcnt(0)
v_cmp_gt_u32 vcc, 1, v29
s_cmp_gt_u32 s97, 0x40000
s_cbranch_scc1 L_pr11
s_nop 1
s_cbranch_vccz L_pr11
s_sleep 2
s_branch L_pl10
L_pw13:
s_waitcnt vmcnt(0)
buffer_atomic_add v14, v13, s[32:35], s47 offen sc1
s_mov_b32 s47, 1073741824
s_mov_b32 s97, 0
L_pl14:
buffer_load_dword v29, off, s[32:35], s6 sc1
s_add_u32 s97, s97, 1
s_waitcnt vmcnt(0)
v_cmp_gt_u32 vcc, s3, v29
s_cmp_gt_u32 s97, 0x40000
s_cbranch_scc1 L_pr15
s_nop 1
s_cbranch_vccz L_pr15
s_sleep 2
s_branch L_pl14
L_pw16:
s_waitcnt vmcnt(0)
s_mov_b32 s97, 0
L_pl17:
buffer_load_dword v29, off, s[36:39], 0 offset:128 sc1
s_add_u32 s97, s97, 1
s_waitcnt vmcnt(0)
v_cmp_gt_u32 vcc, 1, v29
s_cmp_gt_u32 s97, 0x40000
s_cbranch_scc1 L_pr18
s_nop 1
s_cbranch_vccz L_pr18
s_sleep 2
s_branch L_pl17
L_pw20:
s_waitcnt vmcnt(0)
buffer_atomic_add v14, v13, s[32:35], s47 offen sc1
s_mov_b32 s47, 1073741824
s_mov_b32 s97, 0
L_pl21:
buffer_load_dword v29, off, s[32:35], s6 sc1
s_add_u32 s97, s97, 1
s_waitcnt vmcnt(0)
v_cmp_gt_u32 vcc, s3, v29
s_cmp_gt_u32 s97, 0x40000
s_cbranch_scc1 L_pr22
s_nop 1
s_cbranch_vccz L_pr22
s_sleep 2
s_branch L_pl21
L_pw23:
s_waitcnt vmcnt(0)
s_mov_b32 s97, 0
L_pl24:
buffer_load_dword v29, off, s[32:35], s6 offset:128 sc1
s_add_u32 s97, s97, 1
s_waitcnt vmcnt(0)
v_cmp_gt_u32 vcc, 4, v29
s_cmp_gt_u32 s97, 0x40000
s_cbranch_scc1 L_pr25
s_nop 1
s_cbranch_vccz L_pr25
s_sleep 2
s_branch L_pl24
L_pw26:
s_waitcnt vmcnt(0)
s_mov_b32 s97, 0
L_pl27:
buffer_load_dword v29, off, s[32:35], s6 offset:256 sc1
s_add_u32 s97, s97, 1
s_waitcnt vmcnt(0)
v_cmp_gt_u32 vcc, 4, v29
s_cmp_gt_u32 s97, 0x40000
s_cbranch_scc1 L_pr28
s_nop 1
s_cbranch_vccz L_pr28
s_sleep 2
s_branch L_pl27
L_pw29:
s_waitcnt vmcnt(0)
s_mov_b32 s97, 0
L_pl30:
buffer_load_dword v22, v20, s[32:35], 0 offen sc1
s_add_u32 s97, s97, 1
s_waitcnt vmcnt(0)
v_cmp_gt_u32 vcc, v21, v22
s_cmp_gt_u32 s97, 0x40000
s_cbranch_scc1 L_pr31
s_nop 1
s_cbranch_vccz L_pr31
s_sleep 2
s_branch L_pl30
L_pw32:
s_waitcnt vmcnt(0)
s_mov_b32 s97, 0
L_pl33:
buffer_load_dword v22, v20, s[32:35], 0 offen sc1
s_add_u32 s97, s97, 1
s_waitcnt vmcnt(0)
v_cmp_gt_u32 vcc, v21, v22
s_cmp_gt_u32 s97, 0x40000
s_cbranch_scc1 L_pr34
s_nop 1
s_cbranch_vccz L_pr34
s_sleep 2
s_branch L_pl33
L_pw35:
s_waitcnt vmcnt(0)
s_mov_b32 s97, 0
L_pl36:
buffer_load_dword v22, v20, s[32:35], 0 offen sc1
s_add_u32 s97, s97, 1
s_waitcnt vmcnt(0)
v_cmp_gt_u32 vcc, v21, v22
s_cmp_gt_u32 s97, 0x40000
s_cbranch_scc1 L_pr37
s_nop 1
s_cbranch_vccz L_pr37
s_sleep 2
s_branch L_pl36
L_pw38:
s_waitcnt vmcnt(0)
s_mov_b32 s97, 0
L_pl39:
buffer_load_dword v29, off, s[32:35], s6 offset:384 sc1
s_add_u32 s97, s97, 1
s_waitcnt vmcnt(0)
v_cmp_gt_u32 vcc, s5, v29
s_cmp_gt_u32 s97, 0x40000
s_cbranch_scc1 L_pr40
s_nop 1
s_cbranch_vccz L_pr40
s_sleep 2
s_branch L_pl39
L_pw45:
s_waitcnt vmcnt(0)
s_mov_b32 s97, 0
L_pl46:
buffer_load_dword v29, off, s[32:35], s6 offset:384 sc1
s_add_u32 s97, s97, 1
s_waitcnt vmcnt(0)
v_cmp_gt_u32 vcc, s5, v29
s_cmp_gt_u32 s97, 0x40000
s_cbranch_scc1 L_pr47
s_nop 1
s_cbranch_vccz L_pr47
s_sleep 2
s_branch L_pl46
L_pw53:
s_waitcnt vmcnt(0)
s_mov_b32 s97, 0
L_pl54:
buffer_load_dword v20, off, s[32:35], s76 sc1
s_add_u32 s97, s97, 1
s_waitcnt vmcnt(0)
v_cmp_gt_u32 vcc, 45, v20
s_cmp_gt_u32 s97, 0x40000
s_cbranch_scc1 L_pr55
s_nop 1
s_cbranch_vccz L_pr55
s_sleep 2
s_branch L_pl54
L_pw56:
s_waitcnt vmcnt(0)
buffer_atomic_add v14, v13, s[32:35], s47 offen sc1
s_mov_b32 s47, 1073741824
s_mov_b32 s97, 0
L_pl57:
buffer_load_dword v29, off, s[32:35], s6 sc1
s_add_u32 s97, s97, 1
s_waitcnt vmcnt(0)
v_cmp_gt_u32 vcc, s3, v29
s_cmp_gt_u32 s97, 0x40000
s_cbranch_scc1 L_pr58
s_nop 1
s_cbranch_vccz L_pr58
s_sleep 2
s_branch L_pl57
L_pw60:
s_waitcnt vmcnt(0)
s_mov_b32 s97, 0
L_pl61:
buffer_load_dword v20, off, s[32:35], s76 sc1
s_add_u32 s97, s97, 1
s_waitcnt vmcnt(0)
v_cmp_gt_u32 vcc, 45, v20
s_cmp_gt_u32 s97, 0x40000
s_cbranch_scc1 L_pr62
s_nop 1
s_cbranch_vccz L_pr62
s_sleep 2
s_branch L_pl61
L_pw63:
s_waitcnt vmcnt(0)
buffer_atomic_add v14, v13, s[32:35], s47 offen sc1
s_mov_b32 s47, 1073741824
s_mov_b32 s97, 0
L_pl64:
buffer_load_dword v29, off, s[32:35], s6 sc1
s_add_u32 s97, s97, 1
s_waitcnt vmcnt(0)
v_cmp_gt_u32 vcc, s3, v29
s_cmp_gt_u32 s97, 0x40000
s_cbranch_scc1 L_pr65
s_nop 1
s_cbranch_vccz L_pr65
s_sleep 2
s_branch L_pl64
L_pw66:
s_waitcnt vmcnt(0)
s_mov_b32 s97, 0
L_pl67:
buffer_load_dword v29, off, s[32:35], s6 sc1
s_add_u32 s97, s97, 1
s_waitcnt vmcnt(0)
v_cmp_gt_u32 vcc, 8, v29
s_cmp_gt_u32 s97, 0x40000
s_cbranch_scc1 L_pr68
s_nop 1
s_cbranch_vccz L_pr68
s_sleep 2
s_branch L_pl67
L_pw70:
s_waitcnt vmcnt(0)
buffer_atomic_add v14, v13, s[32:35], s47 offen sc1
s_mov_b32 s47, 1073741824
s_mov_b32 s97, 0
L_pl71:
buffer_load_dword v29, off, s[32:35], s6 sc1
s_add_u32 s97, s97, 1
s_waitcnt vmcnt(0)
v_cmp_gt_u32 vcc, s3, v29
s_cmp_gt_u32 s97, 0x40000
s_cbranch_scc1 L_pr72
s_nop 1
s_cbranch_vccz L_pr72
s_sleep 2
s_branch L_pl71
L_pw73:
s_waitcnt vmcnt(0)
s_mov_b32 s97, 0
L_pl74:
buffer_load_dword v29, off, s[32:35], s6 offset:128 sc1
s_add_u32 s97, s97, 1
s_waitcnt vmcnt(0)
v_cmp_gt_u32 vcc, 12, v29
s_cmp_gt_u32 s97, 0x40000
s_cbranch_scc1 L_pr75
s_nop 1
s_cbranch_vccz L_pr75
s_sleep 2
s_branch L_pl74
L_pw76:
s_waitcnt vmcnt(0)
s_mov_b32 s97, 0
L_pl77:
buffer_load_dword v29, off, s[32:35], s6 offset:256 sc1
s_add_u32 s97, s97, 1
s_waitcnt vmcnt(0)
v_cmp_gt_u32 vcc, 3, v29
s_cmp_gt_u32 s97, 0x40000
s_cbranch_scc1 L_pr78
s_nop 1
s_cbranch_vccz L_pr78
s_sleep 2
s_branch L_pl77
L_pw79:
s_waitcnt vmcnt(0)
s_mov_b32 s97, 0
L_pl80:
buffer_load_dword v29, off, s[32:35], s6 offset:384 sc1
s_add_u32 s97, s97, 1
s_waitcnt vmcnt(0)
v_cmp_gt_u32 vcc, 4, v29
s_cmp_gt_u32 s97, 0x40000
s_cbranch_scc1 L_pr81
s_nop 1
s_cbranch_vccz L_pr81
s_sleep 2
s_branch L_pl80
L_codeend:
s_endpgm
.section .rodata,"a"
.p2align 6
.amdhsa_kernel recurrent_scan__sliding_block__mixer_s_mlp__prompt_kernel
  .amdhsa_next_free_vgpr 512
  .amdhsa_next_free_sgpr 102
  .amdhsa_accum_offset 256
  .amdhsa_group_segment_fixed_size 0
  .amdhsa_kernarg_size 88
  .amdhsa_user_sgpr_count 2
  .amdhsa_user_sgpr_kernarg_segment_ptr 1
  .amdhsa_system_sgpr_workgroup_id_x 1
.end_amdhsa_kernel
```
